```python
import torch

def _softmax(x, axis=-1):
    return torch.softmax(x, dim=axis)

def _gelu(x):
    return torch.nn.functional.gelu(x, approximate='tanh')

def _silu(x):
    return torch.nn.functional.silu(x)

def _sigmoid(x):
    return torch.sigmoid(x)

def _layernorm(x, axis=-1, eps=1e-05):
    m = x.mean(dim=axis, keepdim=True)
    v = x.var(dim=axis, keepdim=True, unbiased=False)
    return (x - m) / torch.sqrt(v + eps)

def _scatter_add(tgt, idx, src, axis=0):
    return tgt.clone().index_add_(axis, idx, src)

def _segment_sum(src, seg, n):
    out = torch.zeros((n,) + src.shape[1:], dtype=src.dtype)
    return out.index_add_(0, seg, src)

def _pad(x, pw):
    flat = tuple((v for pair in reversed(pw) for v in pair))
    return torch.nn.functional.pad(x, flat)
kernel_name = 'sequential_preLN__mha_block__mixer_gmlp__prompt'

def setup_inputs():

    _w = lambda a: (lambda t: t.to(torch.bfloat16) if t.is_floating_point() else t)(torch.as_tensor(a))

    def _A_setup():
        B, S, D, H = (1, 2048, 1024, 32)
        return {'x': _w((lambda *s: torch.randn(*s, dtype=torch.bfloat16) * 0.05)(B, S, D)), 'wqkv': _w((lambda *s: torch.randn(*s, dtype=torch.bfloat16) * 0.05)(D, 3 * D)), 'wo': _w((lambda *s: torch.randn(*s, dtype=torch.bfloat16) * 0.05)(D, D))}
    _A_in = _A_setup()

    def _B_setup():
        B, S, D, F = (1, 2048, 1024, 3584)
        Fh = F // 2
        return {'x': _w((lambda *s: torch.randn(*s, dtype=torch.bfloat16) * 0.05)(B, S, D)), 'w_in': _w((lambda *s: torch.randn(*s, dtype=torch.bfloat16) * 1.6)(D, 2 * Fh)), 'w_sp': _w(0.01 * (lambda *s: torch.randn(*s, dtype=torch.bfloat16) * 1.6)(S, S)), 'b_sp': _w(1.0 + 0.01 * (lambda *s: torch.randn(*s, dtype=torch.bfloat16) * 0.05)(S)), 'w_out': _w((lambda *s: torch.randn(*s, dtype=torch.bfloat16) * 0.05)(Fh, D))}
    _B_in = _B_setup()
    return {'A_x': _A_in['x'], 'A_wqkv': _A_in['wqkv'], 'A_wo': _A_in['wo'], 'B_x': _B_in['x'], 'B_w_in': _B_in['w_in'], 'B_w_sp': _B_in['w_sp'], 'B_b_sp': _B_in['b_sp'], 'B_w_out': _B_in['w_out']}

def reference(A_x, A_wqkv, A_wo, B_x, B_w_in, B_w_sp, B_b_sp, B_w_out):

    def _A_ref(x, wqkv, wo):
        B, S, D = x.shape
        H = 32
        Dh = D // H
        qkv = (lambda x, *d: x.permute(*d))((x @ wqkv).reshape(B, S, 3, H, Dh), 2, 0, 3, 1, 4)
        q, k, v = (qkv[0], qkv[1], qkv[2])
        scores = torch.einsum('bhqd,bhkd->bhqk', q, k) * Dh ** (-0.5)
        p = _softmax(scores, axis=-1)
        o = torch.einsum('bhqk,bhkd->bhqd', p, v)
        return (lambda x, *d: x.permute(*d))(o, 0, 2, 1, 3).reshape(B, S, D) @ wo

    def _B_ref(x, w_in, w_sp, b_sp, w_out):
        B, S, D = x.shape
        F = w_in.shape[-1]
        Fh = F // 2
        z = _gelu(torch.einsum('bsd,df->bsf', x, w_in))
        z1 = z[..., :Fh].clone()
        z2 = _layernorm(z[..., Fh:], axis=-1)
        g = torch.einsum('ts,bsf->btf', w_sp, z2) + b_sp[None, :, None]
        return torch.einsum('bsf,fd->bsd', z1 * g, w_out)
    x = A_x
    h = x + _A_ref(_layernorm(x, axis=-1), A_wqkv, A_wo)
    h2 = h + _B_ref(_layernorm(h, axis=-1), B_w_in, B_w_sp, B_b_sp, B_w_out)
    return h2
```

```asm
; @launch grid=(256,1,1) block=(256,1,1) lds=163840
.amdgcn_target "amdgcn-amd-amdhsa--gfx950"
.text
.globl sequential_preLN__mha_block__mixer_gmlp__prompt_kernel
.p2align 12
.p2align 8
.type sequential_preLN__mha_block__mixer_gmlp__prompt_kernel,@function
sequential_preLN__mha_block__mixer_gmlp__prompt_kernel:
s_cmp_ge_u32 s2, 256
s_cbranch_scc1 END
s_load_dwordx2 s[4:5], s[0:1], 0
s_load_dwordx2 s[8:9], s[0:1], 8
s_load_dwordx2 s[36:37], s[0:1], 80
s_load_dwordx2 s[12:13], s[0:1], 16
s_load_dwordx2 s[16:17], s[0:1], 32
s_load_dwordx2 s[20:21], s[0:1], 40
s_load_dwordx2 s[24:25], s[0:1], 48
s_load_dwordx2 s[28:29], s[0:1], 56
s_load_dwordx2 s[32:33], s[0:1], 64
v_lshrrev_b32 v1, 6, v0
v_and_b32 v0, 63, v0
v_readfirstlane_b32 s40, v1
v_lshlrev_b32 v1, 4, v0
s_and_b32 s42, s2, 1
s_lshl_b32 s42, s42, 3
s_bfe_u32 s3, s2, 0x30003
s_or_b32 s42, s42, s3
s_bfe_u32 s43, s2, 0x20001
s_lshl_b32 s43, s43, 2
s_lshr_b32 s3, s2, 6
s_or_b32 s43, s43, s3
s_lshl_b32 s46, s42, 2
s_add_u32 s46, s46, s40
s_mul_i32 s48, s40, 40960
s_and_b32 s44, s2, 3
s_lshl_b32 s44, s44, 2
s_bfe_u32 s3, s2, 0x20003
s_or_b32 s44, s44, s3
s_bfe_u32 s45, s2, 0x10002
s_lshl_b32 s45, s45, 3
s_lshr_b32 s3, s2, 5
s_or_b32 s45, s45, s3
s_lshl_b32 s47, s44, 2
s_add_u32 s47, s47, s40
s_mov_b32 s49, 0
s_mov_b32 s6, 4194304
s_mov_b32 s7, 0x20000
s_mov_b32 s10, 6291456
s_mov_b32 s11, 0x20000
s_mov_b32 s38, 268435456
s_mov_b32 s39, 0x20000
s_mov_b32 s14, 2097152
s_mov_b32 s15, 0x20000
s_mov_b32 s18, 7340032
s_mov_b32 s19, 0x20000
s_mov_b32 s22, 8388608
s_mov_b32 s23, 0x20000
s_mov_b32 s26, 4096
s_mov_b32 s27, 0x20000
s_mov_b32 s30, 3670016
s_mov_b32 s31, 0x20000
s_mov_b32 s34, 4194304
s_mov_b32 s35, 0x20000
s_lshl_b32 s68, s46, 16
s_lshl_b32 s69, s43, 7
s_lshl_b32 s51, s42, 4
s_add_u32 s51, s51, s43
s_lshl_b32 s51, s51, 2
s_add_u32 s51, s51, s40
s_lshl_b32 s71, s51, 12
v_lshrrev_b32 v3, 5, v0
v_and_b32 v4, 31, v0
v_lshlrev_b32 v25, 4, v4
v_lshl_add_u32 v5, v3, 11, v25
s_lshr_b32 s3, s42, 3
s_lshl_b32 s50, s42, 1
s_add_u32 s50, s50, s3
s_and_b32 s3, s43, 12
s_add_u32 s50, s50, s3
s_and_b32 s50, s50, 15
s_lshl_b32 s50, s50, 7
s_waitcnt lgkmcnt(0)
s_load_dword s41, s[36:37], 0
buffer_load_dwordx4 v[64:67], v5, s[4:7], s71 offen offset:0
buffer_load_dwordx4 v[68:71], v5, s[4:7], s71 offen offset:512
buffer_load_dwordx4 v[72:75], v5, s[4:7], s71 offen offset:1024
buffer_load_dwordx4 v[76:79], v5, s[4:7], s71 offen offset:1536
v_lshrrev_b32 v3, 3, v0
v_and_b32 v4, 7, v0
v_xor_b32 v4, v4, v3
v_lshlrev_b32 v6, 4, v4
v_and_b32 v4, 3, v3
v_lshrrev_b32 v3, 2, v3
v_lshl_add_u32 v4, v3, 3, v4
v_lshl_add_u32 v6, v4, 11, v6
v_add_u32 v6, s68, v6
v_add_u32 v7, 31744, v6
v_add_u32 v8, 6144, v6
v_add_u32 v9, 37888, v6
v_lshrrev_b32 v3, 3, v0
s_lshl_b32 s3, s40, 4
v_add_u32 v4, s3, v3
v_mul_u32_u24 v14, 6144, v4
v_add_u32 v14, s69, v14
v_bfe_u32 v3, v0, 4, 1
v_bfe_u32 v4, v0, 1, 2
v_xor_b32 v3, v3, v4
v_lshlrev_b32 v3, 5, v3
v_and_b32 v4, 1, v0
v_lshl_add_u32 v3, v4, 4, v3
v_xor_b32 v4, 64, v3
v_add_u32 v4, 48128, v4
v_add_u32 v15, v14, v4
v_add_u32 v14, v14, v3
v_add_u32 v12, 2048, v14
v_add_u32 v13, 2048, v15
s_mul_i32 s52, s50, 3072
s_add_u32 m0, s48, 0
s_nop 0
buffer_load_dwordx4 v6, s[4:7], s50 offen offset:0 lds
buffer_load_dwordx4 v7, s[4:7], s50 offen offset:1024 lds
buffer_load_dwordx4 v8, s[4:7], s50 offen offset:2048 lds
buffer_load_dwordx4 v9, s[4:7], s50 offen offset:3072 lds
s_add_u32 m0, s48, 16384
s_nop 0
buffer_load_dwordx4 v12, s[8:11], s52 offen offset:0 lds
buffer_load_dwordx4 v13, s[8:11], s52 offen offset:1024 lds
buffer_load_dwordx4 v12, s[8:11], s52 offen offset:2048 lds
buffer_load_dwordx4 v13, s[8:11], s52 offen offset:3072 lds
s_add_u32 m0, s48, 36864
s_nop 0
buffer_load_dwordx4 v14, s[8:11], s52 offen offset:0 lds
buffer_load_dwordx4 v15, s[8:11], s52 offen offset:1024 lds
s_mov_b64 exec, 0
s_bitcmp1_b32 s40, 0
s_cbranch_scc1 TT0_0_0
s_bitcmp1_b32 s40, 1
s_cbranch_scc1 TT0_1_0
s_bitcmp1_b32 s2, 3
s_cbranch_scc1 TT0_2_0
s_bitcmp1_b32 s2, 4
s_cbranch_scc1 TT0_3_0
s_bitcmp1_b32 s2, 5
s_cbranch_scc1 TT0_4_0
s_bitcmp1_b32 s2, 6
s_cbranch_scc1 TP37
s_branch TP66
TT0_4_0:
s_bitcmp1_b32 s2, 6
s_cbranch_scc1 TP2
s_branch TP17
TT0_3_0:
s_bitcmp1_b32 s2, 5
s_cbranch_scc1 TT0_4_8
s_bitcmp1_b32 s2, 6
s_cbranch_scc1 TP51
s_branch TP7
TT0_4_8:
s_bitcmp1_b32 s2, 6
s_cbranch_scc1 TP2
s_branch TP27
TT0_2_0:
s_bitcmp1_b32 s2, 4
s_cbranch_scc1 TT0_3_4
s_bitcmp1_b32 s2, 5
s_cbranch_scc1 TT0_4_4
s_bitcmp1_b32 s2, 6
s_cbranch_scc1 TP43
s_branch TP0
TT0_4_4:
s_bitcmp1_b32 s2, 6
s_cbranch_scc1 TP2
s_branch TP22
TT0_3_4:
s_bitcmp1_b32 s2, 5
s_cbranch_scc1 TT0_4_12
s_bitcmp1_b32 s2, 6
s_cbranch_scc1 TP59
s_branch TP12
TT0_4_12:
s_bitcmp1_b32 s2, 6
s_cbranch_scc1 TP2
s_branch TP32
TT0_1_0:
s_bitcmp1_b32 s2, 3
s_cbranch_scc1 TT0_2_2
s_bitcmp1_b32 s2, 4
s_cbranch_scc1 TT0_3_2
s_bitcmp1_b32 s2, 5
s_cbranch_scc1 TT0_4_2
s_bitcmp1_b32 s2, 6
s_cbranch_scc1 TP39
s_branch TP64
TT0_4_2:
s_bitcmp1_b32 s2, 6
s_cbranch_scc1 TP6
s_branch TP19
TT0_3_2:
s_bitcmp1_b32 s2, 5
s_cbranch_scc1 TT0_4_10
s_bitcmp1_b32 s2, 6
s_cbranch_scc1 TP55
s_branch TP9
TT0_4_10:
s_bitcmp1_b32 s2, 6
s_cbranch_scc1 TP6
s_branch TP29
TT0_2_2:
s_bitcmp1_b32 s2, 4
s_cbranch_scc1 TT0_3_6
s_bitcmp1_b32 s2, 5
s_cbranch_scc1 TT0_4_6
s_bitcmp1_b32 s2, 6
s_cbranch_scc1 TP47
s_branch TP3
TT0_4_6:
s_bitcmp1_b32 s2, 6
s_cbranch_scc1 TP6
s_branch TP24
TT0_3_6:
s_bitcmp1_b32 s2, 5
s_cbranch_scc1 TT0_4_14
s_bitcmp1_b32 s2, 6
s_cbranch_scc1 TP6
s_branch TP14
TT0_4_14:
s_bitcmp1_b32 s2, 6
s_cbranch_scc1 TP6
s_branch TP34
TT0_0_0:
s_bitcmp1_b32 s40, 1
s_cbranch_scc1 TT0_1_1
s_bitcmp1_b32 s2, 3
s_cbranch_scc1 TT0_2_1
s_bitcmp1_b32 s2, 4
s_cbranch_scc1 TT0_3_1
s_bitcmp1_b32 s2, 5
s_cbranch_scc1 TT0_4_1
s_bitcmp1_b32 s2, 6
s_cbranch_scc1 TP38
s_branch TP65
TT0_4_1:
s_bitcmp1_b32 s2, 6
s_cbranch_scc1 TP4
s_branch TP18
TT0_3_1:
s_bitcmp1_b32 s2, 5
s_cbranch_scc1 TT0_4_9
s_bitcmp1_b32 s2, 6
s_cbranch_scc1 TP53
s_branch TP8
TT0_4_9:
s_bitcmp1_b32 s2, 6
s_cbranch_scc1 TP4
s_branch TP28
TT0_2_1:
s_bitcmp1_b32 s2, 4
s_cbranch_scc1 TT0_3_5
s_bitcmp1_b32 s2, 5
s_cbranch_scc1 TT0_4_5
s_bitcmp1_b32 s2, 6
s_cbranch_scc1 TP45
s_branch TP1
TT0_4_5:
s_bitcmp1_b32 s2, 6
s_cbranch_scc1 TP4
s_branch TP23
TT0_3_5:
s_bitcmp1_b32 s2, 5
s_cbranch_scc1 TT0_4_13
s_bitcmp1_b32 s2, 6
s_cbranch_scc1 TP61
s_branch TP13
TT0_4_13:
s_bitcmp1_b32 s2, 6
s_cbranch_scc1 TP4
s_branch TP33
TT0_1_1:
s_bitcmp1_b32 s2, 3
s_cbranch_scc1 TT0_2_3
s_bitcmp1_b32 s2, 4
s_cbranch_scc1 TT0_3_3
s_bitcmp1_b32 s2, 5
s_cbranch_scc1 TT0_4_3
s_bitcmp1_b32 s2, 6
s_cbranch_scc1 TP41
s_branch TP63
TT0_4_3:
s_bitcmp1_b32 s2, 6
s_cbranch_scc1 TP10
s_branch TP21
TT0_3_3:
s_bitcmp1_b32 s2, 5
s_cbranch_scc1 TT0_4_11
s_bitcmp1_b32 s2, 6
s_cbranch_scc1 TP57
s_branch TP11
TT0_4_11:
s_bitcmp1_b32 s2, 6
s_cbranch_scc1 TP10
s_branch TP31
TT0_2_3:
s_bitcmp1_b32 s2, 4
s_cbranch_scc1 TT0_3_7
s_bitcmp1_b32 s2, 5
s_cbranch_scc1 TT0_4_7
s_bitcmp1_b32 s2, 6
s_cbranch_scc1 TP49
s_branch TP5
TT0_4_7:
s_bitcmp1_b32 s2, 6
s_cbranch_scc1 TP10
s_branch TP26
TT0_3_7:
s_bitcmp1_b32 s2, 5
s_cbranch_scc1 TT0_4_15
s_bitcmp1_b32 s2, 6
s_cbranch_scc1 TP10
s_branch TP16
TT0_4_15:
s_bitcmp1_b32 s2, 6
s_cbranch_scc1 TP10
s_branch TP36
.p2align 12
TR0:
s_mov_b64 exec, -1
TP0:
s_cbranch_execz TP2
s_add_u32 s3, s50, 128
s_and_b32 s3, s3, 0x7ff
s_mul_i32 s53, s3, 3072
s_add_u32 s3, s50, 256
s_and_b32 s3, s3, 0x7ff
s_mul_i32 s54, s3, 3072
s_add_u32 s3, s50, 384
s_and_b32 s3, s3, 0x7ff
s_mul_i32 s55, s3, 3072
s_add_u32 s3, s50, 512
s_and_b32 s3, s3, 0x7ff
s_mul_i32 s56, s3, 3072
s_add_u32 s3, s50, 640
s_and_b32 s3, s3, 0x7ff
s_mul_i32 s57, s3, 3072
s_add_u32 s3, s50, 768
s_and_b32 s3, s3, 0x7ff
s_mul_i32 s58, s3, 3072
s_add_u32 s3, s50, 896
s_and_b32 s3, s3, 0x7ff
s_mul_i32 s59, s3, 3072
s_add_u32 s3, s50, 1024
s_and_b32 s3, s3, 0x7ff
s_mul_i32 s60, s3, 3072
s_add_u32 s3, s50, 1152
s_and_b32 s3, s3, 0x7ff
s_mul_i32 s61, s3, 3072
s_add_u32 s3, s50, 1280
s_and_b32 s3, s3, 0x7ff
s_mul_i32 s62, s3, 3072
s_add_u32 s3, s50, 1408
s_and_b32 s3, s3, 0x7ff
s_mul_i32 s63, s3, 3072
s_add_u32 s3, s50, 1536
s_and_b32 s3, s3, 0x7ff
s_mul_i32 s64, s3, 3072
s_add_u32 s3, s50, 1664
s_and_b32 s3, s3, 0x7ff
s_mul_i32 s65, s3, 3072
s_add_u32 s3, s50, 1792
s_and_b32 s3, s3, 0x7ff
s_mul_i32 s66, s3, 3072
s_add_u32 s3, s50, 1920
s_and_b32 s3, s3, 0x7ff
s_mul_i32 s67, s3, 3072
v_and_b32 v3, 7, v0
v_lshrrev_b32 v4, 4, v0
v_xor_b32 v3, v3, v4
v_lshlrev_b32 v10, 4, v3
v_and_b32 v3, 15, v0
v_lshl_add_u32 v10, v3, 7, v10
v_add_u32 v10, s48, v10
v_xor_b32 v11, 64, v10
v_lshlrev_b32 v28, 4, v4
v_lshlrev_b32 v29, 2, v3
s_mul_i32 s3, s40, 192
v_add_u32 v26, s3, v29
s_add_u32 s3, s48, 39936
v_lshl_add_u32 v31, v4, 5, s3
v_lshrrev_b32 v27, 2, v25
v_add_u32 v27, s3, v27
v_bfe_u32 v3, v0, 2, 2
v_and_b32 v4, 3, v0
v_lshl_add_u32 v3, v3, 3, v4
v_lshl_add_u32 v30, v3, 2, s3
v_lshrrev_b32 v3, 5, v0
v_mul_u32_u24 v5, 40960, v3
v_bfe_u32 v3, v0, 4, 1
v_lshl_add_u32 v5, v3, 10, v5
v_bfe_u32 v4, v0, 2, 2
v_lshl_add_u32 v5, v4, 7, v5
v_and_b32 v4, 3, v0
v_lshl_add_u32 v5, v4, 3, v5
v_bfe_u32 v4, v0, 3, 2
v_lshl_add_u32 v16, v4, 5, v5
v_xor_b32 v17, 32, v16
v_xor_b32 v18, 64, v16
v_xor_b32 v19, 96, v16
v_add_u32 v20, 81920, v16
v_add_u32 v21, 81920, v17
v_add_u32 v22, 81920, v18
v_add_u32 v23, 81920, v19
v_lshrrev_b32 v3, 5, v0
v_lshlrev_b32 v5, 8, v3
v_bfe_u32 v3, v0, 2, 1
v_lshl_add_u32 v240, v3, 10, v5
v_lshl_add_u32 v241, v3, 7, v5
v_bfe_u32 v3, v0, 3, 1
v_lshl_add_u32 v240, v3, 6, v240
v_bfe_u32 v3, v0, 4, 1
v_lshl_add_u32 v240, v3, 7, v240
v_and_b32 v3, 3, v0
v_lshl_add_u32 v240, v3, 4, v240
v_lshl_add_u32 v241, v3, 4, v241
v_bfe_u32 v3, v0, 3, 1
v_lshl_add_u32 v241, v3, 6, v241
v_bfe_u32 v3, v0, 4, 1
v_lshl_add_u32 v241, v3, 10, v241
v_lshl_add_u32 v244, v3, 10, v5
v_and_b32 v3, 15, v0
v_lshl_add_u32 v244, v3, 4, v244
v_min_u32 v3, 13, v3
v_lshlrev_b32 v249, 4, v3
v_lshrrev_b32 v3, 4, v0
v_mul_u32_u24 v4, 7168, v3
v_add_u32 v249, v249, v4
v_lshlrev_b32 v253, 4, v3
v_bfe_u32 v3, v0, 2, 2
v_lshl_add_u32 v253, v3, 15, v253
v_and_b32 v3, 3, v0
v_lshl_add_u32 v253, v3, 12, v253
v_lshl_add_u32 v3, v3, 3, s48
v_lshrrev_b32 v4, 2, v0
v_lshl_add_u32 v250, v4, 8, v3
v_lshl_add_u32 v252, v4, 7, v3
v_lshrrev_b32 v3, 3, v0
v_and_b32 v4, 7, v0
v_lshlrev_b32 v4, 4, v4
v_lshl_add_u32 v251, v3, 11, v4
s_and_b32 s3, s40, 1
s_lshl_b32 s3, s3, 11
s_lshr_b32 s68, s40, 1
s_mul_i32 s68, s68, 81920
s_add_u32 s69, s68, s3
v_add_u32 v243, s69, v244
s_sub_u32 s69, s3, s68
s_add_u32 s69, s69, 81920
v_add_u32 v242, s69, v244
v_mov_b32 v4, 0x80000000
v_cmp_gt_u32 vcc, 16, v0
v_lshlrev_b32 v3, 8, v0
s_nop 0
v_cndmask_b32 v245, v4, v3, vcc
v_cmp_gt_u32 vcc, 32, v0
v_lshlrev_b32 v3, 2, v0
s_nop 0
v_cndmask_b32 v246, v4, v3, vcc
s_lshl_b32 s68, s45, 7
v_lshrrev_b32 v3, 3, v0
s_lshl_b32 s3, s40, 4
v_add_u32 v4, s3, v3
v_mul_u32_u24 v247, 2048, v4
v_add_u32 v247, s68, v247
v_bfe_u32 v3, v0, 4, 1
v_bfe_u32 v4, v0, 1, 2
v_xor_b32 v3, v3, v4
v_lshlrev_b32 v3, 5, v3
v_and_b32 v4, 1, v0
v_lshl_add_u32 v3, v4, 4, v3
v_xor_b32 v4, 64, v3
v_add_u32 v4, 15360, v4
v_add_u32 v248, v247, v4
v_add_u32 v247, v247, v3
v_mov_b32 v88, 0x3f803f80
s_waitcnt vmcnt(13)
v_dot2_f32_bf16 v80, v64, v88, 0
v_dot2_f32_bf16 v84, v64, v64, 0
v_dot2_f32_bf16 v81, v65, v88, 0
v_dot2_f32_bf16 v85, v65, v65, 0
v_dot2_f32_bf16 v82, v66, v88, 0
v_dot2_f32_bf16 v86, v66, v66, 0
v_dot2_f32_bf16 v83, v67, v88, 0
v_dot2_f32_bf16 v87, v67, v67, 0
s_waitcnt vmcnt(12)
v_dot2_f32_bf16 v80, v68, v88, v80
v_dot2_f32_bf16 v84, v68, v68, v84
v_dot2_f32_bf16 v81, v69, v88, v81
v_dot2_f32_bf16 v85, v69, v69, v85
v_dot2_f32_bf16 v82, v70, v88, v82
v_dot2_f32_bf16 v86, v70, v70, v86
v_dot2_f32_bf16 v83, v71, v88, v83
v_dot2_f32_bf16 v87, v71, v71, v87
s_waitcnt vmcnt(11)
v_dot2_f32_bf16 v80, v72, v88, v80
v_dot2_f32_bf16 v84, v72, v72, v84
v_dot2_f32_bf16 v81, v73, v88, v81
v_dot2_f32_bf16 v85, v73, v73, v85
v_dot2_f32_bf16 v82, v74, v88, v82
v_dot2_f32_bf16 v86, v74, v74, v86
v_dot2_f32_bf16 v83, v75, v88, v83
v_dot2_f32_bf16 v87, v75, v75, v87
s_waitcnt vmcnt(10)
v_dot2_f32_bf16 v80, v76, v88, v80
v_dot2_f32_bf16 v84, v76, v76, v84
v_dot2_f32_bf16 v81, v77, v88, v81
v_dot2_f32_bf16 v85, v77, v77, v85
v_dot2_f32_bf16 v82, v78, v88, v82
v_dot2_f32_bf16 v86, v78, v78, v86
v_dot2_f32_bf16 v83, v79, v88, v83
v_dot2_f32_bf16 v87, v79, v79, v87
s_waitcnt lgkmcnt(0)
s_add_u32 s41, s41, 0x9e3779b9
s_lshl_b32 s51, s51, 5
v_mov_b32 v2, s41
v_add_f32 v80, v80, v81
v_add_f32 v82, v82, v83
v_add_f32 v84, v84, v85
v_add_f32 v86, v86, v87
v_add_f32 v80, v80, v82
v_add_f32 v81, v84, v86
s_add_u32 s51, s51, 786432
v_add_f32_dpp v80, v80, v80 row_ror:8 row_mask:0xf bank_mask:0xf
v_add_f32_dpp v81, v81, v81 row_ror:8 row_mask:0xf bank_mask:0xf
s_nop 0
v_add_f32_dpp v80, v80, v80 row_ror:4 row_mask:0xf bank_mask:0xf
v_add_f32_dpp v81, v81, v81 row_ror:4 row_mask:0xf bank_mask:0xf
s_nop 0
v_add_f32_dpp v80, v80, v80 row_ror:2 row_mask:0xf bank_mask:0xf
v_add_f32_dpp v81, v81, v81 row_ror:2 row_mask:0xf bank_mask:0xf
s_nop 0
v_add_f32_dpp v80, v80, v80 row_ror:1 row_mask:0xf bank_mask:0xf
v_add_f32_dpp v81, v81, v81 row_ror:1 row_mask:0xf bank_mask:0xf
v_mov_b32 v82, v80
v_mov_b32 v83, v81
s_nop 0
v_permlane16_swap_b32 v82, v80
v_permlane16_swap_b32 v83, v81
v_add_f32 v80, v82, v80
v_add_f32 v81, v83, v81
v_mul_f32 v80, 0xba800000, v80
v_mul_f32 v81, 0x3a800000, v81
v_fma_f32 v81, -v80, v80, v81
v_max_f32 v81, 0, v81
v_add_f32 v81, 0x3727c5ac, v81
v_rsq_f32 v81, v81
v_mov_b32 v82, v2
v_mov_b32 v83, v2
v_lshrrev_b32 v3, 1, v0
v_and_b32 v4, 31, v0
v_cmp_eq_u32 vcc, 0, v4
v_mov_b32 v4, 0x80000000
s_nop 0
v_cndmask_b32 v3, v4, v3, vcc
buffer_store_dwordx4 v[80:83], v3, s[36:39], s51 offen sc1
s_add_u32 m0, s48, 4096
s_add_u32 s70, s50, 128
s_and_b32 s70, s70, 0x7ff
buffer_load_dwordx4 v6, s[4:7], s70 offen offset:0 lds
buffer_load_dwordx4 v7, s[4:7], s70 offen offset:1024 lds
buffer_load_dwordx4 v8, s[4:7], s70 offen offset:2048 lds
buffer_load_dwordx4 v9, s[4:7], s70 offen offset:3072 lds
s_add_u32 m0, s48, 20480
s_nop 0
buffer_load_dwordx4 v12, s[8:11], s53 offen offset:0 lds
buffer_load_dwordx4 v13, s[8:11], s53 offen offset:1024 lds
buffer_load_dwordx4 v12, s[8:11], s53 offen offset:2048 lds
buffer_load_dwordx4 v13, s[8:11], s53 offen offset:3072 lds
v_and_b32 v3, 3, v0
s_mul_i32 s3, s40, 3
s_add_u32 s3, s3, 0
s_and_b32 s68, s3, 3
s_lshl_b32 s68, s68, 5
s_lshr_b32 s3, s3, 2
s_lshl_b32 s69, s3, 11
s_add_u32 s69, s69, 14336
s_cmp_eq_u32 s3, 0
s_cselect_b32 s69, 36864, s69
v_xor_b32 v164, s68, v16
v_add_u32 v164, s69, v164
v_add_u32 v165, 81920, v164
v_cmp_eq_u32 vcc, 0, v3
s_nop 1
v_cndmask_b32 v96, 0, v88, vcc
v_mov_b32 v97, v96
v_mov_b32 v98, v96
v_mov_b32 v99, v96
s_mul_i32 s3, s40, 3
s_add_u32 s3, s3, 1
s_and_b32 s68, s3, 3
s_lshl_b32 s68, s68, 5
s_lshr_b32 s3, s3, 2
s_lshl_b32 s69, s3, 11
s_add_u32 s69, s69, 14336
s_cmp_eq_u32 s3, 0
s_cselect_b32 s69, 36864, s69
v_xor_b32 v166, s68, v16
v_add_u32 v166, s69, v166
v_add_u32 v167, 81920, v166
v_cmp_eq_u32 vcc, 1, v3
s_nop 1
v_cndmask_b32 v100, 0, v88, vcc
v_mov_b32 v101, v100
v_mov_b32 v102, v100
v_mov_b32 v103, v100
s_mul_i32 s3, s40, 3
s_add_u32 s3, s3, 2
s_and_b32 s68, s3, 3
s_lshl_b32 s68, s68, 5
s_lshr_b32 s3, s3, 2
s_lshl_b32 s69, s3, 11
s_add_u32 s69, s69, 14336
s_cmp_eq_u32 s3, 0
s_cselect_b32 s69, 36864, s69
v_xor_b32 v168, s68, v16
v_add_u32 v168, s69, v168
v_add_u32 v169, 81920, v168
v_cmp_eq_u32 vcc, 2, v3
s_nop 1
v_cndmask_b32 v104, 0, v88, vcc
v_mov_b32 v105, v104
v_mov_b32 v106, v104
v_mov_b32 v107, v104
s_lshl_b32 s68, s43, 2
s_add_u32 s68, s68, s40
s_lshl_b32 s68, s68, 12
s_add_u32 s68, s68, 1048576
s_lshl_b32 s69, s42, 8
s_add_u32 s69, s69, s68
v_cmp_gt_u32 vcc, 16, v0
s_nop 1
v_cndmask_b32 v24, v4, v1, vcc
s_lshl_b32 s51, s46, 9
s_add_u32 s51, s51, 786432
s_waitcnt vmcnt(15)
ds_read_b128 a[0:3], v10 offset:0
ds_read_b128 a[4:7], v10 offset:2048
ds_read_b128 a[8:11], v11 offset:0
ds_read_b128 a[12:15], v11 offset:2048
s_waitcnt vmcnt(9)
s_barrier
ds_read_b64_tr_b16 v[112:113], v164 offset:0
ds_read_b64_tr_b16 v[114:115], v164 offset:512
ds_read_b64_tr_b16 v[116:117], v165 offset:0
ds_read_b64_tr_b16 v[118:119], v165 offset:512
ds_read_b64_tr_b16 v[120:121], v166 offset:0
ds_read_b64_tr_b16 v[122:123], v166 offset:512
ds_read_b64_tr_b16 v[124:125], v167 offset:0
ds_read_b64_tr_b16 v[126:127], v167 offset:512
ds_read_b64_tr_b16 v[128:129], v168 offset:0
ds_read_b64_tr_b16 v[130:131], v168 offset:512
ds_read_b64_tr_b16 v[132:133], v169 offset:0
ds_read_b64_tr_b16 v[134:135], v169 offset:512
s_waitcnt lgkmcnt(10)
v_mfma_f32_16x16x32_bf16 v[160:163], v[96:99], v[112:115], 0
s_waitcnt lgkmcnt(8)
v_mfma_f32_16x16x32_bf16 v[160:163], v[96:99], v[116:119], v[160:163]
s_waitcnt lgkmcnt(6)
v_mfma_f32_16x16x32_bf16 v[160:163], v[100:103], v[120:123], v[160:163]
s_waitcnt lgkmcnt(4)
v_mfma_f32_16x16x32_bf16 v[160:163], v[100:103], v[124:127], v[160:163]
s_waitcnt lgkmcnt(2)
v_mfma_f32_16x16x32_bf16 v[160:163], v[104:107], v[128:131], v[160:163]
s_waitcnt lgkmcnt(0)
v_mfma_f32_16x16x32_bf16 v[160:163], v[104:107], v[132:135], v[160:163]
ds_read_b64_tr_b16 v[32:33], v16 offset:16384
ds_read_b64_tr_b16 v[34:35], v16 offset:16896
ds_read_b64_tr_b16 v[36:37], v20 offset:16384
ds_read_b64_tr_b16 v[38:39], v20 offset:16896
ds_read_b64_tr_b16 v[40:41], v17 offset:16384
ds_read_b64_tr_b16 v[42:43], v17 offset:16896
ds_read_b64_tr_b16 v[44:45], v21 offset:16384
ds_read_b64_tr_b16 v[46:47], v21 offset:16896
ds_read_b64_tr_b16 v[48:49], v18 offset:16384
ds_read_b64_tr_b16 v[50:51], v18 offset:16896
ds_read_b64_tr_b16 v[52:53], v22 offset:16384
ds_read_b64_tr_b16 v[54:55], v22 offset:16896
s_add_u32 s50, s50, 128
v_mov_b32 v163, v2
buffer_store_dwordx4 v[160:163], v24, s[36:39], s69 offen sc1
s_add_u32 s50, s50, 128
s_and_b32 s50, s50, 0x7ff
s_add_u32 m0, s48, 8192
s_waitcnt lgkmcnt(10)
v_mfma_f32_16x16x32_bf16 v[64:67], v[32:35], a[0:3], 0
ds_read_b64_tr_b16 v[56:57], v19 offset:16384
buffer_load_dwordx4 v6, s[4:7], s50 offen offset:0 lds
s_waitcnt lgkmcnt(9)
v_mfma_f32_16x16x32_bf16 v[64:67], v[36:39], a[8:11], v[64:67]
ds_read_b64_tr_b16 v[58:59], v19 offset:16896
v_mfma_f32_16x16x32_bf16 v[68:71], v[32:35], a[4:7], 0
ds_read_b64_tr_b16 v[60:61], v23 offset:16384
buffer_load_dwordx4 v7, s[4:7], s50 offen offset:1024 lds
v_mfma_f32_16x16x32_bf16 v[68:71], v[36:39], a[12:15], v[68:71]
ds_read_b64_tr_b16 v[62:63], v23 offset:16896
s_waitcnt lgkmcnt(8)
v_mfma_f32_16x16x32_bf16 v[72:75], v[40:43], a[0:3], 0
ds_read_b64_tr_b16 v[32:33], v16 offset:18432
buffer_load_dwordx4 v8, s[4:7], s50 offen offset:2048 lds
v_mfma_f32_16x16x32_bf16 v[72:75], v[44:47], a[8:11], v[72:75]
ds_read_b64_tr_b16 v[34:35], v16 offset:18944
v_mfma_f32_16x16x32_bf16 v[76:79], v[40:43], a[4:7], 0
ds_read_b64_tr_b16 v[36:37], v20 offset:18432
buffer_load_dwordx4 v9, s[4:7], s50 offen offset:3072 lds
v_mfma_f32_16x16x32_bf16 v[76:79], v[44:47], a[12:15], v[76:79]
ds_read_b64_tr_b16 v[38:39], v20 offset:18944
s_add_u32 m0, s48, 24576
s_waitcnt lgkmcnt(8)
v_mfma_f32_16x16x32_bf16 v[80:83], v[48:51], a[0:3], 0
ds_read_b64_tr_b16 v[40:41], v17 offset:18432
buffer_load_dwordx4 v12, s[8:11], s54 offen offset:0 lds
v_mfma_f32_16x16x32_bf16 v[80:83], v[52:55], a[8:11], v[80:83]
ds_read_b64_tr_b16 v[42:43], v17 offset:18944
v_mfma_f32_16x16x32_bf16 v[84:87], v[48:51], a[4:7], 0
ds_read_b64_tr_b16 v[44:45], v21 offset:18432
buffer_load_dwordx4 v13, s[8:11], s54 offen offset:1024 lds
v_mfma_f32_16x16x32_bf16 v[84:87], v[52:55], a[12:15], v[84:87]
ds_read_b64_tr_b16 v[46:47], v21 offset:18944
s_add_u32 s50, s50, 128
s_waitcnt lgkmcnt(8)
v_mfma_f32_16x16x32_bf16 v[88:91], v[56:59], a[0:3], 0
ds_read_b64_tr_b16 v[48:49], v18 offset:18432
buffer_load_dwordx4 v12, s[8:11], s54 offen offset:2048 lds
v_mfma_f32_16x16x32_bf16 v[88:91], v[60:63], a[8:11], v[88:91]
ds_read_b64_tr_b16 v[50:51], v18 offset:18944
s_and_b32 s50, s50, 0x7ff
v_mfma_f32_16x16x32_bf16 v[92:95], v[56:59], a[4:7], 0
ds_read_b64_tr_b16 v[52:53], v22 offset:18432
buffer_load_dwordx4 v13, s[8:11], s54 offen offset:3072 lds
v_mfma_f32_16x16x32_bf16 v[92:95], v[60:63], a[12:15], v[92:95]
ds_read_b64_tr_b16 v[54:55], v22 offset:18944
s_add_u32 m0, s48, 12288
s_waitcnt lgkmcnt(8)
v_mfma_f32_16x16x32_bf16 v[96:99], a[0:3], v[32:35], 0
ds_read_b64_tr_b16 v[56:57], v19 offset:18432
buffer_load_dwordx4 v6, s[4:7], s50 offen offset:0 lds
v_mfma_f32_16x16x32_bf16 v[96:99], a[8:11], v[36:39], v[96:99]
ds_read_b64_tr_b16 v[58:59], v19 offset:18944
v_mfma_f32_16x16x32_bf16 v[100:103], a[4:7], v[32:35], 0
ds_read_b64_tr_b16 v[60:61], v23 offset:18432
buffer_load_dwordx4 v7, s[4:7], s50 offen offset:1024 lds
v_mfma_f32_16x16x32_bf16 v[100:103], a[12:15], v[36:39], v[100:103]
ds_read_b64_tr_b16 v[62:63], v23 offset:18944
s_waitcnt vmcnt(11) lgkmcnt(8)
s_barrier
v_mfma_f32_16x16x32_bf16 v[104:107], a[0:3], v[40:43], 0
ds_read_b64_tr_b16 v[32:33], v16 offset:20480
buffer_load_dwordx4 v8, s[4:7], s50 offen offset:2048 lds
v_mfma_f32_16x16x32_bf16 v[104:107], a[8:11], v[44:47], v[104:107]
ds_read_b64_tr_b16 v[34:35], v16 offset:20992
ds_read_b128 a[16:19], v10 offset:4096
v_mfma_f32_16x16x32_bf16 v[108:111], a[4:7], v[40:43], 0
ds_read_b64_tr_b16 v[36:37], v20 offset:20480
buffer_load_dwordx4 v9, s[4:7], s50 offen offset:3072 lds
v_mfma_f32_16x16x32_bf16 v[108:111], a[12:15], v[44:47], v[108:111]
ds_read_b64_tr_b16 v[38:39], v20 offset:20992
s_add_u32 m0, s48, 28672
s_waitcnt lgkmcnt(9)
v_mfma_f32_16x16x32_bf16 v[112:115], a[0:3], v[48:51], 0
ds_read_b64_tr_b16 v[40:41], v17 offset:20480
buffer_load_dwordx4 v12, s[8:11], s55 offen offset:0 lds
v_mfma_f32_16x16x32_bf16 v[112:115], a[8:11], v[52:55], v[112:115]
ds_read_b64_tr_b16 v[42:43], v17 offset:20992
ds_read_b128 a[20:23], v10 offset:6144
v_mfma_f32_16x16x32_bf16 v[116:119], a[4:7], v[48:51], 0
ds_read_b64_tr_b16 v[44:45], v21 offset:20480
ds_read_b128 a[24:27], v11 offset:4096
buffer_load_dwordx4 v13, s[8:11], s55 offen offset:1024 lds
v_mfma_f32_16x16x32_bf16 v[116:119], a[12:15], v[52:55], v[116:119]
ds_read_b64_tr_b16 v[46:47], v21 offset:20992
s_add_u32 s50, s50, 128
s_waitcnt lgkmcnt(11)
v_mfma_f32_16x16x32_bf16 v[120:123], a[0:3], v[56:59], 0
ds_read_b64_tr_b16 v[48:49], v18 offset:20480
buffer_load_dwordx4 v12, s[8:11], s55 offen offset:2048 lds
v_mfma_f32_16x16x32_bf16 v[120:123], a[8:11], v[60:63], v[120:123]
ds_read_b64_tr_b16 v[50:51], v18 offset:20992
ds_read_b128 a[28:31], v11 offset:6144
s_and_b32 s50, s50, 0x7ff
v_mfma_f32_16x16x32_bf16 v[124:127], a[4:7], v[56:59], 0
ds_read_b64_tr_b16 v[52:53], v22 offset:20480
buffer_load_dwordx4 v13, s[8:11], s55 offen offset:3072 lds
v_mfma_f32_16x16x32_bf16 v[124:127], a[12:15], v[60:63], v[124:127]
ds_read_b64_tr_b16 v[54:55], v22 offset:20992
s_add_u32 m0, s48, 0
s_waitcnt lgkmcnt(2)
v_mfma_f32_16x16x32_bf16 v[64:67], v[32:35], a[16:19], v[64:67]
ds_read_b64_tr_b16 v[56:57], v19 offset:20480
buffer_load_dwordx4 v6, s[4:7], s50 offen offset:0 lds
v_mfma_f32_16x16x32_bf16 v[64:67], v[36:39], a[24:27], v[64:67]
ds_read_b64_tr_b16 v[58:59], v19 offset:20992
v_mfma_f32_16x16x32_bf16 v[68:71], v[32:35], a[20:23], v[68:71]
ds_read_b64_tr_b16 v[60:61], v23 offset:20480
buffer_load_dwordx4 v7, s[4:7], s50 offen offset:1024 lds
v_mfma_f32_16x16x32_bf16 v[68:71], v[36:39], a[28:31], v[68:71]
ds_read_b64_tr_b16 v[62:63], v23 offset:20992
v_mfma_f32_16x16x32_bf16 v[72:75], v[40:43], a[16:19], v[72:75]
ds_read_b64_tr_b16 v[32:33], v16 offset:22528
buffer_load_dwordx4 v8, s[4:7], s50 offen offset:2048 lds
v_mfma_f32_16x16x32_bf16 v[72:75], v[44:47], a[24:27], v[72:75]
ds_read_b64_tr_b16 v[34:35], v16 offset:23040
v_mfma_f32_16x16x32_bf16 v[76:79], v[40:43], a[20:23], v[76:79]
ds_read_b64_tr_b16 v[36:37], v20 offset:22528
buffer_load_dwordx4 v9, s[4:7], s50 offen offset:3072 lds
v_mfma_f32_16x16x32_bf16 v[76:79], v[44:47], a[28:31], v[76:79]
ds_read_b64_tr_b16 v[38:39], v20 offset:23040
s_waitcnt lgkmcnt(8)
v_mfma_f32_16x16x32_bf16 v[80:83], v[48:51], a[16:19], v[80:83]
ds_read_b64_tr_b16 v[40:41], v17 offset:22528
v_mfma_f32_16x16x32_bf16 v[80:83], v[52:55], a[24:27], v[80:83]
ds_read_b64_tr_b16 v[42:43], v17 offset:23040
s_add_u32 m0, s48, 32768
v_mfma_f32_16x16x32_bf16 v[84:87], v[48:51], a[20:23], v[84:87]
ds_read_b64_tr_b16 v[44:45], v21 offset:22528
buffer_load_dwordx4 v12, s[8:11], s56 offen offset:0 lds
v_mfma_f32_16x16x32_bf16 v[84:87], v[52:55], a[28:31], v[84:87]
ds_read_b64_tr_b16 v[46:47], v21 offset:23040
s_waitcnt lgkmcnt(8)
v_mfma_f32_16x16x32_bf16 v[88:91], v[56:59], a[16:19], v[88:91]
ds_read_b64_tr_b16 v[48:49], v18 offset:22528
buffer_load_dwordx4 v13, s[8:11], s56 offen offset:1024 lds
v_mfma_f32_16x16x32_bf16 v[88:91], v[60:63], a[24:27], v[88:91]
ds_read_b64_tr_b16 v[50:51], v18 offset:23040
v_mfma_f32_16x16x32_bf16 v[92:95], v[56:59], a[20:23], v[92:95]
ds_read_b64_tr_b16 v[52:53], v22 offset:22528
buffer_load_dwordx4 v12, s[8:11], s56 offen offset:2048 lds
v_mfma_f32_16x16x32_bf16 v[92:95], v[60:63], a[28:31], v[92:95]
ds_read_b64_tr_b16 v[54:55], v22 offset:23040
s_add_u32 s50, s50, 128
s_waitcnt lgkmcnt(8)
v_mfma_f32_16x16x32_bf16 v[96:99], a[16:19], v[32:35], v[96:99]
ds_read_b64_tr_b16 v[56:57], v19 offset:22528
buffer_load_dwordx4 v13, s[8:11], s56 offen offset:3072 lds
v_mfma_f32_16x16x32_bf16 v[96:99], a[24:27], v[36:39], v[96:99]
ds_read_b64_tr_b16 v[58:59], v19 offset:23040
s_and_b32 s50, s50, 0x7ff
v_mfma_f32_16x16x32_bf16 v[100:103], a[20:23], v[32:35], v[100:103]
ds_read_b64_tr_b16 v[60:61], v23 offset:22528
v_mfma_f32_16x16x32_bf16 v[100:103], a[28:31], v[36:39], v[100:103]
ds_read_b64_tr_b16 v[62:63], v23 offset:23040
s_add_u32 m0, s48, 4096
s_waitcnt vmcnt(16) lgkmcnt(8)
s_barrier
v_mfma_f32_16x16x32_bf16 v[104:107], a[16:19], v[40:43], v[104:107]
ds_read_b64_tr_b16 v[32:33], v16 offset:24576
buffer_load_dwordx4 v6, s[4:7], s50 offen offset:0 lds
v_mfma_f32_16x16x32_bf16 v[104:107], a[24:27], v[44:47], v[104:107]
ds_read_b64_tr_b16 v[34:35], v16 offset:25088
ds_read_b128 a[32:35], v10 offset:8192
v_mfma_f32_16x16x32_bf16 v[108:111], a[20:23], v[40:43], v[108:111]
ds_read_b64_tr_b16 v[36:37], v20 offset:24576
buffer_load_dwordx4 v7, s[4:7], s50 offen offset:1024 lds
v_mfma_f32_16x16x32_bf16 v[108:111], a[28:31], v[44:47], v[108:111]
ds_read_b64_tr_b16 v[38:39], v20 offset:25088
s_waitcnt lgkmcnt(9)
v_mfma_f32_16x16x32_bf16 v[112:115], a[16:19], v[48:51], v[112:115]
ds_read_b64_tr_b16 v[40:41], v17 offset:24576
buffer_load_dwordx4 v8, s[4:7], s50 offen offset:2048 lds
v_mfma_f32_16x16x32_bf16 v[112:115], a[24:27], v[52:55], v[112:115]
ds_read_b64_tr_b16 v[42:43], v17 offset:25088
ds_read_b128 a[36:39], v10 offset:10240
v_mfma_f32_16x16x32_bf16 v[116:119], a[20:23], v[48:51], v[116:119]
ds_read_b64_tr_b16 v[44:45], v21 offset:24576
ds_read_b128 a[40:43], v11 offset:8192
buffer_load_dwordx4 v9, s[4:7], s50 offen offset:3072 lds
v_mfma_f32_16x16x32_bf16 v[116:119], a[28:31], v[52:55], v[116:119]
ds_read_b64_tr_b16 v[46:47], v21 offset:25088
s_waitcnt lgkmcnt(11)
v_mfma_f32_16x16x32_bf16 v[120:123], a[16:19], v[56:59], v[120:123]
ds_read_b64_tr_b16 v[48:49], v18 offset:24576
v_mfma_f32_16x16x32_bf16 v[120:123], a[24:27], v[60:63], v[120:123]
ds_read_b64_tr_b16 v[50:51], v18 offset:25088
ds_read_b128 a[44:47], v11 offset:10240
v_mfma_f32_16x16x32_bf16 v[124:127], a[20:23], v[56:59], v[124:127]
ds_read_b64_tr_b16 v[52:53], v22 offset:24576
s_add_u32 m0, s48, 16384
v_mfma_f32_16x16x32_bf16 v[124:127], a[28:31], v[60:63], v[124:127]
ds_read_b64_tr_b16 v[54:55], v22 offset:25088
s_waitcnt lgkmcnt(2)
v_mfma_f32_16x16x32_bf16 v[64:67], v[32:35], a[32:35], v[64:67]
ds_read_b64_tr_b16 v[56:57], v19 offset:24576
buffer_load_dwordx4 v12, s[8:11], s57 offen offset:0 lds
v_mfma_f32_16x16x32_bf16 v[64:67], v[36:39], a[40:43], v[64:67]
ds_read_b64_tr_b16 v[58:59], v19 offset:25088
v_mfma_f32_16x16x32_bf16 v[68:71], v[32:35], a[36:39], v[68:71]
ds_read_b64_tr_b16 v[60:61], v23 offset:24576
v_mfma_f32_16x16x32_bf16 v[68:71], v[36:39], a[44:47], v[68:71]
ds_read_b64_tr_b16 v[62:63], v23 offset:25088
v_mfma_f32_16x16x32_bf16 v[72:75], v[40:43], a[32:35], v[72:75]
ds_read_b64_tr_b16 v[32:33], v16 offset:26624
buffer_load_dwordx4 v13, s[8:11], s57 offen offset:1024 lds
v_mfma_f32_16x16x32_bf16 v[72:75], v[44:47], a[40:43], v[72:75]
ds_read_b64_tr_b16 v[34:35], v16 offset:27136
v_mfma_f32_16x16x32_bf16 v[76:79], v[40:43], a[36:39], v[76:79]
ds_read_b64_tr_b16 v[36:37], v20 offset:26624
v_mfma_f32_16x16x32_bf16 v[76:79], v[44:47], a[44:47], v[76:79]
ds_read_b64_tr_b16 v[38:39], v20 offset:27136
s_waitcnt lgkmcnt(8)
v_mfma_f32_16x16x32_bf16 v[80:83], v[48:51], a[32:35], v[80:83]
ds_read_b64_tr_b16 v[40:41], v17 offset:26624
buffer_load_dwordx4 v12, s[8:11], s57 offen offset:2048 lds
v_mfma_f32_16x16x32_bf16 v[80:83], v[52:55], a[40:43], v[80:83]
ds_read_b64_tr_b16 v[42:43], v17 offset:27136
s_add_u32 s50, s50, 128
v_mfma_f32_16x16x32_bf16 v[84:87], v[48:51], a[36:39], v[84:87]
ds_read_b64_tr_b16 v[44:45], v21 offset:26624
s_and_b32 s50, s50, 0x7ff
v_mfma_f32_16x16x32_bf16 v[84:87], v[52:55], a[44:47], v[84:87]
ds_read_b64_tr_b16 v[46:47], v21 offset:27136
s_waitcnt lgkmcnt(8)
v_mfma_f32_16x16x32_bf16 v[88:91], v[56:59], a[32:35], v[88:91]
ds_read_b64_tr_b16 v[48:49], v18 offset:26624
buffer_load_dwordx4 v13, s[8:11], s57 offen offset:3072 lds
v_mfma_f32_16x16x32_bf16 v[88:91], v[60:63], a[40:43], v[88:91]
ds_read_b64_tr_b16 v[50:51], v18 offset:27136
v_mfma_f32_16x16x32_bf16 v[92:95], v[56:59], a[36:39], v[92:95]
ds_read_b64_tr_b16 v[52:53], v22 offset:26624
s_add_u32 m0, s48, 8192
v_mfma_f32_16x16x32_bf16 v[92:95], v[60:63], a[44:47], v[92:95]
ds_read_b64_tr_b16 v[54:55], v22 offset:27136
s_waitcnt lgkmcnt(8)
TP1:
s_cbranch_execz TP4
TP2:
s_cbranch_execz TP15
v_mfma_f32_16x16x32_bf16 v[96:99], a[32:35], v[32:35], v[96:99]
ds_read_b64_tr_b16 v[56:57], v19 offset:26624
buffer_load_dwordx4 v6, s[4:7], s50 offen offset:0 lds
v_mfma_f32_16x16x32_bf16 v[96:99], a[40:43], v[36:39], v[96:99]
ds_read_b64_tr_b16 v[58:59], v19 offset:27136
v_mfma_f32_16x16x32_bf16 v[100:103], a[36:39], v[32:35], v[100:103]
ds_read_b64_tr_b16 v[60:61], v23 offset:26624
v_mfma_f32_16x16x32_bf16 v[100:103], a[44:47], v[36:39], v[100:103]
ds_read_b64_tr_b16 v[62:63], v23 offset:27136
s_waitcnt vmcnt(17) lgkmcnt(8)
s_barrier
v_mfma_f32_16x16x32_bf16 v[104:107], a[32:35], v[40:43], v[104:107]
ds_read_b64_tr_b16 v[32:33], v16 offset:28672
buffer_load_dwordx4 v7, s[4:7], s50 offen offset:1024 lds
v_mfma_f32_16x16x32_bf16 v[104:107], a[40:43], v[44:47], v[104:107]
ds_read_b64_tr_b16 v[34:35], v16 offset:29184
ds_read_b128 a[48:51], v10 offset:12288
v_mfma_f32_16x16x32_bf16 v[108:111], a[36:39], v[40:43], v[108:111]
ds_read_b64_tr_b16 v[36:37], v20 offset:28672
v_mfma_f32_16x16x32_bf16 v[108:111], a[44:47], v[44:47], v[108:111]
ds_read_b64_tr_b16 v[38:39], v20 offset:29184
s_waitcnt lgkmcnt(9)
v_mfma_f32_16x16x32_bf16 v[112:115], a[32:35], v[48:51], v[112:115]
ds_read_b64_tr_b16 v[40:41], v17 offset:28672
buffer_load_dwordx4 v8, s[4:7], s50 offen offset:2048 lds
v_mfma_f32_16x16x32_bf16 v[112:115], a[40:43], v[52:55], v[112:115]
ds_read_b64_tr_b16 v[42:43], v17 offset:29184
ds_read_b128 a[52:55], v10 offset:14336
v_mfma_f32_16x16x32_bf16 v[116:119], a[36:39], v[48:51], v[116:119]
ds_read_b64_tr_b16 v[44:45], v21 offset:28672
ds_read_b128 a[56:59], v11 offset:12288
v_mfma_f32_16x16x32_bf16 v[116:119], a[44:47], v[52:55], v[116:119]
ds_read_b64_tr_b16 v[46:47], v21 offset:29184
s_waitcnt lgkmcnt(11)
v_mfma_f32_16x16x32_bf16 v[120:123], a[32:35], v[56:59], v[120:123]
ds_read_b64_tr_b16 v[48:49], v18 offset:28672
buffer_load_dwordx4 v9, s[4:7], s50 offen offset:3072 lds
v_mfma_f32_16x16x32_bf16 v[120:123], a[40:43], v[60:63], v[120:123]
ds_read_b64_tr_b16 v[50:51], v18 offset:29184
ds_read_b128 a[60:63], v11 offset:14336
v_mfma_f32_16x16x32_bf16 v[124:127], a[36:39], v[56:59], v[124:127]
ds_read_b64_tr_b16 v[52:53], v22 offset:28672
s_add_u32 m0, s48, 20480
v_mfma_f32_16x16x32_bf16 v[124:127], a[44:47], v[60:63], v[124:127]
ds_read_b64_tr_b16 v[54:55], v22 offset:29184
s_waitcnt lgkmcnt(2)
v_mfma_f32_16x16x32_bf16 v[64:67], v[32:35], a[48:51], v[64:67]
ds_read_b64_tr_b16 v[56:57], v19 offset:28672
buffer_load_dwordx4 v12, s[8:11], s58 offen offset:0 lds
v_mfma_f32_16x16x32_bf16 v[64:67], v[36:39], a[56:59], v[64:67]
ds_read_b64_tr_b16 v[58:59], v19 offset:29184
v_mfma_f32_16x16x32_bf16 v[68:71], v[32:35], a[52:55], v[68:71]
ds_read_b64_tr_b16 v[60:61], v23 offset:28672
v_mfma_f32_16x16x32_bf16 v[68:71], v[36:39], a[60:63], v[68:71]
ds_read_b64_tr_b16 v[62:63], v23 offset:29184
v_mfma_f32_16x16x32_bf16 v[72:75], v[40:43], a[48:51], v[72:75]
ds_read_b64_tr_b16 v[32:33], v16 offset:30720
buffer_load_dwordx4 v13, s[8:11], s58 offen offset:1024 lds
v_mfma_f32_16x16x32_bf16 v[72:75], v[44:47], a[56:59], v[72:75]
ds_read_b64_tr_b16 v[34:35], v16 offset:31232
v_mfma_f32_16x16x32_bf16 v[76:79], v[40:43], a[52:55], v[76:79]
ds_read_b64_tr_b16 v[36:37], v20 offset:30720
v_mfma_f32_16x16x32_bf16 v[76:79], v[44:47], a[60:63], v[76:79]
ds_read_b64_tr_b16 v[38:39], v20 offset:31232
s_waitcnt lgkmcnt(8)
v_mfma_f32_16x16x32_bf16 v[80:83], v[48:51], a[48:51], v[80:83]
ds_read_b64_tr_b16 v[40:41], v17 offset:30720
buffer_load_dwordx4 v12, s[8:11], s58 offen offset:2048 lds
v_mfma_f32_16x16x32_bf16 v[80:83], v[52:55], a[56:59], v[80:83]
ds_read_b64_tr_b16 v[42:43], v17 offset:31232
s_add_u32 s50, s50, 128
v_mfma_f32_16x16x32_bf16 v[84:87], v[48:51], a[52:55], v[84:87]
ds_read_b64_tr_b16 v[44:45], v21 offset:30720
s_and_b32 s50, s50, 0x7ff
v_mfma_f32_16x16x32_bf16 v[84:87], v[52:55], a[60:63], v[84:87]
ds_read_b64_tr_b16 v[46:47], v21 offset:31232
s_waitcnt lgkmcnt(8)
v_mfma_f32_16x16x32_bf16 v[88:91], v[56:59], a[48:51], v[88:91]
ds_read_b64_tr_b16 v[48:49], v18 offset:30720
buffer_load_dwordx4 v13, s[8:11], s58 offen offset:3072 lds
v_mfma_f32_16x16x32_bf16 v[88:91], v[60:63], a[56:59], v[88:91]
ds_read_b64_tr_b16 v[50:51], v18 offset:31232
v_mfma_f32_16x16x32_bf16 v[92:95], v[56:59], a[52:55], v[92:95]
ds_read_b64_tr_b16 v[52:53], v22 offset:30720
s_add_u32 m0, s48, 12288
v_mfma_f32_16x16x32_bf16 v[92:95], v[60:63], a[60:63], v[92:95]
ds_read_b64_tr_b16 v[54:55], v22 offset:31232
s_waitcnt lgkmcnt(8)
v_mfma_f32_16x16x32_bf16 v[96:99], a[48:51], v[32:35], v[96:99]
ds_read_b64_tr_b16 v[56:57], v19 offset:30720
buffer_load_dwordx4 v6, s[4:7], s50 offen offset:0 lds
v_mfma_f32_16x16x32_bf16 v[96:99], a[56:59], v[36:39], v[96:99]
ds_read_b64_tr_b16 v[58:59], v19 offset:31232
v_mfma_f32_16x16x32_bf16 v[100:103], a[52:55], v[32:35], v[100:103]
ds_read_b64_tr_b16 v[60:61], v23 offset:30720
v_mfma_f32_16x16x32_bf16 v[100:103], a[60:63], v[36:39], v[100:103]
ds_read_b64_tr_b16 v[62:63], v23 offset:31232
s_waitcnt vmcnt(17) lgkmcnt(8)
s_barrier
v_mfma_f32_16x16x32_bf16 v[104:107], a[48:51], v[40:43], v[104:107]
ds_read_b64_tr_b16 v[32:33], v16 offset:32768
buffer_load_dwordx4 v7, s[4:7], s50 offen offset:1024 lds
v_mfma_f32_16x16x32_bf16 v[104:107], a[56:59], v[44:47], v[104:107]
ds_read_b64_tr_b16 v[34:35], v16 offset:33280
ds_read_b128 a[64:67], v10 offset:0
v_mfma_f32_16x16x32_bf16 v[108:111], a[52:55], v[40:43], v[108:111]
ds_read_b64_tr_b16 v[36:37], v20 offset:32768
v_mfma_f32_16x16x32_bf16 v[108:111], a[60:63], v[44:47], v[108:111]
ds_read_b64_tr_b16 v[38:39], v20 offset:33280
s_waitcnt lgkmcnt(9)
v_mfma_f32_16x16x32_bf16 v[112:115], a[48:51], v[48:51], v[112:115]
ds_read_b64_tr_b16 v[40:41], v17 offset:32768
buffer_load_dwordx4 v8, s[4:7], s50 offen offset:2048 lds
v_mfma_f32_16x16x32_bf16 v[112:115], a[56:59], v[52:55], v[112:115]
ds_read_b64_tr_b16 v[42:43], v17 offset:33280
ds_read_b128 a[68:71], v10 offset:2048
v_mfma_f32_16x16x32_bf16 v[116:119], a[52:55], v[48:51], v[116:119]
ds_read_b64_tr_b16 v[44:45], v21 offset:32768
ds_read_b128 a[72:75], v11 offset:0
v_mfma_f32_16x16x32_bf16 v[116:119], a[60:63], v[52:55], v[116:119]
ds_read_b64_tr_b16 v[46:47], v21 offset:33280
s_waitcnt lgkmcnt(11)
v_mfma_f32_16x16x32_bf16 v[120:123], a[48:51], v[56:59], v[120:123]
ds_read_b64_tr_b16 v[48:49], v18 offset:32768
buffer_load_dwordx4 v9, s[4:7], s50 offen offset:3072 lds
v_mfma_f32_16x16x32_bf16 v[120:123], a[56:59], v[60:63], v[120:123]
ds_read_b64_tr_b16 v[50:51], v18 offset:33280
ds_read_b128 a[76:79], v11 offset:2048
v_mfma_f32_16x16x32_bf16 v[124:127], a[52:55], v[56:59], v[124:127]
ds_read_b64_tr_b16 v[52:53], v22 offset:32768
s_add_u32 m0, s48, 24576
v_mfma_f32_16x16x32_bf16 v[124:127], a[60:63], v[60:63], v[124:127]
ds_read_b64_tr_b16 v[54:55], v22 offset:33280
s_waitcnt lgkmcnt(2)
v_mfma_f32_16x16x32_bf16 v[64:67], v[32:35], a[64:67], v[64:67]
ds_read_b64_tr_b16 v[56:57], v19 offset:32768
buffer_load_dwordx4 v12, s[8:11], s59 offen offset:0 lds
v_mfma_f32_16x16x32_bf16 v[64:67], v[36:39], a[72:75], v[64:67]
ds_read_b64_tr_b16 v[58:59], v19 offset:33280
v_mfma_f32_16x16x32_bf16 v[68:71], v[32:35], a[68:71], v[68:71]
ds_read_b64_tr_b16 v[60:61], v23 offset:32768
v_mfma_f32_16x16x32_bf16 v[68:71], v[36:39], a[76:79], v[68:71]
ds_read_b64_tr_b16 v[62:63], v23 offset:33280
v_mfma_f32_16x16x32_bf16 v[72:75], v[40:43], a[64:67], v[72:75]
ds_read_b64_tr_b16 v[32:33], v16 offset:34816
buffer_load_dwordx4 v13, s[8:11], s59 offen offset:1024 lds
v_mfma_f32_16x16x32_bf16 v[72:75], v[44:47], a[72:75], v[72:75]
ds_read_b64_tr_b16 v[34:35], v16 offset:35328
v_mfma_f32_16x16x32_bf16 v[76:79], v[40:43], a[68:71], v[76:79]
ds_read_b64_tr_b16 v[36:37], v20 offset:34816
v_mfma_f32_16x16x32_bf16 v[76:79], v[44:47], a[76:79], v[76:79]
ds_read_b64_tr_b16 v[38:39], v20 offset:35328
s_waitcnt lgkmcnt(8)
v_mfma_f32_16x16x32_bf16 v[80:83], v[48:51], a[64:67], v[80:83]
ds_read_b64_tr_b16 v[40:41], v17 offset:34816
buffer_load_dwordx4 v12, s[8:11], s59 offen offset:2048 lds
v_mfma_f32_16x16x32_bf16 v[80:83], v[52:55], a[72:75], v[80:83]
ds_read_b64_tr_b16 v[42:43], v17 offset:35328
s_add_u32 s50, s50, 128
v_mfma_f32_16x16x32_bf16 v[84:87], v[48:51], a[68:71], v[84:87]
ds_read_b64_tr_b16 v[44:45], v21 offset:34816
s_and_b32 s50, s50, 0x7ff
v_mfma_f32_16x16x32_bf16 v[84:87], v[52:55], a[76:79], v[84:87]
ds_read_b64_tr_b16 v[46:47], v21 offset:35328
s_waitcnt lgkmcnt(8)
v_mfma_f32_16x16x32_bf16 v[88:91], v[56:59], a[64:67], v[88:91]
ds_read_b64_tr_b16 v[48:49], v18 offset:34816
buffer_load_dwordx4 v13, s[8:11], s59 offen offset:3072 lds
v_mfma_f32_16x16x32_bf16 v[88:91], v[60:63], a[72:75], v[88:91]
ds_read_b64_tr_b16 v[50:51], v18 offset:35328
v_mfma_f32_16x16x32_bf16 v[92:95], v[56:59], a[68:71], v[92:95]
ds_read_b64_tr_b16 v[52:53], v22 offset:34816
s_add_u32 m0, s48, 0
v_mfma_f32_16x16x32_bf16 v[92:95], v[60:63], a[76:79], v[92:95]
ds_read_b64_tr_b16 v[54:55], v22 offset:35328
s_waitcnt lgkmcnt(8)
v_mfma_f32_16x16x32_bf16 v[96:99], a[64:67], v[32:35], v[96:99]
ds_read_b64_tr_b16 v[56:57], v19 offset:34816
buffer_load_dwordx4 v6, s[4:7], s50 offen offset:0 lds
v_mfma_f32_16x16x32_bf16 v[96:99], a[72:75], v[36:39], v[96:99]
ds_read_b64_tr_b16 v[58:59], v19 offset:35328
v_mfma_f32_16x16x32_bf16 v[100:103], a[68:71], v[32:35], v[100:103]
ds_read_b64_tr_b16 v[60:61], v23 offset:34816
v_mfma_f32_16x16x32_bf16 v[100:103], a[76:79], v[36:39], v[100:103]
ds_read_b64_tr_b16 v[62:63], v23 offset:35328
s_waitcnt vmcnt(17) lgkmcnt(8)
s_barrier
v_mfma_f32_16x16x32_bf16 v[104:107], a[64:67], v[40:43], v[104:107]
ds_read_b64_tr_b16 v[32:33], v16 offset:16384
buffer_load_dwordx4 v7, s[4:7], s50 offen offset:1024 lds
v_mfma_f32_16x16x32_bf16 v[104:107], a[72:75], v[44:47], v[104:107]
ds_read_b64_tr_b16 v[34:35], v16 offset:16896
ds_read_b128 a[80:83], v10 offset:4096
v_mfma_f32_16x16x32_bf16 v[108:111], a[68:71], v[40:43], v[108:111]
ds_read_b64_tr_b16 v[36:37], v20 offset:16384
v_mfma_f32_16x16x32_bf16 v[108:111], a[76:79], v[44:47], v[108:111]
ds_read_b64_tr_b16 v[38:39], v20 offset:16896
s_waitcnt lgkmcnt(9)
v_mfma_f32_16x16x32_bf16 v[112:115], a[64:67], v[48:51], v[112:115]
ds_read_b64_tr_b16 v[40:41], v17 offset:16384
buffer_load_dwordx4 v8, s[4:7], s50 offen offset:2048 lds
v_mfma_f32_16x16x32_bf16 v[112:115], a[72:75], v[52:55], v[112:115]
ds_read_b64_tr_b16 v[42:43], v17 offset:16896
ds_read_b128 a[84:87], v10 offset:6144
v_mfma_f32_16x16x32_bf16 v[116:119], a[68:71], v[48:51], v[116:119]
ds_read_b64_tr_b16 v[44:45], v21 offset:16384
ds_read_b128 a[88:91], v11 offset:4096
v_mfma_f32_16x16x32_bf16 v[116:119], a[76:79], v[52:55], v[116:119]
ds_read_b64_tr_b16 v[46:47], v21 offset:16896
s_waitcnt lgkmcnt(11)
v_mfma_f32_16x16x32_bf16 v[120:123], a[64:67], v[56:59], v[120:123]
ds_read_b64_tr_b16 v[48:49], v18 offset:16384
buffer_load_dwordx4 v9, s[4:7], s50 offen offset:3072 lds
v_mfma_f32_16x16x32_bf16 v[120:123], a[72:75], v[60:63], v[120:123]
ds_read_b64_tr_b16 v[50:51], v18 offset:16896
ds_read_b128 a[92:95], v11 offset:6144
v_mfma_f32_16x16x32_bf16 v[124:127], a[68:71], v[56:59], v[124:127]
ds_read_b64_tr_b16 v[52:53], v22 offset:16384
s_add_u32 m0, s48, 28672
v_mfma_f32_16x16x32_bf16 v[124:127], a[76:79], v[60:63], v[124:127]
ds_read_b64_tr_b16 v[54:55], v22 offset:16896
s_waitcnt lgkmcnt(2)
v_mfma_f32_16x16x32_bf16 v[64:67], v[32:35], a[80:83], v[64:67]
ds_read_b64_tr_b16 v[56:57], v19 offset:16384
buffer_load_dwordx4 v12, s[8:11], s60 offen offset:0 lds
v_mfma_f32_16x16x32_bf16 v[64:67], v[36:39], a[88:91], v[64:67]
ds_read_b64_tr_b16 v[58:59], v19 offset:16896
v_mfma_f32_16x16x32_bf16 v[68:71], v[32:35], a[84:87], v[68:71]
ds_read_b64_tr_b16 v[60:61], v23 offset:16384
v_mfma_f32_16x16x32_bf16 v[68:71], v[36:39], a[92:95], v[68:71]
ds_read_b64_tr_b16 v[62:63], v23 offset:16896
v_mfma_f32_16x16x32_bf16 v[72:75], v[40:43], a[80:83], v[72:75]
ds_read_b64_tr_b16 v[32:33], v16 offset:18432
buffer_load_dwordx4 v13, s[8:11], s60 offen offset:1024 lds
v_mfma_f32_16x16x32_bf16 v[72:75], v[44:47], a[88:91], v[72:75]
ds_read_b64_tr_b16 v[34:35], v16 offset:18944
v_mfma_f32_16x16x32_bf16 v[76:79], v[40:43], a[84:87], v[76:79]
ds_read_b64_tr_b16 v[36:37], v20 offset:18432
v_mfma_f32_16x16x32_bf16 v[76:79], v[44:47], a[92:95], v[76:79]
ds_read_b64_tr_b16 v[38:39], v20 offset:18944
s_waitcnt lgkmcnt(8)
v_mfma_f32_16x16x32_bf16 v[80:83], v[48:51], a[80:83], v[80:83]
ds_read_b64_tr_b16 v[40:41], v17 offset:18432
buffer_load_dwordx4 v12, s[8:11], s60 offen offset:2048 lds
v_mfma_f32_16x16x32_bf16 v[80:83], v[52:55], a[88:91], v[80:83]
ds_read_b64_tr_b16 v[42:43], v17 offset:18944
s_add_u32 s50, s50, 128
v_mfma_f32_16x16x32_bf16 v[84:87], v[48:51], a[84:87], v[84:87]
ds_read_b64_tr_b16 v[44:45], v21 offset:18432
s_and_b32 s50, s50, 0x7ff
v_mfma_f32_16x16x32_bf16 v[84:87], v[52:55], a[92:95], v[84:87]
ds_read_b64_tr_b16 v[46:47], v21 offset:18944
s_waitcnt lgkmcnt(8)
v_mfma_f32_16x16x32_bf16 v[88:91], v[56:59], a[80:83], v[88:91]
ds_read_b64_tr_b16 v[48:49], v18 offset:18432
buffer_load_dwordx4 v13, s[8:11], s60 offen offset:3072 lds
v_mfma_f32_16x16x32_bf16 v[88:91], v[60:63], a[88:91], v[88:91]
ds_read_b64_tr_b16 v[50:51], v18 offset:18944
v_mfma_f32_16x16x32_bf16 v[92:95], v[56:59], a[84:87], v[92:95]
ds_read_b64_tr_b16 v[52:53], v22 offset:18432
s_add_u32 m0, s48, 4096
v_mfma_f32_16x16x32_bf16 v[92:95], v[60:63], a[92:95], v[92:95]
ds_read_b64_tr_b16 v[54:55], v22 offset:18944
s_waitcnt lgkmcnt(8)
v_mfma_f32_16x16x32_bf16 v[96:99], a[80:83], v[32:35], v[96:99]
ds_read_b64_tr_b16 v[56:57], v19 offset:18432
buffer_load_dwordx4 v6, s[4:7], s50 offen offset:0 lds
v_mfma_f32_16x16x32_bf16 v[96:99], a[88:91], v[36:39], v[96:99]
ds_read_b64_tr_b16 v[58:59], v19 offset:18944
v_mfma_f32_16x16x32_bf16 v[100:103], a[84:87], v[32:35], v[100:103]
ds_read_b64_tr_b16 v[60:61], v23 offset:18432
v_mfma_f32_16x16x32_bf16 v[100:103], a[92:95], v[36:39], v[100:103]
ds_read_b64_tr_b16 v[62:63], v23 offset:18944
s_waitcnt vmcnt(17) lgkmcnt(8)
s_barrier
v_mfma_f32_16x16x32_bf16 v[104:107], a[80:83], v[40:43], v[104:107]
ds_read_b64_tr_b16 v[32:33], v16 offset:20480
buffer_load_dwordx4 v7, s[4:7], s50 offen offset:1024 lds
v_mfma_f32_16x16x32_bf16 v[104:107], a[88:91], v[44:47], v[104:107]
ds_read_b64_tr_b16 v[34:35], v16 offset:20992
ds_read_b128 a[96:99], v10 offset:8192
v_mfma_f32_16x16x32_bf16 v[108:111], a[84:87], v[40:43], v[108:111]
ds_read_b64_tr_b16 v[36:37], v20 offset:20480
v_mfma_f32_16x16x32_bf16 v[108:111], a[92:95], v[44:47], v[108:111]
ds_read_b64_tr_b16 v[38:39], v20 offset:20992
s_waitcnt lgkmcnt(9)
v_mfma_f32_16x16x32_bf16 v[112:115], a[80:83], v[48:51], v[112:115]
ds_read_b64_tr_b16 v[40:41], v17 offset:20480
buffer_load_dwordx4 v8, s[4:7], s50 offen offset:2048 lds
v_mfma_f32_16x16x32_bf16 v[112:115], a[88:91], v[52:55], v[112:115]
ds_read_b64_tr_b16 v[42:43], v17 offset:20992
ds_read_b128 a[100:103], v10 offset:10240
v_mfma_f32_16x16x32_bf16 v[116:119], a[84:87], v[48:51], v[116:119]
ds_read_b64_tr_b16 v[44:45], v21 offset:20480
ds_read_b128 a[104:107], v11 offset:8192
v_mfma_f32_16x16x32_bf16 v[116:119], a[92:95], v[52:55], v[116:119]
ds_read_b64_tr_b16 v[46:47], v21 offset:20992
s_waitcnt lgkmcnt(11)
v_mfma_f32_16x16x32_bf16 v[120:123], a[80:83], v[56:59], v[120:123]
ds_read_b64_tr_b16 v[48:49], v18 offset:20480
buffer_load_dwordx4 v9, s[4:7], s50 offen offset:3072 lds
v_mfma_f32_16x16x32_bf16 v[120:123], a[88:91], v[60:63], v[120:123]
ds_read_b64_tr_b16 v[50:51], v18 offset:20992
ds_read_b128 a[108:111], v11 offset:10240
v_mfma_f32_16x16x32_bf16 v[124:127], a[84:87], v[56:59], v[124:127]
ds_read_b64_tr_b16 v[52:53], v22 offset:20480
s_add_u32 m0, s48, 32768
v_mfma_f32_16x16x32_bf16 v[124:127], a[92:95], v[60:63], v[124:127]
ds_read_b64_tr_b16 v[54:55], v22 offset:20992
s_waitcnt lgkmcnt(2)
v_mfma_f32_16x16x32_bf16 v[64:67], v[32:35], a[96:99], v[64:67]
ds_read_b64_tr_b16 v[56:57], v19 offset:20480
buffer_load_dwordx4 v12, s[8:11], s61 offen offset:0 lds
v_mfma_f32_16x16x32_bf16 v[64:67], v[36:39], a[104:107], v[64:67]
ds_read_b64_tr_b16 v[58:59], v19 offset:20992
v_mfma_f32_16x16x32_bf16 v[68:71], v[32:35], a[100:103], v[68:71]
ds_read_b64_tr_b16 v[60:61], v23 offset:20480
v_mfma_f32_16x16x32_bf16 v[68:71], v[36:39], a[108:111], v[68:71]
ds_read_b64_tr_b16 v[62:63], v23 offset:20992
v_mfma_f32_16x16x32_bf16 v[72:75], v[40:43], a[96:99], v[72:75]
ds_read_b64_tr_b16 v[32:33], v16 offset:22528
buffer_load_dwordx4 v13, s[8:11], s61 offen offset:1024 lds
v_mfma_f32_16x16x32_bf16 v[72:75], v[44:47], a[104:107], v[72:75]
ds_read_b64_tr_b16 v[34:35], v16 offset:23040
v_mfma_f32_16x16x32_bf16 v[76:79], v[40:43], a[100:103], v[76:79]
ds_read_b64_tr_b16 v[36:37], v20 offset:22528
v_mfma_f32_16x16x32_bf16 v[76:79], v[44:47], a[108:111], v[76:79]
ds_read_b64_tr_b16 v[38:39], v20 offset:23040
s_waitcnt lgkmcnt(8)
v_mfma_f32_16x16x32_bf16 v[80:83], v[48:51], a[96:99], v[80:83]
ds_read_b64_tr_b16 v[40:41], v17 offset:22528
buffer_load_dwordx4 v12, s[8:11], s61 offen offset:2048 lds
v_mfma_f32_16x16x32_bf16 v[80:83], v[52:55], a[104:107], v[80:83]
ds_read_b64_tr_b16 v[42:43], v17 offset:23040
s_add_u32 s50, s50, 128
v_mfma_f32_16x16x32_bf16 v[84:87], v[48:51], a[100:103], v[84:87]
ds_read_b64_tr_b16 v[44:45], v21 offset:22528
s_and_b32 s50, s50, 0x7ff
v_mfma_f32_16x16x32_bf16 v[84:87], v[52:55], a[108:111], v[84:87]
ds_read_b64_tr_b16 v[46:47], v21 offset:23040
s_waitcnt lgkmcnt(8)
v_mfma_f32_16x16x32_bf16 v[88:91], v[56:59], a[96:99], v[88:91]
ds_read_b64_tr_b16 v[48:49], v18 offset:22528
buffer_load_dwordx4 v13, s[8:11], s61 offen offset:3072 lds
v_mfma_f32_16x16x32_bf16 v[88:91], v[60:63], a[104:107], v[88:91]
ds_read_b64_tr_b16 v[50:51], v18 offset:23040
v_mfma_f32_16x16x32_bf16 v[92:95], v[56:59], a[100:103], v[92:95]
ds_read_b64_tr_b16 v[52:53], v22 offset:22528
s_add_u32 m0, s48, 8192
v_mfma_f32_16x16x32_bf16 v[92:95], v[60:63], a[108:111], v[92:95]
ds_read_b64_tr_b16 v[54:55], v22 offset:23040
s_waitcnt lgkmcnt(8)
v_mfma_f32_16x16x32_bf16 v[96:99], a[96:99], v[32:35], v[96:99]
ds_read_b64_tr_b16 v[56:57], v19 offset:22528
buffer_load_dwordx4 v6, s[4:7], s50 offen offset:0 lds
v_mfma_f32_16x16x32_bf16 v[96:99], a[104:107], v[36:39], v[96:99]
ds_read_b64_tr_b16 v[58:59], v19 offset:23040
v_mfma_f32_16x16x32_bf16 v[100:103], a[100:103], v[32:35], v[100:103]
ds_read_b64_tr_b16 v[60:61], v23 offset:22528
v_mfma_f32_16x16x32_bf16 v[100:103], a[108:111], v[36:39], v[100:103]
ds_read_b64_tr_b16 v[62:63], v23 offset:23040
s_waitcnt vmcnt(17) lgkmcnt(8)
s_barrier
v_mfma_f32_16x16x32_bf16 v[104:107], a[96:99], v[40:43], v[104:107]
ds_read_b64_tr_b16 v[32:33], v16 offset:24576
buffer_load_dwordx4 v7, s[4:7], s50 offen offset:1024 lds
v_mfma_f32_16x16x32_bf16 v[104:107], a[104:107], v[44:47], v[104:107]
ds_read_b64_tr_b16 v[34:35], v16 offset:25088
ds_read_b128 a[112:115], v10 offset:12288
v_mfma_f32_16x16x32_bf16 v[108:111], a[100:103], v[40:43], v[108:111]
ds_read_b64_tr_b16 v[36:37], v20 offset:24576
v_mfma_f32_16x16x32_bf16 v[108:111], a[108:111], v[44:47], v[108:111]
ds_read_b64_tr_b16 v[38:39], v20 offset:25088
s_waitcnt lgkmcnt(9)
v_mfma_f32_16x16x32_bf16 v[112:115], a[96:99], v[48:51], v[112:115]
ds_read_b64_tr_b16 v[40:41], v17 offset:24576
buffer_load_dwordx4 v8, s[4:7], s50 offen offset:2048 lds
v_mfma_f32_16x16x32_bf16 v[112:115], a[104:107], v[52:55], v[112:115]
ds_read_b64_tr_b16 v[42:43], v17 offset:25088
ds_read_b128 a[116:119], v10 offset:14336
v_mfma_f32_16x16x32_bf16 v[116:119], a[100:103], v[48:51], v[116:119]
ds_read_b64_tr_b16 v[44:45], v21 offset:24576
ds_read_b128 a[120:123], v11 offset:12288
v_mfma_f32_16x16x32_bf16 v[116:119], a[108:111], v[52:55], v[116:119]
ds_read_b64_tr_b16 v[46:47], v21 offset:25088
s_waitcnt lgkmcnt(11)
v_mfma_f32_16x16x32_bf16 v[120:123], a[96:99], v[56:59], v[120:123]
ds_read_b64_tr_b16 v[48:49], v18 offset:24576
buffer_load_dwordx4 v9, s[4:7], s50 offen offset:3072 lds
v_mfma_f32_16x16x32_bf16 v[120:123], a[104:107], v[60:63], v[120:123]
ds_read_b64_tr_b16 v[50:51], v18 offset:25088
ds_read_b128 a[124:127], v11 offset:14336
v_mfma_f32_16x16x32_bf16 v[124:127], a[100:103], v[56:59], v[124:127]
ds_read_b64_tr_b16 v[52:53], v22 offset:24576
s_add_u32 m0, s48, 16384
v_mfma_f32_16x16x32_bf16 v[124:127], a[108:111], v[60:63], v[124:127]
ds_read_b64_tr_b16 v[54:55], v22 offset:25088
s_waitcnt lgkmcnt(2)
v_mfma_f32_16x16x32_bf16 v[64:67], v[32:35], a[112:115], v[64:67]
ds_read_b64_tr_b16 v[56:57], v19 offset:24576
buffer_load_dwordx4 v12, s[8:11], s62 offen offset:0 lds
v_mfma_f32_16x16x32_bf16 v[64:67], v[36:39], a[120:123], v[64:67]
ds_read_b64_tr_b16 v[58:59], v19 offset:25088
buffer_load_dwordx4 v[220:223], v1, s[36:39], s68 offen offset:0 sc1
v_mfma_f32_16x16x32_bf16 v[68:71], v[32:35], a[116:119], v[68:71]
ds_read_b64_tr_b16 v[60:61], v23 offset:24576
v_mfma_f32_16x16x32_bf16 v[68:71], v[36:39], a[124:127], v[68:71]
ds_read_b64_tr_b16 v[62:63], v23 offset:25088
v_mfma_f32_16x16x32_bf16 v[72:75], v[40:43], a[112:115], v[72:75]
ds_read_b64_tr_b16 v[32:33], v16 offset:26624
buffer_load_dwordx4 v13, s[8:11], s62 offen offset:1024 lds
v_mfma_f32_16x16x32_bf16 v[72:75], v[44:47], a[120:123], v[72:75]
ds_read_b64_tr_b16 v[34:35], v16 offset:27136
buffer_load_dwordx4 v[224:227], v1, s[36:39], s68 offen offset:1024 sc1
v_mfma_f32_16x16x32_bf16 v[76:79], v[40:43], a[116:119], v[76:79]
ds_read_b64_tr_b16 v[36:37], v20 offset:26624
v_mfma_f32_16x16x32_bf16 v[76:79], v[44:47], a[124:127], v[76:79]
ds_read_b64_tr_b16 v[38:39], v20 offset:27136
s_waitcnt lgkmcnt(8)
v_mfma_f32_16x16x32_bf16 v[80:83], v[48:51], a[112:115], v[80:83]
ds_read_b64_tr_b16 v[40:41], v17 offset:26624
buffer_load_dwordx4 v12, s[8:11], s62 offen offset:2048 lds
v_mfma_f32_16x16x32_bf16 v[80:83], v[52:55], a[120:123], v[80:83]
ds_read_b64_tr_b16 v[42:43], v17 offset:27136
s_add_u32 s50, s50, 128
v_mfma_f32_16x16x32_bf16 v[84:87], v[48:51], a[116:119], v[84:87]
ds_read_b64_tr_b16 v[44:45], v21 offset:26624
s_and_b32 s50, s50, 0x7ff
v_mfma_f32_16x16x32_bf16 v[84:87], v[52:55], a[124:127], v[84:87]
ds_read_b64_tr_b16 v[46:47], v21 offset:27136
s_waitcnt lgkmcnt(8)
v_mfma_f32_16x16x32_bf16 v[88:91], v[56:59], a[112:115], v[88:91]
ds_read_b64_tr_b16 v[48:49], v18 offset:26624
buffer_load_dwordx4 v13, s[8:11], s62 offen offset:3072 lds
v_mfma_f32_16x16x32_bf16 v[88:91], v[60:63], a[120:123], v[88:91]
ds_read_b64_tr_b16 v[50:51], v18 offset:27136
buffer_load_dwordx4 v[228:231], v1, s[36:39], s68 offen offset:2048 sc1
v_mfma_f32_16x16x32_bf16 v[92:95], v[56:59], a[116:119], v[92:95]
ds_read_b64_tr_b16 v[52:53], v22 offset:26624
s_add_u32 m0, s48, 12288
v_mfma_f32_16x16x32_bf16 v[92:95], v[60:63], a[124:127], v[92:95]
ds_read_b64_tr_b16 v[54:55], v22 offset:27136
s_waitcnt lgkmcnt(8)
v_mfma_f32_16x16x32_bf16 v[96:99], a[112:115], v[32:35], v[96:99]
ds_read_b64_tr_b16 v[56:57], v19 offset:26624
buffer_load_dwordx4 v6, s[4:7], s50 offen offset:0 lds
v_mfma_f32_16x16x32_bf16 v[96:99], a[120:123], v[36:39], v[96:99]
ds_read_b64_tr_b16 v[58:59], v19 offset:27136
buffer_load_dwordx4 v[232:235], v1, s[36:39], s68 offen offset:3072 sc1
v_mfma_f32_16x16x32_bf16 v[100:103], a[116:119], v[32:35], v[100:103]
ds_read_b64_tr_b16 v[60:61], v23 offset:26624
buffer_load_dwordx4 v[236:239], v25, s[36:39], s51 offen sc1
v_mfma_f32_16x16x32_bf16 v[100:103], a[124:127], v[36:39], v[100:103]
ds_read_b64_tr_b16 v[62:63], v23 offset:27136
s_waitcnt vmcnt(22) lgkmcnt(8)
s_barrier
v_mfma_f32_16x16x32_bf16 v[104:107], a[112:115], v[40:43], v[104:107]
ds_read_b64_tr_b16 v[32:33], v16 offset:28672
buffer_load_dwordx4 v7, s[4:7], s50 offen offset:1024 lds
v_mfma_f32_16x16x32_bf16 v[104:107], a[120:123], v[44:47], v[104:107]
ds_read_b64_tr_b16 v[34:35], v16 offset:29184
ds_read_b128 a[128:131], v10 offset:0
v_mfma_f32_16x16x32_bf16 v[108:111], a[116:119], v[40:43], v[108:111]
ds_read_b64_tr_b16 v[36:37], v20 offset:28672
v_mfma_f32_16x16x32_bf16 v[108:111], a[124:127], v[44:47], v[108:111]
ds_read_b64_tr_b16 v[38:39], v20 offset:29184
s_waitcnt lgkmcnt(9)
v_mfma_f32_16x16x32_bf16 v[112:115], a[112:115], v[48:51], v[112:115]
ds_read_b64_tr_b16 v[40:41], v17 offset:28672
buffer_load_dwordx4 v8, s[4:7], s50 offen offset:2048 lds
v_mfma_f32_16x16x32_bf16 v[112:115], a[120:123], v[52:55], v[112:115]
ds_read_b64_tr_b16 v[42:43], v17 offset:29184
ds_read_b128 a[132:135], v10 offset:2048
v_mfma_f32_16x16x32_bf16 v[116:119], a[116:119], v[48:51], v[116:119]
ds_read_b64_tr_b16 v[44:45], v21 offset:28672
ds_read_b128 a[136:139], v11 offset:0
v_mfma_f32_16x16x32_bf16 v[116:119], a[124:127], v[52:55], v[116:119]
ds_read_b64_tr_b16 v[46:47], v21 offset:29184
s_waitcnt lgkmcnt(11)
v_mfma_f32_16x16x32_bf16 v[120:123], a[112:115], v[56:59], v[120:123]
ds_read_b64_tr_b16 v[48:49], v18 offset:28672
buffer_load_dwordx4 v9, s[4:7], s50 offen offset:3072 lds
v_mfma_f32_16x16x32_bf16 v[120:123], a[120:123], v[60:63], v[120:123]
ds_read_b64_tr_b16 v[50:51], v18 offset:29184
ds_read_b128 a[140:143], v11 offset:2048
v_mfma_f32_16x16x32_bf16 v[124:127], a[116:119], v[56:59], v[124:127]
ds_read_b64_tr_b16 v[52:53], v22 offset:28672
s_add_u32 m0, s48, 20480
v_mfma_f32_16x16x32_bf16 v[124:127], a[124:127], v[60:63], v[124:127]
ds_read_b64_tr_b16 v[54:55], v22 offset:29184
s_waitcnt lgkmcnt(2)
v_mfma_f32_16x16x32_bf16 v[64:67], v[32:35], a[128:131], v[64:67]
ds_read_b64_tr_b16 v[56:57], v19 offset:28672
buffer_load_dwordx4 v12, s[8:11], s63 offen offset:0 lds
v_mfma_f32_16x16x32_bf16 v[64:67], v[36:39], a[136:139], v[64:67]
ds_read_b64_tr_b16 v[58:59], v19 offset:29184
v_mfma_f32_16x16x32_bf16 v[68:71], v[32:35], a[132:135], v[68:71]
ds_read_b64_tr_b16 v[60:61], v23 offset:28672
v_mfma_f32_16x16x32_bf16 v[68:71], v[36:39], a[140:143], v[68:71]
ds_read_b64_tr_b16 v[62:63], v23 offset:29184
v_mfma_f32_16x16x32_bf16 v[72:75], v[40:43], a[128:131], v[72:75]
ds_read_b64_tr_b16 v[32:33], v16 offset:30720
buffer_load_dwordx4 v13, s[8:11], s63 offen offset:1024 lds
v_mfma_f32_16x16x32_bf16 v[72:75], v[44:47], a[136:139], v[72:75]
ds_read_b64_tr_b16 v[34:35], v16 offset:31232
v_mfma_f32_16x16x32_bf16 v[76:79], v[40:43], a[132:135], v[76:79]
ds_read_b64_tr_b16 v[36:37], v20 offset:30720
v_mfma_f32_16x16x32_bf16 v[76:79], v[44:47], a[140:143], v[76:79]
ds_read_b64_tr_b16 v[38:39], v20 offset:31232
s_waitcnt lgkmcnt(8)
v_mfma_f32_16x16x32_bf16 v[80:83], v[48:51], a[128:131], v[80:83]
ds_read_b64_tr_b16 v[40:41], v17 offset:30720
buffer_load_dwordx4 v12, s[8:11], s63 offen offset:2048 lds
v_mfma_f32_16x16x32_bf16 v[80:83], v[52:55], a[136:139], v[80:83]
ds_read_b64_tr_b16 v[42:43], v17 offset:31232
s_add_u32 s50, s50, 128
v_mfma_f32_16x16x32_bf16 v[84:87], v[48:51], a[132:135], v[84:87]
ds_read_b64_tr_b16 v[44:45], v21 offset:30720
s_and_b32 s50, s50, 0x7ff
v_mfma_f32_16x16x32_bf16 v[84:87], v[52:55], a[140:143], v[84:87]
ds_read_b64_tr_b16 v[46:47], v21 offset:31232
s_waitcnt lgkmcnt(8)
v_mfma_f32_16x16x32_bf16 v[88:91], v[56:59], a[128:131], v[88:91]
ds_read_b64_tr_b16 v[48:49], v18 offset:30720
buffer_load_dwordx4 v13, s[8:11], s63 offen offset:3072 lds
v_mfma_f32_16x16x32_bf16 v[88:91], v[60:63], a[136:139], v[88:91]
ds_read_b64_tr_b16 v[50:51], v18 offset:31232
v_mfma_f32_16x16x32_bf16 v[92:95], v[56:59], a[132:135], v[92:95]
ds_read_b64_tr_b16 v[52:53], v22 offset:30720
s_add_u32 m0, s48, 0
v_mfma_f32_16x16x32_bf16 v[92:95], v[60:63], a[140:143], v[92:95]
ds_read_b64_tr_b16 v[54:55], v22 offset:31232
s_waitcnt lgkmcnt(8)
v_mfma_f32_16x16x32_bf16 v[96:99], a[128:131], v[32:35], v[96:99]
ds_read_b64_tr_b16 v[56:57], v19 offset:30720
buffer_load_dwordx4 v6, s[4:7], s50 offen offset:0 lds
TP3:
s_cbranch_execz TP6
TP4:
s_cbranch_execz TP20
v_mfma_f32_16x16x32_bf16 v[96:99], a[136:139], v[36:39], v[96:99]
ds_read_b64_tr_b16 v[58:59], v19 offset:31232
v_mfma_f32_16x16x32_bf16 v[100:103], a[132:135], v[32:35], v[100:103]
ds_read_b64_tr_b16 v[60:61], v23 offset:30720
v_mfma_f32_16x16x32_bf16 v[100:103], a[140:143], v[36:39], v[100:103]
ds_read_b64_tr_b16 v[62:63], v23 offset:31232
s_waitcnt vmcnt(22) lgkmcnt(8)
s_barrier
v_mfma_f32_16x16x32_bf16 v[104:107], a[128:131], v[40:43], v[104:107]
ds_read_b64_tr_b16 v[32:33], v16 offset:32768
buffer_load_dwordx4 v7, s[4:7], s50 offen offset:1024 lds
v_mfma_f32_16x16x32_bf16 v[104:107], a[136:139], v[44:47], v[104:107]
ds_read_b64_tr_b16 v[34:35], v16 offset:33280
ds_read_b128 a[144:147], v10 offset:4096
v_mfma_f32_16x16x32_bf16 v[108:111], a[132:135], v[40:43], v[108:111]
ds_read_b64_tr_b16 v[36:37], v20 offset:32768
v_mfma_f32_16x16x32_bf16 v[108:111], a[140:143], v[44:47], v[108:111]
ds_read_b64_tr_b16 v[38:39], v20 offset:33280
s_waitcnt lgkmcnt(9)
v_mfma_f32_16x16x32_bf16 v[112:115], a[128:131], v[48:51], v[112:115]
ds_read_b64_tr_b16 v[40:41], v17 offset:32768
buffer_load_dwordx4 v8, s[4:7], s50 offen offset:2048 lds
v_mfma_f32_16x16x32_bf16 v[112:115], a[136:139], v[52:55], v[112:115]
ds_read_b64_tr_b16 v[42:43], v17 offset:33280
ds_read_b128 a[148:151], v10 offset:6144
v_mfma_f32_16x16x32_bf16 v[116:119], a[132:135], v[48:51], v[116:119]
ds_read_b64_tr_b16 v[44:45], v21 offset:32768
ds_read_b128 a[152:155], v11 offset:4096
v_mfma_f32_16x16x32_bf16 v[116:119], a[140:143], v[52:55], v[116:119]
ds_read_b64_tr_b16 v[46:47], v21 offset:33280
s_waitcnt lgkmcnt(11)
v_mfma_f32_16x16x32_bf16 v[120:123], a[128:131], v[56:59], v[120:123]
ds_read_b64_tr_b16 v[48:49], v18 offset:32768
buffer_load_dwordx4 v9, s[4:7], s50 offen offset:3072 lds
v_mfma_f32_16x16x32_bf16 v[120:123], a[136:139], v[60:63], v[120:123]
ds_read_b64_tr_b16 v[50:51], v18 offset:33280
ds_read_b128 a[156:159], v11 offset:6144
v_mfma_f32_16x16x32_bf16 v[124:127], a[132:135], v[56:59], v[124:127]
ds_read_b64_tr_b16 v[52:53], v22 offset:32768
s_add_u32 m0, s48, 24576
v_mfma_f32_16x16x32_bf16 v[124:127], a[140:143], v[60:63], v[124:127]
ds_read_b64_tr_b16 v[54:55], v22 offset:33280
s_waitcnt lgkmcnt(2)
v_mfma_f32_16x16x32_bf16 v[64:67], v[32:35], a[144:147], v[64:67]
ds_read_b64_tr_b16 v[56:57], v19 offset:32768
buffer_load_dwordx4 v12, s[8:11], s64 offen offset:0 lds
v_mfma_f32_16x16x32_bf16 v[64:67], v[36:39], a[152:155], v[64:67]
ds_read_b64_tr_b16 v[58:59], v19 offset:33280
v_mfma_f32_16x16x32_bf16 v[68:71], v[32:35], a[148:151], v[68:71]
ds_read_b64_tr_b16 v[60:61], v23 offset:32768
v_mfma_f32_16x16x32_bf16 v[68:71], v[36:39], a[156:159], v[68:71]
ds_read_b64_tr_b16 v[62:63], v23 offset:33280
v_mfma_f32_16x16x32_bf16 v[72:75], v[40:43], a[144:147], v[72:75]
ds_read_b64_tr_b16 v[32:33], v16 offset:34816
buffer_load_dwordx4 v13, s[8:11], s64 offen offset:1024 lds
v_mfma_f32_16x16x32_bf16 v[72:75], v[44:47], a[152:155], v[72:75]
ds_read_b64_tr_b16 v[34:35], v16 offset:35328
v_mfma_f32_16x16x32_bf16 v[76:79], v[40:43], a[148:151], v[76:79]
ds_read_b64_tr_b16 v[36:37], v20 offset:34816
v_mfma_f32_16x16x32_bf16 v[76:79], v[44:47], a[156:159], v[76:79]
ds_read_b64_tr_b16 v[38:39], v20 offset:35328
s_waitcnt lgkmcnt(8)
v_mfma_f32_16x16x32_bf16 v[80:83], v[48:51], a[144:147], v[80:83]
ds_read_b64_tr_b16 v[40:41], v17 offset:34816
buffer_load_dwordx4 v12, s[8:11], s64 offen offset:2048 lds
v_mfma_f32_16x16x32_bf16 v[80:83], v[52:55], a[152:155], v[80:83]
ds_read_b64_tr_b16 v[42:43], v17 offset:35328
s_add_u32 s50, s50, 128
v_mfma_f32_16x16x32_bf16 v[84:87], v[48:51], a[148:151], v[84:87]
ds_read_b64_tr_b16 v[44:45], v21 offset:34816
s_and_b32 s50, s50, 0x7ff
v_mfma_f32_16x16x32_bf16 v[84:87], v[52:55], a[156:159], v[84:87]
ds_read_b64_tr_b16 v[46:47], v21 offset:35328
s_waitcnt lgkmcnt(8)
v_mfma_f32_16x16x32_bf16 v[88:91], v[56:59], a[144:147], v[88:91]
ds_read_b64_tr_b16 v[48:49], v18 offset:34816
buffer_load_dwordx4 v13, s[8:11], s64 offen offset:3072 lds
v_mfma_f32_16x16x32_bf16 v[88:91], v[60:63], a[152:155], v[88:91]
ds_read_b64_tr_b16 v[50:51], v18 offset:35328
v_mfma_f32_16x16x32_bf16 v[92:95], v[56:59], a[148:151], v[92:95]
ds_read_b64_tr_b16 v[52:53], v22 offset:34816
s_add_u32 m0, s48, 4096
v_mfma_f32_16x16x32_bf16 v[92:95], v[60:63], a[156:159], v[92:95]
ds_read_b64_tr_b16 v[54:55], v22 offset:35328
s_waitcnt lgkmcnt(8)
v_mfma_f32_16x16x32_bf16 v[96:99], a[144:147], v[32:35], v[96:99]
ds_read_b64_tr_b16 v[56:57], v19 offset:34816
buffer_load_dwordx4 v6, s[4:7], s50 offen offset:0 lds
v_mfma_f32_16x16x32_bf16 v[96:99], a[152:155], v[36:39], v[96:99]
ds_read_b64_tr_b16 v[58:59], v19 offset:35328
v_mfma_f32_16x16x32_bf16 v[100:103], a[148:151], v[32:35], v[100:103]
ds_read_b64_tr_b16 v[60:61], v23 offset:34816
v_mfma_f32_16x16x32_bf16 v[100:103], a[156:159], v[36:39], v[100:103]
ds_read_b64_tr_b16 v[62:63], v23 offset:35328
s_waitcnt vmcnt(20) lgkmcnt(8)
s_barrier
v_mfma_f32_16x16x32_bf16 v[104:107], a[144:147], v[40:43], v[104:107]
ds_read_b64_tr_b16 v[32:33], v16 offset:16384
buffer_load_dwordx4 v7, s[4:7], s50 offen offset:1024 lds
v_mfma_f32_16x16x32_bf16 v[104:107], a[152:155], v[44:47], v[104:107]
ds_read_b64_tr_b16 v[34:35], v16 offset:16896
ds_read_b128 a[160:163], v10 offset:8192
v_mfma_f32_16x16x32_bf16 v[108:111], a[148:151], v[40:43], v[108:111]
ds_read_b64_tr_b16 v[36:37], v20 offset:16384
v_bitop3_b32 v3, v223, v2, v227 bitop3:0x7e
v_mfma_f32_16x16x32_bf16 v[108:111], a[156:159], v[44:47], v[108:111]
ds_read_b64_tr_b16 v[38:39], v20 offset:16896
s_waitcnt lgkmcnt(9)
v_mfma_f32_16x16x32_bf16 v[112:115], a[144:147], v[48:51], v[112:115]
ds_read_b64_tr_b16 v[40:41], v17 offset:16384
buffer_load_dwordx4 v8, s[4:7], s50 offen offset:2048 lds
v_mfma_f32_16x16x32_bf16 v[112:115], a[152:155], v[52:55], v[112:115]
ds_read_b64_tr_b16 v[42:43], v17 offset:16896
ds_read_b128 a[164:167], v10 offset:10240
v_mfma_f32_16x16x32_bf16 v[116:119], a[148:151], v[48:51], v[116:119]
ds_read_b64_tr_b16 v[44:45], v21 offset:16384
ds_read_b128 a[168:171], v11 offset:8192
v_mfma_f32_16x16x32_bf16 v[116:119], a[156:159], v[52:55], v[116:119]
ds_read_b64_tr_b16 v[46:47], v21 offset:16896
s_waitcnt lgkmcnt(11)
v_mfma_f32_16x16x32_bf16 v[120:123], a[144:147], v[56:59], v[120:123]
ds_read_b64_tr_b16 v[48:49], v18 offset:16384
buffer_load_dwordx4 v9, s[4:7], s50 offen offset:3072 lds
v_mfma_f32_16x16x32_bf16 v[120:123], a[152:155], v[60:63], v[120:123]
ds_read_b64_tr_b16 v[50:51], v18 offset:16896
ds_read_b128 a[172:175], v11 offset:10240
v_mfma_f32_16x16x32_bf16 v[124:127], a[148:151], v[56:59], v[124:127]
ds_read_b64_tr_b16 v[52:53], v22 offset:16384
s_add_u32 m0, s48, 28672
v_mfma_f32_16x16x32_bf16 v[124:127], a[156:159], v[60:63], v[124:127]
ds_read_b64_tr_b16 v[54:55], v22 offset:16896
s_waitcnt lgkmcnt(2)
v_mfma_f32_16x16x32_bf16 v[64:67], v[32:35], a[160:163], v[64:67]
ds_read_b64_tr_b16 v[56:57], v19 offset:16384
buffer_load_dwordx4 v12, s[8:11], s65 offen offset:0 lds
v_mfma_f32_16x16x32_bf16 v[64:67], v[36:39], a[168:171], v[64:67]
ds_read_b64_tr_b16 v[58:59], v19 offset:16896
s_waitcnt vmcnt(23)
v_bitop3_b32 v3, v231, v2, v3 bitop3:0xbe
v_mfma_f32_16x16x32_bf16 v[68:71], v[32:35], a[164:167], v[68:71]
ds_read_b64_tr_b16 v[60:61], v23 offset:16384
s_waitcnt vmcnt(21)
v_bitop3_b32 v3, v235, v2, v3 bitop3:0xbe
v_mfma_f32_16x16x32_bf16 v[68:71], v[36:39], a[172:175], v[68:71]
ds_read_b64_tr_b16 v[62:63], v23 offset:16896
v_mfma_f32_16x16x32_bf16 v[72:75], v[40:43], a[160:163], v[72:75]
ds_read_b64_tr_b16 v[32:33], v16 offset:18432
buffer_load_dwordx4 v13, s[8:11], s65 offen offset:1024 lds
v_mfma_f32_16x16x32_bf16 v[72:75], v[44:47], a[168:171], v[72:75]
ds_read_b64_tr_b16 v[34:35], v16 offset:18944
s_waitcnt vmcnt(21)
v_bitop3_b32 v3, v238, v2, v3 bitop3:0xbe
v_mfma_f32_16x16x32_bf16 v[76:79], v[40:43], a[164:167], v[76:79]
ds_read_b64_tr_b16 v[36:37], v20 offset:18432
v_cmp_ne_u32 vcc, 0, v3
v_mfma_f32_16x16x32_bf16 v[76:79], v[44:47], a[172:175], v[76:79]
ds_read_b64_tr_b16 v[38:39], v20 offset:18944
s_waitcnt lgkmcnt(8)
v_mfma_f32_16x16x32_bf16 v[80:83], v[48:51], a[160:163], v[80:83]
ds_read_b64_tr_b16 v[40:41], v17 offset:18432
buffer_load_dwordx4 v12, s[8:11], s65 offen offset:2048 lds
v_mfma_f32_16x16x32_bf16 v[80:83], v[52:55], a[168:171], v[80:83]
ds_read_b64_tr_b16 v[42:43], v17 offset:18944
s_add_u32 s50, s50, 128
s_cbranch_vccnz RT_G1
RT_G1_B:
v_mfma_f32_16x16x32_bf16 v[84:87], v[48:51], a[164:167], v[84:87]
ds_read_b64_tr_b16 v[44:45], v21 offset:18432
s_and_b32 s50, s50, 0x7ff
v_mfma_f32_16x16x32_bf16 v[84:87], v[52:55], a[172:175], v[84:87]
ds_read_b64_tr_b16 v[46:47], v21 offset:18944
ds_write_b32 v27, v236
s_waitcnt lgkmcnt(9)
v_mfma_f32_16x16x32_bf16 v[88:91], v[56:59], a[160:163], v[88:91]
ds_read_b64_tr_b16 v[48:49], v18 offset:18432
buffer_load_dwordx4 v13, s[8:11], s65 offen offset:3072 lds
v_mfma_f32_16x16x32_bf16 v[88:91], v[60:63], a[168:171], v[88:91]
ds_read_b64_tr_b16 v[50:51], v18 offset:18944
ds_write_b32 v27, v237 offset:128
v_mfma_f32_16x16x32_bf16 v[92:95], v[56:59], a[164:167], v[92:95]
ds_read_b64_tr_b16 v[52:53], v22 offset:18432
s_add_u32 m0, s48, 8192
v_mfma_f32_16x16x32_bf16 v[92:95], v[60:63], a[172:175], v[92:95]
ds_read_b64_tr_b16 v[54:55], v22 offset:18944
v_add_f32 v220, v220, v224
s_waitcnt lgkmcnt(10)
v_mfma_f32_16x16x32_bf16 v[96:99], a[160:163], v[32:35], v[96:99]
ds_read_b64_tr_b16 v[56:57], v19 offset:18432
buffer_load_dwordx4 v6, s[4:7], s50 offen offset:0 lds
v_mfma_f32_16x16x32_bf16 v[96:99], a[168:171], v[36:39], v[96:99]
ds_read_b64_tr_b16 v[58:59], v19 offset:18944
v_add_f32 v221, v221, v225
v_mfma_f32_16x16x32_bf16 v[100:103], a[164:167], v[32:35], v[100:103]
ds_read_b64_tr_b16 v[60:61], v23 offset:18432
v_mfma_f32_16x16x32_bf16 v[100:103], a[172:175], v[36:39], v[100:103]
ds_read_b64_tr_b16 v[62:63], v23 offset:18944
s_waitcnt vmcnt(17) lgkmcnt(10)
s_barrier
v_mfma_f32_16x16x32_bf16 v[104:107], a[160:163], v[40:43], v[104:107]
ds_read_b64_tr_b16 v[32:33], v16 offset:20480
buffer_load_dwordx4 v7, s[4:7], s50 offen offset:1024 lds
v_mfma_f32_16x16x32_bf16 v[104:107], a[168:171], v[44:47], v[104:107]
ds_read_b64_tr_b16 v[34:35], v16 offset:20992
ds_read_b128 a[176:179], v10 offset:12288
v_add_f32 v222, v222, v226
v_mfma_f32_16x16x32_bf16 v[108:111], a[164:167], v[40:43], v[108:111]
ds_read_b64_tr_b16 v[36:37], v20 offset:20480
v_add_f32 v228, v228, v232
v_mfma_f32_16x16x32_bf16 v[108:111], a[172:175], v[44:47], v[108:111]
ds_read_b64_tr_b16 v[38:39], v20 offset:20992
s_waitcnt lgkmcnt(9)
v_mfma_f32_16x16x32_bf16 v[112:115], a[160:163], v[48:51], v[112:115]
ds_read_b64_tr_b16 v[40:41], v17 offset:20480
buffer_load_dwordx4 v8, s[4:7], s50 offen offset:2048 lds
v_mfma_f32_16x16x32_bf16 v[112:115], a[168:171], v[52:55], v[112:115]
ds_read_b64_tr_b16 v[42:43], v17 offset:20992
ds_read_b128 a[180:183], v10 offset:14336
v_add_f32 v229, v229, v233
v_mfma_f32_16x16x32_bf16 v[116:119], a[164:167], v[48:51], v[116:119]
ds_read_b64_tr_b16 v[44:45], v21 offset:20480
ds_read_b128 a[184:187], v11 offset:12288
v_add_f32 v230, v230, v234
v_mfma_f32_16x16x32_bf16 v[116:119], a[172:175], v[52:55], v[116:119]
ds_read_b64_tr_b16 v[46:47], v21 offset:20992
s_waitcnt lgkmcnt(11)
v_mfma_f32_16x16x32_bf16 v[120:123], a[160:163], v[56:59], v[120:123]
ds_read_b64_tr_b16 v[48:49], v18 offset:20480
buffer_load_dwordx4 v9, s[4:7], s50 offen offset:3072 lds
v_mfma_f32_16x16x32_bf16 v[120:123], a[168:171], v[60:63], v[120:123]
ds_read_b64_tr_b16 v[50:51], v18 offset:20992
ds_read_b128 a[188:191], v11 offset:14336
v_add_f32 v220, v220, v228
v_mfma_f32_16x16x32_bf16 v[124:127], a[164:167], v[56:59], v[124:127]
ds_read_b64_tr_b16 v[52:53], v22 offset:20480
s_add_u32 m0, s48, 32768
v_mfma_f32_16x16x32_bf16 v[124:127], a[172:175], v[60:63], v[124:127]
ds_read_b64_tr_b16 v[54:55], v22 offset:20992
v_add_f32 v221, v221, v229
s_waitcnt lgkmcnt(2)
v_mfma_f32_16x16x32_bf16 v[64:67], v[32:35], a[176:179], v[64:67]
ds_read_b64_tr_b16 v[56:57], v19 offset:20480
buffer_load_dwordx4 v12, s[8:11], s66 offen offset:0 lds
v_mfma_f32_16x16x32_bf16 v[64:67], v[36:39], a[184:187], v[64:67]
ds_read_b64_tr_b16 v[58:59], v19 offset:20992
v_add_f32 v222, v222, v230
v_mfma_f32_16x16x32_bf16 v[68:71], v[32:35], a[180:183], v[68:71]
ds_read_b64_tr_b16 v[60:61], v23 offset:20480
v_mfma_f32_16x16x32_bf16 v[68:71], v[36:39], a[188:191], v[68:71]
ds_read_b64_tr_b16 v[62:63], v23 offset:20992
v_mov_b32 v224, v220
v_mfma_f32_16x16x32_bf16 v[72:75], v[40:43], a[176:179], v[72:75]
ds_read_b64_tr_b16 v[32:33], v16 offset:22528
buffer_load_dwordx4 v13, s[8:11], s66 offen offset:1024 lds
v_mfma_f32_16x16x32_bf16 v[72:75], v[44:47], a[184:187], v[72:75]
ds_read_b64_tr_b16 v[34:35], v16 offset:23040
v_mov_b32 v225, v221
v_mfma_f32_16x16x32_bf16 v[76:79], v[40:43], a[180:183], v[76:79]
ds_read_b64_tr_b16 v[36:37], v20 offset:22528
v_mfma_f32_16x16x32_bf16 v[76:79], v[44:47], a[188:191], v[76:79]
ds_read_b64_tr_b16 v[38:39], v20 offset:23040
v_mov_b32 v226, v222
s_waitcnt lgkmcnt(8)
v_mfma_f32_16x16x32_bf16 v[80:83], v[48:51], a[176:179], v[80:83]
ds_read_b64_tr_b16 v[40:41], v17 offset:22528
buffer_load_dwordx4 v12, s[8:11], s66 offen offset:2048 lds
v_mfma_f32_16x16x32_bf16 v[80:83], v[52:55], a[184:187], v[80:83]
ds_read_b64_tr_b16 v[42:43], v17 offset:23040
s_add_u32 s50, s50, 128
v_mfma_f32_16x16x32_bf16 v[84:87], v[48:51], a[180:183], v[84:87]
ds_read_b64_tr_b16 v[44:45], v21 offset:22528
s_and_b32 s50, s50, 0x7ff
v_permlane16_swap_b32 v224, v220
v_mfma_f32_16x16x32_bf16 v[84:87], v[52:55], a[188:191], v[84:87]
ds_read_b64_tr_b16 v[46:47], v21 offset:23040
s_waitcnt lgkmcnt(8)
v_mfma_f32_16x16x32_bf16 v[88:91], v[56:59], a[176:179], v[88:91]
ds_read_b64_tr_b16 v[48:49], v18 offset:22528
buffer_load_dwordx4 v13, s[8:11], s66 offen offset:3072 lds
v_mfma_f32_16x16x32_bf16 v[88:91], v[60:63], a[184:187], v[88:91]
ds_read_b64_tr_b16 v[50:51], v18 offset:23040
v_permlane16_swap_b32 v225, v221
v_mfma_f32_16x16x32_bf16 v[92:95], v[56:59], a[180:183], v[92:95]
ds_read_b64_tr_b16 v[52:53], v22 offset:22528
s_add_u32 m0, s48, 12288
v_permlane16_swap_b32 v226, v222
v_mfma_f32_16x16x32_bf16 v[92:95], v[60:63], a[188:191], v[92:95]
ds_read_b64_tr_b16 v[54:55], v22 offset:23040
s_waitcnt lgkmcnt(8)
v_mfma_f32_16x16x32_bf16 v[96:99], a[176:179], v[32:35], v[96:99]
ds_read_b64_tr_b16 v[56:57], v19 offset:22528
buffer_load_dwordx4 v6, s[4:7], s50 offen offset:0 lds
v_mfma_f32_16x16x32_bf16 v[96:99], a[184:187], v[36:39], v[96:99]
ds_read_b64_tr_b16 v[58:59], v19 offset:23040
v_add_f32 v220, v224, v220
v_mfma_f32_16x16x32_bf16 v[100:103], a[180:183], v[32:35], v[100:103]
ds_read_b64_tr_b16 v[60:61], v23 offset:22528
v_mfma_f32_16x16x32_bf16 v[100:103], a[188:191], v[36:39], v[100:103]
ds_read_b64_tr_b16 v[62:63], v23 offset:23040
s_waitcnt vmcnt(17) lgkmcnt(8)
s_barrier
v_mfma_f32_16x16x32_bf16 v[104:107], a[176:179], v[40:43], v[104:107]
ds_read_b64_tr_b16 v[32:33], v16 offset:24576
buffer_load_dwordx4 v7, s[4:7], s50 offen offset:1024 lds
v_mfma_f32_16x16x32_bf16 v[104:107], a[184:187], v[44:47], v[104:107]
ds_read_b64_tr_b16 v[34:35], v16 offset:25088
ds_read_b128 a[192:195], v10 offset:0
v_add_f32 v221, v225, v221
v_mfma_f32_16x16x32_bf16 v[108:111], a[180:183], v[40:43], v[108:111]
ds_read_b64_tr_b16 v[36:37], v20 offset:24576
v_add_f32 v222, v226, v222
v_mfma_f32_16x16x32_bf16 v[108:111], a[188:191], v[44:47], v[108:111]
ds_read_b64_tr_b16 v[38:39], v20 offset:25088
v_mov_b32 v224, v220
s_waitcnt lgkmcnt(9)
v_mfma_f32_16x16x32_bf16 v[112:115], a[176:179], v[48:51], v[112:115]
ds_read_b64_tr_b16 v[40:41], v17 offset:24576
buffer_load_dwordx4 v8, s[4:7], s50 offen offset:2048 lds
v_mfma_f32_16x16x32_bf16 v[112:115], a[184:187], v[52:55], v[112:115]
ds_read_b64_tr_b16 v[42:43], v17 offset:25088
ds_read_b128 a[196:199], v10 offset:2048
v_mov_b32 v225, v221
v_mfma_f32_16x16x32_bf16 v[116:119], a[180:183], v[48:51], v[116:119]
ds_read_b64_tr_b16 v[44:45], v21 offset:24576
ds_read_b128 a[200:203], v11 offset:0
v_mfma_f32_16x16x32_bf16 v[116:119], a[188:191], v[52:55], v[116:119]
ds_read_b64_tr_b16 v[46:47], v21 offset:25088
v_mov_b32 v226, v222
s_waitcnt lgkmcnt(11)
v_mfma_f32_16x16x32_bf16 v[120:123], a[176:179], v[56:59], v[120:123]
ds_read_b64_tr_b16 v[48:49], v18 offset:24576
buffer_load_dwordx4 v9, s[4:7], s50 offen offset:3072 lds
v_mfma_f32_16x16x32_bf16 v[120:123], a[184:187], v[60:63], v[120:123]
ds_read_b64_tr_b16 v[50:51], v18 offset:25088
ds_read_b128 a[204:207], v11 offset:2048
v_mfma_f32_16x16x32_bf16 v[124:127], a[180:183], v[56:59], v[124:127]
ds_read_b64_tr_b16 v[52:53], v22 offset:24576
s_add_u32 m0, s48, 16384
v_permlane32_swap_b32 v224, v220
v_mfma_f32_16x16x32_bf16 v[124:127], a[188:191], v[60:63], v[124:127]
ds_read_b64_tr_b16 v[54:55], v22 offset:25088
s_waitcnt lgkmcnt(2)
v_mfma_f32_16x16x32_bf16 v[64:67], v[32:35], a[192:195], v[64:67]
ds_read_b64_tr_b16 v[56:57], v19 offset:24576
buffer_load_dwordx4 v12, s[8:11], s67 offen offset:0 lds
v_mfma_f32_16x16x32_bf16 v[64:67], v[36:39], a[200:203], v[64:67]
ds_read_b64_tr_b16 v[58:59], v19 offset:25088
v_permlane32_swap_b32 v225, v221
v_mfma_f32_16x16x32_bf16 v[68:71], v[32:35], a[196:199], v[68:71]
ds_read_b64_tr_b16 v[60:61], v23 offset:24576
v_permlane32_swap_b32 v226, v222
v_mfma_f32_16x16x32_bf16 v[68:71], v[36:39], a[204:207], v[68:71]
ds_read_b64_tr_b16 v[62:63], v23 offset:25088
v_mfma_f32_16x16x32_bf16 v[72:75], v[40:43], a[192:195], v[72:75]
ds_read_b64_tr_b16 v[32:33], v16 offset:26624
buffer_load_dwordx4 v13, s[8:11], s67 offen offset:1024 lds
v_mfma_f32_16x16x32_bf16 v[72:75], v[44:47], a[200:203], v[72:75]
ds_read_b64_tr_b16 v[34:35], v16 offset:27136
v_add_f32 v220, v224, v220
v_mfma_f32_16x16x32_bf16 v[76:79], v[40:43], a[196:199], v[76:79]
ds_read_b64_tr_b16 v[36:37], v20 offset:26624
v_add_f32 v221, v225, v221
v_mfma_f32_16x16x32_bf16 v[76:79], v[44:47], a[204:207], v[76:79]
ds_read_b64_tr_b16 v[38:39], v20 offset:27136
s_waitcnt lgkmcnt(8)
v_mfma_f32_16x16x32_bf16 v[80:83], v[48:51], a[192:195], v[80:83]
ds_read_b64_tr_b16 v[40:41], v17 offset:26624
buffer_load_dwordx4 v12, s[8:11], s67 offen offset:2048 lds
v_mfma_f32_16x16x32_bf16 v[80:83], v[52:55], a[200:203], v[80:83]
ds_read_b64_tr_b16 v[42:43], v17 offset:27136
v_add_f32 v222, v226, v222
v_mfma_f32_16x16x32_bf16 v[84:87], v[48:51], a[196:199], v[84:87]
ds_read_b64_tr_b16 v[44:45], v21 offset:26624
v_mfma_f32_16x16x32_bf16 v[84:87], v[52:55], a[204:207], v[84:87]
ds_read_b64_tr_b16 v[46:47], v21 offset:27136
ds_write_b32 v26, v220 offset:38912
s_waitcnt lgkmcnt(9)
v_mfma_f32_16x16x32_bf16 v[88:91], v[56:59], a[192:195], v[88:91]
ds_read_b64_tr_b16 v[48:49], v18 offset:26624
buffer_load_dwordx4 v13, s[8:11], s67 offen offset:3072 lds
v_mfma_f32_16x16x32_bf16 v[88:91], v[60:63], a[200:203], v[88:91]
ds_read_b64_tr_b16 v[50:51], v18 offset:27136
ds_write_b32 v26, v221 offset:38976
v_mfma_f32_16x16x32_bf16 v[92:95], v[56:59], a[196:199], v[92:95]
ds_read_b64_tr_b16 v[52:53], v22 offset:26624
s_add_u32 m0, s48, 0
v_mfma_f32_16x16x32_bf16 v[92:95], v[60:63], a[204:207], v[92:95]
ds_read_b64_tr_b16 v[54:55], v22 offset:27136
ds_write_b32 v26, v222 offset:39040
s_waitcnt lgkmcnt(11)
v_mfma_f32_16x16x32_bf16 v[96:99], a[192:195], v[32:35], v[96:99]
ds_read_b64_tr_b16 v[56:57], v19 offset:26624
buffer_load_dwordx4 v14, s[8:11], s53 offen offset:0 lds
v_mfma_f32_16x16x32_bf16 v[96:99], a[200:203], v[36:39], v[96:99]
ds_read_b64_tr_b16 v[58:59], v19 offset:27136
v_mfma_f32_16x16x32_bf16 v[100:103], a[196:199], v[32:35], v[100:103]
ds_read_b64_tr_b16 v[60:61], v23 offset:26624
v_mfma_f32_16x16x32_bf16 v[100:103], a[204:207], v[36:39], v[100:103]
ds_read_b64_tr_b16 v[62:63], v23 offset:27136
s_waitcnt vmcnt(17) lgkmcnt(0)
s_barrier
v_mfma_f32_16x16x32_bf16 v[104:107], a[192:195], v[40:43], v[104:107]
ds_read_b64_tr_b16 v[32:33], v16 offset:28672
buffer_load_dwordx4 v15, s[8:11], s53 offen offset:1024 lds
v_mfma_f32_16x16x32_bf16 v[104:107], a[200:203], v[44:47], v[104:107]
ds_read_b64_tr_b16 v[34:35], v16 offset:29184
ds_read_b128 a[208:211], v10 offset:4096
v_mfma_f32_16x16x32_bf16 v[108:111], a[196:199], v[40:43], v[108:111]
ds_read_b64_tr_b16 v[36:37], v20 offset:28672
s_add_u32 m0, s48, 2048
v_mfma_f32_16x16x32_bf16 v[108:111], a[204:207], v[44:47], v[108:111]
ds_read_b64_tr_b16 v[38:39], v20 offset:29184
v_mfma_f32_16x16x32_bf16 v[112:115], a[192:195], v[48:51], v[112:115]
ds_read_b64_tr_b16 v[40:41], v17 offset:28672
buffer_load_dwordx4 v14, s[8:11], s54 offen offset:0 lds
v_mfma_f32_16x16x32_bf16 v[112:115], a[200:203], v[52:55], v[112:115]
ds_read_b64_tr_b16 v[42:43], v17 offset:29184
ds_read_b128 a[212:215], v10 offset:6144
v_mfma_f32_16x16x32_bf16 v[116:119], a[196:199], v[48:51], v[116:119]
ds_read_b64_tr_b16 v[44:45], v21 offset:28672
ds_read_b128 a[216:219], v11 offset:4096
v_mfma_f32_16x16x32_bf16 v[116:119], a[204:207], v[52:55], v[116:119]
ds_read_b64_tr_b16 v[46:47], v21 offset:29184
v_mfma_f32_16x16x32_bf16 v[120:123], a[192:195], v[56:59], v[120:123]
ds_read_b64_tr_b16 v[48:49], v18 offset:28672
buffer_load_dwordx4 v15, s[8:11], s54 offen offset:1024 lds
v_mfma_f32_16x16x32_bf16 v[120:123], a[200:203], v[60:63], v[120:123]
ds_read_b64_tr_b16 v[50:51], v18 offset:29184
ds_read_b128 a[220:223], v11 offset:6144
v_mfma_f32_16x16x32_bf16 v[124:127], a[196:199], v[56:59], v[124:127]
ds_read_b64_tr_b16 v[52:53], v22 offset:28672
s_add_u32 m0, s48, 20480
v_mfma_f32_16x16x32_bf16 v[124:127], a[204:207], v[60:63], v[124:127]
ds_read_b64_tr_b16 v[54:55], v22 offset:29184
s_waitcnt lgkmcnt(2)
v_mfma_f32_16x16x32_bf16 v[64:67], v[32:35], a[208:211], v[64:67]
ds_read_b64_tr_b16 v[56:57], v19 offset:28672
buffer_load_dwordx4 v14, s[8:11], s55 offen offset:0 lds
v_mfma_f32_16x16x32_bf16 v[64:67], v[36:39], a[216:219], v[64:67]
ds_read_b64_tr_b16 v[58:59], v19 offset:29184
ds_read2_b32 v[212:213], v30 offset0:0 offset1:4
v_mfma_f32_16x16x32_bf16 v[68:71], v[32:35], a[212:215], v[68:71]
ds_read_b64_tr_b16 v[60:61], v23 offset:28672
ds_read2_b32 v[214:215], v30 offset0:32 offset1:36
v_mfma_f32_16x16x32_bf16 v[68:71], v[36:39], a[220:223], v[68:71]
ds_read_b64_tr_b16 v[62:63], v23 offset:29184
v_mfma_f32_16x16x32_bf16 v[72:75], v[40:43], a[208:211], v[72:75]
ds_read_b64_tr_b16 v[32:33], v16 offset:30720
buffer_load_dwordx4 v15, s[8:11], s55 offen offset:1024 lds
v_mfma_f32_16x16x32_bf16 v[72:75], v[44:47], a[216:219], v[72:75]
ds_read_b64_tr_b16 v[34:35], v16 offset:31232
ds_read_b128 v[160:163], v28 offset:39168
v_mfma_f32_16x16x32_bf16 v[76:79], v[40:43], a[212:215], v[76:79]
ds_read_b64_tr_b16 v[36:37], v20 offset:30720
s_add_u32 m0, s48, 22528
v_mfma_f32_16x16x32_bf16 v[76:79], v[44:47], a[220:223], v[76:79]
ds_read_b64_tr_b16 v[38:39], v20 offset:31232
s_waitcnt lgkmcnt(11)
v_mfma_f32_16x16x32_bf16 v[80:83], v[48:51], a[208:211], v[80:83]
ds_read_b64_tr_b16 v[40:41], v17 offset:30720
buffer_load_dwordx4 v14, s[8:11], s56 offen offset:0 lds
v_mfma_f32_16x16x32_bf16 v[80:83], v[52:55], a[216:219], v[80:83]
ds_read_b64_tr_b16 v[42:43], v17 offset:31232
ds_read_b128 v[164:167], v28 offset:39232
v_mfma_f32_16x16x32_bf16 v[84:87], v[48:51], a[212:215], v[84:87]
ds_read_b64_tr_b16 v[44:45], v21 offset:30720
ds_read_b128 v[168:171], v28 offset:39296
v_mfma_f32_16x16x32_bf16 v[84:87], v[52:55], a[220:223], v[84:87]
ds_read_b64_tr_b16 v[46:47], v21 offset:31232
s_waitcnt lgkmcnt(11)
v_mfma_f32_16x16x32_bf16 v[88:91], v[56:59], a[208:211], v[88:91]
ds_read_b64_tr_b16 v[48:49], v18 offset:30720
buffer_load_dwordx4 v15, s[8:11], s56 offen offset:1024 lds
v_mfma_f32_16x16x32_bf16 v[88:91], v[60:63], a[216:219], v[88:91]
ds_read_b64_tr_b16 v[50:51], v18 offset:31232
v_mfma_f32_16x16x32_bf16 v[92:95], v[56:59], a[212:215], v[92:95]
ds_read_b64_tr_b16 v[52:53], v22 offset:30720
s_add_u32 m0, s48, 4096
v_mfma_f32_16x16x32_bf16 v[92:95], v[60:63], a[220:223], v[92:95]
ds_read_b64_tr_b16 v[54:55], v22 offset:31232
s_waitcnt lgkmcnt(10)
v_mfma_f32_16x16x32_bf16 v[96:99], a[208:211], v[32:35], v[96:99]
ds_read_b64_tr_b16 v[56:57], v19 offset:30720
buffer_load_dwordx4 v14, s[8:11], s57 offen offset:0 lds
v_mfma_f32_16x16x32_bf16 v[96:99], a[216:219], v[36:39], v[96:99]
ds_read_b64_tr_b16 v[58:59], v19 offset:31232
ds_read_b128 v[172:175], v28 offset:39360
v_mfma_f32_16x16x32_bf16 v[100:103], a[212:215], v[32:35], v[100:103]
ds_read_b64_tr_b16 v[60:61], v23 offset:30720
v_mfma_f32_16x16x32_bf16 v[100:103], a[220:223], v[36:39], v[100:103]
ds_read_b64_tr_b16 v[62:63], v23 offset:31232
s_waitcnt vmcnt(17) lgkmcnt(9)
s_barrier
v_mfma_f32_16x16x32_bf16 v[104:107], a[208:211], v[40:43], v[104:107]
ds_read_b64_tr_b16 v[32:33], v16 offset:32768
buffer_load_dwordx4 v15, s[8:11], s57 offen offset:1024 lds
v_mfma_f32_16x16x32_bf16 v[104:107], a[216:219], v[44:47], v[104:107]
ds_read_b64_tr_b16 v[34:35], v16 offset:33280
ds_read_b128 a[224:227], v10 offset:8192
v_mfma_f32_16x16x32_bf16 v[108:111], a[212:215], v[40:43], v[108:111]
ds_read_b64_tr_b16 v[36:37], v20 offset:32768
s_add_u32 m0, s48, 6144
v_mfma_f32_16x16x32_bf16 v[108:111], a[220:223], v[44:47], v[108:111]
ds_read_b64_tr_b16 v[38:39], v20 offset:33280
s_waitcnt lgkmcnt(10)
v_mfma_f32_16x16x32_bf16 v[112:115], a[208:211], v[48:51], v[112:115]
ds_read_b64_tr_b16 v[40:41], v17 offset:32768
buffer_load_dwordx4 v14, s[8:11], s58 offen offset:0 lds
v_mfma_f32_16x16x32_bf16 v[112:115], a[216:219], v[52:55], v[112:115]
ds_read_b64_tr_b16 v[42:43], v17 offset:33280
ds_read_b128 a[228:231], v10 offset:10240
v_mfma_f32_16x16x32_bf16 v[116:119], a[212:215], v[48:51], v[116:119]
ds_read_b64_tr_b16 v[44:45], v21 offset:32768
ds_read_b128 a[232:235], v11 offset:8192
v_mfma_f32_16x16x32_bf16 v[116:119], a[220:223], v[52:55], v[116:119]
ds_read_b64_tr_b16 v[46:47], v21 offset:33280
s_waitcnt lgkmcnt(11)
v_mfma_f32_16x16x32_bf16 v[120:123], a[208:211], v[56:59], v[120:123]
ds_read_b64_tr_b16 v[48:49], v18 offset:32768
buffer_load_dwordx4 v15, s[8:11], s58 offen offset:1024 lds
v_mfma_f32_16x16x32_bf16 v[120:123], a[216:219], v[60:63], v[120:123]
ds_read_b64_tr_b16 v[50:51], v18 offset:33280
ds_read_b128 a[236:239], v11 offset:10240
v_mfma_f32_16x16x32_bf16 v[124:127], a[212:215], v[56:59], v[124:127]
ds_read_b64_tr_b16 v[52:53], v22 offset:32768
s_add_u32 m0, s48, 24576
v_mfma_f32_16x16x32_bf16 v[124:127], a[220:223], v[60:63], v[124:127]
ds_read_b64_tr_b16 v[54:55], v22 offset:33280
s_waitcnt lgkmcnt(2)
v_mfma_f32_16x16x32_bf16 v[64:67], v[32:35], a[224:227], v[64:67]
ds_read_b64_tr_b16 v[56:57], v19 offset:32768
buffer_load_dwordx4 v14, s[8:11], s59 offen offset:0 lds
v_mfma_f32_16x16x32_bf16 v[64:67], v[36:39], a[232:235], v[64:67]
ds_read_b64_tr_b16 v[58:59], v19 offset:33280
ds_read_b128 v[196:199], v31 offset:0
v_mfma_f32_16x16x32_bf16 v[68:71], v[32:35], a[228:231], v[68:71]
ds_read_b64_tr_b16 v[60:61], v23 offset:32768
ds_read_b128 v[200:203], v31 offset:16
v_mfma_f32_16x16x32_bf16 v[68:71], v[36:39], a[236:239], v[68:71]
ds_read_b64_tr_b16 v[62:63], v23 offset:33280
v_mfma_f32_16x16x32_bf16 v[72:75], v[40:43], a[224:227], v[72:75]
ds_read_b64_tr_b16 v[32:33], v16 offset:34816
buffer_load_dwordx4 v15, s[8:11], s59 offen offset:1024 lds
v_mfma_f32_16x16x32_bf16 v[72:75], v[44:47], a[232:235], v[72:75]
ds_read_b64_tr_b16 v[34:35], v16 offset:35328
ds_read_b128 v[204:207], v31 offset:128
v_mfma_f32_16x16x32_bf16 v[76:79], v[40:43], a[228:231], v[76:79]
ds_read_b64_tr_b16 v[36:37], v20 offset:34816
s_add_u32 m0, s48, 26624
v_mfma_f32_16x16x32_bf16 v[76:79], v[44:47], a[236:239], v[76:79]
ds_read_b64_tr_b16 v[38:39], v20 offset:35328
TP5:
s_cbranch_execz TP10
TP6:
s_cbranch_execz TP25
s_waitcnt lgkmcnt(11)
v_mfma_f32_16x16x32_bf16 v[80:83], v[48:51], a[224:227], v[80:83]
ds_read_b64_tr_b16 v[40:41], v17 offset:34816
buffer_load_dwordx4 v14, s[8:11], s60 offen offset:0 lds
v_mfma_f32_16x16x32_bf16 v[80:83], v[52:55], a[232:235], v[80:83]
ds_read_b64_tr_b16 v[42:43], v17 offset:35328
ds_read_b128 v[208:211], v31 offset:144
v_mfma_f32_16x16x32_bf16 v[84:87], v[48:51], a[228:231], v[84:87]
ds_read_b64_tr_b16 v[44:45], v21 offset:34816
ds_read_b32 v192, v29 offset:39424
v_mfma_f32_16x16x32_bf16 v[84:87], v[52:55], a[236:239], v[84:87]
ds_read_b64_tr_b16 v[46:47], v21 offset:35328
s_waitcnt lgkmcnt(11)
v_mfma_f32_16x16x32_bf16 v[88:91], v[56:59], a[224:227], v[88:91]
ds_read_b64_tr_b16 v[48:49], v18 offset:34816
buffer_load_dwordx4 v15, s[8:11], s60 offen offset:1024 lds
v_mfma_f32_16x16x32_bf16 v[88:91], v[60:63], a[232:235], v[88:91]
ds_read_b64_tr_b16 v[50:51], v18 offset:35328
ds_read_b32 v193, v29 offset:39488
v_mfma_f32_16x16x32_bf16 v[92:95], v[56:59], a[228:231], v[92:95]
ds_read_b64_tr_b16 v[52:53], v22 offset:34816
s_add_u32 m0, s48, 8192
v_mfma_f32_16x16x32_bf16 v[92:95], v[60:63], a[236:239], v[92:95]
ds_read_b64_tr_b16 v[54:55], v22 offset:35328
s_waitcnt lgkmcnt(11)
v_mfma_f32_16x16x32_bf16 v[96:99], a[224:227], v[32:35], v[96:99]
ds_read_b64_tr_b16 v[56:57], v19 offset:34816
buffer_load_dwordx4 v14, s[8:11], s61 offen offset:0 lds
v_mfma_f32_16x16x32_bf16 v[96:99], a[232:235], v[36:39], v[96:99]
ds_read_b64_tr_b16 v[58:59], v19 offset:35328
v_mfma_f32_16x16x32_bf16 v[100:103], a[228:231], v[32:35], v[100:103]
ds_read_b64_tr_b16 v[60:61], v23 offset:34816
v_mfma_f32_16x16x32_bf16 v[100:103], a[236:239], v[36:39], v[100:103]
ds_read_b64_tr_b16 v[62:63], v23 offset:35328
s_waitcnt vmcnt(17) lgkmcnt(9)
s_barrier
v_mfma_f32_16x16x32_bf16 v[104:107], a[224:227], v[40:43], v[104:107]
ds_read_b64_tr_b16 v[32:33], v16 offset:16384
buffer_load_dwordx4 v15, s[8:11], s61 offen offset:1024 lds
v_mfma_f32_16x16x32_bf16 v[104:107], a[232:235], v[44:47], v[104:107]
ds_read_b64_tr_b16 v[34:35], v16 offset:16896
ds_read_b128 a[240:243], v10 offset:12288
v_mfma_f32_16x16x32_bf16 v[108:111], a[228:231], v[40:43], v[108:111]
ds_read_b64_tr_b16 v[36:37], v20 offset:16384
s_add_u32 m0, s48, 10240
v_mfma_f32_16x16x32_bf16 v[108:111], a[236:239], v[44:47], v[108:111]
ds_read_b64_tr_b16 v[38:39], v20 offset:16896
s_waitcnt lgkmcnt(9)
v_mfma_f32_16x16x32_bf16 v[112:115], a[224:227], v[48:51], v[112:115]
ds_read_b64_tr_b16 v[40:41], v17 offset:16384
buffer_load_dwordx4 v14, s[8:11], s62 offen offset:0 lds
v_mfma_f32_16x16x32_bf16 v[112:115], a[232:235], v[52:55], v[112:115]
ds_read_b64_tr_b16 v[42:43], v17 offset:16896
ds_read_b128 a[244:247], v10 offset:14336
v_mfma_f32_16x16x32_bf16 v[116:119], a[228:231], v[48:51], v[116:119]
ds_read_b64_tr_b16 v[44:45], v21 offset:16384
ds_read_b128 a[248:251], v11 offset:12288
v_mfma_f32_16x16x32_bf16 v[116:119], a[236:239], v[52:55], v[116:119]
ds_read_b64_tr_b16 v[46:47], v21 offset:16896
s_waitcnt lgkmcnt(11)
v_mfma_f32_16x16x32_bf16 v[120:123], a[224:227], v[56:59], v[120:123]
ds_read_b64_tr_b16 v[48:49], v18 offset:16384
buffer_load_dwordx4 v15, s[8:11], s62 offen offset:1024 lds
v_mfma_f32_16x16x32_bf16 v[120:123], a[232:235], v[60:63], v[120:123]
ds_read_b64_tr_b16 v[50:51], v18 offset:16896
ds_read_b128 a[252:255], v11 offset:14336
v_mfma_f32_16x16x32_bf16 v[124:127], a[228:231], v[56:59], v[124:127]
ds_read_b64_tr_b16 v[52:53], v22 offset:16384
s_add_u32 m0, s48, 28672
v_mfma_f32_16x16x32_bf16 v[124:127], a[236:239], v[60:63], v[124:127]
ds_read_b64_tr_b16 v[54:55], v22 offset:16896
s_waitcnt lgkmcnt(2)
v_mfma_f32_16x16x32_bf16 v[64:67], v[32:35], a[240:243], v[64:67]
ds_read_b64_tr_b16 v[56:57], v19 offset:16384
buffer_load_dwordx4 v14, s[8:11], s63 offen offset:0 lds
v_mfma_f32_16x16x32_bf16 v[64:67], v[36:39], a[248:251], v[64:67]
ds_read_b64_tr_b16 v[58:59], v19 offset:16896
ds_read_b32 v194, v29 offset:39552
v_mfma_f32_16x16x32_bf16 v[68:71], v[32:35], a[244:247], v[68:71]
ds_read_b64_tr_b16 v[60:61], v23 offset:16384
ds_read_b32 v195, v29 offset:39616
v_mfma_f32_16x16x32_bf16 v[68:71], v[36:39], a[252:255], v[68:71]
ds_read_b64_tr_b16 v[62:63], v23 offset:16896
v_mfma_f32_16x16x32_bf16 v[72:75], v[40:43], a[240:243], v[72:75]
ds_read_b64_tr_b16 v[32:33], v16 offset:18432
buffer_load_dwordx4 v15, s[8:11], s63 offen offset:1024 lds
v_mfma_f32_16x16x32_bf16 v[72:75], v[44:47], a[248:251], v[72:75]
ds_read_b64_tr_b16 v[34:35], v16 offset:18944
s_lshl_b32 s68, s43, 19
v_mfma_f32_16x16x32_bf16 v[76:79], v[40:43], a[244:247], v[76:79]
ds_read_b64_tr_b16 v[36:37], v20 offset:18432
s_add_u32 m0, s48, 30720
v_mfma_f32_16x16x32_bf16 v[76:79], v[44:47], a[252:255], v[76:79]
ds_read_b64_tr_b16 v[38:39], v20 offset:18944
s_waitcnt lgkmcnt(10)
v_mfma_f32_16x16x32_bf16 v[80:83], v[48:51], a[240:243], v[80:83]
ds_read_b64_tr_b16 v[40:41], v17 offset:18432
buffer_load_dwordx4 v14, s[8:11], s64 offen offset:0 lds
v_mfma_f32_16x16x32_bf16 v[80:83], v[52:55], a[248:251], v[80:83]
ds_read_b64_tr_b16 v[42:43], v17 offset:18944
s_lshl_b32 s3, s46, 12
v_mfma_f32_16x16x32_bf16 v[84:87], v[48:51], a[244:247], v[84:87]
ds_read_b64_tr_b16 v[44:45], v21 offset:18432
s_add_u32 s68, s68, s3
v_mfma_f32_16x16x32_bf16 v[84:87], v[52:55], a[252:255], v[84:87]
ds_read_b64_tr_b16 v[46:47], v21 offset:18944
s_waitcnt lgkmcnt(8)
v_mfma_f32_16x16x32_bf16 v[88:91], v[56:59], a[240:243], v[88:91]
ds_read_b64_tr_b16 v[48:49], v18 offset:18432
buffer_load_dwordx4 v15, s[8:11], s64 offen offset:1024 lds
v_mfma_f32_16x16x32_bf16 v[88:91], v[60:63], a[248:251], v[88:91]
ds_read_b64_tr_b16 v[50:51], v18 offset:18944
s_add_u32 s68, s68, 4194304
v_mfma_f32_16x16x32_bf16 v[92:95], v[56:59], a[244:247], v[92:95]
ds_read_b64_tr_b16 v[52:53], v22 offset:18432
s_add_u32 m0, s48, 12288
v_mfma_f32_16x16x32_bf16 v[92:95], v[60:63], a[252:255], v[92:95]
ds_read_b64_tr_b16 v[54:55], v22 offset:18944
s_waitcnt lgkmcnt(8)
v_mfma_f32_16x16x32_bf16 v[96:99], a[240:243], v[32:35], v[96:99]
ds_read_b64_tr_b16 v[56:57], v19 offset:18432
buffer_load_dwordx4 v14, s[8:11], s65 offen offset:0 lds
v_mfma_f32_16x16x32_bf16 v[96:99], a[248:251], v[36:39], v[96:99]
ds_read_b64_tr_b16 v[58:59], v19 offset:18944
v_mfma_f32_16x16x32_bf16 v[100:103], a[244:247], v[32:35], v[100:103]
ds_read_b64_tr_b16 v[60:61], v23 offset:18432
s_add_u32 s69, s68, 262144
v_mfma_f32_16x16x32_bf16 v[100:103], a[252:255], v[36:39], v[100:103]
ds_read_b64_tr_b16 v[62:63], v23 offset:18944
s_waitcnt vmcnt(13) lgkmcnt(8)
s_barrier
v_mfma_f32_16x16x32_bf16 v[104:107], a[240:243], v[40:43], v[104:107]
ds_read_b64_tr_b16 v[32:33], v16 offset:36864
buffer_load_dwordx4 v15, s[8:11], s65 offen offset:1024 lds
v_mfma_f32_16x16x32_bf16 v[104:107], a[248:251], v[44:47], v[104:107]
ds_read_b64_tr_b16 v[34:35], v16 offset:37376
v_mfma_f32_16x16x32_bf16 v[108:111], a[244:247], v[40:43], v[108:111]
ds_read_b64_tr_b16 v[36:37], v20 offset:36864
s_add_u32 m0, s48, 14336
v_mfma_f32_16x16x32_bf16 v[108:111], a[252:255], v[44:47], v[108:111]
ds_read_b64_tr_b16 v[38:39], v20 offset:37376
s_waitcnt lgkmcnt(8)
v_mfma_f32_16x16x32_bf16 v[112:115], a[240:243], v[48:51], v[112:115]
ds_read_b64_tr_b16 v[40:41], v17 offset:36864
buffer_load_dwordx4 v14, s[8:11], s66 offen offset:0 lds
v_mfma_f32_16x16x32_bf16 v[112:115], a[248:251], v[52:55], v[112:115]
ds_read_b64_tr_b16 v[42:43], v17 offset:37376
v_mfma_f32_16x16x32_bf16 v[116:119], a[244:247], v[48:51], v[116:119]
ds_read_b64_tr_b16 v[44:45], v21 offset:36864
v_mfma_f32_16x16x32_bf16 v[116:119], a[252:255], v[52:55], v[116:119]
ds_read_b64_tr_b16 v[46:47], v21 offset:37376
s_waitcnt lgkmcnt(8)
v_mfma_f32_16x16x32_bf16 v[120:123], a[240:243], v[56:59], v[120:123]
ds_read_b64_tr_b16 v[48:49], v18 offset:36864
buffer_load_dwordx4 v15, s[8:11], s66 offen offset:1024 lds
v_mfma_f32_16x16x32_bf16 v[120:123], a[248:251], v[60:63], v[120:123]
ds_read_b64_tr_b16 v[50:51], v18 offset:37376
v_mfma_f32_16x16x32_bf16 v[124:127], a[244:247], v[56:59], v[124:127]
ds_read_b64_tr_b16 v[52:53], v22 offset:36864
v_mfma_f32_16x16x32_bf16 v[124:127], a[252:255], v[60:63], v[124:127]
ds_read_b64_tr_b16 v[54:55], v22 offset:37376
s_waitcnt lgkmcnt(8)
v_pk_fma_f32 v[64:65], v[212:213], v[160:161], v[64:65] op_sel_hi:[0,1,1]
v_pk_fma_f32 v[66:67], v[212:213], v[162:163], v[66:67] op_sel_hi:[0,1,1]
v_pk_fma_f32 v[72:73], v[212:213], v[164:165], v[72:73] op_sel_hi:[0,1,1]
v_pk_fma_f32 v[74:75], v[212:213], v[166:167], v[74:75] op_sel_hi:[0,1,1]
v_pk_mul_f32 v[64:65], v[64:65], v[214:215] op_sel_hi:[1,0]
v_pk_mul_f32 v[66:67], v[66:67], v[214:215] op_sel_hi:[1,0]
v_pk_mul_f32 v[72:73], v[72:73], v[214:215] op_sel_hi:[1,0]
v_pk_mul_f32 v[74:75], v[74:75], v[214:215] op_sel_hi:[1,0]
v_cvt_pk_bf16_f32 v64, v64, v65
v_cvt_pk_bf16_f32 v65, v66, v67
v_cvt_pk_bf16_f32 v66, v72, v73
v_cvt_pk_bf16_f32 v67, v74, v75
buffer_store_dwordx4 v[64:67], v1, s[36:39], s68 offen offset:0 sc1
v_pk_fma_f32 v[68:69], v[212:213], v[160:161], v[68:69] op_sel:[1,0,0]
v_pk_fma_f32 v[70:71], v[212:213], v[162:163], v[70:71] op_sel:[1,0,0]
v_pk_fma_f32 v[76:77], v[212:213], v[164:165], v[76:77] op_sel:[1,0,0]
v_pk_fma_f32 v[78:79], v[212:213], v[166:167], v[78:79] op_sel:[1,0,0]
v_pk_mul_f32 v[68:69], v[68:69], v[214:215] op_sel:[0,1]
v_pk_mul_f32 v[70:71], v[70:71], v[214:215] op_sel:[0,1]
v_pk_mul_f32 v[76:77], v[76:77], v[214:215] op_sel:[0,1]
v_pk_mul_f32 v[78:79], v[78:79], v[214:215] op_sel:[0,1]
v_cvt_pk_bf16_f32 v68, v68, v69
v_cvt_pk_bf16_f32 v69, v70, v71
v_cvt_pk_bf16_f32 v70, v76, v77
v_cvt_pk_bf16_f32 v71, v78, v79
buffer_store_dwordx4 v[68:71], v1, s[36:39], s68 offen offset:1024 sc1
v_pk_fma_f32 v[80:81], v[212:213], v[168:169], v[80:81] op_sel_hi:[0,1,1]
v_pk_fma_f32 v[82:83], v[212:213], v[170:171], v[82:83] op_sel_hi:[0,1,1]
v_pk_fma_f32 v[88:89], v[212:213], v[172:173], v[88:89] op_sel_hi:[0,1,1]
v_pk_fma_f32 v[90:91], v[212:213], v[174:175], v[90:91] op_sel_hi:[0,1,1]
v_pk_mul_f32 v[80:81], v[80:81], v[214:215] op_sel_hi:[1,0]
v_pk_mul_f32 v[82:83], v[82:83], v[214:215] op_sel_hi:[1,0]
v_pk_mul_f32 v[88:89], v[88:89], v[214:215] op_sel_hi:[1,0]
v_pk_mul_f32 v[90:91], v[90:91], v[214:215] op_sel_hi:[1,0]
v_cvt_pk_bf16_f32 v80, v80, v81
v_cvt_pk_bf16_f32 v81, v82, v83
v_cvt_pk_bf16_f32 v82, v88, v89
v_cvt_pk_bf16_f32 v83, v90, v91
buffer_store_dwordx4 v[80:83], v1, s[36:39], s69 offen offset:0 sc1
v_pk_fma_f32 v[84:85], v[212:213], v[168:169], v[84:85] op_sel:[1,0,0]
v_pk_fma_f32 v[86:87], v[212:213], v[170:171], v[86:87] op_sel:[1,0,0]
v_pk_fma_f32 v[92:93], v[212:213], v[172:173], v[92:93] op_sel:[1,0,0]
v_pk_fma_f32 v[94:95], v[212:213], v[174:175], v[94:95] op_sel:[1,0,0]
v_pk_mul_f32 v[84:85], v[84:85], v[214:215] op_sel:[0,1]
v_pk_mul_f32 v[86:87], v[86:87], v[214:215] op_sel:[0,1]
v_pk_mul_f32 v[92:93], v[92:93], v[214:215] op_sel:[0,1]
v_pk_mul_f32 v[94:95], v[94:95], v[214:215] op_sel:[0,1]
v_cvt_pk_bf16_f32 v84, v84, v85
v_cvt_pk_bf16_f32 v85, v86, v87
v_cvt_pk_bf16_f32 v86, v92, v93
v_cvt_pk_bf16_f32 v87, v94, v95
buffer_store_dwordx4 v[84:87], v1, s[36:39], s69 offen offset:1024 sc1
v_pk_fma_f32 v[96:97], v[196:197], v[192:193], v[96:97] op_sel_hi:[1,0,1]
v_pk_fma_f32 v[98:99], v[198:199], v[192:193], v[98:99] op_sel_hi:[1,0,1]
v_pk_fma_f32 v[100:101], v[200:201], v[192:193], v[100:101] op_sel_hi:[1,0,1]
v_pk_fma_f32 v[102:103], v[202:203], v[192:193], v[102:103] op_sel_hi:[1,0,1]
v_pk_mul_f32 v[96:97], v[96:97], v[204:205]
v_pk_mul_f32 v[98:99], v[98:99], v[206:207]
v_pk_mul_f32 v[100:101], v[100:101], v[208:209]
v_pk_mul_f32 v[102:103], v[102:103], v[210:211]
v_cvt_pk_bf16_f32 v96, v96, v97
v_cvt_pk_bf16_f32 v97, v98, v99
v_cvt_pk_bf16_f32 v98, v100, v101
v_cvt_pk_bf16_f32 v99, v102, v103
buffer_store_dwordx4 v[96:99], v1, s[36:39], s68 offen offset:2048 sc1
v_pk_fma_f32 v[104:105], v[196:197], v[192:193], v[104:105] op_sel:[0,1,0]
v_pk_fma_f32 v[106:107], v[198:199], v[192:193], v[106:107] op_sel:[0,1,0]
v_pk_fma_f32 v[108:109], v[200:201], v[192:193], v[108:109] op_sel:[0,1,0]
v_pk_fma_f32 v[110:111], v[202:203], v[192:193], v[110:111] op_sel:[0,1,0]
v_pk_mul_f32 v[104:105], v[104:105], v[204:205]
v_pk_mul_f32 v[106:107], v[106:107], v[206:207]
v_pk_mul_f32 v[108:109], v[108:109], v[208:209]
v_pk_mul_f32 v[110:111], v[110:111], v[210:211]
v_cvt_pk_bf16_f32 v104, v104, v105
v_cvt_pk_bf16_f32 v105, v106, v107
v_cvt_pk_bf16_f32 v106, v108, v109
v_cvt_pk_bf16_f32 v107, v110, v111
buffer_store_dwordx4 v[104:107], v1, s[36:39], s68 offen offset:3072 sc1
v_pk_fma_f32 v[112:113], v[196:197], v[194:195], v[112:113] op_sel_hi:[1,0,1]
v_pk_fma_f32 v[114:115], v[198:199], v[194:195], v[114:115] op_sel_hi:[1,0,1]
v_pk_fma_f32 v[116:117], v[200:201], v[194:195], v[116:117] op_sel_hi:[1,0,1]
v_pk_fma_f32 v[118:119], v[202:203], v[194:195], v[118:119] op_sel_hi:[1,0,1]
v_pk_mul_f32 v[112:113], v[112:113], v[204:205]
v_pk_mul_f32 v[114:115], v[114:115], v[206:207]
v_pk_mul_f32 v[116:117], v[116:117], v[208:209]
v_pk_mul_f32 v[118:119], v[118:119], v[210:211]
v_cvt_pk_bf16_f32 v112, v112, v113
v_cvt_pk_bf16_f32 v113, v114, v115
v_cvt_pk_bf16_f32 v114, v116, v117
v_cvt_pk_bf16_f32 v115, v118, v119
buffer_store_dwordx4 v[112:115], v1, s[36:39], s69 offen offset:2048 sc1
v_pk_fma_f32 v[120:121], v[196:197], v[194:195], v[120:121] op_sel:[0,1,0]
v_pk_fma_f32 v[122:123], v[198:199], v[194:195], v[122:123] op_sel:[0,1,0]
v_pk_fma_f32 v[124:125], v[200:201], v[194:195], v[124:125] op_sel:[0,1,0]
v_pk_fma_f32 v[126:127], v[202:203], v[194:195], v[126:127] op_sel:[0,1,0]
v_pk_mul_f32 v[120:121], v[120:121], v[204:205]
v_pk_mul_f32 v[122:123], v[122:123], v[206:207]
v_pk_mul_f32 v[124:125], v[124:125], v[208:209]
v_pk_mul_f32 v[126:127], v[126:127], v[210:211]
v_cvt_pk_bf16_f32 v120, v120, v121
v_cvt_pk_bf16_f32 v121, v122, v123
v_cvt_pk_bf16_f32 v122, v124, v125
v_cvt_pk_bf16_f32 v123, v126, v127
TP7:
s_cbranch_execz TP2
buffer_store_dwordx4 v[120:123], v1, s[36:39], s69 offen offset:3072 sc1
v_mfma_f32_16x16x32_bf16 v[128:131], v[32:35], a[0:3], 0
ds_read_b64_tr_b16 v[56:57], v19 offset:36864
v_mfma_f32_16x16x32_bf16 v[128:131], v[36:39], a[8:11], v[128:131]
ds_read_b64_tr_b16 v[58:59], v19 offset:37376
s_add_u32 m0, s48, 32768
v_mfma_f32_16x16x32_bf16 v[132:135], v[32:35], a[4:7], 0
ds_read_b64_tr_b16 v[60:61], v23 offset:36864
buffer_load_dwordx4 v14, s[8:11], s67 offen offset:0 lds
v_mfma_f32_16x16x32_bf16 v[132:135], v[36:39], a[12:15], v[132:135]
ds_read_b64_tr_b16 v[62:63], v23 offset:37376
s_waitcnt lgkmcnt(8)
v_mfma_f32_16x16x32_bf16 v[136:139], v[40:43], a[0:3], 0
ds_read_b64_tr_b16 v[32:33], v16 offset:0
buffer_load_dwordx4 v15, s[8:11], s67 offen offset:1024 lds
v_mfma_f32_16x16x32_bf16 v[136:139], v[44:47], a[8:11], v[136:139]
ds_read_b64_tr_b16 v[34:35], v16 offset:512
v_mfma_f32_16x16x32_bf16 v[140:143], v[40:43], a[4:7], 0
ds_read_b64_tr_b16 v[36:37], v20 offset:0
v_mfma_f32_16x16x32_bf16 v[140:143], v[44:47], a[12:15], v[140:143]
ds_read_b64_tr_b16 v[38:39], v20 offset:512
s_waitcnt lgkmcnt(8)
v_mfma_f32_16x16x32_bf16 v[144:147], v[48:51], a[0:3], 0
ds_read_b64_tr_b16 v[40:41], v17 offset:0
s_lshl_b32 s51, s43, 12
s_lshr_b32 s71, s2, 3
v_mfma_f32_16x16x32_bf16 v[144:147], v[52:55], a[8:11], v[144:147]
ds_read_b64_tr_b16 v[42:43], v17 offset:512
s_lshl2_add_u32 s71, s71, s40
v_mfma_f32_16x16x32_bf16 v[148:151], v[48:51], a[4:7], 0
ds_read_b64_tr_b16 v[44:45], v21 offset:0
s_lshr_b32 s70, s45, 3
v_mfma_f32_16x16x32_bf16 v[148:151], v[52:55], a[12:15], v[148:151]
ds_read_b64_tr_b16 v[46:47], v21 offset:512
s_lshl4_add_u32 s71, s71, s70
s_waitcnt lgkmcnt(8)
v_mfma_f32_16x16x32_bf16 v[152:155], v[56:59], a[0:3], 0
ds_read_b64_tr_b16 v[48:49], v18 offset:0
s_lshl_b32 s71, s71, 10
v_mfma_f32_16x16x32_bf16 v[152:155], v[60:63], a[8:11], v[152:155]
ds_read_b64_tr_b16 v[50:51], v18 offset:512
s_lshl_b32 s3, s46, 2
v_lshrrev_b32 v220, 3, v0
v_mfma_f32_16x16x32_bf16 v[156:159], v[56:59], a[4:7], 0
ds_read_b64_tr_b16 v[52:53], v22 offset:0
v_and_b32 v221, 7, v0
v_mfma_f32_16x16x32_bf16 v[156:159], v[60:63], a[12:15], v[156:159]
ds_read_b64_tr_b16 v[54:55], v22 offset:512
s_waitcnt lgkmcnt(8)
v_mfma_f32_16x16x32_bf16 v[128:131], v[32:35], a[16:19], v[128:131]
ds_read_b64_tr_b16 v[56:57], v19 offset:0
v_lshl_add_u32 v220, v220, 11, s71
v_mfma_f32_16x16x32_bf16 v[128:131], v[36:39], a[24:27], v[128:131]
ds_read_b64_tr_b16 v[58:59], v19 offset:512
v_lshl_add_u32 v220, v221, 7, v220
v_mfma_f32_16x16x32_bf16 v[132:135], v[32:35], a[20:23], v[132:135]
ds_read_b64_tr_b16 v[60:61], v23 offset:0
v_cmp_gt_u32 vcc, 8, v0
v_mfma_f32_16x16x32_bf16 v[132:135], v[36:39], a[28:31], v[132:135]
ds_read_b64_tr_b16 v[62:63], v23 offset:512
v_mov_b32 v255, 0x80000000
s_waitcnt lgkmcnt(8)
v_mfma_f32_16x16x32_bf16 v[136:139], v[40:43], a[16:19], v[136:139]
ds_read_b64_tr_b16 v[32:33], v16 offset:2048
s_add_u32 s3, s3, 65536
v_cndmask_b32 v255, v255, v220, vcc
v_mfma_f32_16x16x32_bf16 v[136:139], v[44:47], a[24:27], v[136:139]
ds_read_b64_tr_b16 v[34:35], v16 offset:2560
v_lshlrev_b32 v221, 6, v0
v_mfma_f32_16x16x32_bf16 v[140:143], v[40:43], a[20:23], v[140:143]
ds_read_b64_tr_b16 v[36:37], v20 offset:2048
v_lshrrev_b32 v222, 1, v0
v_mfma_f32_16x16x32_bf16 v[140:143], v[44:47], a[28:31], v[140:143]
ds_read_b64_tr_b16 v[38:39], v20 offset:2560
s_waitcnt lgkmcnt(8)
v_mfma_f32_16x16x32_bf16 v[144:147], v[48:51], a[16:19], v[144:147]
ds_read_b64_tr_b16 v[40:41], v17 offset:2048
s_add_u32 s51, s51, s3
v_and_b32 v223, 1, v0
v_mfma_f32_16x16x32_bf16 v[144:147], v[52:55], a[24:27], v[144:147]
ds_read_b64_tr_b16 v[42:43], v17 offset:2560
s_lshl_b32 s71, s47, 9
v_mfma_f32_16x16x32_bf16 v[148:151], v[48:51], a[20:23], v[148:151]
ds_read_b64_tr_b16 v[44:45], v21 offset:2048
s_add_u32 s71, s71, s45
v_mfma_f32_16x16x32_bf16 v[148:151], v[52:55], a[28:31], v[148:151]
ds_read_b64_tr_b16 v[46:47], v21 offset:2560
s_lshl_b32 s71, s71, 8
s_waitcnt lgkmcnt(8)
v_mfma_f32_16x16x32_bf16 v[152:155], v[56:59], a[16:19], v[152:155]
ds_read_b64_tr_b16 v[48:49], v18 offset:2048
v_lshl_add_u32 v223, v223, 7, s71
v_mfma_f32_16x16x32_bf16 v[152:155], v[60:63], a[24:27], v[152:155]
ds_read_b64_tr_b16 v[50:51], v18 offset:2560
v_lshl_add_u32 v222, v222, 12, v223
v_mfma_f32_16x16x32_bf16 v[156:159], v[56:59], a[20:23], v[156:159]
ds_read_b64_tr_b16 v[52:53], v22 offset:2048
v_mfma_f32_16x16x32_bf16 v[156:159], v[60:63], a[28:31], v[156:159]
ds_read_b64_tr_b16 v[54:55], v22 offset:2560
s_waitcnt lgkmcnt(8)
v_mfma_f32_16x16x32_bf16 v[128:131], v[32:35], a[32:35], v[128:131]
ds_read_b64_tr_b16 v[56:57], v19 offset:2048
ds_read_b128 v[176:179], v28 offset:38912
v_mfma_f32_16x16x32_bf16 v[128:131], v[36:39], a[40:43], v[128:131]
ds_read_b64_tr_b16 v[58:59], v19 offset:2560
ds_read_b128 v[180:183], v28 offset:38976
v_mfma_f32_16x16x32_bf16 v[132:135], v[32:35], a[36:39], v[132:135]
ds_read_b64_tr_b16 v[60:61], v23 offset:2048
ds_read_b128 v[184:187], v28 offset:39040
v_mfma_f32_16x16x32_bf16 v[132:135], v[36:39], a[44:47], v[132:135]
ds_read_b64_tr_b16 v[62:63], v23 offset:2560
ds_read_b128 v[188:191], v28 offset:39104
s_waitcnt lgkmcnt(12)
v_mfma_f32_16x16x32_bf16 v[136:139], v[40:43], a[32:35], v[136:139]
ds_read_b64_tr_b16 v[32:33], v16 offset:20480
v_mul_f32 v216, 0x3e8293ee, v214
v_mfma_f32_16x16x32_bf16 v[136:139], v[44:47], a[40:43], v[136:139]
ds_read_b64_tr_b16 v[34:35], v16 offset:20992
v_mul_f32 v217, 0x3e8293ee, v215
v_mfma_f32_16x16x32_bf16 v[140:143], v[40:43], a[36:39], v[140:143]
ds_read_b64_tr_b16 v[36:37], v20 offset:20480
v_mov_b32 v64, 0
v_mfma_f32_16x16x32_bf16 v[140:143], v[44:47], a[44:47], v[140:143]
ds_read_b64_tr_b16 v[38:39], v20 offset:20992
v_mov_b32 v65, 0
s_waitcnt lgkmcnt(12)
v_mfma_f32_16x16x32_bf16 v[144:147], v[48:51], a[32:35], v[144:147]
ds_read_b64_tr_b16 v[40:41], v17 offset:20480
v_mov_b32 v66, 0
v_mfma_f32_16x16x32_bf16 v[144:147], v[52:55], a[40:43], v[144:147]
ds_read_b64_tr_b16 v[42:43], v17 offset:20992
v_mov_b32 v67, 0
v_mfma_f32_16x16x32_bf16 v[148:151], v[48:51], a[36:39], v[148:151]
ds_read_b64_tr_b16 v[44:45], v21 offset:20480
v_mov_b32 v68, 0
v_mfma_f32_16x16x32_bf16 v[148:151], v[52:55], a[44:47], v[148:151]
ds_read_b64_tr_b16 v[46:47], v21 offset:20992
s_waitcnt lgkmcnt(9)
v_mfma_f32_16x16x32_bf16 v[152:155], v[56:59], a[32:35], v[152:155]
ds_read_b64_tr_b16 v[48:49], v18 offset:20480
v_mov_b32 v69, 0
v_mfma_f32_16x16x32_bf16 v[152:155], v[60:63], a[40:43], v[152:155]
ds_read_b64_tr_b16 v[50:51], v18 offset:20992
v_mov_b32 v70, 0
v_mfma_f32_16x16x32_bf16 v[156:159], v[56:59], a[36:39], v[156:159]
TP8:
s_cbranch_execz TP4
ds_read_b64_tr_b16 v[52:53], v22 offset:20480
v_mov_b32 v71, 0
v_mfma_f32_16x16x32_bf16 v[156:159], v[60:63], a[44:47], v[156:159]
ds_read_b64_tr_b16 v[54:55], v22 offset:20992
v_mov_b32 v72, 0
s_waitcnt lgkmcnt(8)
v_mfma_f32_16x16x32_bf16 v[128:131], v[32:35], a[48:51], v[128:131]
ds_read_b64_tr_b16 v[56:57], v19 offset:20480
v_mov_b32 v73, 0
v_mfma_f32_16x16x32_bf16 v[128:131], v[36:39], a[56:59], v[128:131]
ds_read_b64_tr_b16 v[58:59], v19 offset:20992
v_mov_b32 v74, 0
v_mfma_f32_16x16x32_bf16 v[132:135], v[32:35], a[52:55], v[132:135]
ds_read_b64_tr_b16 v[60:61], v23 offset:20480
v_mov_b32 v75, 0
v_mfma_f32_16x16x32_bf16 v[132:135], v[36:39], a[60:63], v[132:135]
ds_read_b64_tr_b16 v[62:63], v23 offset:20992
v_mov_b32 v76, 0
s_waitcnt lgkmcnt(8)
v_mfma_f32_16x16x32_bf16 v[136:139], v[40:43], a[48:51], v[136:139]
ds_read_b64_tr_b16 v[32:33], v16 offset:22528
v_mov_b32 v77, 0
v_mfma_f32_16x16x32_bf16 v[136:139], v[44:47], a[56:59], v[136:139]
ds_read_b64_tr_b16 v[34:35], v16 offset:23040
v_mov_b32 v78, 0
v_mfma_f32_16x16x32_bf16 v[140:143], v[40:43], a[52:55], v[140:143]
ds_read_b64_tr_b16 v[36:37], v20 offset:22528
v_mfma_f32_16x16x32_bf16 v[140:143], v[44:47], a[60:63], v[140:143]
ds_read_b64_tr_b16 v[38:39], v20 offset:23040
v_mov_b32 v79, 0
s_waitcnt lgkmcnt(8)
v_mfma_f32_16x16x32_bf16 v[144:147], v[48:51], a[48:51], v[144:147]
ds_read_b64_tr_b16 v[40:41], v17 offset:22528
v_mov_b32 v80, 0
v_mfma_f32_16x16x32_bf16 v[144:147], v[52:55], a[56:59], v[144:147]
ds_read_b64_tr_b16 v[42:43], v17 offset:23040
v_mov_b32 v81, 0
v_mfma_f32_16x16x32_bf16 v[148:151], v[48:51], a[52:55], v[148:151]
ds_read_b64_tr_b16 v[44:45], v21 offset:22528
v_mov_b32 v82, 0
v_mfma_f32_16x16x32_bf16 v[148:151], v[52:55], a[60:63], v[148:151]
ds_read_b64_tr_b16 v[46:47], v21 offset:23040
v_mov_b32 v83, 0
s_waitcnt lgkmcnt(8)
v_mfma_f32_16x16x32_bf16 v[152:155], v[56:59], a[48:51], v[152:155]
ds_read_b64_tr_b16 v[48:49], v18 offset:22528
v_mov_b32 v84, 0
v_mfma_f32_16x16x32_bf16 v[152:155], v[60:63], a[56:59], v[152:155]
ds_read_b64_tr_b16 v[50:51], v18 offset:23040
v_mov_b32 v85, 0
v_mfma_f32_16x16x32_bf16 v[156:159], v[56:59], a[52:55], v[156:159]
ds_read_b64_tr_b16 v[52:53], v22 offset:22528
v_mov_b32 v86, 0
v_mfma_f32_16x16x32_bf16 v[156:159], v[60:63], a[60:63], v[156:159]
ds_read_b64_tr_b16 v[54:55], v22 offset:23040
v_mov_b32 v87, 0
s_waitcnt lgkmcnt(8)
v_mfma_f32_16x16x32_bf16 v[128:131], v[32:35], a[64:67], v[128:131]
ds_read_b64_tr_b16 v[56:57], v19 offset:22528
v_mov_b32 v88, 0
v_mfma_f32_16x16x32_bf16 v[128:131], v[36:39], a[72:75], v[128:131]
ds_read_b64_tr_b16 v[58:59], v19 offset:23040
v_mfma_f32_16x16x32_bf16 v[132:135], v[32:35], a[68:71], v[132:135]
ds_read_b64_tr_b16 v[60:61], v23 offset:22528
v_mov_b32 v89, 0
v_mfma_f32_16x16x32_bf16 v[132:135], v[36:39], a[76:79], v[132:135]
ds_read_b64_tr_b16 v[62:63], v23 offset:23040
v_mov_b32 v90, 0
s_waitcnt lgkmcnt(8)
v_mfma_f32_16x16x32_bf16 v[136:139], v[40:43], a[64:67], v[136:139]
ds_read_b64_tr_b16 v[32:33], v16 offset:4096
v_mov_b32 v91, 0
v_mfma_f32_16x16x32_bf16 v[136:139], v[44:47], a[72:75], v[136:139]
ds_read_b64_tr_b16 v[34:35], v16 offset:4608
v_mov_b32 v92, 0
v_mfma_f32_16x16x32_bf16 v[140:143], v[40:43], a[68:71], v[140:143]
ds_read_b64_tr_b16 v[36:37], v20 offset:4096
v_mov_b32 v93, 0
v_mfma_f32_16x16x32_bf16 v[140:143], v[44:47], a[76:79], v[140:143]
ds_read_b64_tr_b16 v[38:39], v20 offset:4608
v_mov_b32 v94, 0
s_waitcnt lgkmcnt(8)
v_mfma_f32_16x16x32_bf16 v[144:147], v[48:51], a[64:67], v[144:147]
ds_read_b64_tr_b16 v[40:41], v17 offset:4096
v_mov_b32 v95, 0
v_mfma_f32_16x16x32_bf16 v[144:147], v[52:55], a[72:75], v[144:147]
ds_read_b64_tr_b16 v[42:43], v17 offset:4608
v_mov_b32 v96, 0
v_mfma_f32_16x16x32_bf16 v[148:151], v[48:51], a[68:71], v[148:151]
ds_read_b64_tr_b16 v[44:45], v21 offset:4096
v_mov_b32 v97, 0
v_mfma_f32_16x16x32_bf16 v[148:151], v[52:55], a[76:79], v[148:151]
ds_read_b64_tr_b16 v[46:47], v21 offset:4608
v_mov_b32 v98, 0
s_waitcnt lgkmcnt(8)
v_mfma_f32_16x16x32_bf16 v[152:155], v[56:59], a[64:67], v[152:155]
ds_read_b64_tr_b16 v[48:49], v18 offset:4096
v_mfma_f32_16x16x32_bf16 v[152:155], v[60:63], a[72:75], v[152:155]
ds_read_b64_tr_b16 v[50:51], v18 offset:4608
v_mov_b32 v99, 0
v_mfma_f32_16x16x32_bf16 v[156:159], v[56:59], a[68:71], v[156:159]
ds_read_b64_tr_b16 v[52:53], v22 offset:4096
v_mov_b32 v100, 0
v_mfma_f32_16x16x32_bf16 v[156:159], v[60:63], a[76:79], v[156:159]
ds_read_b64_tr_b16 v[54:55], v22 offset:4608
v_mov_b32 v101, 0
s_waitcnt lgkmcnt(8)
v_mfma_f32_16x16x32_bf16 v[128:131], v[32:35], a[80:83], v[128:131]
ds_read_b64_tr_b16 v[56:57], v19 offset:4096
v_mov_b32 v102, 0
v_mfma_f32_16x16x32_bf16 v[128:131], v[36:39], a[88:91], v[128:131]
ds_read_b64_tr_b16 v[58:59], v19 offset:4608
v_mov_b32 v103, 0
v_mfma_f32_16x16x32_bf16 v[132:135], v[32:35], a[84:87], v[132:135]
ds_read_b64_tr_b16 v[60:61], v23 offset:4096
v_mov_b32 v104, 0
v_mfma_f32_16x16x32_bf16 v[132:135], v[36:39], a[92:95], v[132:135]
ds_read_b64_tr_b16 v[62:63], v23 offset:4608
v_mov_b32 v105, 0
s_waitcnt lgkmcnt(8)
v_mfma_f32_16x16x32_bf16 v[136:139], v[40:43], a[80:83], v[136:139]
ds_read_b64_tr_b16 v[32:33], v16 offset:6144
v_mov_b32 v106, 0
v_mfma_f32_16x16x32_bf16 v[136:139], v[44:47], a[88:91], v[136:139]
ds_read_b64_tr_b16 v[34:35], v16 offset:6656
v_mov_b32 v107, 0
v_mfma_f32_16x16x32_bf16 v[140:143], v[40:43], a[84:87], v[140:143]
ds_read_b64_tr_b16 v[36:37], v20 offset:6144
v_mov_b32 v108, 0
v_mfma_f32_16x16x32_bf16 v[140:143], v[44:47], a[92:95], v[140:143]
ds_read_b64_tr_b16 v[38:39], v20 offset:6656
v_mov_b32 v109, 0
s_waitcnt lgkmcnt(8)
v_mfma_f32_16x16x32_bf16 v[144:147], v[48:51], a[80:83], v[144:147]
ds_read_b64_tr_b16 v[40:41], v17 offset:6144
v_mfma_f32_16x16x32_bf16 v[144:147], v[52:55], a[88:91], v[144:147]
ds_read_b64_tr_b16 v[42:43], v17 offset:6656
v_mov_b32 v110, 0
v_mfma_f32_16x16x32_bf16 v[148:151], v[48:51], a[84:87], v[148:151]
ds_read_b64_tr_b16 v[44:45], v21 offset:6144
s_waitcnt vmcnt(2)
v_mov_b32 v111, 0
v_mfma_f32_16x16x32_bf16 v[148:151], v[52:55], a[92:95], v[148:151]
ds_read_b64_tr_b16 v[46:47], v21 offset:6656
buffer_atomic_swap v2, v245, s[36:39], s51 offen sc1
s_waitcnt lgkmcnt(8)
v_mfma_f32_16x16x32_bf16 v[152:155], v[56:59], a[80:83], v[152:155]
ds_read_b64_tr_b16 v[48:49], v18 offset:6144
v_mov_b32 v112, 0
v_mov_b32 v113, 0
v_mfma_f32_16x16x32_bf16 v[152:155], v[60:63], a[88:91], v[152:155]
ds_read_b64_tr_b16 v[50:51], v18 offset:6656
v_mov_b32 v114, 0
v_mfma_f32_16x16x32_bf16 v[156:159], v[56:59], a[84:87], v[156:159]
ds_read_b64_tr_b16 v[52:53], v22 offset:6144
v_mov_b32 v115, 0
v_mfma_f32_16x16x32_bf16 v[156:159], v[60:63], a[92:95], v[156:159]
TP9:
s_cbranch_execz TP6
TP10:
s_cbranch_execz TP30
ds_read_b64_tr_b16 v[54:55], v22 offset:6656
v_mov_b32 v116, 0
s_waitcnt lgkmcnt(8)
v_mfma_f32_16x16x32_bf16 v[128:131], v[32:35], a[96:99], v[128:131]
ds_read_b64_tr_b16 v[56:57], v19 offset:6144
v_mov_b32 v117, 0
v_mfma_f32_16x16x32_bf16 v[128:131], v[36:39], a[104:107], v[128:131]
ds_read_b64_tr_b16 v[58:59], v19 offset:6656
v_mov_b32 v118, 0
v_mfma_f32_16x16x32_bf16 v[132:135], v[32:35], a[100:103], v[132:135]
ds_read_b64_tr_b16 v[60:61], v23 offset:6144
v_mov_b32 v119, 0
v_mfma_f32_16x16x32_bf16 v[132:135], v[36:39], a[108:111], v[132:135]
ds_read_b64_tr_b16 v[62:63], v23 offset:6656
s_waitcnt lgkmcnt(8)
s_barrier
v_mfma_f32_16x16x32_bf16 v[136:139], v[40:43], a[96:99], v[136:139]
ds_read_b64_tr_b16 v[32:33], v16 offset:24576
v_mov_b32 v120, 0
v_mfma_f32_16x16x32_bf16 v[136:139], v[44:47], a[104:107], v[136:139]
ds_read_b64_tr_b16 v[34:35], v16 offset:25088
v_mov_b32 v121, 0
v_mfma_f32_16x16x32_bf16 v[140:143], v[40:43], a[100:103], v[140:143]
ds_read_b64_tr_b16 v[36:37], v20 offset:24576
v_mov_b32 v122, 0
v_mfma_f32_16x16x32_bf16 v[140:143], v[44:47], a[108:111], v[140:143]
ds_read_b64_tr_b16 v[38:39], v20 offset:25088
v_mov_b32 v123, 0
s_waitcnt lgkmcnt(8)
v_mfma_f32_16x16x32_bf16 v[144:147], v[48:51], a[96:99], v[144:147]
ds_read_b64_tr_b16 v[40:41], v17 offset:24576
v_mov_b32 v124, 0
v_mfma_f32_16x16x32_bf16 v[144:147], v[52:55], a[104:107], v[144:147]
ds_read_b64_tr_b16 v[42:43], v17 offset:25088
v_mov_b32 v125, 0
v_mfma_f32_16x16x32_bf16 v[148:151], v[48:51], a[100:103], v[148:151]
ds_read_b64_tr_b16 v[44:45], v21 offset:24576
v_mov_b32 v126, 0
v_mfma_f32_16x16x32_bf16 v[148:151], v[52:55], a[108:111], v[148:151]
ds_read_b64_tr_b16 v[46:47], v21 offset:25088
v_mov_b32 v127, 0
s_waitcnt lgkmcnt(8)
v_mfma_f32_16x16x32_bf16 v[152:155], v[56:59], a[96:99], v[152:155]
ds_read_b64_tr_b16 v[48:49], v18 offset:24576
v_mov_b32 v160, 0
v_mfma_f32_16x16x32_bf16 v[152:155], v[60:63], a[104:107], v[152:155]
ds_read_b64_tr_b16 v[50:51], v18 offset:25088
v_mov_b32 v161, 0
v_mfma_f32_16x16x32_bf16 v[156:159], v[56:59], a[100:103], v[156:159]
ds_read_b64_tr_b16 v[52:53], v22 offset:24576
v_mfma_f32_16x16x32_bf16 v[156:159], v[60:63], a[108:111], v[156:159]
ds_read_b64_tr_b16 v[54:55], v22 offset:25088
v_mov_b32 v162, 0
s_waitcnt lgkmcnt(8)
v_mfma_f32_16x16x32_bf16 v[128:131], v[32:35], a[112:115], v[128:131]
ds_read_b64_tr_b16 v[56:57], v19 offset:24576
v_mov_b32 v163, 0
v_mfma_f32_16x16x32_bf16 v[128:131], v[36:39], a[120:123], v[128:131]
ds_read_b64_tr_b16 v[58:59], v19 offset:25088
v_mov_b32 v164, 0
v_mfma_f32_16x16x32_bf16 v[132:135], v[32:35], a[116:119], v[132:135]
ds_read_b64_tr_b16 v[60:61], v23 offset:24576
v_mov_b32 v165, 0
v_mfma_f32_16x16x32_bf16 v[132:135], v[36:39], a[124:127], v[132:135]
ds_read_b64_tr_b16 v[62:63], v23 offset:25088
v_mov_b32 v166, 0
s_waitcnt lgkmcnt(8)
v_mfma_f32_16x16x32_bf16 v[136:139], v[40:43], a[112:115], v[136:139]
ds_read_b64_tr_b16 v[32:33], v16 offset:26624
v_mov_b32 v167, 0
v_mfma_f32_16x16x32_bf16 v[136:139], v[44:47], a[120:123], v[136:139]
ds_read_b64_tr_b16 v[34:35], v16 offset:27136
v_mov_b32 v168, 0
v_mfma_f32_16x16x32_bf16 v[140:143], v[40:43], a[116:119], v[140:143]
ds_read_b64_tr_b16 v[36:37], v20 offset:26624
v_mov_b32 v169, 0
v_mfma_f32_16x16x32_bf16 v[140:143], v[44:47], a[124:127], v[140:143]
ds_read_b64_tr_b16 v[38:39], v20 offset:27136
v_mov_b32 v170, 0
s_waitcnt lgkmcnt(8)
v_mfma_f32_16x16x32_bf16 v[144:147], v[48:51], a[112:115], v[144:147]
ds_read_b64_tr_b16 v[40:41], v17 offset:26624
v_mov_b32 v171, 0
v_mfma_f32_16x16x32_bf16 v[144:147], v[52:55], a[120:123], v[144:147]
ds_read_b64_tr_b16 v[42:43], v17 offset:27136
v_mfma_f32_16x16x32_bf16 v[148:151], v[48:51], a[116:119], v[148:151]
ds_read_b64_tr_b16 v[44:45], v21 offset:26624
v_mov_b32 v172, 0
v_mfma_f32_16x16x32_bf16 v[148:151], v[52:55], a[124:127], v[148:151]
ds_read_b64_tr_b16 v[46:47], v21 offset:27136
v_mov_b32 v173, 0
s_waitcnt lgkmcnt(8)
v_mfma_f32_16x16x32_bf16 v[152:155], v[56:59], a[112:115], v[152:155]
ds_read_b64_tr_b16 v[48:49], v18 offset:26624
v_mov_b32 v174, 0
v_mfma_f32_16x16x32_bf16 v[152:155], v[60:63], a[120:123], v[152:155]
ds_read_b64_tr_b16 v[50:51], v18 offset:27136
v_mov_b32 v175, 0
v_mfma_f32_16x16x32_bf16 v[156:159], v[56:59], a[116:119], v[156:159]
ds_read_b64_tr_b16 v[52:53], v22 offset:26624
s_lshl_b32 s68, s43, 4
v_mfma_f32_16x16x32_bf16 v[156:159], v[60:63], a[124:127], v[156:159]
ds_read_b64_tr_b16 v[54:55], v22 offset:27136
s_add_u32 s68, s68, s42
s_waitcnt lgkmcnt(8)
v_mfma_f32_16x16x32_bf16 v[128:131], v[32:35], a[128:131], v[128:131]
ds_read_b64_tr_b16 v[56:57], v19 offset:26624
s_lshl_b32 s68, s68, 1
v_mfma_f32_16x16x32_bf16 v[128:131], v[36:39], a[136:139], v[128:131]
ds_read_b64_tr_b16 v[58:59], v19 offset:27136
s_lshr_b32 s3, s40, 1
v_mfma_f32_16x16x32_bf16 v[132:135], v[32:35], a[132:135], v[132:135]
ds_read_b64_tr_b16 v[60:61], v23 offset:26624
s_add_u32 s68, s68, s3
v_mfma_f32_16x16x32_bf16 v[132:135], v[36:39], a[140:143], v[132:135]
ds_read_b64_tr_b16 v[62:63], v23 offset:27136
s_lshl_b32 s68, s68, 7
s_waitcnt lgkmcnt(8)
v_mfma_f32_16x16x32_bf16 v[136:139], v[40:43], a[128:131], v[136:139]
ds_read_b64_tr_b16 v[32:33], v16 offset:8192
s_add_u32 s68, s68, 65536
v_mfma_f32_16x16x32_bf16 v[136:139], v[44:47], a[136:139], v[136:139]
ds_read_b64_tr_b16 v[34:35], v16 offset:8704
v_mfma_f32_16x16x32_bf16 v[140:143], v[40:43], a[132:135], v[140:143]
ds_read_b64_tr_b16 v[36:37], v20 offset:8192
s_lshl_b32 s50, s43, 1
v_mfma_f32_16x16x32_bf16 v[140:143], v[44:47], a[140:143], v[140:143]
ds_read_b64_tr_b16 v[38:39], v20 offset:8704
s_and_b32 s69, s40, 1
s_waitcnt lgkmcnt(8)
v_mfma_f32_16x16x32_bf16 v[144:147], v[48:51], a[128:131], v[144:147]
ds_read_b64_tr_b16 v[40:41], v17 offset:8192
s_add_u32 s50, s50, s69
v_mfma_f32_16x16x32_bf16 v[144:147], v[52:55], a[136:139], v[144:147]
ds_read_b64_tr_b16 v[42:43], v17 offset:8704
s_lshl_b32 s50, s50, 1
v_mfma_f32_16x16x32_bf16 v[148:151], v[48:51], a[132:135], v[148:151]
ds_read_b64_tr_b16 v[44:45], v21 offset:8192
s_add_u32 s50, s50, s3
v_mfma_f32_16x16x32_bf16 v[148:151], v[52:55], a[140:143], v[148:151]
ds_read_b64_tr_b16 v[46:47], v21 offset:8704
s_lshl_b32 s50, s50, 17
s_waitcnt lgkmcnt(8)
v_mfma_f32_16x16x32_bf16 v[152:155], v[56:59], a[128:131], v[152:155]
ds_read_b64_tr_b16 v[48:49], v18 offset:8192
s_add_u32 s50, s50, 4194304
v_mfma_f32_16x16x32_bf16 v[152:155], v[60:63], a[136:139], v[152:155]
ds_read_b64_tr_b16 v[50:51], v18 offset:8704
v_mov_b32 v4, 0x80000000
v_mfma_f32_16x16x32_bf16 v[156:159], v[56:59], a[132:135], v[156:159]
ds_read_b64_tr_b16 v[52:53], v22 offset:8192
v_cmp_gt_u32 vcc, 16, v0
v_mfma_f32_16x16x32_bf16 v[156:159], v[60:63], a[140:143], v[156:159]
ds_read_b64_tr_b16 v[54:55], v22 offset:8704
TP11:
s_cbranch_execz TP10
v_lshlrev_b32 v3, 13, v0
s_waitcnt lgkmcnt(8)
v_mfma_f32_16x16x32_bf16 v[128:131], v[32:35], a[144:147], v[128:131]
ds_read_b64_tr_b16 v[56:57], v19 offset:8192
v_mfma_f32_16x16x32_bf16 v[128:131], v[36:39], a[152:155], v[128:131]
ds_read_b64_tr_b16 v[58:59], v19 offset:8704
v_cndmask_b32 v6, v4, v3, vcc
v_mfma_f32_16x16x32_bf16 v[132:135], v[32:35], a[148:151], v[132:135]
ds_read_b64_tr_b16 v[60:61], v23 offset:8192
v_lshlrev_b32 v3, 7, v0
v_mfma_f32_16x16x32_bf16 v[132:135], v[36:39], a[156:159], v[132:135]
ds_read_b64_tr_b16 v[62:63], v23 offset:8704
v_cmp_gt_u32 vcc, 32, v0
s_waitcnt lgkmcnt(8)
v_mfma_f32_16x16x32_bf16 v[136:139], v[40:43], a[144:147], v[136:139]
ds_read_b64_tr_b16 v[32:33], v16 offset:10240
v_lshlrev_b32 v7, 2, v0
v_mfma_f32_16x16x32_bf16 v[136:139], v[44:47], a[152:155], v[136:139]
ds_read_b64_tr_b16 v[34:35], v16 offset:10752
v_cndmask_b32 v11, v4, v3, vcc
v_mfma_f32_16x16x32_bf16 v[140:143], v[40:43], a[148:151], v[140:143]
ds_read_b64_tr_b16 v[36:37], v20 offset:10240
v_add_u32 v8, s48, v1
v_mfma_f32_16x16x32_bf16 v[140:143], v[44:47], a[156:159], v[140:143]
ds_read_b64_tr_b16 v[38:39], v20 offset:10752
s_xor_b32 s71, s40, 2
s_waitcnt lgkmcnt(8)
v_mfma_f32_16x16x32_bf16 v[144:147], v[48:51], a[144:147], v[144:147]
ds_read_b64_tr_b16 v[40:41], v17 offset:10240
s_mul_i32 s71, s71, 40960
v_mfma_f32_16x16x32_bf16 v[144:147], v[52:55], a[152:155], v[144:147]
ds_read_b64_tr_b16 v[42:43], v17 offset:10752
v_add_u32 v9, s71, v1
v_mfma_f32_16x16x32_bf16 v[148:151], v[48:51], a[148:151], v[148:151]
ds_read_b64_tr_b16 v[44:45], v21 offset:10240
v_and_b32 v3, 3, v0
v_mfma_f32_16x16x32_bf16 v[148:151], v[52:55], a[156:159], v[148:151]
ds_read_b64_tr_b16 v[46:47], v21 offset:10752
s_waitcnt lgkmcnt(8)
v_mfma_f32_16x16x32_bf16 v[152:155], v[56:59], a[144:147], v[152:155]
ds_read_b64_tr_b16 v[48:49], v18 offset:10240
v_lshl_add_u32 v12, v3, 4, s48
v_mfma_f32_16x16x32_bf16 v[152:155], v[60:63], a[152:155], v[152:155]
ds_read_b64_tr_b16 v[50:51], v18 offset:10752
s_lshl_b32 s71, s40, 4
v_mfma_f32_16x16x32_bf16 v[156:159], v[56:59], a[148:151], v[156:159]
ds_read_b64_tr_b16 v[52:53], v22 offset:10240
v_mul_u32_u24 v13, 40960, v3
v_mfma_f32_16x16x32_bf16 v[156:159], v[60:63], a[156:159], v[156:159]
ds_read_b64_tr_b16 v[54:55], v22 offset:10752
v_add_u32 v13, s71, v13
s_waitcnt lgkmcnt(8)
v_mfma_f32_16x16x32_bf16 v[128:131], v[32:35], a[160:163], v[128:131]
ds_read_b64_tr_b16 v[56:57], v19 offset:10240
v_lshlrev_b32 v10, 11, v3
v_mfma_f32_16x16x32_bf16 v[128:131], v[36:39], a[168:171], v[128:131]
ds_read_b64_tr_b16 v[58:59], v19 offset:10752
v_bfe_u32 v3, v0, 2, 2
v_mfma_f32_16x16x32_bf16 v[132:135], v[32:35], a[164:167], v[132:135]
ds_read_b64_tr_b16 v[60:61], v23 offset:10240
v_lshl_add_u32 v10, v3, 14, v10
v_mfma_f32_16x16x32_bf16 v[132:135], v[36:39], a[172:175], v[132:135]
ds_read_b64_tr_b16 v[62:63], v23 offset:10752
v_bfe_u32 v3, v0, 4, 1
s_waitcnt lgkmcnt(8)
v_mfma_f32_16x16x32_bf16 v[136:139], v[40:43], a[160:163], v[136:139]
ds_read_b64_tr_b16 v[32:33], v16 offset:28672
v_lshl_add_u32 v10, v3, 5, v10
v_mfma_f32_16x16x32_bf16 v[136:139], v[44:47], a[168:171], v[136:139]
ds_read_b64_tr_b16 v[34:35], v16 offset:29184
v_lshrrev_b32 v3, 5, v0
v_mfma_f32_16x16x32_bf16 v[140:143], v[40:43], a[164:167], v[140:143]
ds_read_b64_tr_b16 v[36:37], v20 offset:28672
v_mfma_f32_16x16x32_bf16 v[140:143], v[44:47], a[172:175], v[140:143]
ds_read_b64_tr_b16 v[38:39], v20 offset:29184
v_lshl_add_u32 v10, v3, 4, v10
s_waitcnt lgkmcnt(8)
v_mfma_f32_16x16x32_bf16 v[144:147], v[48:51], a[160:163], v[144:147]
ds_read_b64_tr_b16 v[40:41], v17 offset:28672
s_mov_b32 s52, s2
v_mfma_f32_16x16x32_bf16 v[144:147], v[52:55], a[168:171], v[144:147]
ds_read_b64_tr_b16 v[42:43], v17 offset:29184
s_and_b32 s52, s52, 7
v_mfma_f32_16x16x32_bf16 v[148:151], v[48:51], a[164:167], v[148:151]
ds_read_b64_tr_b16 v[44:45], v21 offset:28672
s_mov_b32 s53, 0
v_mfma_f32_16x16x32_bf16 v[148:151], v[52:55], a[172:175], v[148:151]
ds_read_b64_tr_b16 v[46:47], v21 offset:29184
s_lshl_b32 s63, s47, 4
s_waitcnt lgkmcnt(8)
v_mfma_f32_16x16x32_bf16 v[152:155], v[56:59], a[160:163], v[152:155]
ds_read_b64_tr_b16 v[48:49], v18 offset:28672
s_add_u32 s63, s63, s45
v_mfma_f32_16x16x32_bf16 v[152:155], v[60:63], a[168:171], v[152:155]
ds_read_b64_tr_b16 v[50:51], v18 offset:29184
s_lshl_b32 s63, s63, 7
v_mfma_f32_16x16x32_bf16 v[156:159], v[56:59], a[164:167], v[156:159]
ds_read_b64_tr_b16 v[52:53], v22 offset:28672
s_lshl_b32 s64, s47, 16
v_mfma_f32_16x16x32_bf16 v[156:159], v[60:63], a[172:175], v[156:159]
ds_read_b64_tr_b16 v[54:55], v22 offset:29184
s_lshl_b32 s71, s45, 7
s_waitcnt lgkmcnt(8)
v_mfma_f32_16x16x32_bf16 v[128:131], v[32:35], a[176:179], v[128:131]
ds_read_b64_tr_b16 v[56:57], v19 offset:28672
s_add_u32 s64, s64, s71
v_mfma_f32_16x16x32_bf16 v[128:131], v[36:39], a[184:187], v[128:131]
ds_read_b64_tr_b16 v[58:59], v19 offset:29184
v_mfma_f32_16x16x32_bf16 v[132:135], v[32:35], a[180:183], v[132:135]
ds_read_b64_tr_b16 v[60:61], v23 offset:28672
v_mov_b32 v254, 0
v_mfma_f32_16x16x32_bf16 v[132:135], v[36:39], a[188:191], v[132:135]
ds_read_b64_tr_b16 v[62:63], v23 offset:29184
s_waitcnt lgkmcnt(8)
v_mfma_f32_16x16x32_bf16 v[136:139], v[40:43], a[176:179], v[136:139]
ds_read_b64_tr_b16 v[32:33], v16 offset:30720
buffer_atomic_or v254, v246, s[36:39], s68 offen sc0 sc1
v_mfma_f32_16x16x32_bf16 v[136:139], v[44:47], a[184:187], v[136:139]
ds_read_b64_tr_b16 v[34:35], v16 offset:31232
v_mfma_f32_16x16x32_bf16 v[140:143], v[40:43], a[180:183], v[140:143]
ds_read_b64_tr_b16 v[36:37], v20 offset:30720
v_mfma_f32_16x16x32_bf16 v[140:143], v[44:47], a[188:191], v[140:143]
ds_read_b64_tr_b16 v[38:39], v20 offset:31232
s_waitcnt lgkmcnt(8)
v_mfma_f32_16x16x32_bf16 v[144:147], v[48:51], a[176:179], v[144:147]
ds_read_b64_tr_b16 v[40:41], v17 offset:30720
v_mfma_f32_16x16x32_bf16 v[144:147], v[52:55], a[184:187], v[144:147]
ds_read_b64_tr_b16 v[42:43], v17 offset:31232
v_mfma_f32_16x16x32_bf16 v[148:151], v[48:51], a[180:183], v[148:151]
ds_read_b64_tr_b16 v[44:45], v21 offset:30720
v_mfma_f32_16x16x32_bf16 v[148:151], v[52:55], a[188:191], v[148:151]
ds_read_b64_tr_b16 v[46:47], v21 offset:31232
s_waitcnt lgkmcnt(8)
v_mfma_f32_16x16x32_bf16 v[152:155], v[56:59], a[176:179], v[152:155]
ds_read_b64_tr_b16 v[48:49], v18 offset:30720
v_mfma_f32_16x16x32_bf16 v[152:155], v[60:63], a[184:187], v[152:155]
ds_read_b64_tr_b16 v[50:51], v18 offset:31232
v_mfma_f32_16x16x32_bf16 v[156:159], v[56:59], a[180:183], v[156:159]
ds_read_b64_tr_b16 v[52:53], v22 offset:30720
v_mfma_f32_16x16x32_bf16 v[156:159], v[60:63], a[188:191], v[156:159]
ds_read_b64_tr_b16 v[54:55], v22 offset:31232
s_waitcnt lgkmcnt(8)
v_mfma_f32_16x16x32_bf16 v[128:131], v[32:35], a[192:195], v[128:131]
ds_read_b64_tr_b16 v[56:57], v19 offset:30720
v_mfma_f32_16x16x32_bf16 v[128:131], v[36:39], a[200:203], v[128:131]
ds_read_b64_tr_b16 v[58:59], v19 offset:31232
TP12:
s_cbranch_execz TP2
v_mfma_f32_16x16x32_bf16 v[132:135], v[32:35], a[196:199], v[132:135]
ds_read_b64_tr_b16 v[60:61], v23 offset:30720
v_mfma_f32_16x16x32_bf16 v[132:135], v[36:39], a[204:207], v[132:135]
ds_read_b64_tr_b16 v[62:63], v23 offset:31232
s_waitcnt lgkmcnt(8)
v_mfma_f32_16x16x32_bf16 v[136:139], v[40:43], a[192:195], v[136:139]
ds_read_b64_tr_b16 v[32:33], v16 offset:12288
v_mfma_f32_16x16x32_bf16 v[136:139], v[44:47], a[200:203], v[136:139]
ds_read_b64_tr_b16 v[34:35], v16 offset:12800
v_mfma_f32_16x16x32_bf16 v[140:143], v[40:43], a[196:199], v[140:143]
ds_read_b64_tr_b16 v[36:37], v20 offset:12288
v_mfma_f32_16x16x32_bf16 v[140:143], v[44:47], a[204:207], v[140:143]
ds_read_b64_tr_b16 v[38:39], v20 offset:12800
s_waitcnt lgkmcnt(8)
v_mfma_f32_16x16x32_bf16 v[144:147], v[48:51], a[192:195], v[144:147]
ds_read_b64_tr_b16 v[40:41], v17 offset:12288
v_mfma_f32_16x16x32_bf16 v[144:147], v[52:55], a[200:203], v[144:147]
ds_read_b64_tr_b16 v[42:43], v17 offset:12800
v_mfma_f32_16x16x32_bf16 v[148:151], v[48:51], a[196:199], v[148:151]
ds_read_b64_tr_b16 v[44:45], v21 offset:12288
v_mfma_f32_16x16x32_bf16 v[148:151], v[52:55], a[204:207], v[148:151]
ds_read_b64_tr_b16 v[46:47], v21 offset:12800
s_waitcnt lgkmcnt(8)
v_mfma_f32_16x16x32_bf16 v[152:155], v[56:59], a[192:195], v[152:155]
ds_read_b64_tr_b16 v[48:49], v18 offset:12288
v_mfma_f32_16x16x32_bf16 v[152:155], v[60:63], a[200:203], v[152:155]
ds_read_b64_tr_b16 v[50:51], v18 offset:12800
v_mfma_f32_16x16x32_bf16 v[156:159], v[56:59], a[196:199], v[156:159]
ds_read_b64_tr_b16 v[52:53], v22 offset:12288
v_mfma_f32_16x16x32_bf16 v[156:159], v[60:63], a[204:207], v[156:159]
ds_read_b64_tr_b16 v[54:55], v22 offset:12800
s_waitcnt lgkmcnt(8)
v_mfma_f32_16x16x32_bf16 v[128:131], v[32:35], a[208:211], v[128:131]
ds_read_b64_tr_b16 v[56:57], v19 offset:12288
v_mfma_f32_16x16x32_bf16 v[128:131], v[36:39], a[216:219], v[128:131]
ds_read_b64_tr_b16 v[58:59], v19 offset:12800
v_mfma_f32_16x16x32_bf16 v[132:135], v[32:35], a[212:215], v[132:135]
ds_read_b64_tr_b16 v[60:61], v23 offset:12288
v_mfma_f32_16x16x32_bf16 v[132:135], v[36:39], a[220:223], v[132:135]
ds_read_b64_tr_b16 v[62:63], v23 offset:12800
s_waitcnt lgkmcnt(8)
v_mfma_f32_16x16x32_bf16 v[136:139], v[40:43], a[208:211], v[136:139]
ds_read_b64_tr_b16 v[32:33], v16 offset:14336
v_mfma_f32_16x16x32_bf16 v[136:139], v[44:47], a[216:219], v[136:139]
ds_read_b64_tr_b16 v[34:35], v16 offset:14848
v_mfma_f32_16x16x32_bf16 v[140:143], v[40:43], a[212:215], v[140:143]
ds_read_b64_tr_b16 v[36:37], v20 offset:14336
v_mfma_f32_16x16x32_bf16 v[140:143], v[44:47], a[220:223], v[140:143]
ds_read_b64_tr_b16 v[38:39], v20 offset:14848
s_waitcnt lgkmcnt(8)
v_mfma_f32_16x16x32_bf16 v[144:147], v[48:51], a[208:211], v[144:147]
ds_read_b64_tr_b16 v[40:41], v17 offset:14336
v_mfma_f32_16x16x32_bf16 v[144:147], v[52:55], a[216:219], v[144:147]
ds_read_b64_tr_b16 v[42:43], v17 offset:14848
v_mfma_f32_16x16x32_bf16 v[148:151], v[48:51], a[212:215], v[148:151]
ds_read_b64_tr_b16 v[44:45], v21 offset:14336
v_mfma_f32_16x16x32_bf16 v[148:151], v[52:55], a[220:223], v[148:151]
ds_read_b64_tr_b16 v[46:47], v21 offset:14848
s_waitcnt lgkmcnt(8)
v_mfma_f32_16x16x32_bf16 v[152:155], v[56:59], a[208:211], v[152:155]
ds_read_b64_tr_b16 v[48:49], v18 offset:14336
v_mfma_f32_16x16x32_bf16 v[152:155], v[60:63], a[216:219], v[152:155]
ds_read_b64_tr_b16 v[50:51], v18 offset:14848
v_mfma_f32_16x16x32_bf16 v[156:159], v[56:59], a[212:215], v[156:159]
ds_read_b64_tr_b16 v[52:53], v22 offset:14336
v_mfma_f32_16x16x32_bf16 v[156:159], v[60:63], a[220:223], v[156:159]
ds_read_b64_tr_b16 v[54:55], v22 offset:14848
s_waitcnt lgkmcnt(8)
v_mfma_f32_16x16x32_bf16 v[128:131], v[32:35], a[224:227], v[128:131]
ds_read_b64_tr_b16 v[56:57], v19 offset:14336
v_mfma_f32_16x16x32_bf16 v[128:131], v[36:39], a[232:235], v[128:131]
ds_read_b64_tr_b16 v[58:59], v19 offset:14848
v_mfma_f32_16x16x32_bf16 v[132:135], v[32:35], a[228:231], v[132:135]
ds_read_b64_tr_b16 v[60:61], v23 offset:14336
v_mfma_f32_16x16x32_bf16 v[132:135], v[36:39], a[236:239], v[132:135]
ds_read_b64_tr_b16 v[62:63], v23 offset:14848
s_waitcnt vmcnt(2) lgkmcnt(8)
s_barrier
v_mfma_f32_16x16x32_bf16 v[136:139], v[40:43], a[224:227], v[136:139]
ds_read_b64_tr_b16 v[32:33], v16 offset:32768
v_mfma_f32_16x16x32_bf16 v[136:139], v[44:47], a[232:235], v[136:139]
ds_read_b64_tr_b16 v[34:35], v16 offset:33280
v_mfma_f32_16x16x32_bf16 v[140:143], v[40:43], a[228:231], v[140:143]
ds_read_b64_tr_b16 v[36:37], v20 offset:32768
v_mfma_f32_16x16x32_bf16 v[140:143], v[44:47], a[236:239], v[140:143]
ds_read_b64_tr_b16 v[38:39], v20 offset:33280
s_waitcnt lgkmcnt(8)
v_mfma_f32_16x16x32_bf16 v[144:147], v[48:51], a[224:227], v[144:147]
ds_read_b64_tr_b16 v[40:41], v17 offset:32768
v_mfma_f32_16x16x32_bf16 v[144:147], v[52:55], a[232:235], v[144:147]
ds_read_b64_tr_b16 v[42:43], v17 offset:33280
v_mfma_f32_16x16x32_bf16 v[148:151], v[48:51], a[228:231], v[148:151]
ds_read_b64_tr_b16 v[44:45], v21 offset:32768
v_mfma_f32_16x16x32_bf16 v[148:151], v[52:55], a[236:239], v[148:151]
ds_read_b64_tr_b16 v[46:47], v21 offset:33280
s_waitcnt lgkmcnt(8)
v_mfma_f32_16x16x32_bf16 v[152:155], v[56:59], a[224:227], v[152:155]
ds_read_b64_tr_b16 v[48:49], v18 offset:32768
s_waitcnt vmcnt(0)
v_mfma_f32_16x16x32_bf16 v[152:155], v[60:63], a[232:235], v[152:155]
ds_read_b64_tr_b16 v[50:51], v18 offset:33280
v_cmp_ne_u32 vcc, v254, v2
v_mfma_f32_16x16x32_bf16 v[156:159], v[56:59], a[228:231], v[156:159]
ds_read_b64_tr_b16 v[52:53], v22 offset:32768
s_mov_b32 vcc_hi, 0
v_mfma_f32_16x16x32_bf16 v[156:159], v[60:63], a[236:239], v[156:159]
ds_read_b64_tr_b16 v[54:55], v22 offset:33280
s_waitcnt lgkmcnt(8)
v_mfma_f32_16x16x32_bf16 v[128:131], v[32:35], a[240:243], v[128:131]
ds_read_b64_tr_b16 v[56:57], v19 offset:32768
s_cbranch_vccnz RT_F1
RT_F1_B:
v_mfma_f32_16x16x32_bf16 v[128:131], v[36:39], a[248:251], v[128:131]
ds_read_b64_tr_b16 v[58:59], v19 offset:33280
s_mov_b32 s51, s50
v_mfma_f32_16x16x32_bf16 v[132:135], v[32:35], a[244:247], v[132:135]
ds_read_b64_tr_b16 v[60:61], v23 offset:32768
buffer_load_dwordx4 a[32:35], v240, s[36:39], s50 offen offset:0 sc1
v_mfma_f32_16x16x32_bf16 v[132:135], v[36:39], a[252:255], v[132:135]
ds_read_b64_tr_b16 v[62:63], v23 offset:33280
s_waitcnt lgkmcnt(8)
v_mfma_f32_16x16x32_bf16 v[136:139], v[40:43], a[240:243], v[136:139]
buffer_load_dword v221, v221, s[24:27], 0 offen
v_mfma_f32_16x16x32_bf16 v[136:139], v[44:47], a[248:251], v[136:139]
buffer_load_dwordx4 a[36:39], v240, s[36:39], s50 offen offset:512 sc1
v_mfma_f32_16x16x32_bf16 v[140:143], v[40:43], a[244:247], v[140:143]
buffer_load_dwordx4 a[40:43], v241, s[36:39], s50 offen offset:2048 sc1
v_mfma_f32_16x16x32_bf16 v[140:143], v[44:47], a[252:255], v[140:143]
buffer_load_dwordx4 a[44:47], v241, s[36:39], s50 offen offset:2560 sc1
s_waitcnt lgkmcnt(4)
v_mfma_f32_16x16x32_bf16 v[144:147], v[48:51], a[240:243], v[144:147]
s_add_u32 s50, s50, 4096
buffer_load_dwordx4 a[48:51], v240, s[36:39], s50 offen offset:0 sc1
v_mfma_f32_16x16x32_bf16 v[144:147], v[52:55], a[248:251], v[144:147]
v_mfma_f32_16x16x32_bf16 v[148:151], v[48:51], a[244:247], v[148:151]
buffer_load_dwordx4 a[52:55], v240, s[36:39], s50 offen offset:512 sc1
v_mfma_f32_16x16x32_bf16 v[148:151], v[52:55], a[252:255], v[148:151]
s_waitcnt lgkmcnt(0)
v_mfma_f32_16x16x32_bf16 v[152:155], v[56:59], a[240:243], v[152:155]
TP13:
s_cbranch_execz TP4
buffer_load_dwordx4 a[56:59], v241, s[36:39], s50 offen offset:2048 sc1
v_mfma_f32_16x16x32_bf16 v[152:155], v[60:63], a[248:251], v[152:155]
buffer_load_dwordx4 a[60:63], v241, s[36:39], s50 offen offset:2560 sc1
v_mfma_f32_16x16x32_bf16 v[156:159], v[56:59], a[244:247], v[156:159]
v_mfma_f32_16x16x32_bf16 v[156:159], v[60:63], a[252:255], v[156:159]
s_add_u32 s50, s50, 4096
v_add_u32 v3, s48, v1
v_pk_fma_f32 v[128:129], v[212:213], v[176:177], v[128:129] op_sel_hi:[0,1,1]
v_pk_fma_f32 v[130:131], v[212:213], v[178:179], v[130:131] op_sel_hi:[0,1,1]
v_pk_fma_f32 v[136:137], v[212:213], v[180:181], v[136:137] op_sel_hi:[0,1,1]
v_pk_fma_f32 v[138:139], v[212:213], v[182:183], v[138:139] op_sel_hi:[0,1,1]
v_pk_mul_f32 v[128:129], v[128:129], v[216:217] op_sel_hi:[1,0]
v_pk_mul_f32 v[130:131], v[130:131], v[216:217] op_sel_hi:[1,0]
v_pk_mul_f32 v[136:137], v[136:137], v[216:217] op_sel_hi:[1,0]
v_pk_mul_f32 v[138:139], v[138:139], v[216:217] op_sel_hi:[1,0]
v_cvt_pk_bf16_f32 v128, v128, v129
v_cvt_pk_bf16_f32 v129, v130, v131
v_cvt_pk_bf16_f32 v130, v136, v137
v_cvt_pk_bf16_f32 v131, v138, v139
ds_write_b128 v3, v[128:131] offset:16384
v_pk_fma_f32 v[132:133], v[212:213], v[176:177], v[132:133] op_sel:[1,0,0]
v_pk_fma_f32 v[134:135], v[212:213], v[178:179], v[134:135] op_sel:[1,0,0]
v_pk_fma_f32 v[140:141], v[212:213], v[180:181], v[140:141] op_sel:[1,0,0]
v_pk_fma_f32 v[142:143], v[212:213], v[182:183], v[142:143] op_sel:[1,0,0]
v_pk_mul_f32 v[132:133], v[132:133], v[216:217] op_sel:[0,1]
v_pk_mul_f32 v[134:135], v[134:135], v[216:217] op_sel:[0,1]
v_pk_mul_f32 v[140:141], v[140:141], v[216:217] op_sel:[0,1]
v_pk_mul_f32 v[142:143], v[142:143], v[216:217] op_sel:[0,1]
v_cvt_pk_bf16_f32 v132, v132, v133
v_cvt_pk_bf16_f32 v133, v134, v135
v_cvt_pk_bf16_f32 v134, v140, v141
v_cvt_pk_bf16_f32 v135, v142, v143
ds_write_b128 v3, v[132:135] offset:17408
v_pk_fma_f32 v[144:145], v[212:213], v[184:185], v[144:145] op_sel_hi:[0,1,1]
v_pk_fma_f32 v[146:147], v[212:213], v[186:187], v[146:147] op_sel_hi:[0,1,1]
v_pk_fma_f32 v[152:153], v[212:213], v[188:189], v[152:153] op_sel_hi:[0,1,1]
v_pk_fma_f32 v[154:155], v[212:213], v[190:191], v[154:155] op_sel_hi:[0,1,1]
v_pk_mul_f32 v[144:145], v[144:145], v[216:217] op_sel_hi:[1,0]
v_pk_mul_f32 v[146:147], v[146:147], v[216:217] op_sel_hi:[1,0]
v_pk_mul_f32 v[152:153], v[152:153], v[216:217] op_sel_hi:[1,0]
v_pk_mul_f32 v[154:155], v[154:155], v[216:217] op_sel_hi:[1,0]
v_cvt_pk_bf16_f32 v144, v144, v145
v_cvt_pk_bf16_f32 v145, v146, v147
v_cvt_pk_bf16_f32 v146, v152, v153
v_cvt_pk_bf16_f32 v147, v154, v155
ds_write_b128 v3, v[144:147] offset:18432
v_pk_fma_f32 v[148:149], v[212:213], v[184:185], v[148:149] op_sel:[1,0,0]
v_pk_fma_f32 v[150:151], v[212:213], v[186:187], v[150:151] op_sel:[1,0,0]
v_pk_fma_f32 v[156:157], v[212:213], v[188:189], v[156:157] op_sel:[1,0,0]
v_pk_fma_f32 v[158:159], v[212:213], v[190:191], v[158:159] op_sel:[1,0,0]
v_pk_mul_f32 v[148:149], v[148:149], v[216:217] op_sel:[0,1]
v_pk_mul_f32 v[150:151], v[150:151], v[216:217] op_sel:[0,1]
v_pk_mul_f32 v[156:157], v[156:157], v[216:217] op_sel:[0,1]
v_pk_mul_f32 v[158:159], v[158:159], v[216:217] op_sel:[0,1]
v_cvt_pk_bf16_f32 v148, v148, v149
v_cvt_pk_bf16_f32 v149, v150, v151
v_cvt_pk_bf16_f32 v150, v156, v157
v_cvt_pk_bf16_f32 v151, v158, v159
ds_write_b128 v3, v[148:151] offset:19456
s_waitcnt lgkmcnt(0)
s_barrier
ds_read_b128 a[0:3], v242 offset:16384
ds_read_b128 a[4:7], v242 offset:16896
ds_read_b128 a[8:11], v242 offset:57344
ds_read_b128 a[12:15], v242 offset:57856
ds_read_b128 a[16:19], v243 offset:16384
ds_read_b128 a[20:23], v243 offset:16896
ds_read_b128 a[24:27], v243 offset:57344
ds_read_b128 a[28:31], v243 offset:57856
v_bfe_u32 v3, v0, 2, 1
v_mov_b32 v40, 0x3f803f80
v_cmp_eq_u32 vcc, 0, v3
v_mov_b32 v36, 0xdddddddd
v_mov_b32 v41, v40
v_cndmask_b32 v32, 0, v40, vcc
v_cndmask_b32 v34, v40, 0, vcc
v_mov_b32 v42, v40
v_mov_b32 v43, v40
v_and_b32 v3, 3, v0
v_cmp_eq_u32 vcc, 0, v3
s_nop 1
v_cndmask_b32 v32, 0, v32, vcc
v_cndmask_b32 v34, 0, v34, vcc
v_mov_b32 v33, v32
v_mov_b32 v35, v34
s_waitcnt vmcnt(8) lgkmcnt(7)
v_mfma_f32_32x32x16_bf16 v[176:191], a[32:35], a[0:3], 0
s_waitcnt vmcnt(6) lgkmcnt(6)
v_mfma_f32_32x32x16_bf16 v[176:191], a[36:39], a[4:7], v[176:191]
s_waitcnt lgkmcnt(5)
v_mfma_f32_32x32x16_bf16 v[192:207], a[32:35], a[8:11], 0
s_waitcnt lgkmcnt(4)
v_mfma_f32_32x32x16_bf16 v[192:207], a[36:39], a[12:15], v[192:207]
s_mov_b32 s62, 0
s_nop 6
v_exp_f32 v176, v176
v_exp_f32 v177, v177
v_exp_f32 v178, v178
s_waitcnt lgkmcnt(3)
v_mfma_f32_32x32x16_bf16 v[208:223], a[32:35], a[16:19], 0
s_lshr_b32 s54, s44, 1
v_exp_f32 v179, v179
v_exp_f32 v180, v180
v_exp_f32 v181, v181
buffer_load_dwordx4 a[64:67], v240, s[36:39], s50 offen offset:0 sc1
buffer_load_dwordx4 a[68:71], v240, s[36:39], s50 offen offset:512 sc1
v_exp_f32 v182, v182
v_exp_f32 v183, v183
s_lshl2_add_u32 s54, s54, s40
v_exp_f32 v184, v184
v_exp_f32 v185, v185
v_exp_f32 v186, v186
s_waitcnt lgkmcnt(2)
v_mfma_f32_32x32x16_bf16 v[208:223], a[36:39], a[20:23], v[208:223]
s_waitcnt lgkmcnt(0)
v_exp_f32 v187, v187
v_exp_f32 v188, v188
v_exp_f32 v189, v189
buffer_load_dwordx4 a[72:75], v241, s[36:39], s50 offen offset:2048 sc1
buffer_load_dwordx4 a[76:79], v241, s[36:39], s50 offen offset:2560 sc1
v_exp_f32 v190, v190
v_exp_f32 v191, v191
s_waitcnt vmcnt(9)
v_smfmac_f32_32x32x32_bf16 v[64:79], a[40:43], v[176:183], v36
s_add_u32 s50, s50, 4096
v_exp_f32 v192, v192
v_exp_f32 v193, v193
v_exp_f32 v194, v194
v_mfma_f32_32x32x16_bf16 v[224:239], a[32:35], a[24:27], 0
s_and_b32 s55, s44, 1
v_exp_f32 v195, v195
v_exp_f32 v196, v196
v_exp_f32 v197, v197
v_smfmac_f32_16x16x64_bf16 v[160:163], v[32:35], v[176:183], v36
buffer_load_dwordx4 a[80:83], v240, s[36:39], s50 offen offset:0 sc1
buffer_load_dwordx4 a[84:87], v240, s[36:39], s50 offen offset:512 sc1
v_exp_f32 v198, v198
v_exp_f32 v199, v199
s_waitcnt vmcnt(10)
v_smfmac_f32_32x32x32_bf16 v[64:79], a[44:47], v[184:191], v36
s_mul_i32 s56, s54, 229376
v_exp_f32 v200, v200
v_exp_f32 v201, v201
v_exp_f32 v202, v202
v_mfma_f32_32x32x16_bf16 v[224:239], a[36:39], a[28:31], v[224:239]
s_mul_i32 s3, s55, 3584
v_exp_f32 v203, v203
v_exp_f32 v204, v204
v_exp_f32 v205, v205
v_smfmac_f32_16x16x64_bf16 v[160:163], v[32:35], v[184:191], v36
buffer_load_dwordx4 a[88:91], v241, s[36:39], s50 offen offset:2048 sc1
buffer_load_dwordx4 a[92:95], v241, s[36:39], s50 offen offset:2560 sc1
s_waitcnt vmcnt(8)
v_exp_f32 v206, v206
v_exp_f32 v207, v207
v_smfmac_f32_32x32x32_bf16 v[80:95], a[40:43], v[192:199], v36
s_add_u32 s50, s50, 4096
v_exp_f32 v208, v208
v_exp_f32 v209, v209
TP14:
s_cbranch_execz TP6
TP15:
s_cbranch_execz TP35
v_exp_f32 v210, v210
v_mfma_f32_32x32x16_bf16 v[176:191], a[48:51], a[0:3], 0
s_add_u32 s56, s56, s3
v_exp_f32 v211, v211
v_exp_f32 v212, v212
v_exp_f32 v213, v213
v_smfmac_f32_16x16x64_bf16 v[164:167], v[32:35], v[192:199], v36
buffer_load_dwordx4 a[96:99], v240, s[36:39], s50 offen offset:0 sc1
buffer_load_dwordx4 a[100:103], v240, s[36:39], s50 offen offset:512 sc1
v_exp_f32 v214, v214
v_exp_f32 v215, v215
v_smfmac_f32_32x32x32_bf16 v[80:95], a[44:47], v[200:207], v36
s_mul_i32 s3, s45, 224
v_exp_f32 v216, v216
v_exp_f32 v217, v217
v_exp_f32 v218, v218
v_mfma_f32_32x32x16_bf16 v[176:191], a[52:55], a[4:7], v[176:191]
s_add_u32 s56, s56, s3
v_exp_f32 v219, v219
v_exp_f32 v220, v220
v_exp_f32 v221, v221
v_smfmac_f32_16x16x64_bf16 v[164:167], v[32:35], v[200:207], v36
buffer_load_dwordx4 a[104:107], v241, s[36:39], s50 offen offset:2048 sc1
buffer_load_dwordx4 a[108:111], v241, s[36:39], s50 offen offset:2560 sc1
v_exp_f32 v222, v222
v_exp_f32 v223, v223
v_smfmac_f32_32x32x32_bf16 v[96:111], a[40:43], v[208:215], v36
s_add_u32 s50, s50, 4096
v_exp_f32 v224, v224
v_exp_f32 v225, v225
v_exp_f32 v226, v226
v_mfma_f32_32x32x16_bf16 v[192:207], a[48:51], a[8:11], 0
v_exp_f32 v227, v227
v_exp_f32 v228, v228
v_exp_f32 v229, v229
v_smfmac_f32_16x16x64_bf16 v[168:171], v[32:35], v[208:215], v36
buffer_load_dwordx4 a[112:115], v240, s[36:39], s50 offen offset:0 sc1
buffer_load_dwordx4 a[116:119], v240, s[36:39], s50 offen offset:512 sc1
v_exp_f32 v230, v230
v_exp_f32 v231, v231
v_smfmac_f32_32x32x32_bf16 v[96:111], a[44:47], v[216:223], v36
v_exp_f32 v232, v232
v_exp_f32 v233, v233
v_exp_f32 v234, v234
v_mfma_f32_32x32x16_bf16 v[192:207], a[52:55], a[12:15], v[192:207]
v_exp_f32 v235, v235
v_exp_f32 v236, v236
v_exp_f32 v237, v237
v_smfmac_f32_16x16x64_bf16 v[168:171], v[32:35], v[216:223], v36
buffer_load_dwordx4 a[120:123], v241, s[36:39], s50 offen offset:2048 sc1
buffer_load_dwordx4 a[124:127], v241, s[36:39], s50 offen offset:2560 sc1
v_exp_f32 v238, v238
v_exp_f32 v239, v239
v_smfmac_f32_32x32x32_bf16 v[112:127], a[40:43], v[224:231], v36
s_add_u32 s50, s50, 4096
v_exp_f32 v176, v176
v_exp_f32 v177, v177
v_exp_f32 v178, v178
v_mfma_f32_32x32x16_bf16 v[208:223], a[48:51], a[16:19], 0
v_exp_f32 v179, v179
v_exp_f32 v180, v180
v_exp_f32 v181, v181
v_smfmac_f32_16x16x64_bf16 v[172:175], v[32:35], v[224:231], v36
buffer_load_dwordx4 a[128:131], v240, s[36:39], s50 offen offset:0 sc1
buffer_load_dwordx4 a[132:135], v240, s[36:39], s50 offen offset:512 sc1
v_exp_f32 v182, v182
v_exp_f32 v183, v183
v_smfmac_f32_32x32x32_bf16 v[112:127], a[44:47], v[232:239], v36
v_exp_f32 v184, v184
v_exp_f32 v185, v185
v_exp_f32 v186, v186
v_mfma_f32_32x32x16_bf16 v[208:223], a[52:55], a[20:23], v[208:223]
v_exp_f32 v187, v187
v_exp_f32 v188, v188
v_exp_f32 v189, v189
v_smfmac_f32_16x16x64_bf16 v[172:175], v[32:35], v[232:239], v36
buffer_load_dwordx4 a[136:139], v241, s[36:39], s50 offen offset:2048 sc1
buffer_load_dwordx4 a[140:143], v241, s[36:39], s50 offen offset:2560 sc1
v_exp_f32 v190, v190
v_exp_f32 v191, v191
v_smfmac_f32_32x32x32_bf16 v[64:79], a[56:59], v[176:183], v36
s_add_u32 s50, s50, 4096
v_exp_f32 v192, v192
v_exp_f32 v193, v193
v_exp_f32 v194, v194
v_mfma_f32_32x32x16_bf16 v[224:239], a[48:51], a[24:27], 0
v_exp_f32 v195, v195
v_exp_f32 v196, v196
v_exp_f32 v197, v197
v_smfmac_f32_16x16x64_bf16 v[160:163], v[32:35], v[176:183], v36
buffer_load_dwordx4 a[144:147], v240, s[36:39], s50 offen offset:0 sc1
buffer_load_dwordx4 a[148:151], v240, s[36:39], s50 offen offset:512 sc1
s_barrier
v_exp_f32 v198, v198
v_exp_f32 v199, v199
v_smfmac_f32_32x32x32_bf16 v[64:79], a[60:63], v[184:191], v36
v_exp_f32 v200, v200
v_exp_f32 v201, v201
v_exp_f32 v202, v202
v_mfma_f32_32x32x16_bf16 v[224:239], a[52:55], a[28:31], v[224:239]
v_exp_f32 v203, v203
v_exp_f32 v204, v204
v_exp_f32 v205, v205
v_smfmac_f32_16x16x64_bf16 v[160:163], v[32:35], v[184:191], v36
buffer_load_dwordx4 a[152:155], v241, s[36:39], s50 offen offset:2048 sc1
buffer_load_dwordx4 a[156:159], v241, s[36:39], s50 offen offset:2560 sc1
s_waitcnt vmcnt(20)
v_exp_f32 v206, v206
v_exp_f32 v207, v207
v_smfmac_f32_32x32x32_bf16 v[80:95], a[56:59], v[192:199], v36
s_add_u32 s50, s50, 4096
v_exp_f32 v208, v208
v_exp_f32 v209, v209
v_exp_f32 v210, v210
v_mfma_f32_32x32x16_bf16 v[176:191], a[64:67], a[0:3], 0
v_exp_f32 v211, v211
v_exp_f32 v212, v212
v_exp_f32 v213, v213
v_smfmac_f32_16x16x64_bf16 v[164:167], v[32:35], v[192:199], v36
buffer_load_dwordx4 a[32:35], v240, s[36:39], s50 offen offset:0 sc1
buffer_load_dwordx4 a[36:39], v240, s[36:39], s50 offen offset:512 sc1
v_exp_f32 v214, v214
v_exp_f32 v215, v215
v_smfmac_f32_32x32x32_bf16 v[80:95], a[60:63], v[200:207], v36
v_exp_f32 v216, v216
v_exp_f32 v217, v217
v_exp_f32 v218, v218
v_mfma_f32_32x32x16_bf16 v[176:191], a[68:71], a[4:7], v[176:191]
v_exp_f32 v219, v219
v_exp_f32 v220, v220
v_exp_f32 v221, v221
v_smfmac_f32_16x16x64_bf16 v[164:167], v[32:35], v[200:207], v36
buffer_load_dwordx4 a[40:43], v241, s[36:39], s50 offen offset:2048 sc1
buffer_load_dwordx4 a[44:47], v241, s[36:39], s50 offen offset:2560 sc1
v_exp_f32 v222, v222
v_exp_f32 v223, v223
v_smfmac_f32_32x32x32_bf16 v[96:111], a[56:59], v[208:215], v36
s_add_u32 s50, s50, 4096
v_exp_f32 v224, v224
v_exp_f32 v225, v225
v_exp_f32 v226, v226
v_mfma_f32_32x32x16_bf16 v[192:207], a[64:67], a[8:11], 0
v_exp_f32 v227, v227
v_exp_f32 v228, v228
v_exp_f32 v229, v229
v_smfmac_f32_16x16x64_bf16 v[168:171], v[32:35], v[208:215], v36
buffer_load_dwordx4 a[48:51], v240, s[36:39], s50 offen offset:0 sc1
buffer_load_dwordx4 a[52:55], v240, s[36:39], s50 offen offset:512 sc1
v_exp_f32 v230, v230
v_exp_f32 v231, v231
v_smfmac_f32_32x32x32_bf16 v[96:111], a[60:63], v[216:223], v36
v_exp_f32 v232, v232
v_exp_f32 v233, v233
v_exp_f32 v234, v234
v_mfma_f32_32x32x16_bf16 v[192:207], a[68:71], a[12:15], v[192:207]
v_exp_f32 v235, v235
v_exp_f32 v236, v236
v_exp_f32 v237, v237
v_smfmac_f32_16x16x64_bf16 v[168:171], v[32:35], v[216:223], v36
s_add_u32 m0, s48, 30720
s_nop 0
buffer_load_dwordx4 v249, s[16:19], s56 offen offset:0 lds
v_exp_f32 v238, v238
v_exp_f32 v239, v239
v_smfmac_f32_32x32x32_bf16 v[112:127], a[56:59], v[224:231], v36
s_add_u32 s56, s56, 27648
v_exp_f32 v176, v176
v_exp_f32 v177, v177
v_exp_f32 v178, v178
v_mfma_f32_32x32x16_bf16 v[208:223], a[64:67], a[16:19], 0
v_exp_f32 v179, v179
v_exp_f32 v180, v180
v_exp_f32 v181, v181
v_smfmac_f32_16x16x64_bf16 v[172:175], v[32:35], v[224:231], v36
s_add_u32 m0, s48, 30720
s_nop 0
buffer_load_dwordx4 v249, s[16:19], s56 offen offset:1024 lds
v_exp_f32 v182, v182
v_exp_f32 v183, v183
v_smfmac_f32_32x32x32_bf16 v[112:127], a[60:63], v[232:239], v36
s_add_u32 s56, s56, 27648
TP16:
s_cbranch_execz TP10
v_exp_f32 v184, v184
v_exp_f32 v185, v185
v_exp_f32 v186, v186
v_mfma_f32_32x32x16_bf16 v[208:223], a[68:71], a[20:23], v[208:223]
v_exp_f32 v187, v187
v_exp_f32 v188, v188
v_exp_f32 v189, v189
v_smfmac_f32_16x16x64_bf16 v[172:175], v[32:35], v[232:239], v36
buffer_load_dwordx4 a[56:59], v241, s[36:39], s50 offen offset:2048 sc1
buffer_load_dwordx4 a[60:63], v241, s[36:39], s50 offen offset:2560 sc1
v_exp_f32 v190, v190
v_exp_f32 v191, v191
v_smfmac_f32_32x32x32_bf16 v[64:79], a[72:75], v[176:183], v36
v_exp_f32 v192, v192
v_exp_f32 v193, v193
v_exp_f32 v194, v194
v_mfma_f32_32x32x16_bf16 v[224:239], a[64:67], a[24:27], 0
v_exp_f32 v195, v195
v_exp_f32 v196, v196
v_exp_f32 v197, v197
v_smfmac_f32_16x16x64_bf16 v[160:163], v[32:35], v[176:183], v36
buffer_load_dword v254, v255, s[12:15], s62 offen
v_exp_f32 v198, v198
v_exp_f32 v199, v199
v_smfmac_f32_32x32x32_bf16 v[64:79], a[76:79], v[184:191], v36
s_mov_b32 s62, 2048
v_exp_f32 v200, v200
v_exp_f32 v201, v201
v_exp_f32 v202, v202
v_mfma_f32_32x32x16_bf16 v[224:239], a[68:71], a[28:31], v[224:239]
s_add_u32 s50, s50, 4096
v_exp_f32 v203, v203
v_exp_f32 v204, v204
v_exp_f32 v205, v205
v_smfmac_f32_16x16x64_bf16 v[160:163], v[32:35], v[184:191], v36
s_waitcnt vmcnt(27)
v_exp_f32 v206, v206
v_exp_f32 v207, v207
v_smfmac_f32_32x32x32_bf16 v[80:95], a[72:75], v[192:199], v36
v_exp_f32 v208, v208
v_exp_f32 v209, v209
v_exp_f32 v210, v210
v_mfma_f32_32x32x16_bf16 v[176:191], a[80:83], a[0:3], 0
v_exp_f32 v211, v211
v_exp_f32 v212, v212
v_exp_f32 v213, v213
v_smfmac_f32_16x16x64_bf16 v[164:167], v[32:35], v[192:199], v36
v_exp_f32 v214, v214
v_exp_f32 v215, v215
v_smfmac_f32_32x32x32_bf16 v[80:95], a[76:79], v[200:207], v36
v_exp_f32 v216, v216
v_exp_f32 v217, v217
v_exp_f32 v218, v218
v_mfma_f32_32x32x16_bf16 v[176:191], a[84:87], a[4:7], v[176:191]
v_exp_f32 v219, v219
v_exp_f32 v220, v220
v_exp_f32 v221, v221
v_smfmac_f32_16x16x64_bf16 v[164:167], v[32:35], v[200:207], v36
buffer_load_dwordx4 a[64:67], v240, s[36:39], s50 offen offset:0 sc1
buffer_load_dwordx4 a[68:71], v240, s[36:39], s50 offen offset:512 sc1
v_exp_f32 v222, v222
v_exp_f32 v223, v223
v_smfmac_f32_32x32x32_bf16 v[96:111], a[72:75], v[208:215], v36
v_exp_f32 v224, v224
v_exp_f32 v225, v225
v_exp_f32 v226, v226
v_mfma_f32_32x32x16_bf16 v[192:207], a[80:83], a[8:11], 0
v_exp_f32 v227, v227
v_exp_f32 v228, v228
v_exp_f32 v229, v229
v_smfmac_f32_16x16x64_bf16 v[168:171], v[32:35], v[208:215], v36
s_add_u32 m0, s48, 30720
s_nop 0
buffer_load_dwordx4 v249, s[16:19], s56 offen offset:2048 lds
v_exp_f32 v230, v230
v_exp_f32 v231, v231
v_smfmac_f32_32x32x32_bf16 v[96:111], a[76:79], v[216:223], v36
s_add_u32 s56, s56, 27648
v_exp_f32 v232, v232
v_exp_f32 v233, v233
v_exp_f32 v234, v234
v_mfma_f32_32x32x16_bf16 v[192:207], a[84:87], a[12:15], v[192:207]
v_exp_f32 v235, v235
v_exp_f32 v236, v236
v_exp_f32 v237, v237
v_smfmac_f32_16x16x64_bf16 v[168:171], v[32:35], v[216:223], v36
v_exp_f32 v238, v238
v_exp_f32 v239, v239
v_smfmac_f32_32x32x32_bf16 v[112:127], a[72:75], v[224:231], v36
v_exp_f32 v176, v176
v_exp_f32 v177, v177
v_exp_f32 v178, v178
v_mfma_f32_32x32x16_bf16 v[208:223], a[80:83], a[16:19], 0
v_exp_f32 v179, v179
v_exp_f32 v180, v180
v_exp_f32 v181, v181
v_smfmac_f32_16x16x64_bf16 v[172:175], v[32:35], v[224:231], v36
v_exp_f32 v182, v182
v_exp_f32 v183, v183
v_smfmac_f32_32x32x32_bf16 v[112:127], a[76:79], v[232:239], v36
v_exp_f32 v184, v184
v_exp_f32 v185, v185
v_exp_f32 v186, v186
v_mfma_f32_32x32x16_bf16 v[208:223], a[84:87], a[20:23], v[208:223]
v_exp_f32 v187, v187
v_exp_f32 v188, v188
v_exp_f32 v189, v189
v_smfmac_f32_16x16x64_bf16 v[172:175], v[32:35], v[232:239], v36
buffer_load_dwordx4 a[72:75], v241, s[36:39], s50 offen offset:2048 sc1
buffer_load_dwordx4 a[76:79], v241, s[36:39], s50 offen offset:2560 sc1
v_exp_f32 v190, v190
v_exp_f32 v191, v191
v_smfmac_f32_32x32x32_bf16 v[64:79], a[88:91], v[176:183], v36
v_exp_f32 v192, v192
v_exp_f32 v193, v193
v_exp_f32 v194, v194
v_mfma_f32_32x32x16_bf16 v[224:239], a[80:83], a[24:27], 0
v_exp_f32 v195, v195
v_exp_f32 v196, v196
v_exp_f32 v197, v197
v_smfmac_f32_16x16x64_bf16 v[160:163], v[32:35], v[176:183], v36
s_add_u32 m0, s48, 30720
s_nop 0
buffer_load_dwordx4 v249, s[16:19], s56 offen offset:3072 lds
v_exp_f32 v198, v198
v_exp_f32 v199, v199
v_smfmac_f32_32x32x32_bf16 v[64:79], a[92:95], v[184:191], v36
s_add_u32 s56, s56, 31744
v_exp_f32 v200, v200
v_exp_f32 v201, v201
v_exp_f32 v202, v202
v_mfma_f32_32x32x16_bf16 v[224:239], a[84:87], a[28:31], v[224:239]
s_add_u32 s50, s50, 4096
v_exp_f32 v203, v203
v_exp_f32 v204, v204
v_exp_f32 v205, v205
v_smfmac_f32_16x16x64_bf16 v[160:163], v[32:35], v[184:191], v36
s_waitcnt vmcnt(29)
v_exp_f32 v206, v206
v_exp_f32 v207, v207
v_smfmac_f32_32x32x32_bf16 v[80:95], a[88:91], v[192:199], v36
v_exp_f32 v208, v208
v_exp_f32 v209, v209
v_exp_f32 v210, v210
v_mfma_f32_32x32x16_bf16 v[176:191], a[96:99], a[0:3], 0
v_exp_f32 v211, v211
v_exp_f32 v212, v212
v_exp_f32 v213, v213
v_smfmac_f32_16x16x64_bf16 v[164:167], v[32:35], v[192:199], v36
v_exp_f32 v214, v214
v_exp_f32 v215, v215
v_smfmac_f32_32x32x32_bf16 v[80:95], a[92:95], v[200:207], v36
v_exp_f32 v216, v216
v_exp_f32 v217, v217
v_exp_f32 v218, v218
v_mfma_f32_32x32x16_bf16 v[176:191], a[100:103], a[4:7], v[176:191]
v_exp_f32 v219, v219
v_exp_f32 v220, v220
v_exp_f32 v221, v221
v_smfmac_f32_16x16x64_bf16 v[164:167], v[32:35], v[200:207], v36
buffer_load_dwordx4 a[80:83], v240, s[36:39], s50 offen offset:0 sc1
buffer_load_dwordx4 a[84:87], v240, s[36:39], s50 offen offset:512 sc1
v_exp_f32 v222, v222
v_exp_f32 v223, v223
v_smfmac_f32_32x32x32_bf16 v[96:111], a[88:91], v[208:215], v36
v_exp_f32 v224, v224
v_exp_f32 v225, v225
v_exp_f32 v226, v226
v_mfma_f32_32x32x16_bf16 v[192:207], a[96:99], a[8:11], 0
v_exp_f32 v227, v227
v_exp_f32 v228, v228
v_exp_f32 v229, v229
v_smfmac_f32_16x16x64_bf16 v[168:171], v[32:35], v[208:215], v36
s_waitcnt vmcnt(8)
buffer_load_dword v254, v255, s[12:15], s62 offen
v_exp_f32 v230, v230
v_exp_f32 v231, v231
v_smfmac_f32_32x32x32_bf16 v[96:111], a[92:95], v[216:223], v36
s_mov_b32 s62, 4096
v_exp_f32 v232, v232
v_exp_f32 v233, v233
v_exp_f32 v234, v234
v_mfma_f32_32x32x16_bf16 v[192:207], a[100:103], a[12:15], v[192:207]
v_exp_f32 v235, v235
v_exp_f32 v236, v236
v_exp_f32 v237, v237
v_smfmac_f32_16x16x64_bf16 v[168:171], v[32:35], v[216:223], v36
v_exp_f32 v238, v238
v_exp_f32 v239, v239
v_smfmac_f32_32x32x32_bf16 v[112:127], a[88:91], v[224:231], v36
TP17:
s_cbranch_execz TP2
v_exp_f32 v176, v176
v_exp_f32 v177, v177
v_exp_f32 v178, v178
v_mfma_f32_32x32x16_bf16 v[208:223], a[96:99], a[16:19], 0
v_exp_f32 v179, v179
v_exp_f32 v180, v180
v_exp_f32 v181, v181
v_smfmac_f32_16x16x64_bf16 v[172:175], v[32:35], v[224:231], v36
s_add_u32 m0, s48, 34816
s_nop 0
buffer_load_dwordx4 v249, s[16:19], s56 offen offset:0 lds
v_exp_f32 v182, v182
v_exp_f32 v183, v183
v_smfmac_f32_32x32x32_bf16 v[112:127], a[92:95], v[232:239], v36
s_add_u32 s56, s56, 27648
v_exp_f32 v184, v184
v_exp_f32 v185, v185
v_exp_f32 v186, v186
v_mfma_f32_32x32x16_bf16 v[208:223], a[100:103], a[20:23], v[208:223]
v_exp_f32 v187, v187
v_exp_f32 v188, v188
v_exp_f32 v189, v189
v_smfmac_f32_16x16x64_bf16 v[172:175], v[32:35], v[232:239], v36
buffer_load_dwordx4 a[88:91], v241, s[36:39], s50 offen offset:2048 sc1
buffer_load_dwordx4 a[92:95], v241, s[36:39], s50 offen offset:2560 sc1
v_exp_f32 v190, v190
v_exp_f32 v191, v191
v_smfmac_f32_32x32x32_bf16 v[64:79], a[104:107], v[176:183], v36
v_exp_f32 v192, v192
v_exp_f32 v193, v193
v_exp_f32 v194, v194
v_mfma_f32_32x32x16_bf16 v[224:239], a[96:99], a[24:27], 0
v_exp_f32 v195, v195
v_exp_f32 v196, v196
v_exp_f32 v197, v197
v_smfmac_f32_16x16x64_bf16 v[160:163], v[32:35], v[176:183], v36
v_exp_f32 v198, v198
v_exp_f32 v199, v199
v_smfmac_f32_32x32x32_bf16 v[64:79], a[108:111], v[184:191], v36
v_exp_f32 v200, v200
v_exp_f32 v201, v201
v_exp_f32 v202, v202
v_mfma_f32_32x32x16_bf16 v[224:239], a[100:103], a[28:31], v[224:239]
s_add_u32 s50, s50, 4096
v_exp_f32 v203, v203
v_exp_f32 v204, v204
v_exp_f32 v205, v205
v_smfmac_f32_16x16x64_bf16 v[160:163], v[32:35], v[184:191], v36
v_exp_f32 v206, v206
v_exp_f32 v207, v207
v_smfmac_f32_32x32x32_bf16 v[80:95], a[104:107], v[192:199], v36
v_exp_f32 v208, v208
v_exp_f32 v209, v209
v_exp_f32 v210, v210
v_mfma_f32_32x32x16_bf16 v[176:191], a[112:115], a[0:3], 0
v_exp_f32 v211, v211
v_exp_f32 v212, v212
v_exp_f32 v213, v213
v_smfmac_f32_16x16x64_bf16 v[164:167], v[32:35], v[192:199], v36
s_add_u32 m0, s48, 34816
s_nop 0
buffer_load_dwordx4 v249, s[16:19], s56 offen offset:1024 lds
v_exp_f32 v214, v214
v_exp_f32 v215, v215
v_smfmac_f32_32x32x32_bf16 v[80:95], a[108:111], v[200:207], v36
s_add_u32 s56, s56, 27648
v_exp_f32 v216, v216
v_exp_f32 v217, v217
v_exp_f32 v218, v218
v_mfma_f32_32x32x16_bf16 v[176:191], a[116:119], a[4:7], v[176:191]
v_exp_f32 v219, v219
v_exp_f32 v220, v220
v_exp_f32 v221, v221
v_smfmac_f32_16x16x64_bf16 v[164:167], v[32:35], v[200:207], v36
buffer_load_dwordx4 a[96:99], v240, s[36:39], s50 offen offset:0 sc1
buffer_load_dwordx4 a[100:103], v240, s[36:39], s50 offen offset:512 sc1
v_exp_f32 v222, v222
v_exp_f32 v223, v223
v_smfmac_f32_32x32x32_bf16 v[96:111], a[104:107], v[208:215], v36
v_exp_f32 v224, v224
v_exp_f32 v225, v225
v_exp_f32 v226, v226
v_mfma_f32_32x32x16_bf16 v[192:207], a[112:115], a[8:11], 0
v_exp_f32 v227, v227
v_exp_f32 v228, v228
v_exp_f32 v229, v229
v_smfmac_f32_16x16x64_bf16 v[168:171], v[32:35], v[208:215], v36
v_exp_f32 v230, v230
v_exp_f32 v231, v231
v_smfmac_f32_32x32x32_bf16 v[96:111], a[108:111], v[216:223], v36
v_exp_f32 v232, v232
v_exp_f32 v233, v233
v_exp_f32 v234, v234
v_mfma_f32_32x32x16_bf16 v[192:207], a[116:119], a[12:15], v[192:207]
v_exp_f32 v235, v235
v_exp_f32 v236, v236
v_exp_f32 v237, v237
v_smfmac_f32_16x16x64_bf16 v[168:171], v[32:35], v[216:223], v36
v_exp_f32 v238, v238
v_exp_f32 v239, v239
v_smfmac_f32_32x32x32_bf16 v[112:127], a[104:107], v[224:231], v36
v_exp_f32 v176, v176
v_exp_f32 v177, v177
v_exp_f32 v178, v178
v_mfma_f32_32x32x16_bf16 v[208:223], a[112:115], a[16:19], 0
v_exp_f32 v179, v179
v_exp_f32 v180, v180
v_exp_f32 v181, v181
v_smfmac_f32_16x16x64_bf16 v[172:175], v[32:35], v[224:231], v36
v_exp_f32 v182, v182
v_exp_f32 v183, v183
v_smfmac_f32_32x32x32_bf16 v[112:127], a[108:111], v[232:239], v36
v_exp_f32 v184, v184
v_exp_f32 v185, v185
v_exp_f32 v186, v186
v_mfma_f32_32x32x16_bf16 v[208:223], a[116:119], a[20:23], v[208:223]
v_exp_f32 v187, v187
v_exp_f32 v188, v188
v_exp_f32 v189, v189
v_smfmac_f32_16x16x64_bf16 v[172:175], v[32:35], v[232:239], v36
buffer_load_dwordx4 a[104:107], v241, s[36:39], s50 offen offset:2048 sc1
buffer_load_dwordx4 a[108:111], v241, s[36:39], s50 offen offset:2560 sc1
v_exp_f32 v190, v190
v_exp_f32 v191, v191
v_smfmac_f32_32x32x32_bf16 v[64:79], a[120:123], v[176:183], v36
v_exp_f32 v192, v192
v_exp_f32 v193, v193
v_exp_f32 v194, v194
v_mfma_f32_32x32x16_bf16 v[224:239], a[112:115], a[24:27], 0
v_exp_f32 v195, v195
v_exp_f32 v196, v196
v_exp_f32 v197, v197
v_smfmac_f32_16x16x64_bf16 v[160:163], v[32:35], v[176:183], v36
s_waitcnt vmcnt(8)
buffer_load_dword v254, v255, s[12:15], s62 offen
v_exp_f32 v198, v198
v_exp_f32 v199, v199
v_smfmac_f32_32x32x32_bf16 v[64:79], a[124:127], v[184:191], v36
s_mov_b32 s62, 6144
v_exp_f32 v200, v200
v_exp_f32 v201, v201
v_exp_f32 v202, v202
v_mfma_f32_32x32x16_bf16 v[224:239], a[116:119], a[28:31], v[224:239]
s_add_u32 s50, s50, 4096
v_exp_f32 v203, v203
v_exp_f32 v204, v204
v_exp_f32 v205, v205
v_smfmac_f32_16x16x64_bf16 v[160:163], v[32:35], v[184:191], v36
v_exp_f32 v206, v206
v_exp_f32 v207, v207
v_smfmac_f32_32x32x32_bf16 v[80:95], a[120:123], v[192:199], v36
v_exp_f32 v208, v208
v_exp_f32 v209, v209
v_exp_f32 v210, v210
v_mfma_f32_32x32x16_bf16 v[176:191], a[128:131], a[0:3], 0
v_exp_f32 v211, v211
v_exp_f32 v212, v212
v_exp_f32 v213, v213
v_smfmac_f32_16x16x64_bf16 v[164:167], v[32:35], v[192:199], v36
s_add_u32 m0, s48, 34816
s_nop 0
buffer_load_dwordx4 v249, s[16:19], s56 offen offset:2048 lds
v_exp_f32 v214, v214
v_exp_f32 v215, v215
v_smfmac_f32_32x32x32_bf16 v[80:95], a[124:127], v[200:207], v36
s_add_u32 s56, s56, 27648
v_exp_f32 v216, v216
v_exp_f32 v217, v217
v_exp_f32 v218, v218
v_mfma_f32_32x32x16_bf16 v[176:191], a[132:135], a[4:7], v[176:191]
v_exp_f32 v219, v219
v_exp_f32 v220, v220
v_exp_f32 v221, v221
v_smfmac_f32_16x16x64_bf16 v[164:167], v[32:35], v[200:207], v36
buffer_load_dwordx4 a[112:115], v240, s[36:39], s50 offen offset:0 sc1
buffer_load_dwordx4 a[116:119], v240, s[36:39], s50 offen offset:512 sc1
v_exp_f32 v222, v222
v_exp_f32 v223, v223
v_smfmac_f32_32x32x32_bf16 v[96:111], a[120:123], v[208:215], v36
v_exp_f32 v224, v224
v_exp_f32 v225, v225
v_exp_f32 v226, v226
v_mfma_f32_32x32x16_bf16 v[192:207], a[128:131], a[8:11], 0
v_exp_f32 v227, v227
v_exp_f32 v228, v228
v_exp_f32 v229, v229
v_smfmac_f32_16x16x64_bf16 v[168:171], v[32:35], v[208:215], v36
s_add_u32 m0, s48, 34816
s_nop 0
TP18:
s_cbranch_execz TP4
buffer_load_dwordx4 v249, s[16:19], s56 offen offset:3072 lds
v_exp_f32 v230, v230
v_exp_f32 v231, v231
v_smfmac_f32_32x32x32_bf16 v[96:111], a[124:127], v[216:223], v36
s_cmp_ge_u32 s44, 14
s_cselect_b32 s3, 2, 0
v_exp_f32 v232, v232
v_exp_f32 v233, v233
v_exp_f32 v234, v234
v_mfma_f32_32x32x16_bf16 v[192:207], a[132:135], a[12:15], v[192:207]
s_sub_u32 s59, s44, s3
v_exp_f32 v235, v235
v_exp_f32 v236, v236
v_exp_f32 v237, v237
v_smfmac_f32_16x16x64_bf16 v[168:171], v[32:35], v[216:223], v36
s_lshl2_add_u32 s59, s59, s40
v_exp_f32 v238, v238
v_exp_f32 v239, v239
v_smfmac_f32_32x32x32_bf16 v[112:127], a[120:123], v[224:231], v36
s_mul_i32 s56, s59, 37
v_exp_f32 v176, v176
v_exp_f32 v177, v177
v_exp_f32 v178, v178
v_mfma_f32_32x32x16_bf16 v[208:223], a[128:131], a[16:19], 0
s_lshr_b32 s56, s56, 8
v_exp_f32 v179, v179
v_exp_f32 v180, v180
v_exp_f32 v181, v181
v_smfmac_f32_16x16x64_bf16 v[172:175], v[32:35], v[224:231], v36
s_mul_i32 s3, s56, 7
v_exp_f32 v182, v182
v_exp_f32 v183, v183
v_smfmac_f32_32x32x32_bf16 v[112:127], a[124:127], v[232:239], v36
s_sub_u32 s57, s59, s3
v_exp_f32 v184, v184
v_exp_f32 v185, v185
v_exp_f32 v186, v186
v_mfma_f32_32x32x16_bf16 v[208:223], a[132:135], a[20:23], v[208:223]
s_mul_i32 s56, s56, 224
v_exp_f32 v187, v187
v_exp_f32 v188, v188
v_exp_f32 v189, v189
v_smfmac_f32_16x16x64_bf16 v[172:175], v[32:35], v[232:239], v36
buffer_load_dwordx4 a[120:123], v241, s[36:39], s50 offen offset:2048 sc1
buffer_load_dwordx4 a[124:127], v241, s[36:39], s50 offen offset:2560 sc1
v_exp_f32 v190, v190
v_exp_f32 v191, v191
v_smfmac_f32_32x32x32_bf16 v[64:79], a[136:139], v[176:183], v36
s_lshl_b32 s60, s57, 5
v_exp_f32 v192, v192
v_exp_f32 v193, v193
v_exp_f32 v194, v194
v_mfma_f32_32x32x16_bf16 v[224:239], a[128:131], a[24:27], 0
s_cmp_ge_u32 s57, 3
s_cselect_b32 s3, 16, 0
v_exp_f32 v195, v195
v_exp_f32 v196, v196
v_exp_f32 v197, v197
v_smfmac_f32_16x16x64_bf16 v[160:163], v[32:35], v[176:183], v36
s_add_u32 s60, s60, s3
v_exp_f32 v198, v198
v_exp_f32 v199, v199
v_smfmac_f32_32x32x32_bf16 v[64:79], a[140:143], v[184:191], v36
s_cmp_eq_u32 s57, 6
s_cselect_b32 s60, 96, s60
s_cselect_b32 s3, 196608, 0
v_exp_f32 v200, v200
v_exp_f32 v201, v201
v_exp_f32 v202, v202
v_mfma_f32_32x32x16_bf16 v[224:239], a[132:135], a[28:31], v[224:239]
s_add_u32 s50, s50, 4096
v_exp_f32 v203, v203
v_exp_f32 v204, v204
v_exp_f32 v205, v205
v_smfmac_f32_16x16x64_bf16 v[160:163], v[32:35], v[184:191], v36
v_exp_f32 v206, v206
v_exp_f32 v207, v207
v_smfmac_f32_32x32x32_bf16 v[80:95], a[136:139], v[192:199], v36
s_add_u32 s3, s3, 15360
v_exp_f32 v208, v208
v_exp_f32 v209, v209
v_exp_f32 v210, v210
v_mfma_f32_32x32x16_bf16 v[176:191], a[144:147], a[0:3], 0
s_add_u32 s56, s56, s60
v_exp_f32 v211, v211
v_exp_f32 v212, v212
v_exp_f32 v213, v213
v_smfmac_f32_16x16x64_bf16 v[164:167], v[32:35], v[192:199], v36
s_lshl_b32 s56, s56, 11
v_exp_f32 v214, v214
v_exp_f32 v215, v215
v_smfmac_f32_32x32x32_bf16 v[80:95], a[140:143], v[200:207], v36
s_lshl_b32 s60, s45, 7
v_exp_f32 v216, v216
v_exp_f32 v217, v217
v_exp_f32 v218, v218
v_mfma_f32_32x32x16_bf16 v[176:191], a[148:151], a[4:7], v[176:191]
s_add_u32 s56, s56, s60
v_exp_f32 v219, v219
v_exp_f32 v220, v220
v_exp_f32 v221, v221
v_smfmac_f32_16x16x64_bf16 v[164:167], v[32:35], v[200:207], v36
buffer_load_dwordx4 a[128:131], v240, s[36:39], s50 offen offset:0 sc1
buffer_load_dwordx4 a[132:135], v240, s[36:39], s50 offen offset:512 sc1
v_exp_f32 v222, v222
v_exp_f32 v223, v223
v_smfmac_f32_32x32x32_bf16 v[96:111], a[136:139], v[208:215], v36
v_exp_f32 v224, v224
v_exp_f32 v225, v225
v_exp_f32 v226, v226
v_mfma_f32_32x32x16_bf16 v[192:207], a[144:147], a[8:11], 0
v_exp_f32 v227, v227
v_exp_f32 v228, v228
v_exp_f32 v229, v229
v_smfmac_f32_16x16x64_bf16 v[168:171], v[32:35], v[208:215], v36
s_waitcnt vmcnt(8)
buffer_load_dword v254, v255, s[12:15], s62 offen
v_exp_f32 v230, v230
v_exp_f32 v231, v231
v_smfmac_f32_32x32x32_bf16 v[96:111], a[140:143], v[216:223], v36
s_mov_b32 s62, 8192
v_exp_f32 v232, v232
v_exp_f32 v233, v233
v_exp_f32 v234, v234
v_mfma_f32_32x32x16_bf16 v[192:207], a[148:151], a[12:15], v[192:207]
v_exp_f32 v235, v235
v_exp_f32 v236, v236
v_exp_f32 v237, v237
v_smfmac_f32_16x16x64_bf16 v[168:171], v[32:35], v[216:223], v36
s_add_u32 m0, s48, 26624
s_nop 0
buffer_load_dwordx4 v251, s[28:31], s56 offen offset:0 lds
v_exp_f32 v238, v238
v_exp_f32 v239, v239
v_smfmac_f32_32x32x32_bf16 v[112:127], a[136:139], v[224:231], v36
s_add_u32 s56, s56, 15360
v_exp_f32 v176, v176
v_exp_f32 v177, v177
v_exp_f32 v178, v178
v_mfma_f32_32x32x16_bf16 v[208:223], a[144:147], a[16:19], 0
v_exp_f32 v179, v179
v_exp_f32 v180, v180
v_exp_f32 v181, v181
v_smfmac_f32_16x16x64_bf16 v[172:175], v[32:35], v[224:231], v36
s_add_u32 m0, s48, 26624
s_nop 0
buffer_load_dwordx4 v251, s[28:31], s56 offen offset:1024 lds
v_exp_f32 v182, v182
v_exp_f32 v183, v183
v_smfmac_f32_32x32x32_bf16 v[112:127], a[140:143], v[232:239], v36
s_add_u32 s56, s56, s3
v_exp_f32 v184, v184
v_exp_f32 v185, v185
v_exp_f32 v186, v186
v_mfma_f32_32x32x16_bf16 v[208:223], a[148:151], a[20:23], v[208:223]
v_exp_f32 v187, v187
v_exp_f32 v188, v188
v_exp_f32 v189, v189
v_smfmac_f32_16x16x64_bf16 v[172:175], v[32:35], v[232:239], v36
buffer_load_dwordx4 a[136:139], v241, s[36:39], s50 offen offset:2048 sc1
buffer_load_dwordx4 a[140:143], v241, s[36:39], s50 offen offset:2560 sc1
v_exp_f32 v190, v190
v_exp_f32 v191, v191
v_smfmac_f32_32x32x32_bf16 v[64:79], a[152:155], v[176:183], v36
v_exp_f32 v192, v192
v_exp_f32 v193, v193
v_exp_f32 v194, v194
v_mfma_f32_32x32x16_bf16 v[224:239], a[144:147], a[24:27], 0
v_exp_f32 v195, v195
v_exp_f32 v196, v196
v_exp_f32 v197, v197
v_smfmac_f32_16x16x64_bf16 v[160:163], v[32:35], v[176:183], v36
v_exp_f32 v198, v198
v_exp_f32 v199, v199
v_smfmac_f32_32x32x32_bf16 v[64:79], a[156:159], v[184:191], v36
v_exp_f32 v200, v200
v_exp_f32 v201, v201
v_exp_f32 v202, v202
v_mfma_f32_32x32x16_bf16 v[224:239], a[148:151], a[28:31], v[224:239]
s_add_u32 s50, s50, 4096
v_exp_f32 v203, v203
v_exp_f32 v204, v204
v_exp_f32 v205, v205
v_smfmac_f32_16x16x64_bf16 v[160:163], v[32:35], v[184:191], v36
v_exp_f32 v206, v206
v_exp_f32 v207, v207
v_smfmac_f32_32x32x32_bf16 v[80:95], a[152:155], v[192:199], v36
v_exp_f32 v208, v208
v_exp_f32 v209, v209
v_exp_f32 v210, v210
v_mfma_f32_32x32x16_bf16 v[176:191], a[32:35], a[0:3], 0
v_exp_f32 v211, v211
v_exp_f32 v212, v212
v_exp_f32 v213, v213
TP19:
s_cbranch_execz TP6
TP20:
s_cbranch_execz TR0
v_smfmac_f32_16x16x64_bf16 v[164:167], v[32:35], v[192:199], v36
v_exp_f32 v214, v214
v_exp_f32 v215, v215
v_smfmac_f32_32x32x32_bf16 v[80:95], a[156:159], v[200:207], v36
v_exp_f32 v216, v216
v_exp_f32 v217, v217
v_exp_f32 v218, v218
v_mfma_f32_32x32x16_bf16 v[176:191], a[36:39], a[4:7], v[176:191]
v_exp_f32 v219, v219
v_exp_f32 v220, v220
v_exp_f32 v221, v221
v_smfmac_f32_16x16x64_bf16 v[164:167], v[32:35], v[200:207], v36
buffer_load_dwordx4 a[144:147], v240, s[36:39], s50 offen offset:0 sc1
buffer_load_dwordx4 a[148:151], v240, s[36:39], s50 offen offset:512 sc1
v_exp_f32 v222, v222
v_exp_f32 v223, v223
v_smfmac_f32_32x32x32_bf16 v[96:111], a[152:155], v[208:215], v36
v_exp_f32 v224, v224
v_exp_f32 v225, v225
v_exp_f32 v226, v226
v_mfma_f32_32x32x16_bf16 v[192:207], a[32:35], a[8:11], 0
v_exp_f32 v227, v227
v_exp_f32 v228, v228
v_exp_f32 v229, v229
v_smfmac_f32_16x16x64_bf16 v[168:171], v[32:35], v[208:215], v36
s_add_u32 m0, s48, 26624
s_nop 0
buffer_load_dwordx4 v251, s[28:31], s56 offen offset:2048 lds
v_exp_f32 v230, v230
v_exp_f32 v231, v231
v_smfmac_f32_32x32x32_bf16 v[96:111], a[156:159], v[216:223], v36
s_add_u32 s56, s56, 15360
v_exp_f32 v232, v232
v_exp_f32 v233, v233
v_exp_f32 v234, v234
v_mfma_f32_32x32x16_bf16 v[192:207], a[36:39], a[12:15], v[192:207]
v_exp_f32 v235, v235
v_exp_f32 v236, v236
v_exp_f32 v237, v237
v_smfmac_f32_16x16x64_bf16 v[168:171], v[32:35], v[216:223], v36
v_exp_f32 v238, v238
v_exp_f32 v239, v239
v_smfmac_f32_32x32x32_bf16 v[112:127], a[152:155], v[224:231], v36
v_exp_f32 v176, v176
v_exp_f32 v177, v177
v_exp_f32 v178, v178
v_mfma_f32_32x32x16_bf16 v[208:223], a[32:35], a[16:19], 0
v_exp_f32 v179, v179
v_exp_f32 v180, v180
v_exp_f32 v181, v181
v_smfmac_f32_16x16x64_bf16 v[172:175], v[32:35], v[224:231], v36
v_exp_f32 v182, v182
v_exp_f32 v183, v183
v_smfmac_f32_32x32x32_bf16 v[112:127], a[156:159], v[232:239], v36
v_exp_f32 v184, v184
v_exp_f32 v185, v185
v_exp_f32 v186, v186
v_mfma_f32_32x32x16_bf16 v[208:223], a[36:39], a[20:23], v[208:223]
v_exp_f32 v187, v187
v_exp_f32 v188, v188
v_exp_f32 v189, v189
v_smfmac_f32_16x16x64_bf16 v[172:175], v[32:35], v[232:239], v36
buffer_load_dwordx4 a[152:155], v241, s[36:39], s50 offen offset:2048 sc1
buffer_load_dwordx4 a[156:159], v241, s[36:39], s50 offen offset:2560 sc1
v_exp_f32 v190, v190
v_exp_f32 v191, v191
v_smfmac_f32_32x32x32_bf16 v[64:79], a[40:43], v[176:183], v36
v_exp_f32 v192, v192
v_exp_f32 v193, v193
v_exp_f32 v194, v194
v_mfma_f32_32x32x16_bf16 v[224:239], a[32:35], a[24:27], 0
v_exp_f32 v195, v195
v_exp_f32 v196, v196
v_exp_f32 v197, v197
v_smfmac_f32_16x16x64_bf16 v[160:163], v[32:35], v[176:183], v36
s_waitcnt vmcnt(9)
buffer_load_dword v254, v255, s[12:15], s62 offen
v_exp_f32 v198, v198
v_exp_f32 v199, v199
v_smfmac_f32_32x32x32_bf16 v[64:79], a[44:47], v[184:191], v36
s_mov_b32 s62, 10240
v_exp_f32 v200, v200
v_exp_f32 v201, v201
v_exp_f32 v202, v202
v_mfma_f32_32x32x16_bf16 v[224:239], a[36:39], a[28:31], v[224:239]
s_add_u32 s50, s50, 4096
v_exp_f32 v203, v203
v_exp_f32 v204, v204
v_exp_f32 v205, v205
v_smfmac_f32_16x16x64_bf16 v[160:163], v[32:35], v[184:191], v36
v_exp_f32 v206, v206
v_exp_f32 v207, v207
v_smfmac_f32_32x32x32_bf16 v[80:95], a[40:43], v[192:199], v36
v_exp_f32 v208, v208
v_exp_f32 v209, v209
v_exp_f32 v210, v210
v_mfma_f32_32x32x16_bf16 v[176:191], a[48:51], a[0:3], 0
v_exp_f32 v211, v211
v_exp_f32 v212, v212
v_exp_f32 v213, v213
v_smfmac_f32_16x16x64_bf16 v[164:167], v[32:35], v[192:199], v36
s_add_u32 m0, s48, 26624
s_nop 0
buffer_load_dwordx4 v251, s[28:31], s56 offen offset:3072 lds
v_exp_f32 v214, v214
v_exp_f32 v215, v215
v_smfmac_f32_32x32x32_bf16 v[80:95], a[44:47], v[200:207], v36
s_lshl_b32 s58, s47, 17
v_exp_f32 v216, v216
v_exp_f32 v217, v217
v_exp_f32 v218, v218
v_mfma_f32_32x32x16_bf16 v[176:191], a[52:55], a[4:7], v[176:191]
s_lshl_b32 s3, s45, 8
v_exp_f32 v219, v219
v_exp_f32 v220, v220
v_exp_f32 v221, v221
v_smfmac_f32_16x16x64_bf16 v[164:167], v[32:35], v[200:207], v36
buffer_load_dwordx4 a[32:35], v240, s[36:39], s50 offen offset:0 sc1
buffer_load_dwordx4 a[36:39], v240, s[36:39], s50 offen offset:512 sc1
v_exp_f32 v222, v222
v_exp_f32 v223, v223
v_smfmac_f32_32x32x32_bf16 v[96:111], a[40:43], v[208:215], v36
s_add_u32 s56, s58, s3
v_exp_f32 v224, v224
v_exp_f32 v225, v225
v_exp_f32 v226, v226
v_mfma_f32_32x32x16_bf16 v[192:207], a[48:51], a[8:11], 0
s_add_u32 s57, s56, 16384
v_exp_f32 v227, v227
v_exp_f32 v228, v228
v_exp_f32 v229, v229
v_smfmac_f32_16x16x64_bf16 v[168:171], v[32:35], v[208:215], v36
v_exp_f32 v230, v230
v_exp_f32 v231, v231
v_smfmac_f32_32x32x32_bf16 v[96:111], a[44:47], v[216:223], v36
v_exp_f32 v232, v232
v_exp_f32 v233, v233
v_exp_f32 v234, v234
v_mfma_f32_32x32x16_bf16 v[192:207], a[52:55], a[12:15], v[192:207]
v_exp_f32 v235, v235
v_exp_f32 v236, v236
v_exp_f32 v237, v237
v_smfmac_f32_16x16x64_bf16 v[168:171], v[32:35], v[216:223], v36
v_exp_f32 v238, v238
v_exp_f32 v239, v239
v_smfmac_f32_32x32x32_bf16 v[112:127], a[40:43], v[224:231], v36
v_exp_f32 v176, v176
v_exp_f32 v177, v177
v_exp_f32 v178, v178
v_mfma_f32_32x32x16_bf16 v[208:223], a[48:51], a[16:19], 0
v_exp_f32 v179, v179
v_exp_f32 v180, v180
v_exp_f32 v181, v181
v_smfmac_f32_16x16x64_bf16 v[172:175], v[32:35], v[224:231], v36
buffer_load_dwordx4 a[160:163], v253, s[20:23], s56 offen offset:0
buffer_load_dwordx4 a[168:171], v253, s[20:23], s56 offen offset:64
v_exp_f32 v182, v182
v_exp_f32 v183, v183
v_smfmac_f32_32x32x32_bf16 v[112:127], a[44:47], v[232:239], v36
v_exp_f32 v184, v184
v_exp_f32 v185, v185
v_exp_f32 v186, v186
v_mfma_f32_32x32x16_bf16 v[208:223], a[52:55], a[20:23], v[208:223]
v_exp_f32 v187, v187
v_exp_f32 v188, v188
v_exp_f32 v189, v189
v_smfmac_f32_16x16x64_bf16 v[172:175], v[32:35], v[232:239], v36
buffer_load_dwordx4 a[40:43], v241, s[36:39], s50 offen offset:2048 sc1
buffer_load_dwordx4 a[44:47], v241, s[36:39], s50 offen offset:2560 sc1
v_exp_f32 v190, v190
v_exp_f32 v191, v191
v_smfmac_f32_32x32x32_bf16 v[64:79], a[56:59], v[176:183], v36
v_exp_f32 v192, v192
v_exp_f32 v193, v193
v_exp_f32 v194, v194
v_mfma_f32_32x32x16_bf16 v[224:239], a[48:51], a[24:27], 0
v_exp_f32 v195, v195
v_exp_f32 v196, v196
v_exp_f32 v197, v197
v_smfmac_f32_16x16x64_bf16 v[160:163], v[32:35], v[176:183], v36
v_exp_f32 v198, v198
v_exp_f32 v199, v199
v_smfmac_f32_32x32x32_bf16 v[64:79], a[60:63], v[184:191], v36
v_exp_f32 v200, v200
v_exp_f32 v201, v201
v_exp_f32 v202, v202
v_mfma_f32_32x32x16_bf16 v[224:239], a[52:55], a[28:31], v[224:239]
s_add_u32 s50, s50, 4096
v_exp_f32 v203, v203
TP21:
s_cbranch_execz TP10
v_exp_f32 v204, v204
v_exp_f32 v205, v205
v_smfmac_f32_16x16x64_bf16 v[160:163], v[32:35], v[184:191], v36
v_exp_f32 v206, v206
v_exp_f32 v207, v207
v_smfmac_f32_32x32x32_bf16 v[80:95], a[56:59], v[192:199], v36
v_exp_f32 v208, v208
v_exp_f32 v209, v209
v_exp_f32 v210, v210
v_mfma_f32_32x32x16_bf16 v[176:191], a[64:67], a[0:3], 0
v_exp_f32 v211, v211
v_exp_f32 v212, v212
v_exp_f32 v213, v213
v_smfmac_f32_16x16x64_bf16 v[164:167], v[32:35], v[192:199], v36
v_exp_f32 v214, v214
v_exp_f32 v215, v215
v_smfmac_f32_32x32x32_bf16 v[80:95], a[60:63], v[200:207], v36
v_exp_f32 v216, v216
v_exp_f32 v217, v217
v_exp_f32 v218, v218
v_mfma_f32_32x32x16_bf16 v[176:191], a[68:71], a[4:7], v[176:191]
v_exp_f32 v219, v219
v_exp_f32 v220, v220
v_exp_f32 v221, v221
v_smfmac_f32_16x16x64_bf16 v[164:167], v[32:35], v[200:207], v36
buffer_load_dwordx4 a[48:51], v240, s[36:39], s50 offen offset:0 sc1
buffer_load_dwordx4 a[52:55], v240, s[36:39], s50 offen offset:512 sc1
v_exp_f32 v222, v222
v_exp_f32 v223, v223
v_smfmac_f32_32x32x32_bf16 v[96:111], a[56:59], v[208:215], v36
v_exp_f32 v224, v224
v_exp_f32 v225, v225
v_exp_f32 v226, v226
v_mfma_f32_32x32x16_bf16 v[192:207], a[64:67], a[8:11], 0
v_exp_f32 v227, v227
v_exp_f32 v228, v228
v_exp_f32 v229, v229
v_smfmac_f32_16x16x64_bf16 v[168:171], v[32:35], v[208:215], v36
s_waitcnt vmcnt(9)
buffer_load_dword v254, v255, s[12:15], s62 offen
v_exp_f32 v230, v230
v_exp_f32 v231, v231
v_smfmac_f32_32x32x32_bf16 v[96:111], a[60:63], v[216:223], v36
s_mov_b32 s62, 12288
v_exp_f32 v232, v232
v_exp_f32 v233, v233
v_exp_f32 v234, v234
v_mfma_f32_32x32x16_bf16 v[192:207], a[68:71], a[12:15], v[192:207]
v_exp_f32 v235, v235
v_exp_f32 v236, v236
v_exp_f32 v237, v237
v_smfmac_f32_16x16x64_bf16 v[168:171], v[32:35], v[216:223], v36
v_exp_f32 v238, v238
v_exp_f32 v239, v239
v_smfmac_f32_32x32x32_bf16 v[112:127], a[56:59], v[224:231], v36
v_exp_f32 v176, v176
v_exp_f32 v177, v177
v_exp_f32 v178, v178
v_mfma_f32_32x32x16_bf16 v[208:223], a[64:67], a[16:19], 0
v_exp_f32 v179, v179
v_exp_f32 v180, v180
v_exp_f32 v181, v181
v_smfmac_f32_16x16x64_bf16 v[172:175], v[32:35], v[224:231], v36
v_exp_f32 v182, v182
v_exp_f32 v183, v183
v_smfmac_f32_32x32x32_bf16 v[112:127], a[60:63], v[232:239], v36
v_exp_f32 v184, v184
v_exp_f32 v185, v185
v_exp_f32 v186, v186
v_mfma_f32_32x32x16_bf16 v[208:223], a[68:71], a[20:23], v[208:223]
v_exp_f32 v187, v187
v_exp_f32 v188, v188
v_exp_f32 v189, v189
v_smfmac_f32_16x16x64_bf16 v[172:175], v[32:35], v[232:239], v36
buffer_load_dwordx4 a[56:59], v241, s[36:39], s50 offen offset:2048 sc1
buffer_load_dwordx4 a[60:63], v241, s[36:39], s50 offen offset:2560 sc1
v_exp_f32 v190, v190
v_exp_f32 v191, v191
v_smfmac_f32_32x32x32_bf16 v[64:79], a[72:75], v[176:183], v36
v_exp_f32 v192, v192
v_exp_f32 v193, v193
v_exp_f32 v194, v194
v_mfma_f32_32x32x16_bf16 v[224:239], a[64:67], a[24:27], 0
v_exp_f32 v195, v195
v_exp_f32 v196, v196
v_exp_f32 v197, v197
v_smfmac_f32_16x16x64_bf16 v[160:163], v[32:35], v[176:183], v36
buffer_load_dwordx4 a[176:179], v253, s[20:23], s56 offen offset:128
buffer_load_dwordx4 a[184:187], v253, s[20:23], s56 offen offset:192
v_exp_f32 v198, v198
v_exp_f32 v199, v199
v_smfmac_f32_32x32x32_bf16 v[64:79], a[76:79], v[184:191], v36
v_exp_f32 v200, v200
v_exp_f32 v201, v201
v_exp_f32 v202, v202
v_mfma_f32_32x32x16_bf16 v[224:239], a[68:71], a[28:31], v[224:239]
s_add_u32 s50, s50, 4096
v_exp_f32 v203, v203
v_exp_f32 v204, v204
v_exp_f32 v205, v205
v_smfmac_f32_16x16x64_bf16 v[160:163], v[32:35], v[184:191], v36
v_exp_f32 v206, v206
v_exp_f32 v207, v207
v_smfmac_f32_32x32x32_bf16 v[80:95], a[72:75], v[192:199], v36
v_exp_f32 v208, v208
v_exp_f32 v209, v209
v_exp_f32 v210, v210
v_mfma_f32_32x32x16_bf16 v[176:191], a[80:83], a[0:3], 0
v_exp_f32 v211, v211
v_exp_f32 v212, v212
v_exp_f32 v213, v213
v_smfmac_f32_16x16x64_bf16 v[164:167], v[32:35], v[192:199], v36
v_exp_f32 v214, v214
v_exp_f32 v215, v215
v_smfmac_f32_32x32x32_bf16 v[80:95], a[76:79], v[200:207], v36
v_exp_f32 v216, v216
v_exp_f32 v217, v217
v_exp_f32 v218, v218
v_mfma_f32_32x32x16_bf16 v[176:191], a[84:87], a[4:7], v[176:191]
v_exp_f32 v219, v219
v_exp_f32 v220, v220
v_exp_f32 v221, v221
v_smfmac_f32_16x16x64_bf16 v[164:167], v[32:35], v[200:207], v36
buffer_load_dwordx4 a[64:67], v240, s[36:39], s50 offen offset:0 sc1
buffer_load_dwordx4 a[68:71], v240, s[36:39], s50 offen offset:512 sc1
v_exp_f32 v222, v222
v_exp_f32 v223, v223
v_smfmac_f32_32x32x32_bf16 v[96:111], a[72:75], v[208:215], v36
v_exp_f32 v224, v224
v_exp_f32 v225, v225
v_exp_f32 v226, v226
v_mfma_f32_32x32x16_bf16 v[192:207], a[80:83], a[8:11], 0
v_exp_f32 v227, v227
v_exp_f32 v228, v228
v_exp_f32 v229, v229
v_smfmac_f32_16x16x64_bf16 v[168:171], v[32:35], v[208:215], v36
v_exp_f32 v230, v230
v_exp_f32 v231, v231
v_smfmac_f32_32x32x32_bf16 v[96:111], a[76:79], v[216:223], v36
v_exp_f32 v232, v232
v_exp_f32 v233, v233
v_exp_f32 v234, v234
v_mfma_f32_32x32x16_bf16 v[192:207], a[84:87], a[12:15], v[192:207]
v_exp_f32 v235, v235
v_exp_f32 v236, v236
v_exp_f32 v237, v237
v_smfmac_f32_16x16x64_bf16 v[168:171], v[32:35], v[216:223], v36
v_exp_f32 v238, v238
v_exp_f32 v239, v239
v_smfmac_f32_32x32x32_bf16 v[112:127], a[72:75], v[224:231], v36
v_exp_f32 v176, v176
v_exp_f32 v177, v177
v_exp_f32 v178, v178
v_mfma_f32_32x32x16_bf16 v[208:223], a[80:83], a[16:19], 0
v_exp_f32 v179, v179
v_exp_f32 v180, v180
v_exp_f32 v181, v181
v_smfmac_f32_16x16x64_bf16 v[172:175], v[32:35], v[224:231], v36
v_exp_f32 v182, v182
v_exp_f32 v183, v183
v_smfmac_f32_32x32x32_bf16 v[112:127], a[76:79], v[232:239], v36
v_exp_f32 v184, v184
v_exp_f32 v185, v185
v_exp_f32 v186, v186
v_mfma_f32_32x32x16_bf16 v[208:223], a[84:87], a[20:23], v[208:223]
v_exp_f32 v187, v187
v_exp_f32 v188, v188
v_exp_f32 v189, v189
v_smfmac_f32_16x16x64_bf16 v[172:175], v[32:35], v[232:239], v36
buffer_load_dwordx4 a[72:75], v241, s[36:39], s50 offen offset:2048 sc1
buffer_load_dwordx4 a[76:79], v241, s[36:39], s50 offen offset:2560 sc1
v_exp_f32 v190, v190
v_exp_f32 v191, v191
v_smfmac_f32_32x32x32_bf16 v[64:79], a[88:91], v[176:183], v36
v_exp_f32 v192, v192
v_exp_f32 v193, v193
v_exp_f32 v194, v194
v_mfma_f32_32x32x16_bf16 v[224:239], a[80:83], a[24:27], 0
v_exp_f32 v195, v195
v_exp_f32 v196, v196
v_exp_f32 v197, v197
v_smfmac_f32_16x16x64_bf16 v[160:163], v[32:35], v[176:183], v36
s_waitcnt vmcnt(8)
buffer_load_dword v254, v255, s[12:15], s62 offen
v_exp_f32 v198, v198
v_exp_f32 v199, v199
v_smfmac_f32_32x32x32_bf16 v[64:79], a[92:95], v[184:191], v36
s_mov_b32 s62, 14336
v_exp_f32 v200, v200
v_exp_f32 v201, v201
v_exp_f32 v202, v202
v_mfma_f32_32x32x16_bf16 v[224:239], a[84:87], a[28:31], v[224:239]
TP22:
s_cbranch_execz TP2
s_add_u32 s50, s50, 4096
v_exp_f32 v203, v203
v_exp_f32 v204, v204
v_exp_f32 v205, v205
v_smfmac_f32_16x16x64_bf16 v[160:163], v[32:35], v[184:191], v36
v_exp_f32 v206, v206
v_exp_f32 v207, v207
v_smfmac_f32_32x32x32_bf16 v[80:95], a[88:91], v[192:199], v36
v_exp_f32 v208, v208
v_exp_f32 v209, v209
v_exp_f32 v210, v210
v_mfma_f32_32x32x16_bf16 v[176:191], a[96:99], a[0:3], 0
v_exp_f32 v211, v211
v_exp_f32 v212, v212
v_exp_f32 v213, v213
v_smfmac_f32_16x16x64_bf16 v[164:167], v[32:35], v[192:199], v36
buffer_load_dwordx4 a[164:167], v253, s[20:23], s57 offen offset:0
buffer_load_dwordx4 a[172:175], v253, s[20:23], s57 offen offset:64
v_exp_f32 v214, v214
v_exp_f32 v215, v215
v_smfmac_f32_32x32x32_bf16 v[80:95], a[92:95], v[200:207], v36
v_exp_f32 v216, v216
v_exp_f32 v217, v217
v_exp_f32 v218, v218
v_mfma_f32_32x32x16_bf16 v[176:191], a[100:103], a[4:7], v[176:191]
v_exp_f32 v219, v219
v_exp_f32 v220, v220
v_exp_f32 v221, v221
v_smfmac_f32_16x16x64_bf16 v[164:167], v[32:35], v[200:207], v36
buffer_load_dwordx4 a[80:83], v240, s[36:39], s50 offen offset:0 sc1
buffer_load_dwordx4 a[84:87], v240, s[36:39], s50 offen offset:512 sc1
v_exp_f32 v222, v222
v_exp_f32 v223, v223
v_smfmac_f32_32x32x32_bf16 v[96:111], a[88:91], v[208:215], v36
v_exp_f32 v224, v224
v_exp_f32 v225, v225
v_exp_f32 v226, v226
v_mfma_f32_32x32x16_bf16 v[192:207], a[96:99], a[8:11], 0
v_exp_f32 v227, v227
v_exp_f32 v228, v228
v_exp_f32 v229, v229
v_smfmac_f32_16x16x64_bf16 v[168:171], v[32:35], v[208:215], v36
v_exp_f32 v230, v230
v_exp_f32 v231, v231
v_smfmac_f32_32x32x32_bf16 v[96:111], a[92:95], v[216:223], v36
v_exp_f32 v232, v232
v_exp_f32 v233, v233
v_exp_f32 v234, v234
v_mfma_f32_32x32x16_bf16 v[192:207], a[100:103], a[12:15], v[192:207]
v_exp_f32 v235, v235
v_exp_f32 v236, v236
v_exp_f32 v237, v237
v_smfmac_f32_16x16x64_bf16 v[168:171], v[32:35], v[216:223], v36
v_exp_f32 v238, v238
v_exp_f32 v239, v239
v_smfmac_f32_32x32x32_bf16 v[112:127], a[88:91], v[224:231], v36
v_exp_f32 v176, v176
v_exp_f32 v177, v177
v_exp_f32 v178, v178
v_mfma_f32_32x32x16_bf16 v[208:223], a[96:99], a[16:19], 0
v_exp_f32 v179, v179
v_exp_f32 v180, v180
v_exp_f32 v181, v181
v_smfmac_f32_16x16x64_bf16 v[172:175], v[32:35], v[224:231], v36
v_exp_f32 v182, v182
v_exp_f32 v183, v183
v_smfmac_f32_32x32x32_bf16 v[112:127], a[92:95], v[232:239], v36
v_exp_f32 v184, v184
v_exp_f32 v185, v185
v_exp_f32 v186, v186
v_mfma_f32_32x32x16_bf16 v[208:223], a[100:103], a[20:23], v[208:223]
v_exp_f32 v187, v187
v_exp_f32 v188, v188
v_exp_f32 v189, v189
v_smfmac_f32_16x16x64_bf16 v[172:175], v[32:35], v[232:239], v36
buffer_load_dwordx4 a[88:91], v241, s[36:39], s50 offen offset:2048 sc1
buffer_load_dwordx4 a[92:95], v241, s[36:39], s50 offen offset:2560 sc1
v_exp_f32 v190, v190
v_exp_f32 v191, v191
v_smfmac_f32_32x32x32_bf16 v[64:79], a[104:107], v[176:183], v36
v_exp_f32 v192, v192
v_exp_f32 v193, v193
v_exp_f32 v194, v194
v_mfma_f32_32x32x16_bf16 v[224:239], a[96:99], a[24:27], 0
v_exp_f32 v195, v195
v_exp_f32 v196, v196
v_exp_f32 v197, v197
v_smfmac_f32_16x16x64_bf16 v[160:163], v[32:35], v[176:183], v36
v_exp_f32 v198, v198
v_exp_f32 v199, v199
v_smfmac_f32_32x32x32_bf16 v[64:79], a[108:111], v[184:191], v36
v_exp_f32 v200, v200
v_exp_f32 v201, v201
v_exp_f32 v202, v202
v_mfma_f32_32x32x16_bf16 v[224:239], a[100:103], a[28:31], v[224:239]
s_add_u32 s50, s50, 4096
v_exp_f32 v203, v203
v_exp_f32 v204, v204
v_exp_f32 v205, v205
v_smfmac_f32_16x16x64_bf16 v[160:163], v[32:35], v[184:191], v36
v_exp_f32 v206, v206
v_exp_f32 v207, v207
v_smfmac_f32_32x32x32_bf16 v[80:95], a[104:107], v[192:199], v36
v_exp_f32 v208, v208
v_exp_f32 v209, v209
v_exp_f32 v210, v210
v_mfma_f32_32x32x16_bf16 v[176:191], a[112:115], a[0:3], 0
v_exp_f32 v211, v211
v_exp_f32 v212, v212
v_exp_f32 v213, v213
v_smfmac_f32_16x16x64_bf16 v[164:167], v[32:35], v[192:199], v36
v_exp_f32 v214, v214
v_exp_f32 v215, v215
v_smfmac_f32_32x32x32_bf16 v[80:95], a[108:111], v[200:207], v36
v_exp_f32 v216, v216
v_exp_f32 v217, v217
v_exp_f32 v218, v218
v_mfma_f32_32x32x16_bf16 v[176:191], a[116:119], a[4:7], v[176:191]
v_exp_f32 v219, v219
v_exp_f32 v220, v220
v_exp_f32 v221, v221
v_smfmac_f32_16x16x64_bf16 v[164:167], v[32:35], v[200:207], v36
buffer_load_dwordx4 a[96:99], v240, s[36:39], s50 offen offset:0 sc1
buffer_load_dwordx4 a[100:103], v240, s[36:39], s50 offen offset:512 sc1
v_exp_f32 v222, v222
v_exp_f32 v223, v223
v_smfmac_f32_32x32x32_bf16 v[96:111], a[104:107], v[208:215], v36
v_exp_f32 v224, v224
v_exp_f32 v225, v225
v_exp_f32 v226, v226
v_mfma_f32_32x32x16_bf16 v[192:207], a[112:115], a[8:11], 0
v_exp_f32 v227, v227
v_exp_f32 v228, v228
v_exp_f32 v229, v229
v_smfmac_f32_16x16x64_bf16 v[168:171], v[32:35], v[208:215], v36
s_waitcnt vmcnt(8)
buffer_load_dword v254, v255, s[12:15], s62 offen
v_exp_f32 v230, v230
v_exp_f32 v231, v231
v_smfmac_f32_32x32x32_bf16 v[96:111], a[108:111], v[216:223], v36
v_exp_f32 v232, v232
v_exp_f32 v233, v233
v_exp_f32 v234, v234
v_mfma_f32_32x32x16_bf16 v[192:207], a[116:119], a[12:15], v[192:207]
v_exp_f32 v235, v235
v_exp_f32 v236, v236
v_exp_f32 v237, v237
v_smfmac_f32_16x16x64_bf16 v[168:171], v[32:35], v[216:223], v36
buffer_load_dwordx4 a[180:183], v253, s[20:23], s57 offen offset:128
buffer_load_dwordx4 a[188:191], v253, s[20:23], s57 offen offset:192
v_exp_f32 v238, v238
v_exp_f32 v239, v239
v_smfmac_f32_32x32x32_bf16 v[112:127], a[104:107], v[224:231], v36
s_add_u32 s56, s64, 8192
v_exp_f32 v176, v176
v_exp_f32 v177, v177
v_exp_f32 v178, v178
v_mfma_f32_32x32x16_bf16 v[208:223], a[112:115], a[16:19], 0
v_exp_f32 v179, v179
v_exp_f32 v180, v180
v_exp_f32 v181, v181
v_smfmac_f32_16x16x64_bf16 v[172:175], v[32:35], v[224:231], v36
v_exp_f32 v182, v182
v_exp_f32 v183, v183
v_smfmac_f32_32x32x32_bf16 v[112:127], a[108:111], v[232:239], v36
v_exp_f32 v184, v184
v_exp_f32 v185, v185
v_exp_f32 v186, v186
v_mfma_f32_32x32x16_bf16 v[208:223], a[116:119], a[20:23], v[208:223]
v_exp_f32 v187, v187
v_exp_f32 v188, v188
v_exp_f32 v189, v189
v_smfmac_f32_16x16x64_bf16 v[172:175], v[32:35], v[232:239], v36
buffer_load_dwordx4 a[104:107], v241, s[36:39], s50 offen offset:2048 sc1
buffer_load_dwordx4 a[108:111], v241, s[36:39], s50 offen offset:2560 sc1
v_exp_f32 v190, v190
v_exp_f32 v191, v191
v_smfmac_f32_32x32x32_bf16 v[64:79], a[120:123], v[176:183], v36
v_exp_f32 v192, v192
v_exp_f32 v193, v193
v_exp_f32 v194, v194
v_mfma_f32_32x32x16_bf16 v[224:239], a[112:115], a[24:27], 0
v_exp_f32 v195, v195
v_exp_f32 v196, v196
v_exp_f32 v197, v197
v_smfmac_f32_16x16x64_bf16 v[160:163], v[32:35], v[176:183], v36
v_exp_f32 v198, v198
v_exp_f32 v199, v199
v_smfmac_f32_32x32x32_bf16 v[64:79], a[124:127], v[184:191], v36
v_exp_f32 v200, v200
v_exp_f32 v201, v201
v_exp_f32 v202, v202
TP23:
s_cbranch_execz TP4
v_mfma_f32_32x32x16_bf16 v[224:239], a[116:119], a[28:31], v[224:239]
s_add_u32 s50, s50, 4096
v_exp_f32 v203, v203
v_exp_f32 v204, v204
v_exp_f32 v205, v205
v_smfmac_f32_16x16x64_bf16 v[160:163], v[32:35], v[184:191], v36
v_exp_f32 v206, v206
v_exp_f32 v207, v207
v_smfmac_f32_32x32x32_bf16 v[80:95], a[120:123], v[192:199], v36
v_exp_f32 v208, v208
v_exp_f32 v209, v209
v_exp_f32 v210, v210
v_mfma_f32_32x32x16_bf16 v[176:191], a[128:131], a[0:3], 0
v_exp_f32 v211, v211
v_exp_f32 v212, v212
v_exp_f32 v213, v213
v_smfmac_f32_16x16x64_bf16 v[164:167], v[32:35], v[192:199], v36
v_exp_f32 v214, v214
v_exp_f32 v215, v215
v_smfmac_f32_32x32x32_bf16 v[80:95], a[124:127], v[200:207], v36
v_exp_f32 v216, v216
v_exp_f32 v217, v217
v_exp_f32 v218, v218
v_mfma_f32_32x32x16_bf16 v[176:191], a[132:135], a[4:7], v[176:191]
v_exp_f32 v219, v219
v_exp_f32 v220, v220
v_exp_f32 v221, v221
v_smfmac_f32_16x16x64_bf16 v[164:167], v[32:35], v[200:207], v36
buffer_load_dwordx4 a[112:115], v240, s[36:39], s50 offen offset:0 sc1
buffer_load_dwordx4 a[116:119], v240, s[36:39], s50 offen offset:512 sc1
v_exp_f32 v222, v222
v_exp_f32 v223, v223
v_smfmac_f32_32x32x32_bf16 v[96:111], a[120:123], v[208:215], v36
v_exp_f32 v224, v224
v_exp_f32 v225, v225
v_exp_f32 v226, v226
v_mfma_f32_32x32x16_bf16 v[192:207], a[128:131], a[8:11], 0
v_exp_f32 v227, v227
v_exp_f32 v228, v228
v_exp_f32 v229, v229
v_smfmac_f32_16x16x64_bf16 v[168:171], v[32:35], v[208:215], v36
v_exp_f32 v230, v230
v_exp_f32 v231, v231
v_smfmac_f32_32x32x32_bf16 v[96:111], a[124:127], v[216:223], v36
v_exp_f32 v232, v232
v_exp_f32 v233, v233
v_exp_f32 v234, v234
v_mfma_f32_32x32x16_bf16 v[192:207], a[132:135], a[12:15], v[192:207]
v_exp_f32 v235, v235
v_exp_f32 v236, v236
v_exp_f32 v237, v237
v_smfmac_f32_16x16x64_bf16 v[168:171], v[32:35], v[216:223], v36
v_exp_f32 v238, v238
v_exp_f32 v239, v239
v_smfmac_f32_32x32x32_bf16 v[112:127], a[120:123], v[224:231], v36
s_lshl1_add_u32 s67, s45, s55
v_exp_f32 v176, v176
v_exp_f32 v177, v177
v_exp_f32 v178, v178
v_mfma_f32_32x32x16_bf16 v[208:223], a[128:131], a[16:19], 0
s_lshl_b32 s67, s67, 5
v_exp_f32 v179, v179
v_exp_f32 v180, v180
v_exp_f32 v181, v181
v_smfmac_f32_16x16x64_bf16 v[172:175], v[32:35], v[224:231], v36
s_add_u32 s67, s67, s54
v_exp_f32 v182, v182
v_exp_f32 v183, v183
v_smfmac_f32_32x32x32_bf16 v[112:127], a[124:127], v[232:239], v36
s_mul_i32 s65, s67, 7168
v_exp_f32 v184, v184
v_exp_f32 v185, v185
v_exp_f32 v186, v186
v_mfma_f32_32x32x16_bf16 v[208:223], a[132:135], a[20:23], v[208:223]
s_add_u32 s65, s65, 20971520
v_exp_f32 v187, v187
v_exp_f32 v188, v188
v_exp_f32 v189, v189
v_smfmac_f32_16x16x64_bf16 v[172:175], v[32:35], v[232:239], v36
buffer_load_dwordx4 a[120:123], v241, s[36:39], s50 offen offset:2048 sc1
buffer_load_dwordx4 a[124:127], v241, s[36:39], s50 offen offset:2560 sc1
v_exp_f32 v190, v190
v_exp_f32 v191, v191
v_smfmac_f32_32x32x32_bf16 v[64:79], a[136:139], v[176:183], v36
s_add_u32 s66, s65, 4096
v_exp_f32 v192, v192
v_exp_f32 v193, v193
v_exp_f32 v194, v194
v_mfma_f32_32x32x16_bf16 v[224:239], a[128:131], a[24:27], 0
v_exp_f32 v195, v195
v_exp_f32 v196, v196
v_exp_f32 v197, v197
v_smfmac_f32_16x16x64_bf16 v[160:163], v[32:35], v[176:183], v36
buffer_load_dwordx4 v[48:51], v10, s[4:7], s64 offen offset:0
buffer_load_dwordx4 v[52:55], v10, s[4:7], s64 offen offset:64
v_exp_f32 v198, v198
v_exp_f32 v199, v199
v_smfmac_f32_32x32x32_bf16 v[64:79], a[140:143], v[184:191], v36
v_exp_f32 v200, v200
v_exp_f32 v201, v201
v_exp_f32 v202, v202
v_mfma_f32_32x32x16_bf16 v[224:239], a[132:135], a[28:31], v[224:239]
s_add_u32 s50, s50, 4096
v_exp_f32 v203, v203
v_exp_f32 v204, v204
v_exp_f32 v205, v205
v_smfmac_f32_16x16x64_bf16 v[160:163], v[32:35], v[184:191], v36
v_exp_f32 v206, v206
v_exp_f32 v207, v207
v_smfmac_f32_32x32x32_bf16 v[80:95], a[136:139], v[192:199], v36
v_exp_f32 v208, v208
v_exp_f32 v209, v209
v_exp_f32 v210, v210
v_mfma_f32_32x32x16_bf16 v[176:191], a[144:147], a[0:3], 0
v_exp_f32 v211, v211
v_exp_f32 v212, v212
v_exp_f32 v213, v213
v_smfmac_f32_16x16x64_bf16 v[164:167], v[32:35], v[192:199], v36
v_exp_f32 v214, v214
v_exp_f32 v215, v215
v_smfmac_f32_32x32x32_bf16 v[80:95], a[140:143], v[200:207], v36
v_exp_f32 v216, v216
v_exp_f32 v217, v217
v_exp_f32 v218, v218
v_mfma_f32_32x32x16_bf16 v[176:191], a[148:151], a[4:7], v[176:191]
v_exp_f32 v219, v219
v_exp_f32 v220, v220
v_exp_f32 v221, v221
v_smfmac_f32_16x16x64_bf16 v[164:167], v[32:35], v[200:207], v36
buffer_load_dwordx4 a[128:131], v240, s[36:39], s50 offen offset:0 sc1
buffer_load_dwordx4 a[132:135], v240, s[36:39], s50 offen offset:512 sc1
v_exp_f32 v222, v222
v_exp_f32 v223, v223
v_smfmac_f32_32x32x32_bf16 v[96:111], a[136:139], v[208:215], v36
v_exp_f32 v224, v224
v_exp_f32 v225, v225
v_exp_f32 v226, v226
v_mfma_f32_32x32x16_bf16 v[192:207], a[144:147], a[8:11], 0
v_exp_f32 v227, v227
v_exp_f32 v228, v228
v_exp_f32 v229, v229
v_smfmac_f32_16x16x64_bf16 v[168:171], v[32:35], v[208:215], v36
ds_read_b64_tr_b16 a[192:193], v250 offset:30720
ds_read_b64_tr_b16 a[194:195], v250 offset:34816
v_exp_f32 v230, v230
v_exp_f32 v231, v231
v_smfmac_f32_32x32x32_bf16 v[96:111], a[140:143], v[216:223], v36
v_exp_f32 v232, v232
v_exp_f32 v233, v233
v_exp_f32 v234, v234
v_mfma_f32_32x32x16_bf16 v[192:207], a[148:151], a[12:15], v[192:207]
v_exp_f32 v235, v235
v_exp_f32 v236, v236
v_exp_f32 v237, v237
v_smfmac_f32_16x16x64_bf16 v[168:171], v[32:35], v[216:223], v36
v_exp_f32 v238, v238
v_exp_f32 v239, v239
v_smfmac_f32_32x32x32_bf16 v[112:127], a[136:139], v[224:231], v36
v_exp_f32 v176, v176
v_exp_f32 v177, v177
v_exp_f32 v178, v178
v_mfma_f32_32x32x16_bf16 v[208:223], a[144:147], a[16:19], 0
v_exp_f32 v179, v179
v_exp_f32 v180, v180
v_exp_f32 v181, v181
v_smfmac_f32_16x16x64_bf16 v[172:175], v[32:35], v[224:231], v36
s_waitcnt lgkmcnt(0)
buffer_store_dwordx4 a[192:195], v1, s[36:39], s65 offen offset:0 sc1
v_mfma_f32_16x16x32_bf16 v[128:131], v[40:43], a[192:195], 0
v_exp_f32 v182, v182
v_exp_f32 v183, v183
v_smfmac_f32_32x32x32_bf16 v[112:127], a[140:143], v[232:239], v36
v_exp_f32 v184, v184
v_exp_f32 v185, v185
v_exp_f32 v186, v186
v_mfma_f32_32x32x16_bf16 v[208:223], a[148:151], a[20:23], v[208:223]
v_exp_f32 v187, v187
v_exp_f32 v188, v188
v_exp_f32 v189, v189
v_smfmac_f32_16x16x64_bf16 v[172:175], v[32:35], v[232:239], v36
buffer_load_dwordx4 a[136:139], v241, s[36:39], s50 offen offset:2048 sc1
buffer_load_dwordx4 a[140:143], v241, s[36:39], s50 offen offset:2560 sc1
v_exp_f32 v190, v190
v_exp_f32 v191, v191
v_smfmac_f32_32x32x32_bf16 v[64:79], a[152:155], v[176:183], v36
v_exp_f32 v192, v192
v_exp_f32 v193, v193
v_exp_f32 v194, v194
v_mfma_f32_32x32x16_bf16 v[224:239], a[144:147], a[24:27], 0
v_exp_f32 v195, v195
TP24:
s_cbranch_execz TP6
TP25:
s_cbranch_execz TR0
v_exp_f32 v196, v196
v_exp_f32 v197, v197
v_smfmac_f32_16x16x64_bf16 v[160:163], v[32:35], v[176:183], v36
ds_read_b64_tr_b16 a[196:197], v250 offset:30752
ds_read_b64_tr_b16 a[198:199], v250 offset:34848
v_exp_f32 v198, v198
v_exp_f32 v199, v199
v_smfmac_f32_32x32x32_bf16 v[64:79], a[156:159], v[184:191], v36
v_exp_f32 v200, v200
v_exp_f32 v201, v201
v_exp_f32 v202, v202
v_mfma_f32_32x32x16_bf16 v[224:239], a[148:151], a[28:31], v[224:239]
s_add_u32 s50, s50, 4096
v_exp_f32 v203, v203
v_exp_f32 v204, v204
v_exp_f32 v205, v205
v_smfmac_f32_16x16x64_bf16 v[160:163], v[32:35], v[184:191], v36
v_exp_f32 v206, v206
v_exp_f32 v207, v207
v_smfmac_f32_32x32x32_bf16 v[80:95], a[152:155], v[192:199], v36
v_exp_f32 v208, v208
v_exp_f32 v209, v209
v_exp_f32 v210, v210
v_mfma_f32_32x32x16_bf16 v[176:191], a[32:35], a[0:3], 0
v_exp_f32 v211, v211
v_exp_f32 v212, v212
v_exp_f32 v213, v213
v_smfmac_f32_16x16x64_bf16 v[164:167], v[32:35], v[192:199], v36
s_waitcnt lgkmcnt(0)
buffer_store_dwordx4 a[196:199], v1, s[36:39], s65 offen offset:1024 sc1
v_mfma_f32_16x16x32_bf16 v[132:135], v[40:43], a[196:199], 0
v_exp_f32 v214, v214
v_exp_f32 v215, v215
v_smfmac_f32_32x32x32_bf16 v[80:95], a[156:159], v[200:207], v36
v_exp_f32 v216, v216
v_exp_f32 v217, v217
v_exp_f32 v218, v218
v_mfma_f32_32x32x16_bf16 v[176:191], a[36:39], a[4:7], v[176:191]
v_exp_f32 v219, v219
v_exp_f32 v220, v220
v_exp_f32 v221, v221
v_smfmac_f32_16x16x64_bf16 v[164:167], v[32:35], v[200:207], v36
buffer_load_dwordx4 a[144:147], v240, s[36:39], s50 offen offset:0 sc1
buffer_load_dwordx4 a[148:151], v240, s[36:39], s50 offen offset:512 sc1
v_exp_f32 v222, v222
v_exp_f32 v223, v223
v_smfmac_f32_32x32x32_bf16 v[96:111], a[152:155], v[208:215], v36
v_exp_f32 v224, v224
v_exp_f32 v225, v225
v_exp_f32 v226, v226
v_mfma_f32_32x32x16_bf16 v[192:207], a[32:35], a[8:11], 0
v_exp_f32 v227, v227
v_exp_f32 v228, v228
v_exp_f32 v229, v229
v_smfmac_f32_16x16x64_bf16 v[168:171], v[32:35], v[208:215], v36
ds_read_b64_tr_b16 a[200:201], v250 offset:30784
ds_read_b64_tr_b16 a[202:203], v250 offset:34880
v_exp_f32 v230, v230
v_exp_f32 v231, v231
v_smfmac_f32_32x32x32_bf16 v[96:111], a[156:159], v[216:223], v36
v_exp_f32 v232, v232
v_exp_f32 v233, v233
v_exp_f32 v234, v234
v_mfma_f32_32x32x16_bf16 v[192:207], a[36:39], a[12:15], v[192:207]
v_exp_f32 v235, v235
v_exp_f32 v236, v236
v_exp_f32 v237, v237
v_smfmac_f32_16x16x64_bf16 v[168:171], v[32:35], v[216:223], v36
buffer_load_dwordx4 v[56:59], v10, s[4:7], s56 offen offset:0
buffer_load_dwordx4 v[60:63], v10, s[4:7], s56 offen offset:64
v_exp_f32 v238, v238
v_exp_f32 v239, v239
v_smfmac_f32_32x32x32_bf16 v[112:127], a[152:155], v[224:231], v36
s_lshl_b32 s62, s52, 18
v_exp_f32 v176, v176
v_exp_f32 v177, v177
v_exp_f32 v178, v178
v_mfma_f32_32x32x16_bf16 v[208:223], a[32:35], a[16:19], 0
v_exp_f32 v179, v179
v_exp_f32 v180, v180
v_exp_f32 v181, v181
v_smfmac_f32_16x16x64_bf16 v[172:175], v[32:35], v[224:231], v36
s_add_u32 m0, s48, 0
s_nop 0
buffer_load_dwordx4 v247, s[12:15], s62 offen offset:0 lds
buffer_load_dwordx4 v248, s[12:15], s62 offen offset:1024 lds
v_exp_f32 v182, v182
v_exp_f32 v183, v183
v_smfmac_f32_32x32x32_bf16 v[112:127], a[156:159], v[232:239], v36
s_add_u32 s62, s62, 131072
v_exp_f32 v184, v184
v_exp_f32 v185, v185
v_exp_f32 v186, v186
v_mfma_f32_32x32x16_bf16 v[208:223], a[36:39], a[20:23], v[208:223]
s_and_b32 s62, s62, 0x1fffff
v_exp_f32 v187, v187
v_exp_f32 v188, v188
v_exp_f32 v189, v189
v_smfmac_f32_16x16x64_bf16 v[172:175], v[32:35], v[232:239], v36
buffer_load_dwordx4 a[152:155], v241, s[36:39], s50 offen offset:2048 sc1
buffer_load_dwordx4 a[156:159], v241, s[36:39], s50 offen offset:2560 sc1
v_exp_f32 v190, v190
v_exp_f32 v191, v191
v_smfmac_f32_32x32x32_bf16 v[64:79], a[40:43], v[176:183], v36
v_exp_f32 v192, v192
v_exp_f32 v193, v193
v_exp_f32 v194, v194
v_mfma_f32_32x32x16_bf16 v[224:239], a[32:35], a[24:27], 0
v_exp_f32 v195, v195
v_exp_f32 v196, v196
v_exp_f32 v197, v197
v_smfmac_f32_16x16x64_bf16 v[160:163], v[32:35], v[176:183], v36
s_waitcnt lgkmcnt(0)
buffer_store_dwordx4 a[200:203], v1, s[36:39], s65 offen offset:2048 sc1
v_mfma_f32_16x16x32_bf16 v[136:139], v[40:43], a[200:203], 0
v_exp_f32 v198, v198
v_exp_f32 v199, v199
v_smfmac_f32_32x32x32_bf16 v[64:79], a[44:47], v[184:191], v36
v_exp_f32 v200, v200
v_exp_f32 v201, v201
v_exp_f32 v202, v202
v_mfma_f32_32x32x16_bf16 v[224:239], a[36:39], a[28:31], v[224:239]
s_add_u32 s50, s50, 4096
v_exp_f32 v203, v203
v_exp_f32 v204, v204
v_exp_f32 v205, v205
v_smfmac_f32_16x16x64_bf16 v[160:163], v[32:35], v[184:191], v36
v_exp_f32 v206, v206
v_exp_f32 v207, v207
v_smfmac_f32_32x32x32_bf16 v[80:95], a[40:43], v[192:199], v36
v_exp_f32 v208, v208
v_exp_f32 v209, v209
v_exp_f32 v210, v210
v_mfma_f32_32x32x16_bf16 v[176:191], a[48:51], a[0:3], 0
v_exp_f32 v211, v211
v_exp_f32 v212, v212
v_exp_f32 v213, v213
v_smfmac_f32_16x16x64_bf16 v[164:167], v[32:35], v[192:199], v36
ds_read_b64_tr_b16 a[204:205], v250 offset:30816
ds_read_b64_tr_b16 a[206:207], v250 offset:34912
v_exp_f32 v214, v214
v_exp_f32 v215, v215
v_smfmac_f32_32x32x32_bf16 v[80:95], a[44:47], v[200:207], v36
v_exp_f32 v216, v216
v_exp_f32 v217, v217
v_exp_f32 v218, v218
v_mfma_f32_32x32x16_bf16 v[176:191], a[52:55], a[4:7], v[176:191]
v_exp_f32 v219, v219
v_exp_f32 v220, v220
v_exp_f32 v221, v221
v_smfmac_f32_16x16x64_bf16 v[164:167], v[32:35], v[200:207], v36
buffer_load_dwordx4 a[32:35], v240, s[36:39], s50 offen offset:0 sc1
buffer_load_dwordx4 a[36:39], v240, s[36:39], s50 offen offset:512 sc1
v_exp_f32 v222, v222
v_exp_f32 v223, v223
v_smfmac_f32_32x32x32_bf16 v[96:111], a[40:43], v[208:215], v36
v_exp_f32 v224, v224
v_exp_f32 v225, v225
v_exp_f32 v226, v226
v_mfma_f32_32x32x16_bf16 v[192:207], a[48:51], a[8:11], 0
v_exp_f32 v227, v227
v_exp_f32 v228, v228
v_exp_f32 v229, v229
v_smfmac_f32_16x16x64_bf16 v[168:171], v[32:35], v[208:215], v36
s_waitcnt lgkmcnt(0)
buffer_store_dwordx4 a[204:207], v1, s[36:39], s65 offen offset:3072 sc1
v_mfma_f32_16x16x32_bf16 v[140:143], v[40:43], a[204:207], 0
v_exp_f32 v230, v230
v_exp_f32 v231, v231
v_smfmac_f32_32x32x32_bf16 v[96:111], a[44:47], v[216:223], v36
v_exp_f32 v232, v232
v_exp_f32 v233, v233
v_exp_f32 v234, v234
v_mfma_f32_32x32x16_bf16 v[192:207], a[52:55], a[12:15], v[192:207]
v_exp_f32 v235, v235
v_exp_f32 v236, v236
v_exp_f32 v237, v237
v_smfmac_f32_16x16x64_bf16 v[168:171], v[32:35], v[216:223], v36
ds_read_b64_tr_b16 a[208:209], v250 offset:30848
ds_read_b64_tr_b16 a[210:211], v250 offset:34944
v_exp_f32 v238, v238
v_exp_f32 v239, v239
v_smfmac_f32_32x32x32_bf16 v[112:127], a[40:43], v[224:231], v36
v_exp_f32 v176, v176
v_exp_f32 v177, v177
TP26:
s_cbranch_execz TP10
v_exp_f32 v178, v178
v_mfma_f32_32x32x16_bf16 v[208:223], a[48:51], a[16:19], 0
v_exp_f32 v179, v179
v_exp_f32 v180, v180
v_exp_f32 v181, v181
v_smfmac_f32_16x16x64_bf16 v[172:175], v[32:35], v[224:231], v36
s_add_u32 m0, s48, 2048
s_nop 0
buffer_load_dwordx4 v247, s[12:15], s62 offen offset:0 lds
buffer_load_dwordx4 v248, s[12:15], s62 offen offset:1024 lds
v_exp_f32 v182, v182
v_exp_f32 v183, v183
v_smfmac_f32_32x32x32_bf16 v[112:127], a[44:47], v[232:239], v36
s_add_u32 s62, s62, 131072
v_exp_f32 v184, v184
v_exp_f32 v185, v185
v_exp_f32 v186, v186
v_mfma_f32_32x32x16_bf16 v[208:223], a[52:55], a[20:23], v[208:223]
s_and_b32 s62, s62, 0x1fffff
v_exp_f32 v187, v187
v_exp_f32 v188, v188
v_exp_f32 v189, v189
v_smfmac_f32_16x16x64_bf16 v[172:175], v[32:35], v[232:239], v36
buffer_load_dwordx4 a[40:43], v241, s[36:39], s50 offen offset:2048 sc1
buffer_load_dwordx4 a[44:47], v241, s[36:39], s50 offen offset:2560 sc1
v_exp_f32 v190, v190
v_exp_f32 v191, v191
v_smfmac_f32_32x32x32_bf16 v[64:79], a[56:59], v[176:183], v36
v_exp_f32 v192, v192
v_exp_f32 v193, v193
v_exp_f32 v194, v194
v_mfma_f32_32x32x16_bf16 v[224:239], a[48:51], a[24:27], 0
v_exp_f32 v195, v195
v_exp_f32 v196, v196
v_exp_f32 v197, v197
v_smfmac_f32_16x16x64_bf16 v[160:163], v[32:35], v[176:183], v36
v_exp_f32 v198, v198
v_exp_f32 v199, v199
v_smfmac_f32_32x32x32_bf16 v[64:79], a[60:63], v[184:191], v36
v_exp_f32 v200, v200
v_exp_f32 v201, v201
v_exp_f32 v202, v202
v_mfma_f32_32x32x16_bf16 v[224:239], a[52:55], a[28:31], v[224:239]
s_add_u32 s50, s50, 4096
v_exp_f32 v203, v203
v_exp_f32 v204, v204
v_exp_f32 v205, v205
v_smfmac_f32_16x16x64_bf16 v[160:163], v[32:35], v[184:191], v36
v_exp_f32 v206, v206
v_exp_f32 v207, v207
v_smfmac_f32_32x32x32_bf16 v[80:95], a[56:59], v[192:199], v36
v_exp_f32 v208, v208
v_exp_f32 v209, v209
v_exp_f32 v210, v210
v_mfma_f32_32x32x16_bf16 v[176:191], a[64:67], a[0:3], 0
v_exp_f32 v211, v211
v_exp_f32 v212, v212
v_exp_f32 v213, v213
v_smfmac_f32_16x16x64_bf16 v[164:167], v[32:35], v[192:199], v36
s_waitcnt lgkmcnt(0)
buffer_store_dwordx4 a[208:211], v1, s[36:39], s66 offen offset:0 sc1
v_mfma_f32_16x16x32_bf16 v[144:147], v[40:43], a[208:211], 0
v_exp_f32 v214, v214
v_exp_f32 v215, v215
v_smfmac_f32_32x32x32_bf16 v[80:95], a[60:63], v[200:207], v36
v_exp_f32 v216, v216
v_exp_f32 v217, v217
v_exp_f32 v218, v218
v_mfma_f32_32x32x16_bf16 v[176:191], a[68:71], a[4:7], v[176:191]
v_exp_f32 v219, v219
v_exp_f32 v220, v220
v_exp_f32 v221, v221
v_smfmac_f32_16x16x64_bf16 v[164:167], v[32:35], v[200:207], v36
buffer_load_dwordx4 a[48:51], v240, s[36:39], s50 offen offset:0 sc1
buffer_load_dwordx4 a[52:55], v240, s[36:39], s50 offen offset:512 sc1
v_exp_f32 v222, v222
v_exp_f32 v223, v223
v_smfmac_f32_32x32x32_bf16 v[96:111], a[56:59], v[208:215], v36
v_exp_f32 v224, v224
v_exp_f32 v225, v225
v_exp_f32 v226, v226
v_mfma_f32_32x32x16_bf16 v[192:207], a[64:67], a[8:11], 0
v_exp_f32 v227, v227
v_exp_f32 v228, v228
v_exp_f32 v229, v229
v_smfmac_f32_16x16x64_bf16 v[168:171], v[32:35], v[208:215], v36
ds_read_b64_tr_b16 a[212:213], v250 offset:30880
ds_read_b64_tr_b16 a[214:215], v250 offset:34976
v_exp_f32 v230, v230
v_exp_f32 v231, v231
v_smfmac_f32_32x32x32_bf16 v[96:111], a[60:63], v[216:223], v36
v_exp_f32 v232, v232
v_exp_f32 v233, v233
v_exp_f32 v234, v234
v_mfma_f32_32x32x16_bf16 v[192:207], a[68:71], a[12:15], v[192:207]
v_exp_f32 v235, v235
v_exp_f32 v236, v236
v_exp_f32 v237, v237
v_smfmac_f32_16x16x64_bf16 v[168:171], v[32:35], v[216:223], v36
v_exp_f32 v238, v238
v_exp_f32 v239, v239
v_smfmac_f32_32x32x32_bf16 v[112:127], a[56:59], v[224:231], v36
v_exp_f32 v176, v176
v_exp_f32 v177, v177
v_exp_f32 v178, v178
v_mfma_f32_32x32x16_bf16 v[208:223], a[64:67], a[16:19], 0
v_exp_f32 v179, v179
v_exp_f32 v180, v180
v_exp_f32 v181, v181
v_smfmac_f32_16x16x64_bf16 v[172:175], v[32:35], v[224:231], v36
s_add_u32 m0, s48, 4096
s_nop 0
buffer_load_dwordx4 v247, s[12:15], s62 offen offset:0 lds
buffer_load_dwordx4 v248, s[12:15], s62 offen offset:1024 lds
v_exp_f32 v182, v182
v_exp_f32 v183, v183
v_smfmac_f32_32x32x32_bf16 v[112:127], a[60:63], v[232:239], v36
s_add_u32 s62, s62, 131072
v_exp_f32 v184, v184
v_exp_f32 v185, v185
v_exp_f32 v186, v186
v_mfma_f32_32x32x16_bf16 v[208:223], a[68:71], a[20:23], v[208:223]
s_and_b32 s62, s62, 0x1fffff
v_exp_f32 v187, v187
v_exp_f32 v188, v188
v_exp_f32 v189, v189
v_smfmac_f32_16x16x64_bf16 v[172:175], v[32:35], v[232:239], v36
buffer_load_dwordx4 a[56:59], v241, s[36:39], s50 offen offset:2048 sc1
buffer_load_dwordx4 a[60:63], v241, s[36:39], s50 offen offset:2560 sc1
v_exp_f32 v190, v190
v_exp_f32 v191, v191
v_smfmac_f32_32x32x32_bf16 v[64:79], a[72:75], v[176:183], v36
v_exp_f32 v192, v192
v_exp_f32 v193, v193
v_exp_f32 v194, v194
v_mfma_f32_32x32x16_bf16 v[224:239], a[64:67], a[24:27], 0
v_exp_f32 v195, v195
v_exp_f32 v196, v196
v_exp_f32 v197, v197
v_smfmac_f32_16x16x64_bf16 v[160:163], v[32:35], v[176:183], v36
s_waitcnt lgkmcnt(0)
buffer_store_dwordx4 a[212:215], v1, s[36:39], s66 offen offset:1024 sc1
v_mfma_f32_16x16x32_bf16 v[148:151], v[40:43], a[212:215], 0
v_exp_f32 v198, v198
v_exp_f32 v199, v199
v_smfmac_f32_32x32x32_bf16 v[64:79], a[76:79], v[184:191], v36
v_exp_f32 v200, v200
v_exp_f32 v201, v201
v_exp_f32 v202, v202
v_mfma_f32_32x32x16_bf16 v[224:239], a[68:71], a[28:31], v[224:239]
s_add_u32 s50, s50, 4096
v_exp_f32 v203, v203
v_exp_f32 v204, v204
v_exp_f32 v205, v205
v_smfmac_f32_16x16x64_bf16 v[160:163], v[32:35], v[184:191], v36
s_waitcnt vmcnt(43)
v_exp_f32 v206, v206
v_exp_f32 v207, v207
v_smfmac_f32_32x32x32_bf16 v[80:95], a[72:75], v[192:199], v36
v_exp_f32 v208, v208
v_exp_f32 v209, v209
v_exp_f32 v210, v210
v_mfma_f32_32x32x16_bf16 v[176:191], a[80:83], a[0:3], 0
v_exp_f32 v211, v211
v_exp_f32 v212, v212
v_exp_f32 v213, v213
v_smfmac_f32_16x16x64_bf16 v[164:167], v[32:35], v[192:199], v36
ds_read_b64_tr_b16 a[216:217], v250 offset:30912
ds_read_b64_tr_b16 a[218:219], v250 offset:35008
v_exp_f32 v214, v214
v_exp_f32 v215, v215
v_smfmac_f32_32x32x32_bf16 v[80:95], a[76:79], v[200:207], v36
v_exp_f32 v216, v216
v_exp_f32 v217, v217
v_exp_f32 v218, v218
v_mfma_f32_32x32x16_bf16 v[176:191], a[84:87], a[4:7], v[176:191]
v_exp_f32 v219, v219
v_exp_f32 v220, v220
v_exp_f32 v221, v221
v_smfmac_f32_16x16x64_bf16 v[164:167], v[32:35], v[200:207], v36
buffer_load_dwordx4 a[64:67], v240, s[36:39], s50 offen offset:0 sc1
buffer_load_dwordx4 a[68:71], v240, s[36:39], s50 offen offset:512 sc1
v_exp_f32 v222, v222
v_exp_f32 v223, v223
v_smfmac_f32_32x32x32_bf16 v[96:111], a[72:75], v[208:215], v36
TP27:
s_cbranch_execz TP2
v_exp_f32 v224, v224
v_exp_f32 v225, v225
v_exp_f32 v226, v226
v_mfma_f32_32x32x16_bf16 v[192:207], a[80:83], a[8:11], 0
v_exp_f32 v227, v227
v_exp_f32 v228, v228
v_exp_f32 v229, v229
v_smfmac_f32_16x16x64_bf16 v[168:171], v[32:35], v[208:215], v36
s_waitcnt lgkmcnt(0)
buffer_store_dwordx4 a[216:219], v1, s[36:39], s66 offen offset:2048 sc1
v_mfma_f32_16x16x32_bf16 v[152:155], v[40:43], a[216:219], 0
v_exp_f32 v230, v230
v_exp_f32 v231, v231
v_smfmac_f32_32x32x32_bf16 v[96:111], a[76:79], v[216:223], v36
s_lshl2_add_u32 s67, s45, s40
v_exp_f32 v232, v232
v_exp_f32 v233, v233
v_exp_f32 v234, v234
v_mfma_f32_32x32x16_bf16 v[192:207], a[84:87], a[12:15], v[192:207]
s_lshl4_add_u32 s67, s67, s44
v_exp_f32 v235, v235
v_exp_f32 v236, v236
v_exp_f32 v237, v237
v_smfmac_f32_16x16x64_bf16 v[168:171], v[32:35], v[216:223], v36
s_lshl_b32 s67, s67, 9
v_exp_f32 v238, v238
v_exp_f32 v239, v239
v_smfmac_f32_32x32x32_bf16 v[112:127], a[72:75], v[224:231], v36
s_add_u32 s66, s67, 2097152
v_exp_f32 v176, v176
v_exp_f32 v177, v177
v_exp_f32 v178, v178
v_mfma_f32_32x32x16_bf16 v[208:223], a[80:83], a[16:19], 0
s_mul_i32 s65, s45, 56
v_exp_f32 v179, v179
v_exp_f32 v180, v180
v_exp_f32 v181, v181
v_smfmac_f32_16x16x64_bf16 v[172:175], v[32:35], v[224:231], v36
s_add_u32 m0, s48, 6144
s_nop 0
buffer_load_dwordx4 v247, s[12:15], s62 offen offset:0 lds
buffer_load_dwordx4 v248, s[12:15], s62 offen offset:1024 lds
v_exp_f32 v182, v182
v_exp_f32 v183, v183
v_smfmac_f32_32x32x32_bf16 v[112:127], a[76:79], v[232:239], v36
s_add_u32 s62, s62, 131072
v_exp_f32 v184, v184
v_exp_f32 v185, v185
v_exp_f32 v186, v186
v_mfma_f32_32x32x16_bf16 v[208:223], a[84:87], a[20:23], v[208:223]
s_and_b32 s62, s62, 0x1fffff
v_exp_f32 v187, v187
v_exp_f32 v188, v188
v_exp_f32 v189, v189
v_smfmac_f32_16x16x64_bf16 v[172:175], v[32:35], v[232:239], v36
buffer_load_dwordx4 a[72:75], v241, s[36:39], s50 offen offset:2048 sc1
buffer_load_dwordx4 a[76:79], v241, s[36:39], s50 offen offset:2560 sc1
v_exp_f32 v190, v190
v_exp_f32 v191, v191
v_smfmac_f32_32x32x32_bf16 v[64:79], a[88:91], v[176:183], v36
s_add_u32 s65, s65, s59
v_exp_f32 v192, v192
v_exp_f32 v193, v193
v_exp_f32 v194, v194
v_mfma_f32_32x32x16_bf16 v[224:239], a[80:83], a[24:27], 0
s_lshl_b32 s65, s65, 12
v_exp_f32 v195, v195
v_exp_f32 v196, v196
v_exp_f32 v197, v197
v_smfmac_f32_16x16x64_bf16 v[160:163], v[32:35], v[176:183], v36
s_add_u32 s65, s65, 37748736
v_exp_f32 v198, v198
v_exp_f32 v199, v199
v_smfmac_f32_32x32x32_bf16 v[64:79], a[92:95], v[184:191], v36
v_exp_f32 v200, v200
v_exp_f32 v201, v201
v_exp_f32 v202, v202
v_mfma_f32_32x32x16_bf16 v[224:239], a[84:87], a[28:31], v[224:239]
s_add_u32 s50, s50, 4096
v_exp_f32 v203, v203
v_exp_f32 v204, v204
v_exp_f32 v205, v205
v_smfmac_f32_16x16x64_bf16 v[160:163], v[32:35], v[184:191], v36
s_waitcnt vmcnt(43)
v_exp_f32 v206, v206
v_exp_f32 v207, v207
v_smfmac_f32_32x32x32_bf16 v[80:95], a[88:91], v[192:199], v36
v_exp_f32 v208, v208
v_exp_f32 v209, v209
v_exp_f32 v210, v210
v_mfma_f32_32x32x16_bf16 v[176:191], a[96:99], a[0:3], 0
v_exp_f32 v211, v211
v_exp_f32 v212, v212
v_exp_f32 v213, v213
v_smfmac_f32_16x16x64_bf16 v[164:167], v[32:35], v[192:199], v36
v_mov_b32_dpp v128, v132 quad_perm:[0,1,2,3] row_mask:0x2 bank_mask:0xf
v_mov_b32_dpp v144, v148 quad_perm:[0,1,2,3] row_mask:0x2 bank_mask:0xf
s_nop 0
v_mov_b32_dpp v128, v136 quad_perm:[0,1,2,3] row_mask:0x4 bank_mask:0xf
v_mov_b32_dpp v144, v152 quad_perm:[0,1,2,3] row_mask:0x4 bank_mask:0xf
s_nop 0
v_mov_b32_dpp v128, v140 quad_perm:[0,1,2,3] row_mask:0x8 bank_mask:0xf
v_exp_f32 v214, v214
v_exp_f32 v215, v215
v_smfmac_f32_32x32x32_bf16 v[80:95], a[92:95], v[200:207], v36
v_exp_f32 v216, v216
v_exp_f32 v217, v217
v_exp_f32 v218, v218
v_mfma_f32_32x32x16_bf16 v[176:191], a[100:103], a[4:7], v[176:191]
v_exp_f32 v219, v219
v_exp_f32 v220, v220
v_exp_f32 v221, v221
v_smfmac_f32_16x16x64_bf16 v[164:167], v[32:35], v[200:207], v36
buffer_load_dwordx4 a[80:83], v240, s[36:39], s50 offen offset:0 sc1
buffer_load_dwordx4 a[84:87], v240, s[36:39], s50 offen offset:512 sc1
v_exp_f32 v222, v222
v_exp_f32 v223, v223
v_smfmac_f32_32x32x32_bf16 v[96:111], a[88:91], v[208:215], v36
v_exp_f32 v224, v224
v_exp_f32 v225, v225
v_exp_f32 v226, v226
v_mfma_f32_32x32x16_bf16 v[192:207], a[96:99], a[8:11], 0
v_exp_f32 v227, v227
v_exp_f32 v228, v228
v_exp_f32 v229, v229
v_smfmac_f32_16x16x64_bf16 v[168:171], v[32:35], v[208:215], v36
v_exp_f32 v230, v230
v_exp_f32 v231, v231
v_smfmac_f32_32x32x32_bf16 v[96:111], a[92:95], v[216:223], v36
v_exp_f32 v232, v232
v_exp_f32 v233, v233
v_exp_f32 v234, v234
v_mfma_f32_32x32x16_bf16 v[192:207], a[100:103], a[12:15], v[192:207]
v_exp_f32 v235, v235
v_exp_f32 v236, v236
v_exp_f32 v237, v237
v_smfmac_f32_16x16x64_bf16 v[168:171], v[32:35], v[216:223], v36
ds_read_b64_tr_b16 a[224:225], v252 offset:26624
ds_read_b64_tr_b16 a[226:227], v252 offset:28672
v_exp_f32 v238, v238
v_exp_f32 v239, v239
v_smfmac_f32_32x32x32_bf16 v[112:127], a[88:91], v[224:231], v36
v_exp_f32 v176, v176
v_exp_f32 v177, v177
v_exp_f32 v178, v178
v_mfma_f32_32x32x16_bf16 v[208:223], a[96:99], a[16:19], 0
v_exp_f32 v179, v179
v_exp_f32 v180, v180
v_exp_f32 v181, v181
v_smfmac_f32_16x16x64_bf16 v[172:175], v[32:35], v[224:231], v36
s_add_u32 m0, s48, 8192
s_nop 0
buffer_load_dwordx4 v247, s[12:15], s62 offen offset:0 lds
buffer_load_dwordx4 v248, s[12:15], s62 offen offset:1024 lds
v_exp_f32 v182, v182
v_exp_f32 v183, v183
v_smfmac_f32_32x32x32_bf16 v[112:127], a[92:95], v[232:239], v36
s_add_u32 s62, s62, 131072
v_exp_f32 v184, v184
v_exp_f32 v185, v185
v_exp_f32 v186, v186
v_mfma_f32_32x32x16_bf16 v[208:223], a[100:103], a[20:23], v[208:223]
s_and_b32 s62, s62, 0x1fffff
v_exp_f32 v187, v187
v_exp_f32 v188, v188
v_exp_f32 v189, v189
v_smfmac_f32_16x16x64_bf16 v[172:175], v[32:35], v[232:239], v36
buffer_load_dwordx4 a[88:91], v241, s[36:39], s50 offen offset:2048 sc1
buffer_load_dwordx4 a[92:95], v241, s[36:39], s50 offen offset:2560 sc1
v_exp_f32 v190, v190
v_exp_f32 v191, v191
v_smfmac_f32_32x32x32_bf16 v[64:79], a[104:107], v[176:183], v36
v_exp_f32 v192, v192
v_exp_f32 v193, v193
v_exp_f32 v194, v194
v_mfma_f32_32x32x16_bf16 v[224:239], a[96:99], a[24:27], 0
v_exp_f32 v195, v195
v_exp_f32 v196, v196
v_exp_f32 v197, v197
v_smfmac_f32_16x16x64_bf16 v[160:163], v[32:35], v[176:183], v36
buffer_store_dword v128, v7, s[36:39], s66 offen offset:0 sc1
buffer_store_dword v144, v7, s[36:39], s66 offen offset:256 sc1
v_exp_f32 v198, v198
v_exp_f32 v199, v199
v_smfmac_f32_32x32x32_bf16 v[64:79], a[108:111], v[184:191], v36
v_exp_f32 v200, v200
TP28:
s_cbranch_execz TP4
v_exp_f32 v201, v201
v_exp_f32 v202, v202
v_mfma_f32_32x32x16_bf16 v[224:239], a[100:103], a[28:31], v[224:239]
s_add_u32 s50, s50, 4096
v_exp_f32 v203, v203
v_exp_f32 v204, v204
v_exp_f32 v205, v205
v_smfmac_f32_16x16x64_bf16 v[160:163], v[32:35], v[184:191], v36
s_waitcnt vmcnt(47)
v_exp_f32 v206, v206
v_exp_f32 v207, v207
v_smfmac_f32_32x32x32_bf16 v[80:95], a[104:107], v[192:199], v36
v_exp_f32 v208, v208
v_exp_f32 v209, v209
v_exp_f32 v210, v210
v_mfma_f32_32x32x16_bf16 v[176:191], a[112:115], a[0:3], 0
v_exp_f32 v211, v211
v_exp_f32 v212, v212
v_exp_f32 v213, v213
v_smfmac_f32_16x16x64_bf16 v[164:167], v[32:35], v[192:199], v36
s_waitcnt lgkmcnt(0)
buffer_store_dwordx4 a[224:227], v1, s[36:39], s65 offen offset:0 sc1
v_exp_f32 v214, v214
v_exp_f32 v215, v215
v_smfmac_f32_32x32x32_bf16 v[80:95], a[108:111], v[200:207], v36
v_exp_f32 v216, v216
v_exp_f32 v217, v217
v_exp_f32 v218, v218
v_mfma_f32_32x32x16_bf16 v[176:191], a[116:119], a[4:7], v[176:191]
v_exp_f32 v219, v219
v_exp_f32 v220, v220
v_exp_f32 v221, v221
v_smfmac_f32_16x16x64_bf16 v[164:167], v[32:35], v[200:207], v36
buffer_load_dwordx4 a[96:99], v240, s[36:39], s50 offen offset:0 sc1
buffer_load_dwordx4 a[100:103], v240, s[36:39], s50 offen offset:512 sc1
v_exp_f32 v222, v222
v_exp_f32 v223, v223
v_smfmac_f32_32x32x32_bf16 v[96:111], a[104:107], v[208:215], v36
v_exp_f32 v224, v224
v_exp_f32 v225, v225
v_exp_f32 v226, v226
v_mfma_f32_32x32x16_bf16 v[192:207], a[112:115], a[8:11], 0
v_exp_f32 v227, v227
v_exp_f32 v228, v228
v_exp_f32 v229, v229
v_smfmac_f32_16x16x64_bf16 v[168:171], v[32:35], v[208:215], v36
ds_read_b64_tr_b16 a[228:229], v252 offset:26656
ds_read_b64_tr_b16 a[230:231], v252 offset:28704
v_exp_f32 v230, v230
v_exp_f32 v231, v231
v_smfmac_f32_32x32x32_bf16 v[96:111], a[108:111], v[216:223], v36
v_exp_f32 v232, v232
v_exp_f32 v233, v233
v_exp_f32 v234, v234
v_mfma_f32_32x32x16_bf16 v[192:207], a[116:119], a[12:15], v[192:207]
v_exp_f32 v235, v235
v_exp_f32 v236, v236
v_exp_f32 v237, v237
v_smfmac_f32_16x16x64_bf16 v[168:171], v[32:35], v[216:223], v36
s_waitcnt lgkmcnt(0)
buffer_store_dwordx4 a[228:231], v1, s[36:39], s65 offen offset:1024 sc1
v_exp_f32 v238, v238
v_exp_f32 v239, v239
v_smfmac_f32_32x32x32_bf16 v[112:127], a[104:107], v[224:231], v36
v_exp_f32 v176, v176
v_exp_f32 v177, v177
v_exp_f32 v178, v178
v_mfma_f32_32x32x16_bf16 v[208:223], a[112:115], a[16:19], 0
v_exp_f32 v179, v179
v_exp_f32 v180, v180
v_exp_f32 v181, v181
v_smfmac_f32_16x16x64_bf16 v[172:175], v[32:35], v[224:231], v36
s_add_u32 m0, s48, 10240
s_nop 0
buffer_load_dwordx4 v247, s[12:15], s62 offen offset:0 lds
buffer_load_dwordx4 v248, s[12:15], s62 offen offset:1024 lds
v_exp_f32 v182, v182
v_exp_f32 v183, v183
v_smfmac_f32_32x32x32_bf16 v[112:127], a[108:111], v[232:239], v36
s_add_u32 s62, s62, 131072
v_exp_f32 v184, v184
v_exp_f32 v185, v185
v_exp_f32 v186, v186
v_mfma_f32_32x32x16_bf16 v[208:223], a[116:119], a[20:23], v[208:223]
s_and_b32 s62, s62, 0x1fffff
v_exp_f32 v187, v187
v_exp_f32 v188, v188
v_exp_f32 v189, v189
v_smfmac_f32_16x16x64_bf16 v[172:175], v[32:35], v[232:239], v36
buffer_load_dwordx4 a[104:107], v241, s[36:39], s50 offen offset:2048 sc1
buffer_load_dwordx4 a[108:111], v241, s[36:39], s50 offen offset:2560 sc1
v_exp_f32 v190, v190
v_exp_f32 v191, v191
v_smfmac_f32_32x32x32_bf16 v[64:79], a[120:123], v[176:183], v36
v_exp_f32 v192, v192
v_exp_f32 v193, v193
v_exp_f32 v194, v194
v_mfma_f32_32x32x16_bf16 v[224:239], a[112:115], a[24:27], 0
v_exp_f32 v195, v195
v_exp_f32 v196, v196
v_exp_f32 v197, v197
v_smfmac_f32_16x16x64_bf16 v[160:163], v[32:35], v[176:183], v36
ds_read_b64_tr_b16 a[232:233], v252 offset:26688
ds_read_b64_tr_b16 a[234:235], v252 offset:28736
v_exp_f32 v198, v198
v_exp_f32 v199, v199
v_smfmac_f32_32x32x32_bf16 v[64:79], a[124:127], v[184:191], v36
v_exp_f32 v200, v200
v_exp_f32 v201, v201
v_exp_f32 v202, v202
v_mfma_f32_32x32x16_bf16 v[224:239], a[116:119], a[28:31], v[224:239]
s_add_u32 s50, s50, 4096
v_exp_f32 v203, v203
v_exp_f32 v204, v204
v_exp_f32 v205, v205
v_smfmac_f32_16x16x64_bf16 v[160:163], v[32:35], v[184:191], v36
s_waitcnt vmcnt(48)
v_exp_f32 v206, v206
v_exp_f32 v207, v207
v_smfmac_f32_32x32x32_bf16 v[80:95], a[120:123], v[192:199], v36
v_exp_f32 v208, v208
v_exp_f32 v209, v209
v_exp_f32 v210, v210
v_mfma_f32_32x32x16_bf16 v[176:191], a[128:131], a[0:3], 0
v_exp_f32 v211, v211
v_exp_f32 v212, v212
v_exp_f32 v213, v213
v_smfmac_f32_16x16x64_bf16 v[164:167], v[32:35], v[192:199], v36
s_waitcnt lgkmcnt(0)
buffer_store_dwordx4 a[232:235], v1, s[36:39], s65 offen offset:2048 sc1
v_exp_f32 v214, v214
v_exp_f32 v215, v215
v_smfmac_f32_32x32x32_bf16 v[80:95], a[124:127], v[200:207], v36
v_exp_f32 v216, v216
v_exp_f32 v217, v217
v_exp_f32 v218, v218
v_mfma_f32_32x32x16_bf16 v[176:191], a[132:135], a[4:7], v[176:191]
v_exp_f32 v219, v219
v_exp_f32 v220, v220
v_exp_f32 v221, v221
v_smfmac_f32_16x16x64_bf16 v[164:167], v[32:35], v[200:207], v36
buffer_load_dwordx4 a[112:115], v240, s[36:39], s50 offen offset:0 sc1
buffer_load_dwordx4 a[116:119], v240, s[36:39], s50 offen offset:512 sc1
v_exp_f32 v222, v222
v_exp_f32 v223, v223
v_smfmac_f32_32x32x32_bf16 v[96:111], a[120:123], v[208:215], v36
v_exp_f32 v224, v224
v_exp_f32 v225, v225
v_exp_f32 v226, v226
v_mfma_f32_32x32x16_bf16 v[192:207], a[128:131], a[8:11], 0
v_exp_f32 v227, v227
v_exp_f32 v228, v228
v_exp_f32 v229, v229
v_smfmac_f32_16x16x64_bf16 v[168:171], v[32:35], v[208:215], v36
ds_read_b64_tr_b16 a[236:237], v252 offset:26720
ds_read_b64_tr_b16 a[238:239], v252 offset:28768
v_exp_f32 v230, v230
v_exp_f32 v231, v231
v_smfmac_f32_32x32x32_bf16 v[96:111], a[124:127], v[216:223], v36
v_exp_f32 v232, v232
v_exp_f32 v233, v233
v_exp_f32 v234, v234
v_mfma_f32_32x32x16_bf16 v[192:207], a[132:135], a[12:15], v[192:207]
v_exp_f32 v235, v235
v_exp_f32 v236, v236
v_exp_f32 v237, v237
v_smfmac_f32_16x16x64_bf16 v[168:171], v[32:35], v[216:223], v36
s_waitcnt lgkmcnt(0)
buffer_store_dwordx4 a[236:239], v1, s[36:39], s65 offen offset:3072 sc1
v_exp_f32 v238, v238
v_exp_f32 v239, v239
v_smfmac_f32_32x32x32_bf16 v[112:127], a[120:123], v[224:231], v36
s_lshl_b32 s67, s45, 13
v_exp_f32 v176, v176
v_exp_f32 v177, v177
v_exp_f32 v178, v178
v_mfma_f32_32x32x16_bf16 v[208:223], a[128:131], a[16:19], 0
s_add_u32 s65, s58, s67
v_exp_f32 v179, v179
v_exp_f32 v180, v180
v_exp_f32 v181, v181
v_smfmac_f32_16x16x64_bf16 v[172:175], v[32:35], v[224:231], v36
s_add_u32 m0, s48, 12288
s_nop 0
buffer_load_dwordx4 v247, s[12:15], s62 offen offset:0 lds
buffer_load_dwordx4 v248, s[12:15], s62 offen offset:1024 lds
v_exp_f32 v182, v182
v_exp_f32 v183, v183
TP29:
s_cbranch_execz TP6
TP30:
s_cbranch_execz TR0
v_smfmac_f32_32x32x32_bf16 v[112:127], a[124:127], v[232:239], v36
s_add_u32 s62, s62, 131072
v_exp_f32 v184, v184
v_exp_f32 v185, v185
v_exp_f32 v186, v186
v_mfma_f32_32x32x16_bf16 v[208:223], a[132:135], a[20:23], v[208:223]
s_and_b32 s62, s62, 0x1fffff
v_exp_f32 v187, v187
v_exp_f32 v188, v188
v_exp_f32 v189, v189
v_smfmac_f32_16x16x64_bf16 v[172:175], v[32:35], v[232:239], v36
buffer_load_dwordx4 a[120:123], v241, s[36:39], s50 offen offset:2048 sc1
buffer_load_dwordx4 a[124:127], v241, s[36:39], s50 offen offset:2560 sc1
v_exp_f32 v190, v190
v_exp_f32 v191, v191
v_smfmac_f32_32x32x32_bf16 v[64:79], a[136:139], v[176:183], v36
s_add_u32 s65, s65, 29360128
v_exp_f32 v192, v192
v_exp_f32 v193, v193
v_exp_f32 v194, v194
v_mfma_f32_32x32x16_bf16 v[224:239], a[128:131], a[24:27], 0
s_add_u32 s66, s65, 4096
v_exp_f32 v195, v195
v_exp_f32 v196, v196
v_exp_f32 v197, v197
v_smfmac_f32_16x16x64_bf16 v[160:163], v[32:35], v[176:183], v36
s_lshl4_add_u32 s54, s40, s45
v_exp_f32 v198, v198
v_exp_f32 v199, v199
v_smfmac_f32_32x32x32_bf16 v[64:79], a[140:143], v[184:191], v36
s_lshl_b32 s54, s54, 7
v_exp_f32 v200, v200
v_exp_f32 v201, v201
v_exp_f32 v202, v202
v_mfma_f32_32x32x16_bf16 v[224:239], a[132:135], a[28:31], v[224:239]
s_add_u32 s50, s50, 4096
v_exp_f32 v203, v203
v_exp_f32 v204, v204
v_exp_f32 v205, v205
v_smfmac_f32_16x16x64_bf16 v[160:163], v[32:35], v[184:191], v36
s_waitcnt vmcnt(47)
v_exp_f32 v206, v206
v_exp_f32 v207, v207
v_smfmac_f32_32x32x32_bf16 v[80:95], a[136:139], v[192:199], v36
s_lshl2_add_u32 s54, s44, s54
v_exp_f32 v208, v208
v_exp_f32 v209, v209
v_exp_f32 v210, v210
v_mfma_f32_32x32x16_bf16 v[176:191], a[144:147], a[0:3], 0
s_add_u32 s54, s54, 262144
v_exp_f32 v211, v211
v_exp_f32 v212, v212
v_exp_f32 v213, v213
v_smfmac_f32_16x16x64_bf16 v[164:167], v[32:35], v[192:199], v36
buffer_store_dwordx4 a[160:163], v1, s[36:39], s65 offen offset:0 sc1
v_exp_f32 v214, v214
v_exp_f32 v215, v215
v_smfmac_f32_32x32x32_bf16 v[80:95], a[140:143], v[200:207], v36
v_exp_f32 v216, v216
v_exp_f32 v217, v217
v_exp_f32 v218, v218
v_mfma_f32_32x32x16_bf16 v[176:191], a[148:151], a[4:7], v[176:191]
v_exp_f32 v219, v219
v_exp_f32 v220, v220
v_exp_f32 v221, v221
v_smfmac_f32_16x16x64_bf16 v[164:167], v[32:35], v[200:207], v36
buffer_load_dwordx4 a[128:131], v240, s[36:39], s50 offen offset:0 sc1
buffer_load_dwordx4 a[132:135], v240, s[36:39], s50 offen offset:512 sc1
v_exp_f32 v222, v222
v_exp_f32 v223, v223
v_smfmac_f32_32x32x32_bf16 v[96:111], a[136:139], v[208:215], v36
v_exp_f32 v224, v224
v_exp_f32 v225, v225
v_exp_f32 v226, v226
v_mfma_f32_32x32x16_bf16 v[192:207], a[144:147], a[8:11], 0
v_exp_f32 v227, v227
v_exp_f32 v228, v228
v_exp_f32 v229, v229
v_smfmac_f32_16x16x64_bf16 v[168:171], v[32:35], v[208:215], v36
buffer_store_dwordx4 a[164:167], v1, s[36:39], s65 offen offset:1024 sc1
v_exp_f32 v230, v230
v_exp_f32 v231, v231
v_smfmac_f32_32x32x32_bf16 v[96:111], a[140:143], v[216:223], v36
v_exp_f32 v232, v232
v_exp_f32 v233, v233
v_exp_f32 v234, v234
v_mfma_f32_32x32x16_bf16 v[192:207], a[148:151], a[12:15], v[192:207]
v_exp_f32 v235, v235
v_exp_f32 v236, v236
v_exp_f32 v237, v237
v_smfmac_f32_16x16x64_bf16 v[168:171], v[32:35], v[216:223], v36
s_waitcnt vmcnt(8)
buffer_atomic_swap v2, v6, s[36:39], s54 offen sc1
v_exp_f32 v238, v238
v_exp_f32 v239, v239
v_smfmac_f32_32x32x32_bf16 v[112:127], a[136:139], v[224:231], v36
v_exp_f32 v176, v176
v_exp_f32 v177, v177
v_exp_f32 v178, v178
v_mfma_f32_32x32x16_bf16 v[208:223], a[144:147], a[16:19], 0
v_exp_f32 v179, v179
v_exp_f32 v180, v180
v_exp_f32 v181, v181
v_smfmac_f32_16x16x64_bf16 v[172:175], v[32:35], v[224:231], v36
s_add_u32 m0, s48, 14336
s_nop 0
buffer_load_dwordx4 v247, s[12:15], s62 offen offset:0 lds
buffer_load_dwordx4 v248, s[12:15], s62 offen offset:1024 lds
v_exp_f32 v182, v182
v_exp_f32 v183, v183
v_smfmac_f32_32x32x32_bf16 v[112:127], a[140:143], v[232:239], v36
s_add_u32 s62, s62, 131072
v_exp_f32 v184, v184
v_exp_f32 v185, v185
v_exp_f32 v186, v186
v_mfma_f32_32x32x16_bf16 v[208:223], a[148:151], a[20:23], v[208:223]
s_and_b32 s62, s62, 0x1fffff
v_exp_f32 v187, v187
v_exp_f32 v188, v188
v_exp_f32 v189, v189
v_smfmac_f32_16x16x64_bf16 v[172:175], v[32:35], v[232:239], v36
buffer_load_dwordx4 a[136:139], v241, s[36:39], s50 offen offset:2048 sc1
buffer_load_dwordx4 a[140:143], v241, s[36:39], s50 offen offset:2560 sc1
v_exp_f32 v190, v190
v_exp_f32 v191, v191
v_smfmac_f32_32x32x32_bf16 v[64:79], a[152:155], v[176:183], v36
v_exp_f32 v192, v192
v_exp_f32 v193, v193
v_exp_f32 v194, v194
v_mfma_f32_32x32x16_bf16 v[224:239], a[144:147], a[24:27], 0
v_exp_f32 v195, v195
v_exp_f32 v196, v196
v_exp_f32 v197, v197
v_smfmac_f32_16x16x64_bf16 v[160:163], v[32:35], v[176:183], v36
buffer_store_dwordx4 a[168:171], v1, s[36:39], s65 offen offset:2048 sc1
v_exp_f32 v198, v198
v_exp_f32 v199, v199
v_smfmac_f32_32x32x32_bf16 v[64:79], a[156:159], v[184:191], v36
v_exp_f32 v200, v200
v_exp_f32 v201, v201
v_exp_f32 v202, v202
v_mfma_f32_32x32x16_bf16 v[224:239], a[148:151], a[28:31], v[224:239]
s_add_u32 s50, s50, 4096
v_exp_f32 v203, v203
v_exp_f32 v204, v204
v_exp_f32 v205, v205
v_smfmac_f32_16x16x64_bf16 v[160:163], v[32:35], v[184:191], v36
v_exp_f32 v206, v206
v_exp_f32 v207, v207
v_smfmac_f32_32x32x32_bf16 v[80:95], a[152:155], v[192:199], v36
v_exp_f32 v208, v208
v_exp_f32 v209, v209
v_exp_f32 v210, v210
v_mfma_f32_32x32x16_bf16 v[176:191], a[32:35], a[0:3], 0
v_exp_f32 v211, v211
v_exp_f32 v212, v212
v_exp_f32 v213, v213
v_smfmac_f32_16x16x64_bf16 v[164:167], v[32:35], v[192:199], v36
v_exp_f32 v214, v214
v_exp_f32 v215, v215
v_smfmac_f32_32x32x32_bf16 v[80:95], a[156:159], v[200:207], v36
v_exp_f32 v216, v216
v_exp_f32 v217, v217
v_exp_f32 v218, v218
v_mfma_f32_32x32x16_bf16 v[176:191], a[36:39], a[4:7], v[176:191]
v_exp_f32 v219, v219
v_exp_f32 v220, v220
v_exp_f32 v221, v221
v_smfmac_f32_16x16x64_bf16 v[164:167], v[32:35], v[200:207], v36
buffer_load_dwordx4 a[144:147], v240, s[36:39], s50 offen offset:0 sc1
buffer_load_dwordx4 a[148:151], v240, s[36:39], s50 offen offset:512 sc1
v_exp_f32 v222, v222
v_exp_f32 v223, v223
v_smfmac_f32_32x32x32_bf16 v[96:111], a[152:155], v[208:215], v36
v_exp_f32 v224, v224
v_exp_f32 v225, v225
v_exp_f32 v226, v226
v_mfma_f32_32x32x16_bf16 v[192:207], a[32:35], a[8:11], 0
v_exp_f32 v227, v227
v_exp_f32 v228, v228
v_exp_f32 v229, v229
v_smfmac_f32_16x16x64_bf16 v[168:171], v[32:35], v[208:215], v36
buffer_store_dwordx4 a[172:175], v1, s[36:39], s65 offen offset:3072 sc1
v_exp_f32 v230, v230
v_exp_f32 v231, v231
v_smfmac_f32_32x32x32_bf16 v[96:111], a[156:159], v[216:223], v36
TP31:
s_cbranch_execz TP10
v_exp_f32 v232, v232
v_exp_f32 v233, v233
v_exp_f32 v234, v234
v_mfma_f32_32x32x16_bf16 v[192:207], a[36:39], a[12:15], v[192:207]
v_exp_f32 v235, v235
v_exp_f32 v236, v236
v_exp_f32 v237, v237
v_smfmac_f32_16x16x64_bf16 v[168:171], v[32:35], v[216:223], v36
v_exp_f32 v238, v238
v_exp_f32 v239, v239
v_smfmac_f32_32x32x32_bf16 v[112:127], a[152:155], v[224:231], v36
v_exp_f32 v176, v176
v_exp_f32 v177, v177
v_exp_f32 v178, v178
v_mfma_f32_32x32x16_bf16 v[208:223], a[32:35], a[16:19], 0
v_exp_f32 v179, v179
v_exp_f32 v180, v180
v_exp_f32 v181, v181
v_smfmac_f32_16x16x64_bf16 v[172:175], v[32:35], v[224:231], v36
s_add_u32 m0, s48, 16384
s_nop 0
buffer_load_dwordx4 v247, s[12:15], s62 offen offset:0 lds
buffer_load_dwordx4 v248, s[12:15], s62 offen offset:1024 lds
v_exp_f32 v182, v182
v_exp_f32 v183, v183
v_smfmac_f32_32x32x32_bf16 v[112:127], a[156:159], v[232:239], v36
s_add_u32 s62, s62, 131072
v_exp_f32 v184, v184
v_exp_f32 v185, v185
v_exp_f32 v186, v186
v_mfma_f32_32x32x16_bf16 v[208:223], a[36:39], a[20:23], v[208:223]
s_and_b32 s62, s62, 0x1fffff
v_exp_f32 v187, v187
v_exp_f32 v188, v188
v_exp_f32 v189, v189
v_smfmac_f32_16x16x64_bf16 v[172:175], v[32:35], v[232:239], v36
buffer_load_dwordx4 a[152:155], v241, s[36:39], s50 offen offset:2048 sc1
buffer_load_dwordx4 a[156:159], v241, s[36:39], s50 offen offset:2560 sc1
v_exp_f32 v190, v190
v_exp_f32 v191, v191
v_smfmac_f32_32x32x32_bf16 v[64:79], a[40:43], v[176:183], v36
v_exp_f32 v192, v192
v_exp_f32 v193, v193
v_exp_f32 v194, v194
v_mfma_f32_32x32x16_bf16 v[224:239], a[32:35], a[24:27], 0
v_exp_f32 v195, v195
v_exp_f32 v196, v196
v_exp_f32 v197, v197
v_smfmac_f32_16x16x64_bf16 v[160:163], v[32:35], v[176:183], v36
buffer_store_dwordx4 a[176:179], v1, s[36:39], s66 offen offset:0 sc1
v_exp_f32 v198, v198
v_exp_f32 v199, v199
v_smfmac_f32_32x32x32_bf16 v[64:79], a[44:47], v[184:191], v36
v_exp_f32 v200, v200
v_exp_f32 v201, v201
v_exp_f32 v202, v202
v_mfma_f32_32x32x16_bf16 v[224:239], a[36:39], a[28:31], v[224:239]
s_add_u32 s50, s50, 4096
v_exp_f32 v203, v203
v_exp_f32 v204, v204
v_exp_f32 v205, v205
v_smfmac_f32_16x16x64_bf16 v[160:163], v[32:35], v[184:191], v36
v_exp_f32 v206, v206
v_exp_f32 v207, v207
v_smfmac_f32_32x32x32_bf16 v[80:95], a[40:43], v[192:199], v36
v_exp_f32 v208, v208
v_exp_f32 v209, v209
v_exp_f32 v210, v210
v_mfma_f32_32x32x16_bf16 v[176:191], a[48:51], a[0:3], 0
v_exp_f32 v211, v211
v_exp_f32 v212, v212
v_exp_f32 v213, v213
v_smfmac_f32_16x16x64_bf16 v[164:167], v[32:35], v[192:199], v36
v_exp_f32 v214, v214
v_exp_f32 v215, v215
v_smfmac_f32_32x32x32_bf16 v[80:95], a[44:47], v[200:207], v36
v_exp_f32 v216, v216
v_exp_f32 v217, v217
v_exp_f32 v218, v218
v_mfma_f32_32x32x16_bf16 v[176:191], a[52:55], a[4:7], v[176:191]
v_exp_f32 v219, v219
v_exp_f32 v220, v220
v_exp_f32 v221, v221
v_smfmac_f32_16x16x64_bf16 v[164:167], v[32:35], v[200:207], v36
v_exp_f32 v222, v222
v_exp_f32 v223, v223
v_smfmac_f32_32x32x32_bf16 v[96:111], a[40:43], v[208:215], v36
v_exp_f32 v224, v224
v_exp_f32 v225, v225
v_exp_f32 v226, v226
v_mfma_f32_32x32x16_bf16 v[192:207], a[48:51], a[8:11], 0
v_exp_f32 v227, v227
v_exp_f32 v228, v228
v_exp_f32 v229, v229
v_smfmac_f32_16x16x64_bf16 v[168:171], v[32:35], v[208:215], v36
v_exp_f32 v230, v230
v_exp_f32 v231, v231
v_smfmac_f32_32x32x32_bf16 v[96:111], a[44:47], v[216:223], v36
v_exp_f32 v232, v232
v_exp_f32 v233, v233
v_exp_f32 v234, v234
v_mfma_f32_32x32x16_bf16 v[192:207], a[52:55], a[12:15], v[192:207]
v_exp_f32 v235, v235
v_exp_f32 v236, v236
v_exp_f32 v237, v237
v_smfmac_f32_16x16x64_bf16 v[168:171], v[32:35], v[216:223], v36
v_exp_f32 v238, v238
v_exp_f32 v239, v239
v_smfmac_f32_32x32x32_bf16 v[112:127], a[40:43], v[224:231], v36
v_exp_f32 v176, v176
v_exp_f32 v177, v177
v_exp_f32 v178, v178
v_mfma_f32_32x32x16_bf16 v[208:223], a[48:51], a[16:19], 0
v_exp_f32 v179, v179
v_exp_f32 v180, v180
v_exp_f32 v181, v181
v_smfmac_f32_16x16x64_bf16 v[172:175], v[32:35], v[224:231], v36
s_add_u32 m0, s48, 18432
s_nop 0
buffer_load_dwordx4 v247, s[12:15], s62 offen offset:0 lds
buffer_load_dwordx4 v248, s[12:15], s62 offen offset:1024 lds
v_exp_f32 v182, v182
v_exp_f32 v183, v183
v_smfmac_f32_32x32x32_bf16 v[112:127], a[44:47], v[232:239], v36
s_add_u32 s62, s62, 131072
v_exp_f32 v184, v184
v_exp_f32 v185, v185
v_exp_f32 v186, v186
v_mfma_f32_32x32x16_bf16 v[208:223], a[52:55], a[20:23], v[208:223]
s_and_b32 s62, s62, 0x1fffff
v_exp_f32 v187, v187
v_exp_f32 v188, v188
v_exp_f32 v189, v189
v_smfmac_f32_16x16x64_bf16 v[172:175], v[32:35], v[232:239], v36
buffer_store_dwordx4 a[180:183], v1, s[36:39], s66 offen offset:1024 sc1
v_exp_f32 v190, v190
v_exp_f32 v191, v191
v_smfmac_f32_32x32x32_bf16 v[64:79], a[56:59], v[176:183], v36
v_exp_f32 v192, v192
v_exp_f32 v193, v193
v_exp_f32 v194, v194
v_mfma_f32_32x32x16_bf16 v[224:239], a[48:51], a[24:27], 0
v_exp_f32 v195, v195
v_exp_f32 v196, v196
v_exp_f32 v197, v197
v_smfmac_f32_16x16x64_bf16 v[160:163], v[32:35], v[176:183], v36
v_exp_f32 v198, v198
v_exp_f32 v199, v199
v_smfmac_f32_32x32x32_bf16 v[64:79], a[60:63], v[184:191], v36
v_exp_f32 v200, v200
v_exp_f32 v201, v201
v_exp_f32 v202, v202
v_mfma_f32_32x32x16_bf16 v[224:239], a[52:55], a[28:31], v[224:239]
v_exp_f32 v203, v203
v_exp_f32 v204, v204
v_exp_f32 v205, v205
v_smfmac_f32_16x16x64_bf16 v[160:163], v[32:35], v[184:191], v36
v_exp_f32 v206, v206
v_exp_f32 v207, v207
v_smfmac_f32_32x32x32_bf16 v[80:95], a[56:59], v[192:199], v36
v_exp_f32 v208, v208
v_exp_f32 v209, v209
v_exp_f32 v210, v210
v_mfma_f32_32x32x16_bf16 v[176:191], a[64:67], a[0:3], 0
v_exp_f32 v211, v211
v_exp_f32 v212, v212
v_exp_f32 v213, v213
v_smfmac_f32_16x16x64_bf16 v[164:167], v[32:35], v[192:199], v36
buffer_store_dwordx4 a[184:187], v1, s[36:39], s66 offen offset:2048 sc1
v_exp_f32 v214, v214
v_exp_f32 v215, v215
v_smfmac_f32_32x32x32_bf16 v[80:95], a[60:63], v[200:207], v36
v_exp_f32 v216, v216
v_exp_f32 v217, v217
v_exp_f32 v218, v218
v_mfma_f32_32x32x16_bf16 v[176:191], a[68:71], a[4:7], v[176:191]
v_exp_f32 v219, v219
v_exp_f32 v220, v220
v_exp_f32 v221, v221
v_smfmac_f32_16x16x64_bf16 v[164:167], v[32:35], v[200:207], v36
v_exp_f32 v222, v222
v_exp_f32 v223, v223
v_smfmac_f32_32x32x32_bf16 v[96:111], a[56:59], v[208:215], v36
v_exp_f32 v224, v224
v_exp_f32 v225, v225
v_exp_f32 v226, v226
v_mfma_f32_32x32x16_bf16 v[192:207], a[64:67], a[8:11], 0
v_exp_f32 v227, v227
v_exp_f32 v228, v228
v_exp_f32 v229, v229
v_smfmac_f32_16x16x64_bf16 v[168:171], v[32:35], v[208:215], v36
v_exp_f32 v230, v230
TP32:
s_cbranch_execz TP2
v_exp_f32 v231, v231
v_smfmac_f32_32x32x32_bf16 v[96:111], a[60:63], v[216:223], v36
v_exp_f32 v232, v232
v_exp_f32 v233, v233
v_exp_f32 v234, v234
v_mfma_f32_32x32x16_bf16 v[192:207], a[68:71], a[12:15], v[192:207]
v_exp_f32 v235, v235
v_exp_f32 v236, v236
v_exp_f32 v237, v237
v_smfmac_f32_16x16x64_bf16 v[168:171], v[32:35], v[216:223], v36
v_exp_f32 v238, v238
v_exp_f32 v239, v239
v_smfmac_f32_32x32x32_bf16 v[112:127], a[56:59], v[224:231], v36
s_lshr_b32 s3, s40, 1
v_exp_f32 v176, v176
v_exp_f32 v177, v177
v_exp_f32 v178, v178
v_mfma_f32_32x32x16_bf16 v[208:223], a[64:67], a[16:19], 0
s_lshl1_add_u32 s58, s42, s3
v_exp_f32 v179, v179
v_exp_f32 v180, v180
v_exp_f32 v181, v181
v_smfmac_f32_16x16x64_bf16 v[172:175], v[32:35], v[224:231], v36
s_add_u32 m0, s48, 20480
s_nop 0
buffer_load_dwordx4 v247, s[12:15], s62 offen offset:0 lds
buffer_load_dwordx4 v248, s[12:15], s62 offen offset:1024 lds
v_exp_f32 v182, v182
v_exp_f32 v183, v183
v_smfmac_f32_32x32x32_bf16 v[112:127], a[60:63], v[232:239], v36
s_add_u32 s62, s62, 131072
v_exp_f32 v184, v184
v_exp_f32 v185, v185
v_exp_f32 v186, v186
v_mfma_f32_32x32x16_bf16 v[208:223], a[68:71], a[20:23], v[208:223]
s_and_b32 s62, s62, 0x1fffff
v_exp_f32 v187, v187
v_exp_f32 v188, v188
v_exp_f32 v189, v189
v_smfmac_f32_16x16x64_bf16 v[172:175], v[32:35], v[232:239], v36
s_and_b32 s3, s40, 1
v_exp_f32 v190, v190
v_exp_f32 v191, v191
v_smfmac_f32_32x32x32_bf16 v[64:79], a[72:75], v[176:183], v36
s_lshl1_add_u32 s59, s43, s3
v_exp_f32 v192, v192
v_exp_f32 v193, v193
v_exp_f32 v194, v194
v_mfma_f32_32x32x16_bf16 v[224:239], a[64:67], a[24:27], 0
s_lshl_b32 s61, s58, 17
v_exp_f32 v195, v195
v_exp_f32 v196, v196
v_exp_f32 v197, v197
v_smfmac_f32_16x16x64_bf16 v[160:163], v[32:35], v[176:183], v36
buffer_store_dwordx4 a[188:191], v1, s[36:39], s66 offen offset:3072 sc1
v_exp_f32 v198, v198
v_exp_f32 v199, v199
v_smfmac_f32_32x32x32_bf16 v[64:79], a[76:79], v[184:191], v36
s_lshl_b32 s3, s59, 11
v_exp_f32 v200, v200
v_exp_f32 v201, v201
v_exp_f32 v202, v202
v_mfma_f32_32x32x16_bf16 v[224:239], a[68:71], a[28:31], v[224:239]
s_add_u32 s61, s61, s3
v_exp_f32 v203, v203
v_exp_f32 v204, v204
v_exp_f32 v205, v205
v_smfmac_f32_16x16x64_bf16 v[160:163], v[32:35], v[184:191], v36
v_exp_f32 v206, v206
v_exp_f32 v207, v207
v_smfmac_f32_32x32x32_bf16 v[80:95], a[72:75], v[192:199], v36
s_add_u32 s61, s61, 12582912
v_exp_f32 v208, v208
v_exp_f32 v209, v209
v_exp_f32 v210, v210
v_mfma_f32_32x32x16_bf16 v[176:191], a[80:83], a[0:3], 0
s_lshl_b32 s58, s58, 12
v_exp_f32 v211, v211
v_exp_f32 v212, v212
v_exp_f32 v213, v213
v_smfmac_f32_16x16x64_bf16 v[164:167], v[32:35], v[192:199], v36
s_lshl2_add_u32 s58, s59, s58
v_exp_f32 v214, v214
v_exp_f32 v215, v215
v_smfmac_f32_32x32x32_bf16 v[80:95], a[76:79], v[200:207], v36
s_add_u32 s58, s58, 131072
v_exp_f32 v216, v216
v_exp_f32 v217, v217
v_exp_f32 v218, v218
v_mfma_f32_32x32x16_bf16 v[176:191], a[84:87], a[4:7], v[176:191]
s_add_u32 s59, s61, 65536
v_exp_f32 v219, v219
v_exp_f32 v220, v220
v_exp_f32 v221, v221
v_smfmac_f32_16x16x64_bf16 v[164:167], v[32:35], v[200:207], v36
s_add_u32 s55, s63, 262144
v_exp_f32 v222, v222
v_exp_f32 v223, v223
v_smfmac_f32_32x32x32_bf16 v[96:111], a[72:75], v[208:215], v36
s_lshl2_add_u32 s3, s45, s40
v_exp_f32 v224, v224
v_exp_f32 v225, v225
v_exp_f32 v226, v226
v_mfma_f32_32x32x16_bf16 v[192:207], a[80:83], a[8:11], 0
s_lshl_b32 s3, s3, 13
v_exp_f32 v227, v227
v_exp_f32 v228, v228
v_exp_f32 v229, v229
v_smfmac_f32_16x16x64_bf16 v[168:171], v[32:35], v[208:215], v36
s_add_u32 s56, s3, 2097152
v_exp_f32 v230, v230
v_exp_f32 v231, v231
v_smfmac_f32_32x32x32_bf16 v[96:111], a[76:79], v[216:223], v36
s_add_u32 s57, s56, 4096
v_exp_f32 v232, v232
v_exp_f32 v233, v233
v_exp_f32 v234, v234
v_mfma_f32_32x32x16_bf16 v[192:207], a[84:87], a[12:15], v[192:207]
v_exp_f32 v235, v235
v_exp_f32 v236, v236
v_exp_f32 v237, v237
v_smfmac_f32_16x16x64_bf16 v[168:171], v[32:35], v[216:223], v36
v_exp_f32 v238, v238
v_exp_f32 v239, v239
v_smfmac_f32_32x32x32_bf16 v[112:127], a[72:75], v[224:231], v36
v_exp_f32 v176, v176
v_exp_f32 v177, v177
v_exp_f32 v178, v178
v_mfma_f32_32x32x16_bf16 v[208:223], a[80:83], a[16:19], 0
v_exp_f32 v179, v179
v_exp_f32 v180, v180
v_exp_f32 v181, v181
v_smfmac_f32_16x16x64_bf16 v[172:175], v[32:35], v[224:231], v36
s_add_u32 m0, s48, 22528
s_nop 0
buffer_load_dwordx4 v247, s[12:15], s62 offen offset:0 lds
buffer_load_dwordx4 v248, s[12:15], s62 offen offset:1024 lds
v_exp_f32 v182, v182
v_exp_f32 v183, v183
v_smfmac_f32_32x32x32_bf16 v[112:127], a[76:79], v[232:239], v36
s_add_u32 s62, s62, 131072
v_exp_f32 v184, v184
v_exp_f32 v185, v185
v_exp_f32 v186, v186
v_mfma_f32_32x32x16_bf16 v[208:223], a[84:87], a[20:23], v[208:223]
s_and_b32 s62, s62, 0x1fffff
v_exp_f32 v187, v187
v_exp_f32 v188, v188
v_exp_f32 v189, v189
v_smfmac_f32_16x16x64_bf16 v[172:175], v[32:35], v[232:239], v36
v_exp_f32 v190, v190
v_exp_f32 v191, v191
v_smfmac_f32_32x32x32_bf16 v[64:79], a[88:91], v[176:183], v36
v_exp_f32 v192, v192
v_exp_f32 v193, v193
v_exp_f32 v194, v194
v_mfma_f32_32x32x16_bf16 v[224:239], a[80:83], a[24:27], 0
v_exp_f32 v195, v195
v_exp_f32 v196, v196
v_exp_f32 v197, v197
v_smfmac_f32_16x16x64_bf16 v[160:163], v[32:35], v[176:183], v36
v_exp_f32 v198, v198
v_exp_f32 v199, v199
v_smfmac_f32_32x32x32_bf16 v[64:79], a[92:95], v[184:191], v36
v_exp_f32 v200, v200
v_exp_f32 v201, v201
v_exp_f32 v202, v202
v_mfma_f32_32x32x16_bf16 v[224:239], a[84:87], a[28:31], v[224:239]
v_exp_f32 v203, v203
v_exp_f32 v204, v204
v_exp_f32 v205, v205
v_smfmac_f32_16x16x64_bf16 v[160:163], v[32:35], v[184:191], v36
v_exp_f32 v206, v206
v_exp_f32 v207, v207
v_smfmac_f32_32x32x32_bf16 v[80:95], a[88:91], v[192:199], v36
v_exp_f32 v208, v208
v_exp_f32 v209, v209
v_exp_f32 v210, v210
v_mfma_f32_32x32x16_bf16 v[176:191], a[96:99], a[0:3], 0
v_exp_f32 v211, v211
v_exp_f32 v212, v212
v_exp_f32 v213, v213
v_smfmac_f32_16x16x64_bf16 v[164:167], v[32:35], v[192:199], v36
v_exp_f32 v214, v214
v_exp_f32 v215, v215
v_smfmac_f32_32x32x32_bf16 v[80:95], a[92:95], v[200:207], v36
v_exp_f32 v216, v216
v_exp_f32 v217, v217
v_exp_f32 v218, v218
v_mfma_f32_32x32x16_bf16 v[176:191], a[100:103], a[4:7], v[176:191]
v_exp_f32 v219, v219
v_exp_f32 v220, v220
v_exp_f32 v221, v221
v_smfmac_f32_16x16x64_bf16 v[164:167], v[32:35], v[200:207], v36
TP33:
s_cbranch_execz TP4
v_exp_f32 v222, v222
v_exp_f32 v223, v223
v_smfmac_f32_32x32x32_bf16 v[96:111], a[88:91], v[208:215], v36
v_exp_f32 v224, v224
v_exp_f32 v225, v225
v_exp_f32 v226, v226
v_mfma_f32_32x32x16_bf16 v[192:207], a[96:99], a[8:11], 0
v_exp_f32 v227, v227
v_exp_f32 v228, v228
v_exp_f32 v229, v229
v_smfmac_f32_16x16x64_bf16 v[168:171], v[32:35], v[208:215], v36
v_exp_f32 v230, v230
v_exp_f32 v231, v231
v_smfmac_f32_32x32x32_bf16 v[96:111], a[92:95], v[216:223], v36
v_exp_f32 v232, v232
v_exp_f32 v233, v233
v_exp_f32 v234, v234
v_mfma_f32_32x32x16_bf16 v[192:207], a[100:103], a[12:15], v[192:207]
v_exp_f32 v235, v235
v_exp_f32 v236, v236
v_exp_f32 v237, v237
v_smfmac_f32_16x16x64_bf16 v[168:171], v[32:35], v[216:223], v36
v_exp_f32 v238, v238
v_exp_f32 v239, v239
v_smfmac_f32_32x32x32_bf16 v[112:127], a[88:91], v[224:231], v36
v_exp_f32 v176, v176
v_exp_f32 v177, v177
v_exp_f32 v178, v178
v_mfma_f32_32x32x16_bf16 v[208:223], a[96:99], a[16:19], 0
v_exp_f32 v179, v179
v_exp_f32 v180, v180
v_exp_f32 v181, v181
v_smfmac_f32_16x16x64_bf16 v[172:175], v[32:35], v[224:231], v36
s_add_u32 m0, s48, 24576
s_nop 0
buffer_load_dwordx4 v247, s[12:15], s62 offen offset:0 lds
buffer_load_dwordx4 v248, s[12:15], s62 offen offset:1024 lds
v_exp_f32 v182, v182
v_exp_f32 v183, v183
v_smfmac_f32_32x32x32_bf16 v[112:127], a[92:95], v[232:239], v36
s_add_u32 s62, s62, 131072
v_exp_f32 v184, v184
v_exp_f32 v185, v185
v_exp_f32 v186, v186
v_mfma_f32_32x32x16_bf16 v[208:223], a[100:103], a[20:23], v[208:223]
s_and_b32 s62, s62, 0x1fffff
v_exp_f32 v187, v187
v_exp_f32 v188, v188
v_exp_f32 v189, v189
v_smfmac_f32_16x16x64_bf16 v[172:175], v[32:35], v[232:239], v36
v_mov_b32 v254, 0
buffer_atomic_or v254, v246, s[36:39], s55 offen sc0 sc1
v_exp_f32 v190, v190
v_exp_f32 v191, v191
v_smfmac_f32_32x32x32_bf16 v[64:79], a[104:107], v[176:183], v36
v_exp_f32 v192, v192
v_exp_f32 v193, v193
v_exp_f32 v194, v194
v_mfma_f32_32x32x16_bf16 v[224:239], a[96:99], a[24:27], 0
v_exp_f32 v195, v195
v_exp_f32 v196, v196
v_exp_f32 v197, v197
v_smfmac_f32_16x16x64_bf16 v[160:163], v[32:35], v[176:183], v36
v_exp_f32 v198, v198
v_exp_f32 v199, v199
v_smfmac_f32_32x32x32_bf16 v[64:79], a[108:111], v[184:191], v36
v_exp_f32 v200, v200
v_exp_f32 v201, v201
v_exp_f32 v202, v202
v_mfma_f32_32x32x16_bf16 v[224:239], a[100:103], a[28:31], v[224:239]
v_exp_f32 v203, v203
v_exp_f32 v204, v204
v_exp_f32 v205, v205
v_smfmac_f32_16x16x64_bf16 v[160:163], v[32:35], v[184:191], v36
s_waitcnt vmcnt(30)
v_exp_f32 v206, v206
v_exp_f32 v207, v207
v_smfmac_f32_32x32x32_bf16 v[80:95], a[104:107], v[192:199], v36
v_exp_f32 v208, v208
v_exp_f32 v209, v209
v_exp_f32 v210, v210
v_mfma_f32_32x32x16_bf16 v[176:191], a[112:115], a[0:3], 0
v_exp_f32 v211, v211
v_exp_f32 v212, v212
v_exp_f32 v213, v213
v_smfmac_f32_16x16x64_bf16 v[164:167], v[32:35], v[192:199], v36
v_exp_f32 v214, v214
v_exp_f32 v215, v215
v_smfmac_f32_32x32x32_bf16 v[80:95], a[108:111], v[200:207], v36
v_exp_f32 v216, v216
v_exp_f32 v217, v217
v_exp_f32 v218, v218
v_mfma_f32_32x32x16_bf16 v[176:191], a[116:119], a[4:7], v[176:191]
v_exp_f32 v219, v219
v_exp_f32 v220, v220
v_exp_f32 v221, v221
v_smfmac_f32_16x16x64_bf16 v[164:167], v[32:35], v[200:207], v36
v_exp_f32 v222, v222
v_exp_f32 v223, v223
v_smfmac_f32_32x32x32_bf16 v[96:111], a[104:107], v[208:215], v36
v_exp_f32 v224, v224
v_exp_f32 v225, v225
v_exp_f32 v226, v226
v_mfma_f32_32x32x16_bf16 v[192:207], a[112:115], a[8:11], 0
v_exp_f32 v227, v227
v_exp_f32 v228, v228
v_exp_f32 v229, v229
v_smfmac_f32_16x16x64_bf16 v[168:171], v[32:35], v[208:215], v36
v_exp_f32 v230, v230
v_exp_f32 v231, v231
v_smfmac_f32_32x32x32_bf16 v[96:111], a[108:111], v[216:223], v36
v_exp_f32 v232, v232
v_exp_f32 v233, v233
v_exp_f32 v234, v234
v_mfma_f32_32x32x16_bf16 v[192:207], a[116:119], a[12:15], v[192:207]
v_exp_f32 v235, v235
v_exp_f32 v236, v236
v_exp_f32 v237, v237
v_smfmac_f32_16x16x64_bf16 v[168:171], v[32:35], v[216:223], v36
v_exp_f32 v238, v238
v_exp_f32 v239, v239
v_smfmac_f32_32x32x32_bf16 v[112:127], a[104:107], v[224:231], v36
v_exp_f32 v176, v176
v_exp_f32 v177, v177
v_exp_f32 v178, v178
v_mfma_f32_32x32x16_bf16 v[208:223], a[112:115], a[16:19], 0
v_exp_f32 v179, v179
v_exp_f32 v180, v180
v_exp_f32 v181, v181
v_smfmac_f32_16x16x64_bf16 v[172:175], v[32:35], v[224:231], v36
s_add_u32 m0, s48, 26624
s_nop 0
buffer_load_dwordx4 v247, s[12:15], s62 offen offset:0 lds
buffer_load_dwordx4 v248, s[12:15], s62 offen offset:1024 lds
v_exp_f32 v182, v182
v_exp_f32 v183, v183
v_smfmac_f32_32x32x32_bf16 v[112:127], a[108:111], v[232:239], v36
s_add_u32 s62, s62, 131072
v_exp_f32 v184, v184
v_exp_f32 v185, v185
v_exp_f32 v186, v186
v_mfma_f32_32x32x16_bf16 v[208:223], a[116:119], a[20:23], v[208:223]
s_and_b32 s62, s62, 0x1fffff
v_exp_f32 v187, v187
v_exp_f32 v188, v188
v_exp_f32 v189, v189
v_smfmac_f32_16x16x64_bf16 v[172:175], v[32:35], v[232:239], v36
v_exp_f32 v190, v190
v_exp_f32 v191, v191
v_smfmac_f32_32x32x32_bf16 v[64:79], a[120:123], v[176:183], v36
v_exp_f32 v192, v192
v_exp_f32 v193, v193
v_exp_f32 v194, v194
v_mfma_f32_32x32x16_bf16 v[224:239], a[112:115], a[24:27], 0
v_exp_f32 v195, v195
v_exp_f32 v196, v196
v_exp_f32 v197, v197
v_smfmac_f32_16x16x64_bf16 v[160:163], v[32:35], v[176:183], v36
v_exp_f32 v198, v198
v_exp_f32 v199, v199
v_smfmac_f32_32x32x32_bf16 v[64:79], a[124:127], v[184:191], v36
v_exp_f32 v200, v200
v_exp_f32 v201, v201
v_exp_f32 v202, v202
v_mfma_f32_32x32x16_bf16 v[224:239], a[116:119], a[28:31], v[224:239]
v_exp_f32 v203, v203
v_exp_f32 v204, v204
v_exp_f32 v205, v205
v_smfmac_f32_16x16x64_bf16 v[160:163], v[32:35], v[184:191], v36
s_waitcnt vmcnt(23)
v_exp_f32 v206, v206
v_exp_f32 v207, v207
v_smfmac_f32_32x32x32_bf16 v[80:95], a[120:123], v[192:199], v36
v_exp_f32 v208, v208
v_exp_f32 v209, v209
v_exp_f32 v210, v210
v_mfma_f32_32x32x16_bf16 v[176:191], a[128:131], a[0:3], 0
v_exp_f32 v211, v211
v_exp_f32 v212, v212
v_exp_f32 v213, v213
v_smfmac_f32_16x16x64_bf16 v[164:167], v[32:35], v[192:199], v36
v_exp_f32 v214, v214
v_exp_f32 v215, v215
v_smfmac_f32_32x32x32_bf16 v[80:95], a[124:127], v[200:207], v36
v_exp_f32 v216, v216
v_exp_f32 v217, v217
v_exp_f32 v218, v218
v_mfma_f32_32x32x16_bf16 v[176:191], a[132:135], a[4:7], v[176:191]
v_exp_f32 v219, v219
v_exp_f32 v220, v220
v_exp_f32 v221, v221
v_smfmac_f32_16x16x64_bf16 v[164:167], v[32:35], v[200:207], v36
v_exp_f32 v222, v222
v_exp_f32 v223, v223
v_smfmac_f32_32x32x32_bf16 v[96:111], a[120:123], v[208:215], v36
TP34:
s_cbranch_execz TP6
TP35:
s_cbranch_execz TR0
v_exp_f32 v224, v224
v_exp_f32 v225, v225
v_exp_f32 v226, v226
v_mfma_f32_32x32x16_bf16 v[192:207], a[128:131], a[8:11], 0
v_exp_f32 v227, v227
v_exp_f32 v228, v228
v_exp_f32 v229, v229
v_smfmac_f32_16x16x64_bf16 v[168:171], v[32:35], v[208:215], v36
v_exp_f32 v230, v230
v_exp_f32 v231, v231
v_smfmac_f32_32x32x32_bf16 v[96:111], a[124:127], v[216:223], v36
v_exp_f32 v232, v232
v_exp_f32 v233, v233
v_exp_f32 v234, v234
v_mfma_f32_32x32x16_bf16 v[192:207], a[132:135], a[12:15], v[192:207]
v_exp_f32 v235, v235
v_exp_f32 v236, v236
v_exp_f32 v237, v237
v_smfmac_f32_16x16x64_bf16 v[168:171], v[32:35], v[216:223], v36
v_exp_f32 v238, v238
v_exp_f32 v239, v239
v_smfmac_f32_32x32x32_bf16 v[112:127], a[120:123], v[224:231], v36
v_exp_f32 v176, v176
v_exp_f32 v177, v177
v_exp_f32 v178, v178
v_mfma_f32_32x32x16_bf16 v[208:223], a[128:131], a[16:19], 0
v_exp_f32 v179, v179
v_exp_f32 v180, v180
v_exp_f32 v181, v181
v_smfmac_f32_16x16x64_bf16 v[172:175], v[32:35], v[224:231], v36
s_add_u32 m0, s48, 28672
s_nop 0
buffer_load_dwordx4 v247, s[12:15], s62 offen offset:0 lds
buffer_load_dwordx4 v248, s[12:15], s62 offen offset:1024 lds
v_exp_f32 v182, v182
v_exp_f32 v183, v183
v_smfmac_f32_32x32x32_bf16 v[112:127], a[124:127], v[232:239], v36
s_add_u32 s62, s62, 131072
v_exp_f32 v184, v184
v_exp_f32 v185, v185
v_exp_f32 v186, v186
v_mfma_f32_32x32x16_bf16 v[208:223], a[132:135], a[20:23], v[208:223]
s_and_b32 s62, s62, 0x1fffff
v_exp_f32 v187, v187
v_exp_f32 v188, v188
v_exp_f32 v189, v189
v_smfmac_f32_16x16x64_bf16 v[172:175], v[32:35], v[232:239], v36
s_waitcnt vmcnt(4)
v_cmp_ne_u32 vcc, v254, v2
v_exp_f32 v190, v190
v_exp_f32 v191, v191
v_smfmac_f32_32x32x32_bf16 v[64:79], a[136:139], v[176:183], v36
s_and_b64 vcc, vcc, 0xffff
v_exp_f32 v192, v192
v_exp_f32 v193, v193
v_exp_f32 v194, v194
v_mfma_f32_32x32x16_bf16 v[224:239], a[128:131], a[24:27], 0
s_cbranch_vccnz RT_FP
RT_FP_B:
v_exp_f32 v195, v195
v_exp_f32 v196, v196
v_exp_f32 v197, v197
v_smfmac_f32_16x16x64_bf16 v[160:163], v[32:35], v[176:183], v36
buffer_load_dwordx4 v[128:131], v1, s[36:39], s56 offen offset:0 sc1
buffer_load_dwordx4 v[132:135], v1, s[36:39], s56 offen offset:1024 sc1
v_exp_f32 v198, v198
v_exp_f32 v199, v199
v_smfmac_f32_32x32x32_bf16 v[64:79], a[140:143], v[184:191], v36
v_exp_f32 v200, v200
v_exp_f32 v201, v201
v_exp_f32 v202, v202
v_mfma_f32_32x32x16_bf16 v[224:239], a[132:135], a[28:31], v[224:239]
v_exp_f32 v203, v203
v_exp_f32 v204, v204
v_exp_f32 v205, v205
v_smfmac_f32_16x16x64_bf16 v[160:163], v[32:35], v[184:191], v36
v_exp_f32 v206, v206
v_exp_f32 v207, v207
v_smfmac_f32_32x32x32_bf16 v[80:95], a[136:139], v[192:199], v36
v_exp_f32 v208, v208
v_exp_f32 v209, v209
v_exp_f32 v210, v210
v_mfma_f32_32x32x16_bf16 v[176:191], a[144:147], a[0:3], 0
v_exp_f32 v211, v211
v_exp_f32 v212, v212
v_exp_f32 v213, v213
v_smfmac_f32_16x16x64_bf16 v[164:167], v[32:35], v[192:199], v36
buffer_load_dwordx4 v[136:139], v1, s[36:39], s56 offen offset:2048 sc1
buffer_load_dwordx4 v[140:143], v1, s[36:39], s56 offen offset:3072 sc1
v_exp_f32 v214, v214
v_exp_f32 v215, v215
v_smfmac_f32_32x32x32_bf16 v[80:95], a[140:143], v[200:207], v36
v_exp_f32 v216, v216
v_exp_f32 v217, v217
v_exp_f32 v218, v218
v_mfma_f32_32x32x16_bf16 v[176:191], a[148:151], a[4:7], v[176:191]
v_exp_f32 v219, v219
v_exp_f32 v220, v220
v_exp_f32 v221, v221
v_smfmac_f32_16x16x64_bf16 v[164:167], v[32:35], v[200:207], v36
buffer_load_dwordx4 v[144:147], v1, s[36:39], s57 offen offset:0 sc1
buffer_load_dwordx4 v[148:151], v1, s[36:39], s57 offen offset:1024 sc1
v_exp_f32 v222, v222
v_exp_f32 v223, v223
v_smfmac_f32_32x32x32_bf16 v[96:111], a[136:139], v[208:215], v36
v_exp_f32 v224, v224
v_exp_f32 v225, v225
v_exp_f32 v226, v226
v_mfma_f32_32x32x16_bf16 v[192:207], a[144:147], a[8:11], 0
v_exp_f32 v227, v227
v_exp_f32 v228, v228
v_exp_f32 v229, v229
v_smfmac_f32_16x16x64_bf16 v[168:171], v[32:35], v[208:215], v36
buffer_load_dwordx4 v[152:155], v1, s[36:39], s57 offen offset:2048 sc1
buffer_load_dwordx4 v[156:159], v1, s[36:39], s57 offen offset:3072 sc1
v_exp_f32 v230, v230
v_exp_f32 v231, v231
v_smfmac_f32_32x32x32_bf16 v[96:111], a[140:143], v[216:223], v36
v_exp_f32 v232, v232
v_exp_f32 v233, v233
v_exp_f32 v234, v234
v_mfma_f32_32x32x16_bf16 v[192:207], a[148:151], a[12:15], v[192:207]
v_exp_f32 v235, v235
v_exp_f32 v236, v236
v_exp_f32 v237, v237
v_smfmac_f32_16x16x64_bf16 v[168:171], v[32:35], v[216:223], v36
v_exp_f32 v238, v238
v_exp_f32 v239, v239
v_smfmac_f32_32x32x32_bf16 v[112:127], a[136:139], v[224:231], v36
v_exp_f32 v176, v176
v_exp_f32 v177, v177
v_exp_f32 v178, v178
v_mfma_f32_32x32x16_bf16 v[208:223], a[144:147], a[16:19], 0
v_exp_f32 v179, v179
v_exp_f32 v180, v180
v_exp_f32 v181, v181
v_smfmac_f32_16x16x64_bf16 v[172:175], v[32:35], v[224:231], v36
v_exp_f32 v182, v182
v_exp_f32 v183, v183
v_smfmac_f32_32x32x32_bf16 v[112:127], a[140:143], v[232:239], v36
v_exp_f32 v184, v184
v_exp_f32 v185, v185
v_exp_f32 v186, v186
v_mfma_f32_32x32x16_bf16 v[208:223], a[148:151], a[20:23], v[208:223]
v_exp_f32 v187, v187
v_exp_f32 v188, v188
v_exp_f32 v189, v189
v_smfmac_f32_16x16x64_bf16 v[172:175], v[32:35], v[232:239], v36
v_exp_f32 v190, v190
v_exp_f32 v191, v191
v_smfmac_f32_32x32x32_bf16 v[64:79], a[152:155], v[176:183], v36
v_exp_f32 v192, v192
v_exp_f32 v193, v193
v_exp_f32 v194, v194
v_mfma_f32_32x32x16_bf16 v[224:239], a[144:147], a[24:27], 0
v_exp_f32 v195, v195
v_exp_f32 v196, v196
v_exp_f32 v197, v197
v_smfmac_f32_16x16x64_bf16 v[160:163], v[32:35], v[176:183], v36
v_exp_f32 v198, v198
v_exp_f32 v199, v199
v_smfmac_f32_32x32x32_bf16 v[64:79], a[156:159], v[184:191], v36
v_exp_f32 v200, v200
v_exp_f32 v201, v201
v_exp_f32 v202, v202
v_mfma_f32_32x32x16_bf16 v[224:239], a[148:151], a[28:31], v[224:239]
v_exp_f32 v203, v203
v_exp_f32 v204, v204
v_exp_f32 v205, v205
v_smfmac_f32_16x16x64_bf16 v[160:163], v[32:35], v[184:191], v36
v_exp_f32 v206, v206
v_exp_f32 v207, v207
v_smfmac_f32_32x32x32_bf16 v[80:95], a[152:155], v[192:199], v36
v_exp_f32 v208, v208
v_exp_f32 v209, v209
v_exp_f32 v210, v210
s_nop 5
ds_write_b128 v8, v[64:67] offset:30720
ds_write_b128 v8, v[68:71] offset:31744
v_exp_f32 v211, v211
v_exp_f32 v212, v212
v_exp_f32 v213, v213
v_smfmac_f32_16x16x64_bf16 v[164:167], v[32:35], v[192:199], v36
v_exp_f32 v214, v214
v_exp_f32 v215, v215
v_smfmac_f32_32x32x32_bf16 v[80:95], a[156:159], v[200:207], v36
v_exp_f32 v216, v216
v_exp_f32 v217, v217
v_exp_f32 v218, v218
ds_write_b128 v8, v[72:75] offset:32768
ds_write_b128 v8, v[76:79] offset:33792
v_exp_f32 v219, v219
TP36:
s_cbranch_execz TP10
v_exp_f32 v220, v220
v_exp_f32 v221, v221
v_smfmac_f32_16x16x64_bf16 v[164:167], v[32:35], v[200:207], v36
ds_write_b32 v8, v160 offset:38912
v_exp_f32 v222, v222
v_exp_f32 v223, v223
v_smfmac_f32_32x32x32_bf16 v[96:111], a[152:155], v[208:215], v36
v_exp_f32 v224, v224
v_exp_f32 v225, v225
v_exp_f32 v226, v226
s_nop 3
ds_write_b128 v8, v[80:83] offset:34816
ds_write_b128 v8, v[84:87] offset:35840
v_exp_f32 v227, v227
v_exp_f32 v228, v228
v_exp_f32 v229, v229
v_smfmac_f32_16x16x64_bf16 v[168:171], v[32:35], v[208:215], v36
v_exp_f32 v230, v230
v_exp_f32 v231, v231
v_smfmac_f32_32x32x32_bf16 v[96:111], a[156:159], v[216:223], v36
v_exp_f32 v232, v232
v_exp_f32 v233, v233
v_exp_f32 v234, v234
ds_write_b128 v8, v[88:91] offset:36864
ds_write_b128 v8, v[92:95] offset:37888
v_exp_f32 v235, v235
v_exp_f32 v236, v236
v_exp_f32 v237, v237
v_smfmac_f32_16x16x64_bf16 v[168:171], v[32:35], v[216:223], v36
ds_write_b32 v8, v164 offset:38916
v_exp_f32 v238, v238
v_exp_f32 v239, v239
s_waitcnt lgkmcnt(0)
s_barrier
ds_read_b64 v[44:45], v9 offset:38912
ds_read_b128 v[176:179], v9 offset:30720
ds_read_b128 v[180:183], v9 offset:31744
ds_read_b128 v[184:187], v9 offset:32768
ds_read_b128 v[188:191], v9 offset:33792
ds_read_b128 v[192:195], v9 offset:34816
ds_read_b128 v[196:199], v9 offset:35840
ds_read_b128 v[200:203], v9 offset:36864
ds_read_b128 v[204:207], v9 offset:37888
v_smfmac_f32_32x32x32_bf16 v[112:127], a[152:155], v[224:231], v36
v_smfmac_f32_16x16x64_bf16 v[172:175], v[32:35], v[224:231], v36
v_smfmac_f32_32x32x32_bf16 v[112:127], a[156:159], v[232:239], v36
v_smfmac_f32_16x16x64_bf16 v[172:175], v[32:35], v[232:239], v36
AT_FIN:
s_waitcnt lgkmcnt(8)
v_add_f32 v44, v44, v168
s_waitcnt lgkmcnt(7)
v_pk_add_f32 v[96:97], v[96:97], v[176:177]
v_pk_add_f32 v[98:99], v[98:99], v[178:179]
s_waitcnt lgkmcnt(6)
v_pk_add_f32 v[100:101], v[100:101], v[180:181]
v_pk_add_f32 v[102:103], v[102:103], v[182:183]
v_rcp_f32 v46, v44
s_waitcnt lgkmcnt(5)
v_pk_add_f32 v[104:105], v[104:105], v[184:185]
v_pk_add_f32 v[106:107], v[106:107], v[186:187]
s_waitcnt lgkmcnt(4)
v_pk_add_f32 v[108:109], v[108:109], v[188:189]
v_pk_add_f32 v[110:111], v[110:111], v[190:191]
v_pk_mul_f32 v[96:97], v[96:97], v[46:47] op_sel_hi:[1,0]
v_pk_mul_f32 v[98:99], v[98:99], v[46:47] op_sel_hi:[1,0]
v_pk_mul_f32 v[100:101], v[100:101], v[46:47] op_sel_hi:[1,0]
v_pk_mul_f32 v[102:103], v[102:103], v[46:47] op_sel_hi:[1,0]
v_cvt_pk_bf16_f32 v176, v96, v97
v_cvt_pk_bf16_f32 v177, v98, v99
v_cvt_pk_bf16_f32 v178, v100, v101
v_cvt_pk_bf16_f32 v179, v102, v103
buffer_store_dwordx4 v[176:179], v244, s[36:39], s61 offen offset:0 sc1
v_pk_mul_f32 v[104:105], v[104:105], v[46:47] op_sel_hi:[1,0]
v_pk_mul_f32 v[106:107], v[106:107], v[46:47] op_sel_hi:[1,0]
v_pk_mul_f32 v[108:109], v[108:109], v[46:47] op_sel_hi:[1,0]
v_pk_mul_f32 v[110:111], v[110:111], v[46:47] op_sel_hi:[1,0]
v_cvt_pk_bf16_f32 v180, v104, v105
v_cvt_pk_bf16_f32 v181, v106, v107
v_cvt_pk_bf16_f32 v182, v108, v109
v_cvt_pk_bf16_f32 v183, v110, v111
buffer_store_dwordx4 v[180:183], v244, s[36:39], s61 offen offset:512 sc1
v_add_f32 v45, v45, v172
s_waitcnt lgkmcnt(3)
v_pk_add_f32 v[112:113], v[112:113], v[192:193]
v_pk_add_f32 v[114:115], v[114:115], v[194:195]
s_waitcnt lgkmcnt(2)
v_pk_add_f32 v[116:117], v[116:117], v[196:197]
v_pk_add_f32 v[118:119], v[118:119], v[198:199]
v_rcp_f32 v47, v45
s_waitcnt lgkmcnt(1)
v_pk_add_f32 v[120:121], v[120:121], v[200:201]
v_pk_add_f32 v[122:123], v[122:123], v[202:203]
s_waitcnt lgkmcnt(0)
v_pk_add_f32 v[124:125], v[124:125], v[204:205]
v_pk_add_f32 v[126:127], v[126:127], v[206:207]
v_pk_mul_f32 v[112:113], v[112:113], v[46:47] op_sel:[0,1]
v_pk_mul_f32 v[114:115], v[114:115], v[46:47] op_sel:[0,1]
v_pk_mul_f32 v[116:117], v[116:117], v[46:47] op_sel:[0,1]
v_pk_mul_f32 v[118:119], v[118:119], v[46:47] op_sel:[0,1]
v_cvt_pk_bf16_f32 v192, v112, v113
v_cvt_pk_bf16_f32 v193, v114, v115
v_cvt_pk_bf16_f32 v194, v116, v117
v_cvt_pk_bf16_f32 v195, v118, v119
buffer_store_dwordx4 v[192:195], v244, s[36:39], s59 offen offset:0 sc1
v_pk_mul_f32 v[120:121], v[120:121], v[46:47] op_sel:[0,1]
v_pk_mul_f32 v[122:123], v[122:123], v[46:47] op_sel:[0,1]
v_pk_mul_f32 v[124:125], v[124:125], v[46:47] op_sel:[0,1]
v_pk_mul_f32 v[126:127], v[126:127], v[46:47] op_sel:[0,1]
v_cvt_pk_bf16_f32 v196, v120, v121
v_cvt_pk_bf16_f32 v197, v122, v123
v_cvt_pk_bf16_f32 v198, v124, v125
v_cvt_pk_bf16_f32 v199, v126, v127
buffer_store_dwordx4 v[196:199], v244, s[36:39], s59 offen offset:512 sc1
v_mfma_f32_16x16x32_bf16 v[208:211], v[40:43], v[176:179], 0
v_mfma_f32_16x16x32_bf16 v[208:211], v[40:43], v[180:183], v[208:211]
v_mfma_f32_16x16x32_bf16 v[208:211], v[40:43], v[192:195], v[208:211]
v_mfma_f32_16x16x32_bf16 v[208:211], v[40:43], v[196:199], v[208:211]
v_min_f32 v3, v44, v45
v_max_f32 v4, v44, v45
v_cmp_nle_f32 vcc, 0x2b800000, v3
s_nop 0
s_mov_b64 s[68:69], vcc
v_cmp_nge_f32 vcc, 0x5f800000, v4
s_nop 0
s_or_b64 s[68:69], s[68:69], vcc
v_cmp_u_f32 vcc, v44, v45
s_nop 0
s_or_b64 s[68:69], s[68:69], vcc
v_mov_b32 v3, 0x207
v_cmp_class_f32 vcc, v208, v3
s_nop 0
s_or_b64 s[68:69], s[68:69], vcc
s_cselect_b32 s3, 1, 0
v_mov_b32 v3, s3
ds_write_b32 v13, v3 offset:38920
s_waitcnt vmcnt(12) lgkmcnt(0)
s_barrier
ds_read_b32 v3, v12 offset:38920
s_waitcnt lgkmcnt(0)
v_cmp_lt_u32 vcc, s53, v3
s_nop 4
s_cbranch_vccnz AT_FB
s_add_u32 m0, s48, 30720
s_nop 0
buffer_load_dwordx4 v247, s[12:15], s62 offen offset:0 lds
buffer_load_dwordx4 v248, s[12:15], s62 offen offset:1024 lds
v_permlane16_swap_b32 v48, v50
v_permlane16_swap_b32 v49, v51
v_permlane16_swap_b32 v52, v54
v_permlane16_swap_b32 v53, v55
v_permlane16_swap_b32 v56, v58
v_permlane16_swap_b32 v57, v59
v_permlane16_swap_b32 v60, v62
v_permlane16_swap_b32 v61, v63
s_waitcnt vmcnt(9)
v_pk_add_f32 v[128:129], v[128:129], v[144:145]
v_pk_add_f32 v[130:131], v[130:131], v[146:147]
s_waitcnt vmcnt(8)
v_pk_add_f32 v[132:133], v[132:133], v[148:149]
v_pk_add_f32 v[134:135], v[134:135], v[150:151]
s_waitcnt vmcnt(7)
v_pk_add_f32 v[136:137], v[136:137], v[152:153]
v_pk_add_f32 v[138:139], v[138:139], v[154:155]
TP37:
s_cbranch_execz TP2
s_waitcnt vmcnt(6)
v_pk_add_f32 v[140:141], v[140:141], v[156:157]
v_pk_add_f32 v[142:143], v[142:143], v[158:159]
v_pk_add_f32 v[128:129], v[128:129], v[136:137]
v_pk_add_f32 v[130:131], v[130:131], v[138:139]
v_pk_add_f32 v[132:133], v[132:133], v[140:141]
v_pk_add_f32 v[134:135], v[134:135], v[142:143]
v_pk_add_f32 v[128:129], v[128:129], v[132:133]
v_pk_add_f32 v[130:131], v[130:131], v[134:135]
v_lshlrev_b32 v64, 16, v48
v_and_b32 v65, 0xffff0000, v48
v_lshlrev_b32 v66, 16, v49
v_and_b32 v67, 0xffff0000, v49
v_lshlrev_b32 v72, 16, v50
v_and_b32 v73, 0xffff0000, v50
v_lshlrev_b32 v74, 16, v51
v_and_b32 v75, 0xffff0000, v51
v_lshlrev_b32 v80, 16, v52
v_and_b32 v81, 0xffff0000, v52
v_lshlrev_b32 v82, 16, v53
v_and_b32 v83, 0xffff0000, v53
v_lshlrev_b32 v88, 16, v54
v_and_b32 v89, 0xffff0000, v54
v_lshlrev_b32 v90, 16, v55
v_and_b32 v91, 0xffff0000, v55
v_lshlrev_b32 v68, 16, v56
v_and_b32 v69, 0xffff0000, v56
v_lshlrev_b32 v70, 16, v57
v_and_b32 v71, 0xffff0000, v57
v_lshlrev_b32 v76, 16, v58
v_and_b32 v77, 0xffff0000, v58
v_lshlrev_b32 v78, 16, v59
v_and_b32 v79, 0xffff0000, v59
v_lshlrev_b32 v84, 16, v60
v_and_b32 v85, 0xffff0000, v60
v_lshlrev_b32 v86, 16, v61
v_and_b32 v87, 0xffff0000, v61
v_lshlrev_b32 v92, 16, v62
v_and_b32 v93, 0xffff0000, v62
v_lshlrev_b32 v94, 16, v63
v_and_b32 v95, 0xffff0000, v63
ds_write_b128 v8, v[128:131] offset:32768
v_add_u32 v13, 4096, v1
s_lshr_b32 s60, s44, 2
v_add_u32 v3, s60, v0
v_and_b32 v3, 3, v3
s_lshr_b32 s3, s45, 1
s_and_b32 s3, s3, 4
v_add_u32 v4, s3, v0
v_and_or_b32 v5, v4, 4, v3
s_lshl_b32 s3, s45, 1
s_add_u32 s3, s3, 1
s_lshl_b32 s3, s3, 5
s_add_u32 s3, s3, s40
v_lshl_add_u32 v3, v5, 2, s3
v_bfe_u32 v4, v0, 3, 1
v_lshlrev_b32 v4, 5, v4
v_sub_u32 v3, v3, v4
v_mul_u32_u24 v26, 7168, v3
v_add_u32 v26, 20971520, v26
s_add_u32 s62, s63, 131072
v_mov_b32 v254, 0
v_readlane_b32 s51, v26, 0
s_add_u32 m0, s48, 33792
s_waitcnt vmcnt(2)
buffer_atomic_swap v2, v11, s[36:39], s58 offen sc1
s_nop 1
buffer_load_dwordx4 v1, s[36:39], s51 offen offset:0 sc1 lds
buffer_load_dwordx4 v1, s[36:39], s51 offen offset:1024 sc1 lds
buffer_load_dwordx4 v1, s[36:39], s51 offen offset:2048 sc1 lds
buffer_load_dwordx4 v1, s[36:39], s51 offen offset:3072 sc1 lds
s_add_u32 m0, s48, 37888
s_nop 0
buffer_load_dwordx4 v13, s[36:39], s51 offen offset:0 sc1 lds
buffer_load_dwordx4 v13, s[36:39], s51 offen offset:1024 sc1 lds
buffer_load_dwordx4 v13, s[36:39], s51 offen offset:2048 sc1 lds
buffer_atomic_or v254, v246, s[36:39], s62 offen sc0 sc1
s_lshl_b32 s53, s47, 16
s_add_u32 s3, s53, 16777216
v_lshl_add_u32 v25, v5, 13, s3
s_lshl_b32 s60, s52, 1
v_add_u32 v3, s60, v0
v_and_b32 v4, 15, v3
s_add_u32 s3, s53, 12582912
v_lshl_add_u32 v31, v4, 12, s3
s_lshr_b32 s60, s44, 2
v_mov_b32 v3, s60
v_mov_b32 v4, s44
v_cmp_gt_u32 vcc, 4, v0
s_nop 1
v_cndmask_b32 v3, v3, v4, vcc
v_add_u32 v3, v3, v0
v_and_b32 v3, 3, v3
s_and_b32 s3, s44, 12
v_add_u32 v4, s3, v0
v_and_or_b32 v3, v4, 12, v3
s_lshl_b32 s3, s53, 1
s_add_u32 s3, s3, 29360128
v_lshl_add_u32 v28, v3, 13, s3
s_lshl_b32 s3, s45, 6
s_add_u32 s3, s3, s40
v_lshl_add_u32 v3, v3, 2, s3
v_mul_u32_u24 v27, 7168, v3
v_add_u32 v27, 41943040, v27
s_lshr_b32 s60, s44, 2
v_add_u32 v3, s60, v0
v_and_b32 v3, 3, v3
s_lshr_b32 s3, s45, 1
s_and_b32 s3, s3, 4
v_add_u32 v4, s3, v0
v_and_or_b32 v5, v4, 4, v3
s_and_b32 s3, s45, 1
s_lshl_b32 s3, s3, 1
s_lshr_b32 s60, s40, 1
s_add_u32 s3, s3, s60
s_lshl2_add_u32 s3, s44, s3
s_and_b32 s61, s40, 1
s_lshl4_add_u32 s3, s3, s61
v_lshl_add_u32 v3, v5, 1, s3
v_mul_u32_u24 v29, 7168, v3
v_add_u32 v29, 50331648, v29
s_and_b32 s3, s45, 14
s_add_u32 s3, s3, s60
s_mul_i32 s3, s3, 229376
s_lshl_b32 s61, s61, 11
s_add_u32 s3, s3, s61
s_add_u32 s3, s3, 37748736
v_mul_u32_u24 v30, 28672, v5
v_add_u32 v30, s3, v30
v_add_u32 v14, 40960, v1
v_add_u32 v15, 81920, v1
v_add_u32 v24, 122880, v1
v_mov_b32 v4, 0x80000000
v_cmp_gt_u32 vcc, 16, v0
v_lshlrev_b32 v3, 7, v0
s_nop 0
v_cndmask_b32 v240, v4, v3, vcc
v_cmp_gt_u32 vcc, 8, v0
v_lshlrev_b32 v3, 8, v0
s_nop 0
v_cndmask_b32 v241, v4, v3, vcc
v_lshrrev_b32 v245, 4, v0
v_bfe_u32 v3, v0, 2, 2
v_and_b32 v244, 15, v0
v_cmp_eq_u32 vcc, v3, v245
v_lshlrev_b32 v242, 4, v244
v_and_b32 v5, 3, v0
v_cndmask_b32 v242, v4, v242, vcc
v_lshl_add_u32 v250, v3, 3, v5
v_lshlrev_b32 v250, 1, v250
v_lshl_add_u32 v5, v245, 2, v5
v_and_b32 v3, 8, v0
v_lshl_add_u32 v5, v3, 1, v5
v_and_b32 v3, 4, v0
v_cmp_eq_u32 vcc, 0, v3
v_lshlrev_b32 v5, 4, v5
v_lshl_add_u32 v244, v244, 2, s48
v_cndmask_b32 v243, v4, v5, vcc
v_lshl_add_u32 v245, v245, 4, s48
v_and_b32 v3, 31, v0
v_lshl_add_u32 v249, v3, 2, s48
s_mov_b32 s54, 0x22222222
s_mov_b32 s55, 0x22222222
s_mov_b32 s56, 0x44444444
s_mov_b32 s57, 0x44444444
s_mov_b32 s58, 0x88888888
s_mov_b32 s59, 0x88888888
ds_read_b64_tr_b16 v[32:33], v16 offset:0
ds_read_b64_tr_b16 v[34:35], v16 offset:512
ds_read_b64_tr_b16 v[36:37], v20 offset:0
ds_read_b64_tr_b16 v[38:39], v20 offset:512
ds_read_b64_tr_b16 v[40:41], v17 offset:0
TP38:
s_cbranch_execz TP4
ds_read_b64_tr_b16 v[42:43], v17 offset:512
ds_read_b64_tr_b16 v[44:45], v21 offset:0
ds_read_b64_tr_b16 v[46:47], v21 offset:512
ds_read_b64_tr_b16 v[48:49], v18 offset:0
ds_read_b64_tr_b16 v[50:51], v18 offset:512
ds_read_b64_tr_b16 v[52:53], v22 offset:0
ds_read_b64_tr_b16 v[54:55], v22 offset:512
v_mov_b32 v192, 0x3f803f80
v_mov_b32 v193, v192
v_mov_b32 v194, v192
v_mov_b32 v195, v192
v_readlane_b32 s50, v31, 0
v_readlane_b32 s53, v31, 1
v_readlane_b32 s60, v31, 2
v_readlane_b32 s61, v31, 3
s_mov_b64 exec, 0
s_bitcmp1_b32 s40, 0
s_cbranch_scc1 TT1_0_0
s_bitcmp1_b32 s40, 1
s_cbranch_scc1 TR1
s_branch TP40
TT1_0_0:
s_bitcmp1_b32 s40, 1
s_cbranch_scc1 TR1
s_branch TP42
TR1:
s_mov_b64 exec, -1
v_mov_b32 v255, 0
buffer_atomic_or v255, v246, s[36:39], s62 offen sc0 sc1
s_waitcnt vmcnt(1)
v_cmp_ne_u32 vcc, v254, v2
s_mov_b32 vcc_hi, 0
s_nop 3
s_cbranch_vccnz RT_F2
RT_F2_B:
buffer_load_dwordx4 a[0:3], v1, s[36:39], s50 offen offset:0 sc1
buffer_load_dwordx4 a[4:7], v1, s[36:39], s50 offen offset:1024 sc1
buffer_load_dwordx4 a[8:11], v1, s[36:39], s50 offen offset:2048 sc1
buffer_load_dwordx4 a[12:15], v1, s[36:39], s50 offen offset:3072 sc1
buffer_load_dwordx4 a[16:19], v1, s[36:39], s53 offen offset:0 sc1
buffer_load_dwordx4 a[20:23], v1, s[36:39], s53 offen offset:1024 sc1
buffer_load_dwordx4 a[24:27], v1, s[36:39], s53 offen offset:2048 sc1
buffer_load_dwordx4 a[28:31], v1, s[36:39], s53 offen offset:3072 sc1
buffer_load_dwordx4 a[32:35], v1, s[36:39], s60 offen offset:0 sc1
buffer_load_dwordx4 a[36:39], v1, s[36:39], s60 offen offset:1024 sc1
buffer_load_dwordx4 a[40:43], v1, s[36:39], s60 offen offset:2048 sc1
buffer_load_dwordx4 a[44:47], v1, s[36:39], s60 offen offset:3072 sc1
s_waitcnt vmcnt(8) lgkmcnt(8)
v_mfma_f32_16x16x32_bf16 v[64:67], v[32:35], a[0:3], v[64:67]
ds_read_b64_tr_b16 v[56:57], v19 offset:0
ds_read_b64_tr_b16 v[58:59], v19 offset:512
v_mfma_f32_16x16x32_bf16 v[64:67], v[36:39], a[8:11], v[64:67]
buffer_load_dwordx4 a[48:51], v1, s[36:39], s61 offen offset:0 sc1
v_mfma_f32_16x16x32_bf16 v[68:71], v[32:35], a[4:7], v[68:71]
ds_read_b64_tr_b16 v[60:61], v23 offset:0
ds_read_b64_tr_b16 v[62:63], v23 offset:512
v_mfma_f32_16x16x32_bf16 v[68:71], v[36:39], a[12:15], v[68:71]
v_readlane_b32 s50, v31, 4
s_waitcnt lgkmcnt(8)
v_mfma_f32_16x16x32_bf16 v[72:75], v[40:43], a[0:3], v[72:75]
ds_read_b64_tr_b16 v[32:33], v16 offset:2048
ds_read_b64_tr_b16 v[34:35], v16 offset:2560
v_mfma_f32_16x16x32_bf16 v[72:75], v[44:47], a[8:11], v[72:75]
buffer_load_dwordx4 a[52:55], v1, s[36:39], s61 offen offset:1024 sc1
v_mfma_f32_16x16x32_bf16 v[76:79], v[40:43], a[4:7], v[76:79]
ds_read_b64_tr_b16 v[36:37], v20 offset:2048
ds_read_b64_tr_b16 v[38:39], v20 offset:2560
v_mfma_f32_16x16x32_bf16 v[76:79], v[44:47], a[12:15], v[76:79]
v_readlane_b32 s53, v31, 5
s_waitcnt lgkmcnt(8)
v_mfma_f32_16x16x32_bf16 v[80:83], v[48:51], a[0:3], v[80:83]
ds_read_b64_tr_b16 v[40:41], v17 offset:2048
ds_read_b64_tr_b16 v[42:43], v17 offset:2560
v_mfma_f32_16x16x32_bf16 v[80:83], v[52:55], a[8:11], v[80:83]
buffer_load_dwordx4 a[56:59], v1, s[36:39], s61 offen offset:2048 sc1
v_mfma_f32_16x16x32_bf16 v[84:87], v[48:51], a[4:7], v[84:87]
ds_read_b64_tr_b16 v[44:45], v21 offset:2048
ds_read_b64_tr_b16 v[46:47], v21 offset:2560
v_mfma_f32_16x16x32_bf16 v[84:87], v[52:55], a[12:15], v[84:87]
v_readlane_b32 s60, v31, 6
s_waitcnt lgkmcnt(8)
v_mfma_f32_16x16x32_bf16 v[88:91], v[56:59], a[0:3], v[88:91]
ds_read_b64_tr_b16 v[48:49], v18 offset:2048
ds_read_b64_tr_b16 v[50:51], v18 offset:2560
v_mfma_f32_16x16x32_bf16 v[88:91], v[60:63], a[8:11], v[88:91]
buffer_load_dwordx4 a[60:63], v1, s[36:39], s61 offen offset:3072 sc1
v_mfma_f32_16x16x32_bf16 v[92:95], v[56:59], a[4:7], v[92:95]
ds_read_b64_tr_b16 v[52:53], v22 offset:2048
ds_read_b64_tr_b16 v[54:55], v22 offset:2560
v_mfma_f32_16x16x32_bf16 v[92:95], v[60:63], a[12:15], v[92:95]
v_readlane_b32 s61, v31, 7
s_waitcnt vmcnt(8) lgkmcnt(8)
v_mfma_f32_16x16x32_bf16 v[64:67], v[32:35], a[16:19], v[64:67]
ds_read_b64_tr_b16 v[56:57], v19 offset:2048
ds_read_b64_tr_b16 v[58:59], v19 offset:2560
v_mfma_f32_16x16x32_bf16 v[64:67], v[36:39], a[24:27], v[64:67]
buffer_load_dwordx4 a[64:67], v1, s[36:39], s50 offen offset:0 sc1
v_mfma_f32_16x16x32_bf16 v[68:71], v[32:35], a[20:23], v[68:71]
ds_read_b64_tr_b16 v[60:61], v23 offset:2048
ds_read_b64_tr_b16 v[62:63], v23 offset:2560
v_mfma_f32_16x16x32_bf16 v[68:71], v[36:39], a[28:31], v[68:71]
s_waitcnt lgkmcnt(8)
v_mfma_f32_16x16x32_bf16 v[72:75], v[40:43], a[16:19], v[72:75]
ds_read_b64_tr_b16 v[32:33], v16 offset:4096
ds_read_b64_tr_b16 v[34:35], v16 offset:4608
v_mfma_f32_16x16x32_bf16 v[72:75], v[44:47], a[24:27], v[72:75]
buffer_load_dwordx4 a[68:71], v1, s[36:39], s50 offen offset:1024 sc1
v_mfma_f32_16x16x32_bf16 v[76:79], v[40:43], a[20:23], v[76:79]
ds_read_b64_tr_b16 v[36:37], v20 offset:4096
ds_read_b64_tr_b16 v[38:39], v20 offset:4608
v_mfma_f32_16x16x32_bf16 v[76:79], v[44:47], a[28:31], v[76:79]
s_waitcnt lgkmcnt(8)
v_mfma_f32_16x16x32_bf16 v[80:83], v[48:51], a[16:19], v[80:83]
ds_read_b64_tr_b16 v[40:41], v17 offset:4096
ds_read_b64_tr_b16 v[42:43], v17 offset:4608
v_mfma_f32_16x16x32_bf16 v[80:83], v[52:55], a[24:27], v[80:83]
buffer_load_dwordx4 a[72:75], v1, s[36:39], s50 offen offset:2048 sc1
v_mfma_f32_16x16x32_bf16 v[84:87], v[48:51], a[20:23], v[84:87]
ds_read_b64_tr_b16 v[44:45], v21 offset:4096
ds_read_b64_tr_b16 v[46:47], v21 offset:4608
v_mfma_f32_16x16x32_bf16 v[84:87], v[52:55], a[28:31], v[84:87]
s_waitcnt lgkmcnt(8)
v_mfma_f32_16x16x32_bf16 v[88:91], v[56:59], a[16:19], v[88:91]
ds_read_b64_tr_b16 v[48:49], v18 offset:4096
ds_read_b64_tr_b16 v[50:51], v18 offset:4608
v_mfma_f32_16x16x32_bf16 v[88:91], v[60:63], a[24:27], v[88:91]
buffer_load_dwordx4 a[76:79], v1, s[36:39], s50 offen offset:3072 sc1
v_mfma_f32_16x16x32_bf16 v[92:95], v[56:59], a[20:23], v[92:95]
ds_read_b64_tr_b16 v[52:53], v22 offset:4096
ds_read_b64_tr_b16 v[54:55], v22 offset:4608
v_mfma_f32_16x16x32_bf16 v[92:95], v[60:63], a[28:31], v[92:95]
v_readlane_b32 s50, v31, 8
s_waitcnt vmcnt(8) lgkmcnt(8)
v_mfma_f32_16x16x32_bf16 v[64:67], v[32:35], a[32:35], v[64:67]
ds_read_b64_tr_b16 v[56:57], v19 offset:4096
ds_read_b64_tr_b16 v[58:59], v19 offset:4608
v_mfma_f32_16x16x32_bf16 v[64:67], v[36:39], a[40:43], v[64:67]
buffer_load_dwordx4 a[80:83], v1, s[36:39], s53 offen offset:0 sc1
v_mfma_f32_16x16x32_bf16 v[68:71], v[32:35], a[36:39], v[68:71]
ds_read_b64_tr_b16 v[60:61], v23 offset:4096
ds_read_b64_tr_b16 v[62:63], v23 offset:4608
v_mfma_f32_16x16x32_bf16 v[68:71], v[36:39], a[44:47], v[68:71]
s_waitcnt lgkmcnt(8)
v_mfma_f32_16x16x32_bf16 v[72:75], v[40:43], a[32:35], v[72:75]
ds_read_b64_tr_b16 v[32:33], v16 offset:6144
TP39:
s_cbranch_execz TP6
TP40:
s_cbranch_execz TR1
ds_read_b64_tr_b16 v[34:35], v16 offset:6656
v_mfma_f32_16x16x32_bf16 v[72:75], v[44:47], a[40:43], v[72:75]
buffer_load_dwordx4 a[84:87], v1, s[36:39], s53 offen offset:1024 sc1
v_mfma_f32_16x16x32_bf16 v[76:79], v[40:43], a[36:39], v[76:79]
ds_read_b64_tr_b16 v[36:37], v20 offset:6144
ds_read_b64_tr_b16 v[38:39], v20 offset:6656
v_mfma_f32_16x16x32_bf16 v[76:79], v[44:47], a[44:47], v[76:79]
s_waitcnt lgkmcnt(8)
v_mfma_f32_16x16x32_bf16 v[80:83], v[48:51], a[32:35], v[80:83]
ds_read_b64_tr_b16 v[40:41], v17 offset:6144
ds_read_b64_tr_b16 v[42:43], v17 offset:6656
v_mfma_f32_16x16x32_bf16 v[80:83], v[52:55], a[40:43], v[80:83]
buffer_load_dwordx4 a[88:91], v1, s[36:39], s53 offen offset:2048 sc1
v_mfma_f32_16x16x32_bf16 v[84:87], v[48:51], a[36:39], v[84:87]
ds_read_b64_tr_b16 v[44:45], v21 offset:6144
ds_read_b64_tr_b16 v[46:47], v21 offset:6656
v_mfma_f32_16x16x32_bf16 v[84:87], v[52:55], a[44:47], v[84:87]
s_waitcnt lgkmcnt(8)
v_mfma_f32_16x16x32_bf16 v[88:91], v[56:59], a[32:35], v[88:91]
ds_read_b64_tr_b16 v[48:49], v18 offset:6144
ds_read_b64_tr_b16 v[50:51], v18 offset:6656
v_mfma_f32_16x16x32_bf16 v[88:91], v[60:63], a[40:43], v[88:91]
buffer_load_dwordx4 a[92:95], v1, s[36:39], s53 offen offset:3072 sc1
v_mfma_f32_16x16x32_bf16 v[92:95], v[56:59], a[36:39], v[92:95]
ds_read_b64_tr_b16 v[52:53], v22 offset:6144
ds_read_b64_tr_b16 v[54:55], v22 offset:6656
v_mfma_f32_16x16x32_bf16 v[92:95], v[60:63], a[44:47], v[92:95]
v_readlane_b32 s53, v31, 9
s_waitcnt vmcnt(8) lgkmcnt(8)
v_mfma_f32_16x16x32_bf16 v[64:67], v[32:35], a[48:51], v[64:67]
ds_read_b64_tr_b16 v[56:57], v19 offset:6144
ds_read_b64_tr_b16 v[58:59], v19 offset:6656
v_mfma_f32_16x16x32_bf16 v[64:67], v[36:39], a[56:59], v[64:67]
buffer_load_dwordx4 a[96:99], v1, s[36:39], s60 offen offset:0 sc1
v_mfma_f32_16x16x32_bf16 v[68:71], v[32:35], a[52:55], v[68:71]
ds_read_b64_tr_b16 v[60:61], v23 offset:6144
ds_read_b64_tr_b16 v[62:63], v23 offset:6656
v_mfma_f32_16x16x32_bf16 v[68:71], v[36:39], a[60:63], v[68:71]
s_waitcnt lgkmcnt(8)
v_mfma_f32_16x16x32_bf16 v[72:75], v[40:43], a[48:51], v[72:75]
ds_read_b64_tr_b16 v[32:33], v16 offset:8192
ds_read_b64_tr_b16 v[34:35], v16 offset:8704
v_mfma_f32_16x16x32_bf16 v[72:75], v[44:47], a[56:59], v[72:75]
buffer_load_dwordx4 a[100:103], v1, s[36:39], s60 offen offset:1024 sc1
v_mfma_f32_16x16x32_bf16 v[76:79], v[40:43], a[52:55], v[76:79]
ds_read_b64_tr_b16 v[36:37], v20 offset:8192
ds_read_b64_tr_b16 v[38:39], v20 offset:8704
v_mfma_f32_16x16x32_bf16 v[76:79], v[44:47], a[60:63], v[76:79]
s_waitcnt lgkmcnt(8)
v_mfma_f32_16x16x32_bf16 v[80:83], v[48:51], a[48:51], v[80:83]
ds_read_b64_tr_b16 v[40:41], v17 offset:8192
ds_read_b64_tr_b16 v[42:43], v17 offset:8704
v_mfma_f32_16x16x32_bf16 v[80:83], v[52:55], a[56:59], v[80:83]
buffer_load_dwordx4 a[104:107], v1, s[36:39], s60 offen offset:2048 sc1
v_mfma_f32_16x16x32_bf16 v[84:87], v[48:51], a[52:55], v[84:87]
ds_read_b64_tr_b16 v[44:45], v21 offset:8192
ds_read_b64_tr_b16 v[46:47], v21 offset:8704
v_mfma_f32_16x16x32_bf16 v[84:87], v[52:55], a[60:63], v[84:87]
s_waitcnt lgkmcnt(8)
v_mfma_f32_16x16x32_bf16 v[88:91], v[56:59], a[48:51], v[88:91]
ds_read_b64_tr_b16 v[48:49], v18 offset:8192
ds_read_b64_tr_b16 v[50:51], v18 offset:8704
v_mfma_f32_16x16x32_bf16 v[88:91], v[60:63], a[56:59], v[88:91]
buffer_load_dwordx4 a[108:111], v1, s[36:39], s60 offen offset:3072 sc1
v_mfma_f32_16x16x32_bf16 v[92:95], v[56:59], a[52:55], v[92:95]
ds_read_b64_tr_b16 v[52:53], v22 offset:8192
ds_read_b64_tr_b16 v[54:55], v22 offset:8704
v_mfma_f32_16x16x32_bf16 v[92:95], v[60:63], a[60:63], v[92:95]
v_readlane_b32 s60, v31, 10
s_waitcnt vmcnt(8) lgkmcnt(8)
v_mfma_f32_16x16x32_bf16 v[64:67], v[32:35], a[64:67], v[64:67]
ds_read_b64_tr_b16 v[56:57], v19 offset:8192
ds_read_b64_tr_b16 v[58:59], v19 offset:8704
v_mfma_f32_16x16x32_bf16 v[64:67], v[36:39], a[72:75], v[64:67]
buffer_load_dwordx4 a[112:115], v1, s[36:39], s61 offen offset:0 sc1
v_mfma_f32_16x16x32_bf16 v[68:71], v[32:35], a[68:71], v[68:71]
ds_read_b64_tr_b16 v[60:61], v23 offset:8192
ds_read_b64_tr_b16 v[62:63], v23 offset:8704
v_mfma_f32_16x16x32_bf16 v[68:71], v[36:39], a[76:79], v[68:71]
s_waitcnt lgkmcnt(8)
v_mfma_f32_16x16x32_bf16 v[72:75], v[40:43], a[64:67], v[72:75]
ds_read_b64_tr_b16 v[32:33], v16 offset:10240
ds_read_b64_tr_b16 v[34:35], v16 offset:10752
v_mfma_f32_16x16x32_bf16 v[72:75], v[44:47], a[72:75], v[72:75]
buffer_load_dwordx4 a[116:119], v1, s[36:39], s61 offen offset:1024 sc1
v_mfma_f32_16x16x32_bf16 v[76:79], v[40:43], a[68:71], v[76:79]
ds_read_b64_tr_b16 v[36:37], v20 offset:10240
ds_read_b64_tr_b16 v[38:39], v20 offset:10752
v_mfma_f32_16x16x32_bf16 v[76:79], v[44:47], a[76:79], v[76:79]
s_waitcnt lgkmcnt(8)
v_mfma_f32_16x16x32_bf16 v[80:83], v[48:51], a[64:67], v[80:83]
ds_read_b64_tr_b16 v[40:41], v17 offset:10240
ds_read_b64_tr_b16 v[42:43], v17 offset:10752
v_mfma_f32_16x16x32_bf16 v[80:83], v[52:55], a[72:75], v[80:83]
buffer_load_dwordx4 a[120:123], v1, s[36:39], s61 offen offset:2048 sc1
v_mfma_f32_16x16x32_bf16 v[84:87], v[48:51], a[68:71], v[84:87]
ds_read_b64_tr_b16 v[44:45], v21 offset:10240
ds_read_b64_tr_b16 v[46:47], v21 offset:10752
v_mfma_f32_16x16x32_bf16 v[84:87], v[52:55], a[76:79], v[84:87]
s_waitcnt lgkmcnt(8)
v_mfma_f32_16x16x32_bf16 v[88:91], v[56:59], a[64:67], v[88:91]
ds_read_b64_tr_b16 v[48:49], v18 offset:10240
ds_read_b64_tr_b16 v[50:51], v18 offset:10752
v_mfma_f32_16x16x32_bf16 v[88:91], v[60:63], a[72:75], v[88:91]
buffer_load_dwordx4 a[124:127], v1, s[36:39], s61 offen offset:3072 sc1
v_mfma_f32_16x16x32_bf16 v[92:95], v[56:59], a[68:71], v[92:95]
ds_read_b64_tr_b16 v[52:53], v22 offset:10240
ds_read_b64_tr_b16 v[54:55], v22 offset:10752
v_mfma_f32_16x16x32_bf16 v[92:95], v[60:63], a[76:79], v[92:95]
v_readlane_b32 s61, v31, 11
s_waitcnt vmcnt(8) lgkmcnt(8)
v_mfma_f32_16x16x32_bf16 v[64:67], v[32:35], a[80:83], v[64:67]
ds_read_b64_tr_b16 v[56:57], v19 offset:10240
ds_read_b64_tr_b16 v[58:59], v19 offset:10752
v_mfma_f32_16x16x32_bf16 v[64:67], v[36:39], a[88:91], v[64:67]
buffer_load_dwordx4 a[128:131], v1, s[36:39], s50 offen offset:0 sc1
v_mfma_f32_16x16x32_bf16 v[68:71], v[32:35], a[84:87], v[68:71]
ds_read_b64_tr_b16 v[60:61], v23 offset:10240
ds_read_b64_tr_b16 v[62:63], v23 offset:10752
v_mfma_f32_16x16x32_bf16 v[68:71], v[36:39], a[92:95], v[68:71]
s_waitcnt lgkmcnt(8)
v_mfma_f32_16x16x32_bf16 v[72:75], v[40:43], a[80:83], v[72:75]
ds_read_b64_tr_b16 v[32:33], v16 offset:12288
ds_read_b64_tr_b16 v[34:35], v16 offset:12800
v_mfma_f32_16x16x32_bf16 v[72:75], v[44:47], a[88:91], v[72:75]
buffer_load_dwordx4 a[132:135], v1, s[36:39], s50 offen offset:1024 sc1
v_mfma_f32_16x16x32_bf16 v[76:79], v[40:43], a[84:87], v[76:79]
ds_read_b64_tr_b16 v[36:37], v20 offset:12288
ds_read_b64_tr_b16 v[38:39], v20 offset:12800
v_mfma_f32_16x16x32_bf16 v[76:79], v[44:47], a[92:95], v[76:79]
s_waitcnt lgkmcnt(8)
v_mfma_f32_16x16x32_bf16 v[80:83], v[48:51], a[80:83], v[80:83]
ds_read_b64_tr_b16 v[40:41], v17 offset:12288
ds_read_b64_tr_b16 v[42:43], v17 offset:12800
v_mfma_f32_16x16x32_bf16 v[80:83], v[52:55], a[88:91], v[80:83]
buffer_load_dwordx4 a[136:139], v1, s[36:39], s50 offen offset:2048 sc1
v_mfma_f32_16x16x32_bf16 v[84:87], v[48:51], a[84:87], v[84:87]
ds_read_b64_tr_b16 v[44:45], v21 offset:12288
ds_read_b64_tr_b16 v[46:47], v21 offset:12800
v_mfma_f32_16x16x32_bf16 v[84:87], v[52:55], a[92:95], v[84:87]
s_waitcnt lgkmcnt(8)
v_mfma_f32_16x16x32_bf16 v[88:91], v[56:59], a[80:83], v[88:91]
ds_read_b64_tr_b16 v[48:49], v18 offset:12288
ds_read_b64_tr_b16 v[50:51], v18 offset:12800
v_mfma_f32_16x16x32_bf16 v[88:91], v[60:63], a[88:91], v[88:91]
buffer_load_dwordx4 a[140:143], v1, s[36:39], s50 offen offset:3072 sc1
v_mfma_f32_16x16x32_bf16 v[92:95], v[56:59], a[84:87], v[92:95]
ds_read_b64_tr_b16 v[52:53], v22 offset:12288
ds_read_b64_tr_b16 v[54:55], v22 offset:12800
v_mfma_f32_16x16x32_bf16 v[92:95], v[60:63], a[92:95], v[92:95]
v_readlane_b32 s50, v31, 12
s_waitcnt vmcnt(8) lgkmcnt(8)
v_mfma_f32_16x16x32_bf16 v[64:67], v[32:35], a[96:99], v[64:67]
ds_read_b64_tr_b16 v[56:57], v19 offset:12288
ds_read_b64_tr_b16 v[58:59], v19 offset:12800
v_mfma_f32_16x16x32_bf16 v[64:67], v[36:39], a[104:107], v[64:67]
buffer_load_dwordx4 a[144:147], v1, s[36:39], s53 offen offset:0 sc1
v_mfma_f32_16x16x32_bf16 v[68:71], v[32:35], a[100:103], v[68:71]
ds_read_b64_tr_b16 v[60:61], v23 offset:12288
ds_read_b64_tr_b16 v[62:63], v23 offset:12800
v_mfma_f32_16x16x32_bf16 v[68:71], v[36:39], a[108:111], v[68:71]
s_waitcnt lgkmcnt(8)
v_mfma_f32_16x16x32_bf16 v[72:75], v[40:43], a[96:99], v[72:75]
ds_read_b64_tr_b16 v[32:33], v16 offset:14336
ds_read_b64_tr_b16 v[34:35], v16 offset:14848
v_mfma_f32_16x16x32_bf16 v[72:75], v[44:47], a[104:107], v[72:75]
buffer_load_dwordx4 a[148:151], v1, s[36:39], s53 offen offset:1024 sc1
v_mfma_f32_16x16x32_bf16 v[76:79], v[40:43], a[100:103], v[76:79]
ds_read_b64_tr_b16 v[36:37], v20 offset:14336
ds_read_b64_tr_b16 v[38:39], v20 offset:14848
v_mfma_f32_16x16x32_bf16 v[76:79], v[44:47], a[108:111], v[76:79]
s_waitcnt lgkmcnt(8)
v_mfma_f32_16x16x32_bf16 v[80:83], v[48:51], a[96:99], v[80:83]
ds_read_b64_tr_b16 v[40:41], v17 offset:14336
ds_read_b64_tr_b16 v[42:43], v17 offset:14848
v_mfma_f32_16x16x32_bf16 v[80:83], v[52:55], a[104:107], v[80:83]
buffer_load_dwordx4 a[152:155], v1, s[36:39], s53 offen offset:2048 sc1
v_mfma_f32_16x16x32_bf16 v[84:87], v[48:51], a[100:103], v[84:87]
ds_read_b64_tr_b16 v[44:45], v21 offset:14336
ds_read_b64_tr_b16 v[46:47], v21 offset:14848
v_mfma_f32_16x16x32_bf16 v[84:87], v[52:55], a[108:111], v[84:87]
s_waitcnt lgkmcnt(8)
v_mfma_f32_16x16x32_bf16 v[88:91], v[56:59], a[96:99], v[88:91]
ds_read_b64_tr_b16 v[48:49], v18 offset:14336
ds_read_b64_tr_b16 v[50:51], v18 offset:14848
v_mfma_f32_16x16x32_bf16 v[88:91], v[60:63], a[104:107], v[88:91]
buffer_load_dwordx4 a[156:159], v1, s[36:39], s53 offen offset:3072 sc1
v_mfma_f32_16x16x32_bf16 v[92:95], v[56:59], a[100:103], v[92:95]
ds_read_b64_tr_b16 v[52:53], v22 offset:14336
ds_read_b64_tr_b16 v[54:55], v22 offset:14848
v_mfma_f32_16x16x32_bf16 v[92:95], v[60:63], a[108:111], v[92:95]
v_readlane_b32 s53, v31, 13
s_waitcnt vmcnt(8) lgkmcnt(8)
v_mfma_f32_16x16x32_bf16 v[64:67], v[32:35], a[112:115], v[64:67]
ds_read_b64_tr_b16 v[56:57], v19 offset:14336
ds_read_b64_tr_b16 v[58:59], v19 offset:14848
v_mfma_f32_16x16x32_bf16 v[64:67], v[36:39], a[120:123], v[64:67]
buffer_load_dwordx4 a[160:163], v1, s[36:39], s60 offen offset:0 sc1
v_mfma_f32_16x16x32_bf16 v[68:71], v[32:35], a[116:119], v[68:71]
ds_read_b64_tr_b16 v[60:61], v23 offset:14336
ds_read_b64_tr_b16 v[62:63], v23 offset:14848
v_mfma_f32_16x16x32_bf16 v[68:71], v[36:39], a[124:127], v[68:71]
s_waitcnt lgkmcnt(8)
v_mfma_f32_16x16x32_bf16 v[72:75], v[40:43], a[112:115], v[72:75]
ds_read_b64_tr_b16 v[32:33], v16 offset:16384
ds_read_b64_tr_b16 v[34:35], v16 offset:16896
v_mfma_f32_16x16x32_bf16 v[72:75], v[44:47], a[120:123], v[72:75]
buffer_load_dwordx4 a[164:167], v1, s[36:39], s60 offen offset:1024 sc1
v_mfma_f32_16x16x32_bf16 v[76:79], v[40:43], a[116:119], v[76:79]
ds_read_b64_tr_b16 v[36:37], v20 offset:16384
ds_read_b64_tr_b16 v[38:39], v20 offset:16896
v_mfma_f32_16x16x32_bf16 v[76:79], v[44:47], a[124:127], v[76:79]
s_waitcnt lgkmcnt(8)
v_mfma_f32_16x16x32_bf16 v[80:83], v[48:51], a[112:115], v[80:83]
ds_read_b64_tr_b16 v[40:41], v17 offset:16384
ds_read_b64_tr_b16 v[42:43], v17 offset:16896
v_mfma_f32_16x16x32_bf16 v[80:83], v[52:55], a[120:123], v[80:83]
buffer_load_dwordx4 a[168:171], v1, s[36:39], s60 offen offset:2048 sc1
v_mfma_f32_16x16x32_bf16 v[84:87], v[48:51], a[116:119], v[84:87]
ds_read_b64_tr_b16 v[44:45], v21 offset:16384
ds_read_b64_tr_b16 v[46:47], v21 offset:16896
v_mfma_f32_16x16x32_bf16 v[84:87], v[52:55], a[124:127], v[84:87]
s_waitcnt lgkmcnt(8)
v_mfma_f32_16x16x32_bf16 v[88:91], v[56:59], a[112:115], v[88:91]
ds_read_b64_tr_b16 v[48:49], v18 offset:16384
ds_read_b64_tr_b16 v[50:51], v18 offset:16896
v_mfma_f32_16x16x32_bf16 v[88:91], v[60:63], a[120:123], v[88:91]
buffer_load_dwordx4 a[172:175], v1, s[36:39], s60 offen offset:3072 sc1
v_mfma_f32_16x16x32_bf16 v[92:95], v[56:59], a[116:119], v[92:95]
ds_read_b64_tr_b16 v[52:53], v22 offset:16384
ds_read_b64_tr_b16 v[54:55], v22 offset:16896
v_mfma_f32_16x16x32_bf16 v[92:95], v[60:63], a[124:127], v[92:95]
v_readlane_b32 s60, v31, 14
s_waitcnt vmcnt(8) lgkmcnt(8)
v_mfma_f32_16x16x32_bf16 v[64:67], v[32:35], a[128:131], v[64:67]
ds_read_b64_tr_b16 v[56:57], v19 offset:16384
ds_read_b64_tr_b16 v[58:59], v19 offset:16896
v_mfma_f32_16x16x32_bf16 v[64:67], v[36:39], a[136:139], v[64:67]
buffer_load_dwordx4 a[176:179], v1, s[36:39], s61 offen offset:0 sc1
v_mfma_f32_16x16x32_bf16 v[68:71], v[32:35], a[132:135], v[68:71]
ds_read_b64_tr_b16 v[60:61], v23 offset:16384
ds_read_b64_tr_b16 v[62:63], v23 offset:16896
v_mfma_f32_16x16x32_bf16 v[68:71], v[36:39], a[140:143], v[68:71]
s_waitcnt lgkmcnt(8)
v_mfma_f32_16x16x32_bf16 v[72:75], v[40:43], a[128:131], v[72:75]
ds_read_b64_tr_b16 v[32:33], v16 offset:18432
ds_read_b64_tr_b16 v[34:35], v16 offset:18944
v_mfma_f32_16x16x32_bf16 v[72:75], v[44:47], a[136:139], v[72:75]
buffer_load_dwordx4 a[180:183], v1, s[36:39], s61 offen offset:1024 sc1
v_mfma_f32_16x16x32_bf16 v[76:79], v[40:43], a[132:135], v[76:79]
ds_read_b64_tr_b16 v[36:37], v20 offset:18432
ds_read_b64_tr_b16 v[38:39], v20 offset:18944
v_mfma_f32_16x16x32_bf16 v[76:79], v[44:47], a[140:143], v[76:79]
s_waitcnt lgkmcnt(8)
v_mfma_f32_16x16x32_bf16 v[80:83], v[48:51], a[128:131], v[80:83]
ds_read_b64_tr_b16 v[40:41], v17 offset:18432
ds_read_b64_tr_b16 v[42:43], v17 offset:18944
v_mfma_f32_16x16x32_bf16 v[80:83], v[52:55], a[136:139], v[80:83]
buffer_load_dwordx4 a[184:187], v1, s[36:39], s61 offen offset:2048 sc1
v_mfma_f32_16x16x32_bf16 v[84:87], v[48:51], a[132:135], v[84:87]
ds_read_b64_tr_b16 v[44:45], v21 offset:18432
ds_read_b64_tr_b16 v[46:47], v21 offset:18944
v_mfma_f32_16x16x32_bf16 v[84:87], v[52:55], a[140:143], v[84:87]
s_waitcnt lgkmcnt(8)
v_mfma_f32_16x16x32_bf16 v[88:91], v[56:59], a[128:131], v[88:91]
ds_read_b64_tr_b16 v[48:49], v18 offset:18432
ds_read_b64_tr_b16 v[50:51], v18 offset:18944
v_mfma_f32_16x16x32_bf16 v[88:91], v[60:63], a[136:139], v[88:91]
buffer_load_dwordx4 a[188:191], v1, s[36:39], s61 offen offset:3072 sc1
v_mfma_f32_16x16x32_bf16 v[92:95], v[56:59], a[132:135], v[92:95]
ds_read_b64_tr_b16 v[52:53], v22 offset:18432
ds_read_b64_tr_b16 v[54:55], v22 offset:18944
v_mfma_f32_16x16x32_bf16 v[92:95], v[60:63], a[140:143], v[92:95]
v_readlane_b32 s61, v31, 15
s_waitcnt vmcnt(8) lgkmcnt(8)
v_mfma_f32_16x16x32_bf16 v[64:67], v[32:35], a[144:147], v[64:67]
ds_read_b64_tr_b16 v[56:57], v19 offset:18432
ds_read_b64_tr_b16 v[58:59], v19 offset:18944
v_mfma_f32_16x16x32_bf16 v[64:67], v[36:39], a[152:155], v[64:67]
buffer_load_dwordx4 a[192:195], v1, s[36:39], s50 offen offset:0 sc1
v_mfma_f32_16x16x32_bf16 v[68:71], v[32:35], a[148:151], v[68:71]
ds_read_b64_tr_b16 v[60:61], v23 offset:18432
ds_read_b64_tr_b16 v[62:63], v23 offset:18944
v_mfma_f32_16x16x32_bf16 v[68:71], v[36:39], a[156:159], v[68:71]
s_waitcnt lgkmcnt(8)
v_mfma_f32_16x16x32_bf16 v[72:75], v[40:43], a[144:147], v[72:75]
ds_read_b64_tr_b16 v[32:33], v16 offset:20480
ds_read_b64_tr_b16 v[34:35], v16 offset:20992
v_mfma_f32_16x16x32_bf16 v[72:75], v[44:47], a[152:155], v[72:75]
buffer_load_dwordx4 a[196:199], v1, s[36:39], s50 offen offset:1024 sc1
v_mfma_f32_16x16x32_bf16 v[76:79], v[40:43], a[148:151], v[76:79]
ds_read_b64_tr_b16 v[36:37], v20 offset:20480
ds_read_b64_tr_b16 v[38:39], v20 offset:20992
v_mfma_f32_16x16x32_bf16 v[76:79], v[44:47], a[156:159], v[76:79]
s_waitcnt lgkmcnt(8)
v_mfma_f32_16x16x32_bf16 v[80:83], v[48:51], a[144:147], v[80:83]
ds_read_b64_tr_b16 v[40:41], v17 offset:20480
ds_read_b64_tr_b16 v[42:43], v17 offset:20992
v_mfma_f32_16x16x32_bf16 v[80:83], v[52:55], a[152:155], v[80:83]
buffer_load_dwordx4 a[200:203], v1, s[36:39], s50 offen offset:2048 sc1
v_mfma_f32_16x16x32_bf16 v[84:87], v[48:51], a[148:151], v[84:87]
ds_read_b64_tr_b16 v[44:45], v21 offset:20480
ds_read_b64_tr_b16 v[46:47], v21 offset:20992
v_mfma_f32_16x16x32_bf16 v[84:87], v[52:55], a[156:159], v[84:87]
s_waitcnt lgkmcnt(8)
v_mfma_f32_16x16x32_bf16 v[88:91], v[56:59], a[144:147], v[88:91]
ds_read_b64_tr_b16 v[48:49], v18 offset:20480
ds_read_b64_tr_b16 v[50:51], v18 offset:20992
v_mfma_f32_16x16x32_bf16 v[88:91], v[60:63], a[152:155], v[88:91]
buffer_load_dwordx4 a[204:207], v1, s[36:39], s50 offen offset:3072 sc1
v_mfma_f32_16x16x32_bf16 v[92:95], v[56:59], a[148:151], v[92:95]
ds_read_b64_tr_b16 v[52:53], v22 offset:20480
ds_read_b64_tr_b16 v[54:55], v22 offset:20992
v_mfma_f32_16x16x32_bf16 v[92:95], v[60:63], a[156:159], v[92:95]
s_waitcnt vmcnt(8) lgkmcnt(8)
v_mfma_f32_16x16x32_bf16 v[64:67], v[32:35], a[160:163], v[64:67]
ds_read_b64_tr_b16 v[56:57], v19 offset:20480
ds_read_b64_tr_b16 v[58:59], v19 offset:20992
v_mfma_f32_16x16x32_bf16 v[64:67], v[36:39], a[168:171], v[64:67]
buffer_load_dwordx4 a[208:211], v1, s[36:39], s53 offen offset:0 sc1
v_mfma_f32_16x16x32_bf16 v[68:71], v[32:35], a[164:167], v[68:71]
ds_read_b64_tr_b16 v[60:61], v23 offset:20480
ds_read_b64_tr_b16 v[62:63], v23 offset:20992
v_mfma_f32_16x16x32_bf16 v[68:71], v[36:39], a[172:175], v[68:71]
s_waitcnt lgkmcnt(8)
v_mfma_f32_16x16x32_bf16 v[72:75], v[40:43], a[160:163], v[72:75]
ds_read_b64_tr_b16 v[32:33], v16 offset:22528
ds_read_b64_tr_b16 v[34:35], v16 offset:23040
v_mfma_f32_16x16x32_bf16 v[72:75], v[44:47], a[168:171], v[72:75]
buffer_load_dwordx4 a[212:215], v1, s[36:39], s53 offen offset:1024 sc1
v_mfma_f32_16x16x32_bf16 v[76:79], v[40:43], a[164:167], v[76:79]
ds_read_b64_tr_b16 v[36:37], v20 offset:22528
ds_read_b64_tr_b16 v[38:39], v20 offset:23040
v_mfma_f32_16x16x32_bf16 v[76:79], v[44:47], a[172:175], v[76:79]
s_waitcnt lgkmcnt(8)
v_mfma_f32_16x16x32_bf16 v[80:83], v[48:51], a[160:163], v[80:83]
ds_read_b64_tr_b16 v[40:41], v17 offset:22528
ds_read_b64_tr_b16 v[42:43], v17 offset:23040
v_mfma_f32_16x16x32_bf16 v[80:83], v[52:55], a[168:171], v[80:83]
buffer_load_dwordx4 a[216:219], v1, s[36:39], s53 offen offset:2048 sc1
v_mfma_f32_16x16x32_bf16 v[84:87], v[48:51], a[164:167], v[84:87]
ds_read_b64_tr_b16 v[44:45], v21 offset:22528
ds_read_b64_tr_b16 v[46:47], v21 offset:23040
v_mfma_f32_16x16x32_bf16 v[84:87], v[52:55], a[172:175], v[84:87]
s_waitcnt lgkmcnt(8)
v_mfma_f32_16x16x32_bf16 v[88:91], v[56:59], a[160:163], v[88:91]
ds_read_b64_tr_b16 v[48:49], v18 offset:22528
ds_read_b64_tr_b16 v[50:51], v18 offset:23040
v_mfma_f32_16x16x32_bf16 v[88:91], v[60:63], a[168:171], v[88:91]
buffer_load_dwordx4 a[220:223], v1, s[36:39], s53 offen offset:3072 sc1
v_mfma_f32_16x16x32_bf16 v[92:95], v[56:59], a[164:167], v[92:95]
ds_read_b64_tr_b16 v[52:53], v22 offset:22528
ds_read_b64_tr_b16 v[54:55], v22 offset:23040
v_mfma_f32_16x16x32_bf16 v[92:95], v[60:63], a[172:175], v[92:95]
s_waitcnt vmcnt(8) lgkmcnt(8)
v_mfma_f32_16x16x32_bf16 v[64:67], v[32:35], a[176:179], v[64:67]
ds_read_b64_tr_b16 v[56:57], v19 offset:22528
ds_read_b64_tr_b16 v[58:59], v19 offset:23040
v_mfma_f32_16x16x32_bf16 v[64:67], v[36:39], a[184:187], v[64:67]
buffer_load_dwordx4 a[224:227], v1, s[36:39], s60 offen offset:0 sc1
v_mfma_f32_16x16x32_bf16 v[68:71], v[32:35], a[180:183], v[68:71]
ds_read_b64_tr_b16 v[60:61], v23 offset:22528
ds_read_b64_tr_b16 v[62:63], v23 offset:23040
v_mfma_f32_16x16x32_bf16 v[68:71], v[36:39], a[188:191], v[68:71]
s_waitcnt lgkmcnt(8)
v_mfma_f32_16x16x32_bf16 v[72:75], v[40:43], a[176:179], v[72:75]
ds_read_b64_tr_b16 v[32:33], v16 offset:24576
ds_read_b64_tr_b16 v[34:35], v16 offset:25088
v_mfma_f32_16x16x32_bf16 v[72:75], v[44:47], a[184:187], v[72:75]
buffer_load_dwordx4 a[228:231], v1, s[36:39], s60 offen offset:1024 sc1
v_mfma_f32_16x16x32_bf16 v[76:79], v[40:43], a[180:183], v[76:79]
ds_read_b64_tr_b16 v[36:37], v20 offset:24576
ds_read_b64_tr_b16 v[38:39], v20 offset:25088
v_mfma_f32_16x16x32_bf16 v[76:79], v[44:47], a[188:191], v[76:79]
s_waitcnt lgkmcnt(8)
v_mfma_f32_16x16x32_bf16 v[80:83], v[48:51], a[176:179], v[80:83]
ds_read_b64_tr_b16 v[40:41], v17 offset:24576
ds_read_b64_tr_b16 v[42:43], v17 offset:25088
v_mfma_f32_16x16x32_bf16 v[80:83], v[52:55], a[184:187], v[80:83]
buffer_load_dwordx4 a[232:235], v1, s[36:39], s60 offen offset:2048 sc1
v_mfma_f32_16x16x32_bf16 v[84:87], v[48:51], a[180:183], v[84:87]
ds_read_b64_tr_b16 v[44:45], v21 offset:24576
ds_read_b64_tr_b16 v[46:47], v21 offset:25088
v_mfma_f32_16x16x32_bf16 v[84:87], v[52:55], a[188:191], v[84:87]
s_waitcnt lgkmcnt(8)
v_mfma_f32_16x16x32_bf16 v[88:91], v[56:59], a[176:179], v[88:91]
ds_read_b64_tr_b16 v[48:49], v18 offset:24576
ds_read_b64_tr_b16 v[50:51], v18 offset:25088
v_mfma_f32_16x16x32_bf16 v[88:91], v[60:63], a[184:187], v[88:91]
buffer_load_dwordx4 a[236:239], v1, s[36:39], s60 offen offset:3072 sc1
v_mfma_f32_16x16x32_bf16 v[92:95], v[56:59], a[180:183], v[92:95]
ds_read_b64_tr_b16 v[52:53], v22 offset:24576
ds_read_b64_tr_b16 v[54:55], v22 offset:25088
v_mfma_f32_16x16x32_bf16 v[92:95], v[60:63], a[188:191], v[92:95]
s_waitcnt vmcnt(8) lgkmcnt(8)
v_mfma_f32_16x16x32_bf16 v[64:67], v[32:35], a[192:195], v[64:67]
ds_read_b64_tr_b16 v[56:57], v19 offset:24576
ds_read_b64_tr_b16 v[58:59], v19 offset:25088
v_mfma_f32_16x16x32_bf16 v[64:67], v[36:39], a[200:203], v[64:67]
buffer_load_dwordx4 a[240:243], v1, s[36:39], s61 offen offset:0 sc1
v_mfma_f32_16x16x32_bf16 v[68:71], v[32:35], a[196:199], v[68:71]
ds_read_b64_tr_b16 v[60:61], v23 offset:24576
ds_read_b64_tr_b16 v[62:63], v23 offset:25088
v_mfma_f32_16x16x32_bf16 v[68:71], v[36:39], a[204:207], v[68:71]
s_waitcnt lgkmcnt(8)
v_mfma_f32_16x16x32_bf16 v[72:75], v[40:43], a[192:195], v[72:75]
ds_read_b64_tr_b16 v[32:33], v16 offset:26624
ds_read_b64_tr_b16 v[34:35], v16 offset:27136
v_mfma_f32_16x16x32_bf16 v[72:75], v[44:47], a[200:203], v[72:75]
buffer_load_dwordx4 a[244:247], v1, s[36:39], s61 offen offset:1024 sc1
v_mfma_f32_16x16x32_bf16 v[76:79], v[40:43], a[196:199], v[76:79]
ds_read_b64_tr_b16 v[36:37], v20 offset:26624
ds_read_b64_tr_b16 v[38:39], v20 offset:27136
v_mfma_f32_16x16x32_bf16 v[76:79], v[44:47], a[204:207], v[76:79]
s_add_u32 m0, s48, 5120
s_waitcnt lgkmcnt(8)
v_mfma_f32_16x16x32_bf16 v[80:83], v[48:51], a[192:195], v[80:83]
ds_read_b64_tr_b16 v[40:41], v17 offset:26624
ds_read_b64_tr_b16 v[42:43], v17 offset:27136
v_mfma_f32_16x16x32_bf16 v[80:83], v[52:55], a[200:203], v[80:83]
buffer_load_dwordx4 a[248:251], v1, s[36:39], s61 offen offset:2048 sc1
v_mfma_f32_16x16x32_bf16 v[84:87], v[48:51], a[196:199], v[84:87]
ds_read_b64_tr_b16 v[44:45], v21 offset:26624
ds_read_b64_tr_b16 v[46:47], v21 offset:27136
v_mfma_f32_16x16x32_bf16 v[84:87], v[52:55], a[204:207], v[84:87]
v_readlane_b32 s67, v26, 1
s_waitcnt lgkmcnt(8)
v_mfma_f32_16x16x32_bf16 v[88:91], v[56:59], a[192:195], v[88:91]
ds_read_b64_tr_b16 v[48:49], v18 offset:26624
ds_read_b64_tr_b16 v[50:51], v18 offset:27136
v_mfma_f32_16x16x32_bf16 v[88:91], v[60:63], a[200:203], v[88:91]
buffer_load_dwordx4 a[252:255], v1, s[36:39], s61 offen offset:3072 sc1
v_mfma_f32_16x16x32_bf16 v[92:95], v[56:59], a[196:199], v[92:95]
ds_read_b64_tr_b16 v[52:53], v22 offset:26624
ds_read_b64_tr_b16 v[54:55], v22 offset:27136
v_mfma_f32_16x16x32_bf16 v[92:95], v[60:63], a[204:207], v[92:95]
s_waitcnt vmcnt(8) lgkmcnt(8)
s_barrier
v_mfma_f32_16x16x32_bf16 v[64:67], v[32:35], a[208:211], v[64:67]
ds_read_b64_tr_b16 v[56:57], v19 offset:26624
ds_read_b64_tr_b16 v[58:59], v19 offset:27136
v_mfma_f32_16x16x32_bf16 v[64:67], v[36:39], a[216:219], v[64:67]
buffer_load_dwordx4 v1, s[36:39], s67 offen offset:0 sc1 lds
v_mfma_f32_16x16x32_bf16 v[68:71], v[32:35], a[212:215], v[68:71]
ds_read_b64_tr_b16 v[60:61], v23 offset:26624
ds_read_b64_tr_b16 v[62:63], v23 offset:27136
v_mfma_f32_16x16x32_bf16 v[68:71], v[36:39], a[220:223], v[68:71]
s_waitcnt lgkmcnt(8)
ds_read_b128 v[128:131], v1 offset:32768
v_mfma_f32_16x16x32_bf16 v[72:75], v[40:43], a[208:211], v[72:75]
ds_read_b64_tr_b16 v[32:33], v16 offset:28672
ds_read_b64_tr_b16 v[34:35], v16 offset:29184
v_mfma_f32_16x16x32_bf16 v[72:75], v[44:47], a[216:219], v[72:75]
buffer_load_dwordx4 v1, s[36:39], s67 offen offset:1024 sc1 lds
v_mfma_f32_16x16x32_bf16 v[76:79], v[40:43], a[212:215], v[76:79]
ds_read_b64_tr_b16 v[36:37], v20 offset:28672
ds_read_b64_tr_b16 v[38:39], v20 offset:29184
v_mfma_f32_16x16x32_bf16 v[76:79], v[44:47], a[220:223], v[76:79]
s_waitcnt lgkmcnt(9)
ds_read_b128 v[132:135], v14 offset:32768
v_mfma_f32_16x16x32_bf16 v[80:83], v[48:51], a[208:211], v[80:83]
ds_read_b64_tr_b16 v[40:41], v17 offset:28672
ds_read_b64_tr_b16 v[42:43], v17 offset:29184
v_mfma_f32_16x16x32_bf16 v[80:83], v[52:55], a[216:219], v[80:83]
buffer_load_dwordx4 v1, s[36:39], s67 offen offset:2048 sc1 lds
v_mfma_f32_16x16x32_bf16 v[84:87], v[48:51], a[212:215], v[84:87]
ds_read_b64_tr_b16 v[44:45], v21 offset:28672
ds_read_b64_tr_b16 v[46:47], v21 offset:29184
v_mfma_f32_16x16x32_bf16 v[84:87], v[52:55], a[220:223], v[84:87]
s_waitcnt lgkmcnt(10)
ds_read_b128 v[136:139], v15 offset:32768
v_mfma_f32_16x16x32_bf16 v[88:91], v[56:59], a[208:211], v[88:91]
ds_read_b64_tr_b16 v[48:49], v18 offset:28672
ds_read_b64_tr_b16 v[50:51], v18 offset:29184
v_mfma_f32_16x16x32_bf16 v[88:91], v[60:63], a[216:219], v[88:91]
buffer_load_dwordx4 v1, s[36:39], s67 offen offset:3072 sc1 lds
v_mfma_f32_16x16x32_bf16 v[92:95], v[56:59], a[212:215], v[92:95]
ds_read_b64_tr_b16 v[52:53], v22 offset:28672
ds_read_b64_tr_b16 v[54:55], v22 offset:29184
v_mfma_f32_16x16x32_bf16 v[92:95], v[60:63], a[220:223], v[92:95]
s_add_u32 m0, s48, 9216
s_waitcnt vmcnt(8) lgkmcnt(10)
ds_read_b128 v[140:143], v24 offset:32768
v_mfma_f32_16x16x32_bf16 v[64:67], v[32:35], a[224:227], v[64:67]
ds_read_b64_tr_b16 v[56:57], v19 offset:28672
ds_read_b64_tr_b16 v[58:59], v19 offset:29184
v_mfma_f32_16x16x32_bf16 v[64:67], v[36:39], a[232:235], v[64:67]
buffer_load_dwordx4 v13, s[36:39], s67 offen offset:0 sc1 lds
v_mfma_f32_16x16x32_bf16 v[68:71], v[32:35], a[228:231], v[68:71]
ds_read_b64_tr_b16 v[60:61], v23 offset:28672
ds_read_b64_tr_b16 v[62:63], v23 offset:29184
v_mfma_f32_16x16x32_bf16 v[68:71], v[36:39], a[236:239], v[68:71]
s_lshl_b32 s53, s47, 16
s_waitcnt lgkmcnt(10)
v_mfma_f32_16x16x32_bf16 v[72:75], v[40:43], a[224:227], v[72:75]
ds_read_b64_tr_b16 v[32:33], v16 offset:30720
ds_read_b64_tr_b16 v[34:35], v16 offset:31232
v_mfma_f32_16x16x32_bf16 v[72:75], v[44:47], a[232:235], v[72:75]
buffer_load_dwordx4 v13, s[36:39], s67 offen offset:1024 sc1 lds
v_mfma_f32_16x16x32_bf16 v[76:79], v[40:43], a[228:231], v[76:79]
ds_read_b64_tr_b16 v[36:37], v20 offset:30720
ds_read_b64_tr_b16 v[38:39], v20 offset:31232
v_mfma_f32_16x16x32_bf16 v[76:79], v[44:47], a[236:239], v[76:79]
s_lshl_b32 s3, s45, 12
s_waitcnt lgkmcnt(9)
v_mfma_f32_16x16x32_bf16 v[80:83], v[48:51], a[224:227], v[80:83]
ds_read_b64_tr_b16 v[40:41], v17 offset:30720
ds_read_b64_tr_b16 v[42:43], v17 offset:31232
v_mfma_f32_16x16x32_bf16 v[80:83], v[52:55], a[232:235], v[80:83]
buffer_load_dwordx4 v13, s[36:39], s67 offen offset:2048 sc1 lds
v_mfma_f32_16x16x32_bf16 v[84:87], v[48:51], a[228:231], v[84:87]
ds_read_b64_tr_b16 v[44:45], v21 offset:30720
ds_read_b64_tr_b16 v[46:47], v21 offset:31232
v_mfma_f32_16x16x32_bf16 v[84:87], v[52:55], a[236:239], v[84:87]
s_add_u32 s53, s53, s3
s_waitcnt lgkmcnt(8)
v_mfma_f32_16x16x32_bf16 v[88:91], v[56:59], a[224:227], v[88:91]
ds_read_b64_tr_b16 v[48:49], v18 offset:30720
ds_read_b64_tr_b16 v[50:51], v18 offset:31232
v_mfma_f32_16x16x32_bf16 v[88:91], v[60:63], a[232:235], v[88:91]
s_add_u32 s53, s53, 16777216
s_lshl_b32 s60, s63, 1
v_mfma_f32_16x16x32_bf16 v[92:95], v[56:59], a[228:231], v[92:95]
ds_read_b64_tr_b16 v[52:53], v22 offset:30720
ds_read_b64_tr_b16 v[54:55], v22 offset:31232
v_mfma_f32_16x16x32_bf16 v[92:95], v[60:63], a[236:239], v[92:95]
s_add_u32 s60, s60, 1310720
s_waitcnt vmcnt(7) lgkmcnt(8)
v_mfma_f32_16x16x32_bf16 v[64:67], v[32:35], a[240:243], v[64:67]
ds_read_b64_tr_b16 v[56:57], v19 offset:30720
ds_read_b64_tr_b16 v[58:59], v19 offset:31232
v_mfma_f32_16x16x32_bf16 v[64:67], v[36:39], a[248:251], v[64:67]
s_lshl_b32 s61, s47, 11
s_lshl2_add_u32 s61, s45, s61
v_mfma_f32_16x16x32_bf16 v[68:71], v[32:35], a[244:247], v[68:71]
ds_read_b64_tr_b16 v[60:61], v23 offset:30720
ds_read_b64_tr_b16 v[62:63], v23 offset:31232
v_mfma_f32_16x16x32_bf16 v[68:71], v[36:39], a[252:255], v[68:71]
s_add_u32 s61, s61, 393216
s_waitcnt lgkmcnt(8)
TP41:
s_cbranch_execz TP10
TP42:
s_cbranch_execz TR1
v_mfma_f32_16x16x32_bf16 v[72:75], v[40:43], a[240:243], v[72:75]
s_add_u32 s62, s63, 393216
v_mfma_f32_16x16x32_bf16 v[72:75], v[44:47], a[248:251], v[72:75]
v_mfma_f32_16x16x32_bf16 v[76:79], v[40:43], a[244:247], v[76:79]
v_mfma_f32_16x16x32_bf16 v[76:79], v[44:47], a[252:255], v[76:79]
s_waitcnt lgkmcnt(4)
v_mfma_f32_16x16x32_bf16 v[80:83], v[48:51], a[240:243], v[80:83]
v_mfma_f32_16x16x32_bf16 v[80:83], v[52:55], a[248:251], v[80:83]
v_cvt_pk_bf16_f32 v176, v64, v65
v_cvt_pk_bf16_f32 v177, v66, v67
v_mfma_f32_16x16x32_bf16 v[84:87], v[48:51], a[244:247], v[84:87]
v_cvt_pk_bf16_f32 v178, v72, v73
v_cvt_pk_bf16_f32 v179, v74, v75
v_mfma_f32_16x16x32_bf16 v[84:87], v[52:55], a[252:255], v[84:87]
s_waitcnt lgkmcnt(0)
v_mfma_f32_16x16x32_bf16 v[88:91], v[56:59], a[240:243], v[88:91]
v_cvt_pk_bf16_f32 v184, v68, v69
v_cvt_pk_bf16_f32 v185, v70, v71
v_mfma_f32_16x16x32_bf16 v[88:91], v[60:63], a[248:251], v[88:91]
v_cvt_pk_bf16_f32 v186, v76, v77
v_cvt_pk_bf16_f32 v187, v78, v79
v_mfma_f32_16x16x32_bf16 v[92:95], v[56:59], a[244:247], v[92:95]
buffer_store_dwordx4 v[176:179], v1, s[36:39], s53 offen offset:0 sc1
v_mfma_f32_16x16x32_bf16 v[92:95], v[60:63], a[252:255], v[92:95]
buffer_store_dwordx4 v[184:187], v1, s[36:39], s53 offen offset:1024 sc1
v_mfma_f32_16x16x32_bf16 v[196:199], v[192:195], v[176:179], 0
v_mfma_f32_16x16x32_bf16 v[200:203], v[176:179], v[176:179], 0
v_cvt_pk_bf16_f32 v180, v80, v81
v_cvt_pk_bf16_f32 v181, v82, v83
v_cvt_pk_bf16_f32 v182, v88, v89
v_cvt_pk_bf16_f32 v183, v90, v91
buffer_store_dwordx4 v[180:183], v1, s[36:39], s53 offen offset:2048 sc1
v_mfma_f32_16x16x32_bf16 v[204:207], v[192:195], v[184:187], 0
v_mfma_f32_16x16x32_bf16 v[208:211], v[184:187], v[184:187], 0
v_cvt_pk_bf16_f32 v188, v84, v85
v_cvt_pk_bf16_f32 v189, v86, v87
v_cvt_pk_bf16_f32 v190, v92, v93
v_cvt_pk_bf16_f32 v191, v94, v95
buffer_store_dwordx4 v[188:191], v1, s[36:39], s53 offen offset:3072 sc1
v_mfma_f32_16x16x32_bf16 v[196:199], v[192:195], v[180:183], v[196:199]
v_mfma_f32_16x16x32_bf16 v[200:203], v[180:183], v[180:183], v[200:203]
v_mfma_f32_16x16x32_bf16 v[204:207], v[192:195], v[188:191], v[204:207]
v_mfma_f32_16x16x32_bf16 v[208:211], v[188:191], v[188:191], v[208:211]
v_readlane_b32 s51, v26, 2
s_add_u32 m0, s48, 12288
v_pk_add_f32 v[128:129], v[128:129], v[136:137]
v_pk_add_f32 v[130:131], v[130:131], v[138:139]
v_pk_add_f32 v[132:133], v[132:133], v[140:141]
v_pk_add_f32 v[134:135], v[134:135], v[142:143]
v_pk_add_f32 v[128:129], v[128:129], v[132:133]
v_pk_add_f32 v[130:131], v[130:131], v[134:135]
v_cndmask_b32 v200, v200, v201, s[54:55]
v_cndmask_b32 v202, v202, v203, s[58:59]
v_cndmask_b32 v208, v208, v209, s[54:55]
v_cndmask_b32 v210, v210, v211, s[58:59]
v_mov_b32 v198, v204
s_or_b64 vcc, s[56:57], s[58:59]
v_cndmask_b32 v197, v200, v202, vcc
v_cndmask_b32 v199, v208, v210, vcc
buffer_store_dwordx4 v[196:199], v242, s[36:39], s60 offen offset:0 sc1
s_barrier
ds_write_b128 v8, v[128:131] offset:0
buffer_load_dwordx4 v1, s[36:39], s51 offen offset:0 sc1 lds
buffer_load_dwordx4 v1, s[36:39], s51 offen offset:1024 sc1 lds
buffer_load_dwordx4 v1, s[36:39], s51 offen offset:2048 sc1 lds
buffer_load_dwordx4 v1, s[36:39], s51 offen offset:3072 sc1 lds
s_add_u32 m0, s48, 16384
s_nop 0
buffer_load_dwordx4 v13, s[36:39], s51 offen offset:0 sc1 lds
buffer_load_dwordx4 v13, s[36:39], s51 offen offset:1024 sc1 lds
buffer_load_dwordx4 v13, s[36:39], s51 offen offset:2048 sc1 lds
v_readlane_b32 s67, v26, 3
s_add_u32 m0, s48, 19456
v_mov_b32 v254, 0
s_waitcnt vmcnt(7)
buffer_atomic_swap v2, v240, s[36:39], s61 offen sc1
s_nop 0
buffer_load_dwordx4 v1, s[36:39], s67 offen offset:0 sc1 lds
buffer_atomic_or v254, v246, s[36:39], s62 offen sc0 sc1
buffer_load_dwordx4 v1, s[36:39], s67 offen offset:1024 sc1 lds
buffer_load_dwordx4 v1, s[36:39], s67 offen offset:2048 sc1 lds
buffer_load_dwordx4 v1, s[36:39], s67 offen offset:3072 sc1 lds
s_add_u32 m0, s48, 23552
s_nop 0
buffer_load_dwordx4 v13, s[36:39], s67 offen offset:0 sc1 lds
v_mov_b32 v255, 0
buffer_atomic_or v255, v246, s[36:39], s62 offen sc0 sc1
buffer_load_dwordx4 v13, s[36:39], s67 offen offset:1024 sc1 lds
buffer_load_dwordx4 v13, s[36:39], s67 offen offset:2048 sc1 lds
v_readlane_b32 s50, v25, 0
v_readlane_b32 s66, v25, 1
s_lshl_b32 s53, s47, 12
s_add_u32 s53, s53, 1310720
s_lshl_b32 s60, s47, 6
ds_read_b128 v[32:35], v1 offset:33792
ds_read_b128 v[36:39], v14 offset:33792
ds_read_b128 v[40:43], v15 offset:33792
ds_read_b128 v[44:47], v24 offset:33792
ds_read_b128 v[48:51], v1 offset:34816
ds_read_b128 v[52:55], v14 offset:34816
ds_read_b128 v[56:59], v15 offset:34816
ds_read_b128 v[60:63], v24 offset:34816
s_mov_b64 exec, 0
s_bitcmp1_b32 s40, 0
s_cbranch_scc1 TT2_0_0
s_bitcmp1_b32 s40, 1
s_cbranch_scc1 TP48
s_branch TP44
TT2_0_0:
s_bitcmp1_b32 s40, 1
s_cbranch_scc1 TP50
s_branch TP46
TR2:
s_mov_b64 exec, -1
s_waitcnt vmcnt(7)
v_cmp_ne_u32 vcc, v254, v2
s_nop 0
s_and_b64 vcc, vcc, 0xffff
s_nop 2
s_cbranch_vccnz RT_F3
RT_F3_B:
buffer_load_dwordx4 a[0:3], v1, s[36:39], s50 offen offset:0 sc1
buffer_load_dwordx4 a[4:7], v1, s[36:39], s50 offen offset:1024 sc1
buffer_load_dwordx4 a[8:11], v1, s[36:39], s50 offen offset:2048 sc1
buffer_load_dwordx4 a[12:15], v1, s[36:39], s50 offen offset:3072 sc1
buffer_load_dwordx4 a[16:19], v13, s[36:39], s50 offen offset:0 sc1
buffer_load_dwordx4 a[20:23], v13, s[36:39], s50 offen offset:1024 sc1
buffer_load_dwordx4 a[24:27], v13, s[36:39], s50 offen offset:2048 sc1
buffer_load_dwordx4 a[28:31], v13, s[36:39], s50 offen offset:3072 sc1
buffer_load_dwordx4 a[32:35], v1, s[36:39], s66 offen offset:0 sc1
buffer_load_dwordx4 a[36:39], v1, s[36:39], s66 offen offset:1024 sc1
buffer_load_dwordx4 a[40:43], v1, s[36:39], s66 offen offset:2048 sc1
buffer_load_dwordx4 a[44:47], v1, s[36:39], s66 offen offset:3072 sc1
s_waitcnt vmcnt(4) lgkmcnt(4)
v_mfma_f32_16x16x32_bf16 v[64:67], a[0:3], v[32:35], 0
buffer_load_dwordx4 a[48:51], v13, s[36:39], s66 offen offset:0 sc1
v_mfma_f32_16x16x32_bf16 v[64:67], a[8:11], v[36:39], v[64:67]
v_mfma_f32_16x16x32_bf16 v[64:67], a[16:19], v[40:43], v[64:67]
buffer_load_dwordx4 a[52:55], v13, s[36:39], s66 offen offset:1024 sc1
v_mfma_f32_16x16x32_bf16 v[64:67], a[24:27], v[44:47], v[64:67]
v_mfma_f32_16x16x32_bf16 v[68:71], a[4:7], v[32:35], 0
ds_read_b128 v[32:35], v1 offset:35840
v_mfma_f32_16x16x32_bf16 v[68:71], a[12:15], v[36:39], v[68:71]
ds_read_b128 v[36:39], v14 offset:35840
v_mfma_f32_16x16x32_bf16 v[68:71], a[20:23], v[40:43], v[68:71]
ds_read_b128 v[40:43], v15 offset:35840
v_mfma_f32_16x16x32_bf16 v[68:71], a[28:31], v[44:47], v[68:71]
ds_read_b128 v[44:47], v24 offset:35840
s_waitcnt lgkmcnt(4)
v_mfma_f32_16x16x32_bf16 v[72:75], a[0:3], v[48:51], 0
buffer_load_dwordx4 a[56:59], v13, s[36:39], s66 offen offset:2048 sc1
v_mfma_f32_16x16x32_bf16 v[72:75], a[8:11], v[52:55], v[72:75]
v_mfma_f32_16x16x32_bf16 v[72:75], a[16:19], v[56:59], v[72:75]
buffer_load_dwordx4 a[60:63], v13, s[36:39], s66 offen offset:3072 sc1
v_mfma_f32_16x16x32_bf16 v[72:75], a[24:27], v[60:63], v[72:75]
v_mfma_f32_16x16x32_bf16 v[76:79], a[4:7], v[48:51], 0
ds_read_b128 v[48:51], v1 offset:36864
v_mfma_f32_16x16x32_bf16 v[76:79], a[12:15], v[52:55], v[76:79]
ds_read_b128 v[52:55], v14 offset:36864
v_mfma_f32_16x16x32_bf16 v[76:79], a[20:23], v[56:59], v[76:79]
ds_read_b128 v[56:59], v15 offset:36864
v_mfma_f32_16x16x32_bf16 v[76:79], a[28:31], v[60:63], v[76:79]
ds_read_b128 v[60:63], v24 offset:36864
s_waitcnt lgkmcnt(4)
v_mfma_f32_16x16x32_bf16 v[80:83], a[0:3], v[32:35], 0
buffer_load_dwordx4 v[192:195], v1, s[36:39], s53 offen offset:0 sc1
v_mfma_f32_16x16x32_bf16 v[80:83], a[8:11], v[36:39], v[80:83]
v_mfma_f32_16x16x32_bf16 v[80:83], a[16:19], v[40:43], v[80:83]
buffer_load_dwordx4 v[196:199], v1, s[36:39], s53 offen offset:1024 sc1
v_mfma_f32_16x16x32_bf16 v[80:83], a[24:27], v[44:47], v[80:83]
v_mfma_f32_16x16x32_bf16 v[84:87], a[4:7], v[32:35], 0
ds_read_b128 v[32:35], v1 offset:37888
v_mfma_f32_16x16x32_bf16 v[84:87], a[12:15], v[36:39], v[84:87]
ds_read_b128 v[36:39], v14 offset:37888
v_mfma_f32_16x16x32_bf16 v[84:87], a[20:23], v[40:43], v[84:87]
ds_read_b128 v[40:43], v15 offset:37888
v_mfma_f32_16x16x32_bf16 v[84:87], a[28:31], v[44:47], v[84:87]
ds_read_b128 v[44:47], v24 offset:37888
s_waitcnt lgkmcnt(4)
v_mfma_f32_16x16x32_bf16 v[88:91], a[0:3], v[48:51], 0
buffer_load_dwordx4 v[200:203], v1, s[36:39], s53 offen offset:2048 sc1
v_mfma_f32_16x16x32_bf16 v[88:91], a[8:11], v[52:55], v[88:91]
v_mfma_f32_16x16x32_bf16 v[88:91], a[16:19], v[56:59], v[88:91]
buffer_load_dwordx4 v[204:207], v1, s[36:39], s53 offen offset:3072 sc1
v_mfma_f32_16x16x32_bf16 v[88:91], a[24:27], v[60:63], v[88:91]
v_mfma_f32_16x16x32_bf16 v[92:95], a[4:7], v[48:51], 0
ds_read_b128 v[48:51], v1 offset:38912
v_mfma_f32_16x16x32_bf16 v[92:95], a[12:15], v[52:55], v[92:95]
ds_read_b128 v[52:55], v14 offset:38912
v_mfma_f32_16x16x32_bf16 v[92:95], a[20:23], v[56:59], v[92:95]
ds_read_b128 v[56:59], v15 offset:38912
v_mfma_f32_16x16x32_bf16 v[92:95], a[28:31], v[60:63], v[92:95]
ds_read_b128 v[60:63], v24 offset:38912
s_waitcnt lgkmcnt(4)
v_mfma_f32_16x16x32_bf16 v[96:99], a[0:3], v[32:35], 0
buffer_load_ushort v184, v250, s[24:27], s60 offen offset:0
v_mfma_f32_16x16x32_bf16 v[96:99], a[8:11], v[36:39], v[96:99]
v_mfma_f32_16x16x32_bf16 v[96:99], a[16:19], v[40:43], v[96:99]
buffer_load_ushort v188, v250, s[24:27], s60 offen offset:8
v_mfma_f32_16x16x32_bf16 v[96:99], a[24:27], v[44:47], v[96:99]
v_mfma_f32_16x16x32_bf16 v[100:103], a[4:7], v[32:35], 0
ds_read_b128 v[32:35], v1 offset:39936
v_mfma_f32_16x16x32_bf16 v[100:103], a[12:15], v[36:39], v[100:103]
ds_read_b128 v[36:39], v14 offset:39936
v_readlane_b32 s50, v25, 2
v_mfma_f32_16x16x32_bf16 v[100:103], a[20:23], v[40:43], v[100:103]
ds_read_b128 v[40:43], v15 offset:39936
v_mfma_f32_16x16x32_bf16 v[100:103], a[28:31], v[44:47], v[100:103]
ds_read_b128 v[44:47], v24 offset:39936
s_waitcnt lgkmcnt(4)
v_mfma_f32_16x16x32_bf16 v[104:107], a[0:3], v[48:51], 0
buffer_load_dwordx4 a[64:67], v1, s[36:39], s50 offen offset:0 sc1
v_mfma_f32_16x16x32_bf16 v[104:107], a[8:11], v[52:55], v[104:107]
v_mfma_f32_16x16x32_bf16 v[104:107], a[16:19], v[56:59], v[104:107]
v_mfma_f32_16x16x32_bf16 v[104:107], a[24:27], v[60:63], v[104:107]
s_waitcnt lgkmcnt(0)
s_barrier
v_mfma_f32_16x16x32_bf16 v[108:111], a[4:7], v[48:51], 0
ds_read_b128 v[48:51], v1 offset:5120
v_mfma_f32_16x16x32_bf16 v[108:111], a[12:15], v[52:55], v[108:111]
ds_read_b128 v[52:55], v14 offset:5120
v_mfma_f32_16x16x32_bf16 v[108:111], a[20:23], v[56:59], v[108:111]
ds_read_b128 v[56:59], v15 offset:5120
v_mfma_f32_16x16x32_bf16 v[108:111], a[28:31], v[60:63], v[108:111]
ds_read_b128 v[60:63], v24 offset:5120
v_mfma_f32_16x16x32_bf16 v[112:115], a[0:3], v[32:35], 0
buffer_load_dwordx4 a[68:71], v1, s[36:39], s50 offen offset:1024 sc1
v_mfma_f32_16x16x32_bf16 v[112:115], a[8:11], v[36:39], v[112:115]
v_mfma_f32_16x16x32_bf16 v[112:115], a[16:19], v[40:43], v[112:115]
buffer_load_dwordx4 a[72:75], v1, s[36:39], s50 offen offset:2048 sc1
v_mfma_f32_16x16x32_bf16 v[112:115], a[24:27], v[44:47], v[112:115]
v_mfma_f32_16x16x32_bf16 v[116:119], a[4:7], v[32:35], 0
ds_read_b128 v[32:35], v1 offset:6144
v_mfma_f32_16x16x32_bf16 v[116:119], a[12:15], v[36:39], v[116:119]
ds_read_b128 v[36:39], v14 offset:6144
v_mfma_f32_16x16x32_bf16 v[116:119], a[20:23], v[40:43], v[116:119]
ds_read_b128 v[40:43], v15 offset:6144
v_mfma_f32_16x16x32_bf16 v[116:119], a[28:31], v[44:47], v[116:119]
ds_read_b128 v[44:47], v24 offset:6144
s_waitcnt vmcnt(9) lgkmcnt(4)
v_mfma_f32_16x16x32_bf16 v[64:67], a[32:35], v[48:51], v[64:67]
buffer_load_dwordx4 a[76:79], v1, s[36:39], s50 offen offset:3072 sc1
v_mfma_f32_16x16x32_bf16 v[64:67], a[40:43], v[52:55], v[64:67]
v_lshrrev_b32 v3, 5, v0
v_mfma_f32_16x16x32_bf16 v[64:67], a[48:51], v[56:59], v[64:67]
buffer_load_dwordx4 a[80:83], v13, s[36:39], s50 offen offset:0 sc1
v_mfma_f32_16x16x32_bf16 v[64:67], a[56:59], v[60:63], v[64:67]
v_lshl_add_u32 v3, v3, 6, v244
v_mfma_f32_16x16x32_bf16 v[68:71], a[36:39], v[48:51], v[68:71]
ds_read_b128 v[48:51], v1 offset:7168
ds_read_b32 v152, v244 offset:512
v_mfma_f32_16x16x32_bf16 v[68:71], a[44:47], v[52:55], v[68:71]
ds_read_b128 v[52:55], v14 offset:7168
v_mfma_f32_16x16x32_bf16 v[68:71], a[52:55], v[56:59], v[68:71]
ds_read_b128 v[56:59], v15 offset:7168
ds_read_b32 v153, v244 offset:576
v_mfma_f32_16x16x32_bf16 v[68:71], a[60:63], v[60:63], v[68:71]
ds_read_b128 v[60:63], v24 offset:7168
s_waitcnt lgkmcnt(6)
v_mfma_f32_16x16x32_bf16 v[72:75], a[32:35], v[32:35], v[72:75]
buffer_load_dwordx4 a[84:87], v13, s[36:39], s50 offen offset:1024 sc1
v_mfma_f32_16x16x32_bf16 v[72:75], a[40:43], v[36:39], v[72:75]
ds_read_b32 v154, v244 offset:640
v_mfma_f32_16x16x32_bf16 v[72:75], a[48:51], v[40:43], v[72:75]
buffer_load_dwordx4 a[88:91], v13, s[36:39], s50 offen offset:2048 sc1
v_mfma_f32_16x16x32_bf16 v[72:75], a[56:59], v[44:47], v[72:75]
ds_read_b32 v155, v244 offset:704
v_mfma_f32_16x16x32_bf16 v[76:79], a[36:39], v[32:35], v[76:79]
ds_read_b128 v[32:35], v1 offset:8192
v_mfma_f32_16x16x32_bf16 v[76:79], a[44:47], v[36:39], v[76:79]
ds_read_b128 v[36:39], v14 offset:8192
ds_read_b32 v156, v244 offset:768
v_mfma_f32_16x16x32_bf16 v[76:79], a[52:55], v[40:43], v[76:79]
ds_read_b128 v[40:43], v15 offset:8192
v_readlane_b32 s66, v25, 3
v_mfma_f32_16x16x32_bf16 v[76:79], a[60:63], v[44:47], v[76:79]
ds_read_b128 v[44:47], v24 offset:8192
s_waitcnt lgkmcnt(7)
v_mfma_f32_16x16x32_bf16 v[80:83], a[32:35], v[48:51], v[80:83]
buffer_load_dwordx4 a[92:95], v13, s[36:39], s50 offen offset:3072 sc1
v_mfma_f32_16x16x32_bf16 v[80:83], a[40:43], v[52:55], v[80:83]
ds_read_b32 v157, v244 offset:832
ds_read_b32 v158, v244 offset:896
v_mfma_f32_16x16x32_bf16 v[80:83], a[48:51], v[56:59], v[80:83]
buffer_load_dwordx4 a[96:99], v1, s[36:39], s66 offen offset:0 sc1
v_mfma_f32_16x16x32_bf16 v[80:83], a[56:59], v[60:63], v[80:83]
v_mfma_f32_16x16x32_bf16 v[84:87], a[36:39], v[48:51], v[84:87]
ds_read_b128 v[48:51], v1 offset:9216
v_mov_b32 v224, 0
v_mfma_f32_16x16x32_bf16 v[84:87], a[44:47], v[52:55], v[84:87]
ds_read_b128 v[52:55], v14 offset:9216
v_mfma_f32_16x16x32_bf16 v[84:87], a[52:55], v[56:59], v[84:87]
ds_read_b128 v[56:59], v15 offset:9216
v_mov_b32 v225, 0
v_mfma_f32_16x16x32_bf16 v[84:87], a[60:63], v[60:63], v[84:87]
ds_read_b128 v[60:63], v24 offset:9216
s_waitcnt lgkmcnt(6)
v_mfma_f32_16x16x32_bf16 v[88:91], a[32:35], v[32:35], v[88:91]
buffer_load_dwordx4 a[100:103], v1, s[36:39], s66 offen offset:1024 sc1
v_mfma_f32_16x16x32_bf16 v[88:91], a[40:43], v[36:39], v[88:91]
v_mov_b32 v226, 0
v_mfma_f32_16x16x32_bf16 v[88:91], a[48:51], v[40:43], v[88:91]
buffer_load_dwordx4 a[104:107], v1, s[36:39], s66 offen offset:2048 sc1
v_mfma_f32_16x16x32_bf16 v[88:91], a[56:59], v[44:47], v[88:91]
v_mov_b32 v227, 0
v_mfma_f32_16x16x32_bf16 v[92:95], a[36:39], v[32:35], v[92:95]
ds_read_b128 v[32:35], v1 offset:10240
v_mfma_f32_16x16x32_bf16 v[92:95], a[44:47], v[36:39], v[92:95]
ds_read_b128 v[36:39], v14 offset:10240
v_mov_b32 v228, 0
v_mfma_f32_16x16x32_bf16 v[92:95], a[52:55], v[40:43], v[92:95]
ds_read_b128 v[40:43], v15 offset:10240
v_mfma_f32_16x16x32_bf16 v[92:95], a[60:63], v[44:47], v[92:95]
ds_read_b128 v[44:47], v24 offset:10240
s_waitcnt lgkmcnt(4)
v_mfma_f32_16x16x32_bf16 v[96:99], a[32:35], v[48:51], v[96:99]
buffer_load_dwordx4 a[108:111], v1, s[36:39], s66 offen offset:3072 sc1
v_mfma_f32_16x16x32_bf16 v[96:99], a[40:43], v[52:55], v[96:99]
v_mov_b32 v229, 0
v_mov_b32 v230, 0
v_mfma_f32_16x16x32_bf16 v[96:99], a[48:51], v[56:59], v[96:99]
buffer_load_dwordx4 a[112:115], v13, s[36:39], s66 offen offset:0 sc1
v_mfma_f32_16x16x32_bf16 v[96:99], a[56:59], v[60:63], v[96:99]
v_mov_b32 v231, 0
v_mfma_f32_16x16x32_bf16 v[100:103], a[36:39], v[48:51], v[100:103]
ds_read_b128 v[48:51], v1 offset:11264
v_mfma_f32_16x16x32_bf16 v[100:103], a[44:47], v[52:55], v[100:103]
ds_read_b128 v[52:55], v14 offset:11264
v_mfma_f32_16x16x32_bf16 v[100:103], a[52:55], v[56:59], v[100:103]
ds_read_b128 v[56:59], v15 offset:11264
v_mov_b32 v232, 0
v_mfma_f32_16x16x32_bf16 v[100:103], a[60:63], v[60:63], v[100:103]
ds_read_b128 v[60:63], v24 offset:11264
s_waitcnt lgkmcnt(4)
v_mfma_f32_16x16x32_bf16 v[104:107], a[32:35], v[32:35], v[104:107]
buffer_load_dwordx4 a[116:119], v13, s[36:39], s66 offen offset:1024 sc1
v_mfma_f32_16x16x32_bf16 v[104:107], a[40:43], v[36:39], v[104:107]
v_mov_b32 v233, 0
v_mfma_f32_16x16x32_bf16 v[104:107], a[48:51], v[40:43], v[104:107]
v_mov_b32 v234, 0
v_mfma_f32_16x16x32_bf16 v[104:107], a[56:59], v[44:47], v[104:107]
s_waitcnt lgkmcnt(0)
s_barrier
v_mfma_f32_16x16x32_bf16 v[108:111], a[36:39], v[32:35], v[108:111]
ds_read_b128 v[32:35], v1 offset:12288
v_mov_b32 v235, 0
v_mfma_f32_16x16x32_bf16 v[108:111], a[44:47], v[36:39], v[108:111]
ds_read_b128 v[36:39], v14 offset:12288
v_mfma_f32_16x16x32_bf16 v[108:111], a[52:55], v[40:43], v[108:111]
ds_read_b128 v[40:43], v15 offset:12288
v_mfma_f32_16x16x32_bf16 v[108:111], a[60:63], v[44:47], v[108:111]
ds_read_b128 v[44:47], v24 offset:12288
v_mfma_f32_16x16x32_bf16 v[112:115], a[32:35], v[48:51], v[112:115]
buffer_load_dwordx4 a[120:123], v13, s[36:39], s66 offen offset:2048 sc1
v_mfma_f32_16x16x32_bf16 v[112:115], a[40:43], v[52:55], v[112:115]
v_mov_b32 v236, 0
v_mov_b32 v237, 0
v_mfma_f32_16x16x32_bf16 v[112:115], a[48:51], v[56:59], v[112:115]
buffer_load_dwordx4 a[124:127], v13, s[36:39], s66 offen offset:3072 sc1
v_mfma_f32_16x16x32_bf16 v[112:115], a[56:59], v[60:63], v[112:115]
v_mov_b32 v238, 0
v_mfma_f32_16x16x32_bf16 v[116:119], a[36:39], v[48:51], v[116:119]
ds_read_b128 v[48:51], v1 offset:13312
v_readlane_b32 s51, v26, 4
v_mfma_f32_16x16x32_bf16 v[116:119], a[44:47], v[52:55], v[116:119]
ds_read_b128 v[52:55], v14 offset:13312
v_mov_b32 v239, 0
v_mfma_f32_16x16x32_bf16 v[116:119], a[52:55], v[56:59], v[116:119]
ds_read_b128 v[56:59], v15 offset:13312
s_add_u32 m0, s48, 26624
v_mfma_f32_16x16x32_bf16 v[116:119], a[60:63], v[60:63], v[116:119]
ds_read_b128 v[60:63], v24 offset:13312
s_waitcnt vmcnt(8) lgkmcnt(4)
v_mfma_f32_16x16x32_bf16 v[64:67], a[64:67], v[32:35], v[64:67]
buffer_load_dwordx4 v1, s[36:39], s51 offen offset:0 sc1 lds
v_mfma_f32_16x16x32_bf16 v[64:67], a[72:75], v[36:39], v[64:67]
v_mfma_f32_16x16x32_bf16 v[64:67], a[80:83], v[40:43], v[64:67]
buffer_load_dwordx4 v1, s[36:39], s51 offen offset:1024 sc1 lds
v_mfma_f32_16x16x32_bf16 v[64:67], a[88:91], v[44:47], v[64:67]
v_add_f32 v192, v192, v196
v_mfma_f32_16x16x32_bf16 v[68:71], a[68:71], v[32:35], v[68:71]
ds_read_b128 v[32:35], v1 offset:14336
v_mfma_f32_16x16x32_bf16 v[68:71], a[76:79], v[36:39], v[68:71]
ds_read_b128 v[36:39], v14 offset:14336
v_add_f32 v193, v193, v197
v_mfma_f32_16x16x32_bf16 v[68:71], a[84:87], v[40:43], v[68:71]
ds_read_b128 v[40:43], v15 offset:14336
v_mfma_f32_16x16x32_bf16 v[68:71], a[92:95], v[44:47], v[68:71]
ds_read_b128 v[44:47], v24 offset:14336
s_waitcnt lgkmcnt(4)
v_mfma_f32_16x16x32_bf16 v[72:75], a[64:67], v[48:51], v[72:75]
buffer_load_dwordx4 v1, s[36:39], s51 offen offset:2048 sc1 lds
v_mfma_f32_16x16x32_bf16 v[72:75], a[72:75], v[52:55], v[72:75]
v_add_f32 v194, v194, v198
v_mfma_f32_16x16x32_bf16 v[72:75], a[80:83], v[56:59], v[72:75]
buffer_load_dwordx4 v1, s[36:39], s51 offen offset:3072 sc1 lds
v_mfma_f32_16x16x32_bf16 v[72:75], a[88:91], v[60:63], v[72:75]
v_add_f32 v195, v195, v199
v_mfma_f32_16x16x32_bf16 v[76:79], a[68:71], v[48:51], v[76:79]
ds_read_b128 v[48:51], v1 offset:15360
v_add_f32 v200, v200, v204
v_mfma_f32_16x16x32_bf16 v[76:79], a[76:79], v[52:55], v[76:79]
ds_read_b128 v[52:55], v14 offset:15360
v_mfma_f32_16x16x32_bf16 v[76:79], a[84:87], v[56:59], v[76:79]
ds_read_b128 v[56:59], v15 offset:15360
s_add_u32 m0, s48, 30720
v_mfma_f32_16x16x32_bf16 v[76:79], a[92:95], v[60:63], v[76:79]
ds_read_b128 v[60:63], v24 offset:15360
s_waitcnt lgkmcnt(4)
v_mfma_f32_16x16x32_bf16 v[80:83], a[64:67], v[32:35], v[80:83]
buffer_load_dwordx4 v13, s[36:39], s51 offen offset:0 sc1 lds
v_mfma_f32_16x16x32_bf16 v[80:83], a[72:75], v[36:39], v[80:83]
v_add_f32 v201, v201, v205
v_add_f32 v202, v202, v206
v_mfma_f32_16x16x32_bf16 v[80:83], a[80:83], v[40:43], v[80:83]
buffer_load_dwordx4 v13, s[36:39], s51 offen offset:1024 sc1 lds
v_mfma_f32_16x16x32_bf16 v[80:83], a[88:91], v[44:47], v[80:83]
v_mfma_f32_16x16x32_bf16 v[84:87], a[68:71], v[32:35], v[84:87]
ds_read_b128 v[32:35], v1 offset:16384
v_add_f32 v203, v203, v207
v_mfma_f32_16x16x32_bf16 v[84:87], a[76:79], v[36:39], v[84:87]
ds_read_b128 v[36:39], v14 offset:16384
v_readlane_b32 s50, v25, 4
v_mfma_f32_16x16x32_bf16 v[84:87], a[84:87], v[40:43], v[84:87]
ds_read_b128 v[40:43], v15 offset:16384
v_add_f32 v192, v192, v200
v_mfma_f32_16x16x32_bf16 v[84:87], a[92:95], v[44:47], v[84:87]
ds_read_b128 v[44:47], v24 offset:16384
s_waitcnt lgkmcnt(4)
v_mfma_f32_16x16x32_bf16 v[88:91], a[64:67], v[48:51], v[88:91]
buffer_load_dwordx4 v13, s[36:39], s51 offen offset:2048 sc1 lds
v_mfma_f32_16x16x32_bf16 v[88:91], a[72:75], v[52:55], v[88:91]
v_add_f32 v193, v193, v201
v_mfma_f32_16x16x32_bf16 v[88:91], a[80:83], v[56:59], v[88:91]
buffer_load_dwordx4 a[128:131], v1, s[36:39], s50 offen offset:0 sc1
v_mfma_f32_16x16x32_bf16 v[88:91], a[88:91], v[60:63], v[88:91]
v_mfma_f32_16x16x32_bf16 v[92:95], a[68:71], v[48:51], v[92:95]
ds_read_b128 v[48:51], v1 offset:17408
v_add_f32 v194, v194, v202
v_mfma_f32_16x16x32_bf16 v[92:95], a[76:79], v[52:55], v[92:95]
ds_read_b128 v[52:55], v14 offset:17408
v_mfma_f32_16x16x32_bf16 v[92:95], a[84:87], v[56:59], v[92:95]
ds_read_b128 v[56:59], v15 offset:17408
v_add_f32 v195, v195, v203
v_mfma_f32_16x16x32_bf16 v[92:95], a[92:95], v[60:63], v[92:95]
ds_read_b128 v[60:63], v24 offset:17408
s_waitcnt lgkmcnt(4)
v_mfma_f32_16x16x32_bf16 v[96:99], a[64:67], v[32:35], v[96:99]
buffer_load_dwordx4 a[132:135], v1, s[36:39], s50 offen offset:1024 sc1
v_mfma_f32_16x16x32_bf16 v[96:99], a[72:75], v[36:39], v[96:99]
v_permlane32_swap_b32 v192, v194
v_mfma_f32_16x16x32_bf16 v[96:99], a[80:83], v[40:43], v[96:99]
buffer_load_dwordx4 a[136:139], v1, s[36:39], s50 offen offset:2048 sc1
v_mfma_f32_16x16x32_bf16 v[96:99], a[88:91], v[44:47], v[96:99]
v_permlane32_swap_b32 v193, v195
v_mfma_f32_16x16x32_bf16 v[100:103], a[68:71], v[32:35], v[100:103]
ds_read_b128 v[32:35], v1 offset:18432
v_mfma_f32_16x16x32_bf16 v[100:103], a[76:79], v[36:39], v[100:103]
ds_read_b128 v[36:39], v14 offset:18432
v_mfma_f32_16x16x32_bf16 v[100:103], a[84:87], v[40:43], v[100:103]
ds_read_b128 v[40:43], v15 offset:18432
v_add_f32 v192, v192, v194
v_mfma_f32_16x16x32_bf16 v[100:103], a[92:95], v[44:47], v[100:103]
ds_read_b128 v[44:47], v24 offset:18432
s_waitcnt lgkmcnt(4)
v_mfma_f32_16x16x32_bf16 v[104:107], a[64:67], v[48:51], v[104:107]
buffer_load_dwordx4 a[140:143], v1, s[36:39], s50 offen offset:3072 sc1
v_mfma_f32_16x16x32_bf16 v[104:107], a[72:75], v[52:55], v[104:107]
v_add_f32 v193, v193, v195
v_mfma_f32_16x16x32_bf16 v[104:107], a[80:83], v[56:59], v[104:107]
v_mfma_f32_16x16x32_bf16 v[104:107], a[88:91], v[60:63], v[104:107]
s_waitcnt lgkmcnt(0)
s_barrier
v_mfma_f32_16x16x32_bf16 v[108:111], a[68:71], v[48:51], v[108:111]
ds_read_b128 v[48:51], v1 offset:19456
v_mov_b32 v194, v192
v_mfma_f32_16x16x32_bf16 v[108:111], a[76:79], v[52:55], v[108:111]
ds_read_b128 v[52:55], v14 offset:19456
v_mov_b32 v195, v193
v_mfma_f32_16x16x32_bf16 v[108:111], a[84:87], v[56:59], v[108:111]
ds_read_b128 v[56:59], v15 offset:19456
v_mfma_f32_16x16x32_bf16 v[108:111], a[92:95], v[60:63], v[108:111]
ds_read_b128 v[60:63], v24 offset:19456
v_mfma_f32_16x16x32_bf16 v[112:115], a[64:67], v[32:35], v[112:115]
buffer_load_dwordx4 a[144:147], v13, s[36:39], s50 offen offset:0 sc1
v_mfma_f32_16x16x32_bf16 v[112:115], a[72:75], v[36:39], v[112:115]
v_permlane16_swap_b32 v194, v192
v_mfma_f32_16x16x32_bf16 v[112:115], a[80:83], v[40:43], v[112:115]
buffer_load_dwordx4 a[148:151], v13, s[36:39], s50 offen offset:1024 sc1
v_mfma_f32_16x16x32_bf16 v[112:115], a[88:91], v[44:47], v[112:115]
v_permlane16_swap_b32 v195, v193
v_mfma_f32_16x16x32_bf16 v[116:119], a[68:71], v[32:35], v[116:119]
ds_read_b128 v[32:35], v1 offset:20480
v_mfma_f32_16x16x32_bf16 v[116:119], a[76:79], v[36:39], v[116:119]
ds_read_b128 v[36:39], v14 offset:20480
v_add_f32 v192, v194, v192
v_mfma_f32_16x16x32_bf16 v[116:119], a[84:87], v[40:43], v[116:119]
ds_read_b128 v[40:43], v15 offset:20480
v_mfma_f32_16x16x32_bf16 v[116:119], a[92:95], v[44:47], v[116:119]
ds_read_b128 v[44:47], v24 offset:20480
s_waitcnt vmcnt(13) lgkmcnt(4)
v_mfma_f32_16x16x32_bf16 v[64:67], a[96:99], v[48:51], v[64:67]
buffer_load_dwordx4 a[152:155], v13, s[36:39], s50 offen offset:2048 sc1
v_mfma_f32_16x16x32_bf16 v[64:67], a[104:107], v[52:55], v[64:67]
v_lshlrev_b32 v184, 16, v184
v_add_f32 v193, v195, v193
v_mfma_f32_16x16x32_bf16 v[64:67], a[112:115], v[56:59], v[64:67]
buffer_load_dwordx4 a[156:159], v13, s[36:39], s50 offen offset:3072 sc1
v_mfma_f32_16x16x32_bf16 v[64:67], a[120:123], v[60:63], v[64:67]
v_mul_f32 v192, 0xba800000, v192
v_mfma_f32_16x16x32_bf16 v[68:71], a[100:103], v[48:51], v[68:71]
ds_read_b128 v[48:51], v1 offset:21504
v_readlane_b32 s67, v26, 5
v_mfma_f32_16x16x32_bf16 v[68:71], a[108:111], v[52:55], v[68:71]
ds_read_b128 v[52:55], v14 offset:21504
v_mul_f32 v193, 0x3a800000, v193
v_mfma_f32_16x16x32_bf16 v[68:71], a[116:119], v[56:59], v[68:71]
ds_read_b128 v[56:59], v15 offset:21504
s_add_u32 m0, s48, 33792
v_mfma_f32_16x16x32_bf16 v[68:71], a[124:127], v[60:63], v[68:71]
ds_read_b128 v[60:63], v24 offset:21504
s_waitcnt lgkmcnt(4)
v_mfma_f32_16x16x32_bf16 v[72:75], a[96:99], v[32:35], v[72:75]
buffer_load_dwordx4 v1, s[36:39], s67 offen offset:0 sc1 lds
v_mfma_f32_16x16x32_bf16 v[72:75], a[104:107], v[36:39], v[72:75]
v_lshlrev_b32 v188, 16, v188
v_fma_f32 v193, -v192, v192, v193
v_mfma_f32_16x16x32_bf16 v[72:75], a[112:115], v[40:43], v[72:75]
buffer_load_dwordx4 v1, s[36:39], s67 offen offset:1024 sc1 lds
v_mfma_f32_16x16x32_bf16 v[72:75], a[120:123], v[44:47], v[72:75]
v_max_f32 v193, 0, v193
v_mfma_f32_16x16x32_bf16 v[76:79], a[100:103], v[32:35], v[76:79]
ds_read_b128 v[32:35], v1 offset:22528
v_add_f32 v193, 0x3727c5ac, v193
v_mfma_f32_16x16x32_bf16 v[76:79], a[108:111], v[36:39], v[76:79]
ds_read_b128 v[36:39], v14 offset:22528
v_mfma_f32_16x16x32_bf16 v[76:79], a[116:119], v[40:43], v[76:79]
ds_read_b128 v[40:43], v15 offset:22528
v_mov_b32 v185, v184
v_mfma_f32_16x16x32_bf16 v[76:79], a[124:127], v[44:47], v[76:79]
ds_read_b128 v[44:47], v24 offset:22528
s_waitcnt lgkmcnt(4)
v_mfma_f32_16x16x32_bf16 v[80:83], a[96:99], v[48:51], v[80:83]
buffer_load_dwordx4 v1, s[36:39], s67 offen offset:2048 sc1 lds
v_mfma_f32_16x16x32_bf16 v[80:83], a[104:107], v[52:55], v[80:83]
v_rsq_f32 v194, v193
v_mfma_f32_16x16x32_bf16 v[80:83], a[112:115], v[56:59], v[80:83]
buffer_load_dwordx4 v1, s[36:39], s67 offen offset:3072 sc1 lds
v_mfma_f32_16x16x32_bf16 v[80:83], a[120:123], v[60:63], v[80:83]
s_add_u32 m0, s48, 37888
v_mfma_f32_16x16x32_bf16 v[84:87], a[100:103], v[48:51], v[84:87]
ds_read_b128 v[48:51], v1 offset:23552
v_mul_f32 v193, v193, v194
v_mfma_f32_16x16x32_bf16 v[84:87], a[108:111], v[52:55], v[84:87]
ds_read_b128 v[52:55], v14 offset:23552
v_mov_b32 v189, v188
v_mfma_f32_16x16x32_bf16 v[84:87], a[116:119], v[56:59], v[84:87]
ds_read_b128 v[56:59], v15 offset:23552
v_mul_f32 v195, v194, v194
v_mfma_f32_16x16x32_bf16 v[84:87], a[124:127], v[60:63], v[84:87]
ds_read_b128 v[60:63], v24 offset:23552
s_waitcnt lgkmcnt(4)
v_mfma_f32_16x16x32_bf16 v[88:91], a[96:99], v[32:35], v[88:91]
buffer_load_dwordx4 v13, s[36:39], s67 offen offset:0 sc1 lds
v_mfma_f32_16x16x32_bf16 v[88:91], a[104:107], v[36:39], v[88:91]
v_mul_f32 v195, v195, v194
v_mfma_f32_16x16x32_bf16 v[88:91], a[112:115], v[40:43], v[88:91]
TP43:
s_cbranch_execz TP2
TP44:
s_cbranch_execz TP52
buffer_load_dwordx4 v13, s[36:39], s67 offen offset:1024 sc1 lds
v_mfma_f32_16x16x32_bf16 v[88:91], a[120:123], v[44:47], v[88:91]
v_readlane_b32 s66, v25, 5
v_mfma_f32_16x16x32_bf16 v[92:95], a[100:103], v[32:35], v[92:95]
ds_read_b128 v[32:35], v1 offset:24576
v_mov_b32 v186, v184
v_mfma_f32_16x16x32_bf16 v[92:95], a[108:111], v[36:39], v[92:95]
ds_read_b128 v[36:39], v14 offset:24576
v_mul_f32 v194, 0xc0135761, v194
v_mfma_f32_16x16x32_bf16 v[92:95], a[116:119], v[40:43], v[92:95]
ds_read_b128 v[40:43], v15 offset:24576
v_mul_f32 v195, 0xbdd2d3e8, v195
v_mfma_f32_16x16x32_bf16 v[92:95], a[124:127], v[44:47], v[92:95]
ds_read_b128 v[44:47], v24 offset:24576
s_waitcnt lgkmcnt(4)
v_mfma_f32_16x16x32_bf16 v[96:99], a[96:99], v[48:51], v[96:99]
buffer_load_dwordx4 v13, s[36:39], s67 offen offset:2048 sc1 lds
v_mfma_f32_16x16x32_bf16 v[96:99], a[104:107], v[52:55], v[96:99]
ds_write_b32 v3, v192 offset:1024
v_mfma_f32_16x16x32_bf16 v[96:99], a[112:115], v[56:59], v[96:99]
buffer_load_dwordx4 a[160:163], v1, s[36:39], s66 offen offset:0 sc1
v_mfma_f32_16x16x32_bf16 v[96:99], a[120:123], v[60:63], v[96:99]
v_mov_b32 v190, v188
v_mfma_f32_16x16x32_bf16 v[100:103], a[100:103], v[48:51], v[100:103]
ds_read_b128 v[48:51], v1 offset:25600
ds_write_b32 v3, v193 offset:1152
v_mfma_f32_16x16x32_bf16 v[100:103], a[108:111], v[52:55], v[100:103]
ds_read_b128 v[52:55], v14 offset:25600
v_mfma_f32_16x16x32_bf16 v[100:103], a[116:119], v[56:59], v[100:103]
ds_read_b128 v[56:59], v15 offset:25600
ds_write_b32 v3, v194 offset:1280
v_mfma_f32_16x16x32_bf16 v[100:103], a[124:127], v[60:63], v[100:103]
ds_read_b128 v[60:63], v24 offset:25600
s_waitcnt lgkmcnt(7)
v_mfma_f32_16x16x32_bf16 v[104:107], a[96:99], v[32:35], v[104:107]
buffer_load_dwordx4 a[164:167], v1, s[36:39], s66 offen offset:1024 sc1
v_mfma_f32_16x16x32_bf16 v[104:107], a[104:107], v[36:39], v[104:107]
ds_write_b32 v3, v195 offset:1408
v_mfma_f32_16x16x32_bf16 v[104:107], a[112:115], v[40:43], v[104:107]
v_mov_b32 v187, v184
v_mfma_f32_16x16x32_bf16 v[104:107], a[120:123], v[44:47], v[104:107]
s_waitcnt vmcnt(17) lgkmcnt(0)
s_barrier
v_mfma_f32_16x16x32_bf16 v[108:111], a[100:103], v[32:35], v[108:111]
ds_read_b128 v[32:35], v1 offset:26624
ds_read_b128 v[120:123], v245 offset:1024
v_mfma_f32_16x16x32_bf16 v[108:111], a[108:111], v[36:39], v[108:111]
ds_read_b128 v[36:39], v14 offset:26624
ds_read_b128 v[124:127], v245 offset:1088
v_mfma_f32_16x16x32_bf16 v[108:111], a[116:119], v[40:43], v[108:111]
ds_read_b128 v[40:43], v15 offset:26624
v_mfma_f32_16x16x32_bf16 v[108:111], a[124:127], v[44:47], v[108:111]
ds_read_b128 v[44:47], v24 offset:26624
v_mfma_f32_16x16x32_bf16 v[112:115], a[96:99], v[48:51], v[112:115]
buffer_load_dwordx4 a[168:171], v1, s[36:39], s66 offen offset:2048 sc1
v_mfma_f32_16x16x32_bf16 v[112:115], a[104:107], v[52:55], v[112:115]
v_mov_b32 v191, v188
v_mfma_f32_16x16x32_bf16 v[112:115], a[112:115], v[56:59], v[112:115]
buffer_load_dwordx4 a[172:175], v1, s[36:39], s66 offen offset:3072 sc1
v_mfma_f32_16x16x32_bf16 v[112:115], a[120:123], v[60:63], v[112:115]
ds_read_b128 v[128:131], v245 offset:1152
ds_read_b128 v[132:135], v245 offset:1216
v_mfma_f32_16x16x32_bf16 v[116:119], a[100:103], v[48:51], v[116:119]
ds_read_b128 v[48:51], v1 offset:27648
v_mfma_f32_16x16x32_bf16 v[116:119], a[108:111], v[52:55], v[116:119]
ds_read_b128 v[52:55], v14 offset:27648
ds_read_b128 v[136:139], v245 offset:1280
v_mfma_f32_16x16x32_bf16 v[116:119], a[116:119], v[56:59], v[116:119]
ds_read_b128 v[56:59], v15 offset:27648
v_mfma_f32_16x16x32_bf16 v[116:119], a[124:127], v[60:63], v[116:119]
ds_read_b128 v[60:63], v24 offset:27648
s_waitcnt vmcnt(11) lgkmcnt(7)
v_mfma_f32_16x16x32_bf16 v[64:67], a[128:131], v[32:35], v[64:67]
buffer_load_dwordx4 a[176:179], v13, s[36:39], s66 offen offset:0 sc1
v_mfma_f32_16x16x32_bf16 v[64:67], a[136:139], v[36:39], v[64:67]
ds_read_b128 v[140:143], v245 offset:1344
v_mfma_f32_16x16x32_bf16 v[64:67], a[144:147], v[40:43], v[64:67]
buffer_load_dwordx4 a[180:183], v13, s[36:39], s66 offen offset:1024 sc1
v_mfma_f32_16x16x32_bf16 v[64:67], a[152:155], v[44:47], v[64:67]
ds_read_b128 v[144:147], v245 offset:1408
v_mfma_f32_16x16x32_bf16 v[68:71], a[132:135], v[32:35], v[68:71]
ds_read_b128 v[32:35], v1 offset:28672
v_mfma_f32_16x16x32_bf16 v[68:71], a[140:143], v[36:39], v[68:71]
ds_read_b128 v[36:39], v14 offset:28672
ds_read_b128 v[148:151], v245 offset:1472
v_mfma_f32_16x16x32_bf16 v[68:71], a[148:151], v[40:43], v[68:71]
ds_read_b128 v[40:43], v15 offset:28672
v_mfma_f32_16x16x32_bf16 v[68:71], a[156:159], v[44:47], v[68:71]
ds_read_b128 v[44:47], v24 offset:28672
s_waitcnt lgkmcnt(7)
v_mfma_f32_16x16x32_bf16 v[72:75], a[128:131], v[48:51], v[72:75]
buffer_load_dwordx4 a[184:187], v13, s[36:39], s66 offen offset:2048 sc1
v_mfma_f32_16x16x32_bf16 v[72:75], a[136:139], v[52:55], v[72:75]
ds_read_b32 v16, v244 offset:1024
v_mfma_f32_16x16x32_bf16 v[72:75], a[144:147], v[56:59], v[72:75]
buffer_load_dwordx4 a[188:191], v13, s[36:39], s66 offen offset:3072 sc1
v_mfma_f32_16x16x32_bf16 v[72:75], a[152:155], v[60:63], v[72:75]
ds_read_b32 v17, v244 offset:1088
v_mfma_f32_16x16x32_bf16 v[76:79], a[132:135], v[48:51], v[76:79]
ds_read_b128 v[48:51], v1 offset:29696
ds_read_b32 v18, v244 offset:1152
v_mfma_f32_16x16x32_bf16 v[76:79], a[140:143], v[52:55], v[76:79]
ds_read_b128 v[52:55], v14 offset:29696
v_readlane_b32 s51, v26, 6
v_mfma_f32_16x16x32_bf16 v[76:79], a[148:151], v[56:59], v[76:79]
ds_read_b128 v[56:59], v15 offset:29696
s_add_u32 m0, s48, 5120
v_mfma_f32_16x16x32_bf16 v[76:79], a[156:159], v[60:63], v[76:79]
ds_read_b128 v[60:63], v24 offset:29696
s_waitcnt lgkmcnt(7)
v_mfma_f32_16x16x32_bf16 v[80:83], a[128:131], v[32:35], v[80:83]
buffer_load_dwordx4 v1, s[36:39], s51 offen offset:0 sc1 lds
v_mfma_f32_16x16x32_bf16 v[80:83], a[136:139], v[36:39], v[80:83]
ds_read_b32 v19, v244 offset:1216
ds_read_b32 v20, v244 offset:1280
v_mfma_f32_16x16x32_bf16 v[80:83], a[144:147], v[40:43], v[80:83]
buffer_load_dwordx4 v1, s[36:39], s51 offen offset:1024 sc1 lds
v_mfma_f32_16x16x32_bf16 v[80:83], a[152:155], v[44:47], v[80:83]
v_mfma_f32_16x16x32_bf16 v[84:87], a[132:135], v[32:35], v[84:87]
ds_read_b128 v[32:35], v1 offset:30720
ds_read_b32 v21, v244 offset:1344
v_mfma_f32_16x16x32_bf16 v[84:87], a[140:143], v[36:39], v[84:87]
ds_read_b128 v[36:39], v14 offset:30720
v_mfma_f32_16x16x32_bf16 v[84:87], a[148:151], v[40:43], v[84:87]
ds_read_b128 v[40:43], v15 offset:30720
ds_read_b32 v22, v244 offset:1408
v_mfma_f32_16x16x32_bf16 v[84:87], a[156:159], v[44:47], v[84:87]
ds_read_b128 v[44:47], v24 offset:30720
s_waitcnt lgkmcnt(8)
v_mfma_f32_16x16x32_bf16 v[88:91], a[128:131], v[48:51], v[88:91]
buffer_load_dwordx4 v1, s[36:39], s51 offen offset:2048 sc1 lds
v_mfma_f32_16x16x32_bf16 v[88:91], a[136:139], v[52:55], v[88:91]
ds_read_b32 v23, v244 offset:1472
v_mfma_f32_16x16x32_bf16 v[88:91], a[144:147], v[56:59], v[88:91]
buffer_load_dwordx4 v1, s[36:39], s51 offen offset:3072 sc1 lds
v_mfma_f32_16x16x32_bf16 v[88:91], a[152:155], v[60:63], v[88:91]
v_mfma_f32_16x16x32_bf16 v[92:95], a[132:135], v[48:51], v[92:95]
ds_read_b128 v[48:51], v1 offset:31744
s_lshl_b32 s60, s47, 13
v_mfma_f32_16x16x32_bf16 v[92:95], a[140:143], v[52:55], v[92:95]
ds_read_b128 v[52:55], v14 offset:31744
s_add_u32 m0, s48, 9216
v_mfma_f32_16x16x32_bf16 v[92:95], a[148:151], v[56:59], v[92:95]
ds_read_b128 v[56:59], v15 offset:31744
s_add_u32 s60, s60, 1572864
v_mfma_f32_16x16x32_bf16 v[92:95], a[156:159], v[60:63], v[92:95]
ds_read_b128 v[60:63], v24 offset:31744
s_waitcnt lgkmcnt(5)
v_mfma_f32_16x16x32_bf16 v[96:99], a[128:131], v[32:35], v[96:99]
buffer_load_dwordx4 v13, s[36:39], s51 offen offset:0 sc1 lds
v_mfma_f32_16x16x32_bf16 v[96:99], a[136:139], v[36:39], v[96:99]
s_lshl_b32 s3, s45, 9
v_mfma_f32_16x16x32_bf16 v[96:99], a[144:147], v[40:43], v[96:99]
buffer_load_dwordx4 v13, s[36:39], s51 offen offset:1024 sc1 lds
v_mfma_f32_16x16x32_bf16 v[96:99], a[152:155], v[44:47], v[96:99]
s_add_u32 s53, s60, s3
v_mfma_f32_16x16x32_bf16 v[100:103], a[132:135], v[32:35], v[100:103]
ds_read_b128 v[32:35], v1 offset:32768
v_mfma_f32_16x16x32_bf16 v[100:103], a[140:143], v[36:39], v[100:103]
ds_read_b128 v[36:39], v14 offset:32768
v_mfma_f32_16x16x32_bf16 v[100:103], a[148:151], v[40:43], v[100:103]
ds_read_b128 v[40:43], v15 offset:32768
s_lshl_b32 s61, s40, 11
v_mfma_f32_16x16x32_bf16 v[100:103], a[156:159], v[44:47], v[100:103]
ds_read_b128 v[44:47], v24 offset:32768
s_waitcnt lgkmcnt(4)
v_mfma_f32_16x16x32_bf16 v[104:107], a[128:131], v[48:51], v[104:107]
buffer_load_dwordx4 v13, s[36:39], s51 offen offset:2048 sc1 lds
v_mfma_f32_16x16x32_bf16 v[104:107], a[136:139], v[52:55], v[104:107]
s_lshl_b32 s3, s45, 7
v_mfma_f32_16x16x32_bf16 v[104:107], a[144:147], v[56:59], v[104:107]
v_readlane_b32 s50, v25, 6
v_mfma_f32_16x16x32_bf16 v[104:107], a[152:155], v[60:63], v[104:107]
s_waitcnt vmcnt(15) lgkmcnt(0)
s_barrier
v_mfma_f32_16x16x32_bf16 v[108:111], a[132:135], v[48:51], v[108:111]
ds_read_b128 v[48:51], v1 offset:33792
s_add_u32 s61, s61, s3
v_mfma_f32_16x16x32_bf16 v[108:111], a[140:143], v[52:55], v[108:111]
ds_read_b128 v[52:55], v14 offset:33792
s_lshl2_add_u32 s61, s44, s61
v_mfma_f32_16x16x32_bf16 v[108:111], a[148:151], v[56:59], v[108:111]
ds_read_b128 v[56:59], v15 offset:33792
v_mfma_f32_16x16x32_bf16 v[108:111], a[156:159], v[60:63], v[108:111]
ds_read_b128 v[60:63], v24 offset:33792
v_mfma_f32_16x16x32_bf16 v[112:115], a[128:131], v[32:35], v[112:115]
buffer_load_dwordx4 a[192:195], v1, s[36:39], s50 offen offset:0 sc1
v_mfma_f32_16x16x32_bf16 v[112:115], a[136:139], v[36:39], v[112:115]
s_add_u32 s61, s61, 524288
v_mfma_f32_16x16x32_bf16 v[112:115], a[144:147], v[40:43], v[112:115]
buffer_load_dwordx4 a[196:199], v1, s[36:39], s50 offen offset:1024 sc1
v_mfma_f32_16x16x32_bf16 v[112:115], a[152:155], v[44:47], v[112:115]
s_add_u32 s62, s63, 524288
v_mfma_f32_16x16x32_bf16 v[116:119], a[132:135], v[32:35], v[116:119]
ds_read_b128 v[32:35], v1 offset:34816
v_mfma_f32_16x16x32_bf16 v[116:119], a[140:143], v[36:39], v[116:119]
ds_read_b128 v[36:39], v14 offset:34816
v_readlane_b32 s65, v27, 0
v_mfma_f32_16x16x32_bf16 v[116:119], a[148:151], v[40:43], v[116:119]
ds_read_b128 v[40:43], v15 offset:34816
v_mfma_f32_16x16x32_bf16 v[116:119], a[156:159], v[44:47], v[116:119]
ds_read_b128 v[44:47], v24 offset:34816
s_waitcnt vmcnt(9) lgkmcnt(4)
v_mfma_f32_16x16x32_bf16 v[64:67], a[160:163], v[48:51], v[64:67]
buffer_load_dwordx4 a[200:203], v1, s[36:39], s50 offen offset:2048 sc1
v_mfma_f32_16x16x32_bf16 v[64:67], a[168:171], v[52:55], v[64:67]
v_fmac_f32 v96, v120, v156
v_fmac_f32 v97, v121, v156
v_mfma_f32_16x16x32_bf16 v[64:67], a[176:179], v[56:59], v[64:67]
buffer_load_dwordx4 a[204:207], v1, s[36:39], s50 offen offset:3072 sc1
v_mfma_f32_16x16x32_bf16 v[64:67], a[184:187], v[60:63], v[64:67]
v_fmac_f32 v98, v122, v156
v_mfma_f32_16x16x32_bf16 v[68:71], a[164:167], v[48:51], v[68:71]
ds_read_b128 v[48:51], v1 offset:35840
v_mfma_f32_16x16x32_bf16 v[68:71], a[172:175], v[52:55], v[68:71]
ds_read_b128 v[52:55], v14 offset:35840
v_fmac_f32 v99, v123, v156
v_mfma_f32_16x16x32_bf16 v[68:71], a[180:183], v[56:59], v[68:71]
ds_read_b128 v[56:59], v15 offset:35840
v_mfma_f32_16x16x32_bf16 v[68:71], a[188:191], v[60:63], v[68:71]
ds_read_b128 v[60:63], v24 offset:35840
s_waitcnt lgkmcnt(4)
v_mfma_f32_16x16x32_bf16 v[72:75], a[160:163], v[32:35], v[72:75]
buffer_load_dwordx4 a[208:211], v13, s[36:39], s50 offen offset:0 sc1
v_mfma_f32_16x16x32_bf16 v[72:75], a[168:171], v[36:39], v[72:75]
v_fmac_f32 v104, v120, v157
v_fmac_f32 v105, v121, v157
v_mfma_f32_16x16x32_bf16 v[72:75], a[176:179], v[40:43], v[72:75]
buffer_load_dwordx4 a[212:215], v13, s[36:39], s50 offen offset:1024 sc1
v_mfma_f32_16x16x32_bf16 v[72:75], a[184:187], v[44:47], v[72:75]
v_fmac_f32 v106, v122, v157
v_mfma_f32_16x16x32_bf16 v[76:79], a[164:167], v[32:35], v[76:79]
ds_read_b128 v[32:35], v1 offset:36864
v_mfma_f32_16x16x32_bf16 v[76:79], a[172:175], v[36:39], v[76:79]
ds_read_b128 v[36:39], v14 offset:36864
v_fmac_f32 v107, v123, v157
v_mfma_f32_16x16x32_bf16 v[76:79], a[180:183], v[40:43], v[76:79]
ds_read_b128 v[40:43], v15 offset:36864
v_mfma_f32_16x16x32_bf16 v[76:79], a[188:191], v[44:47], v[76:79]
ds_read_b128 v[44:47], v24 offset:36864
s_waitcnt lgkmcnt(4)
v_mfma_f32_16x16x32_bf16 v[80:83], a[160:163], v[48:51], v[80:83]
buffer_load_dwordx4 a[216:219], v13, s[36:39], s50 offen offset:2048 sc1
v_mfma_f32_16x16x32_bf16 v[80:83], a[168:171], v[52:55], v[80:83]
v_fmac_f32 v112, v120, v158
v_fmac_f32 v113, v121, v158
v_mfma_f32_16x16x32_bf16 v[80:83], a[176:179], v[56:59], v[80:83]
buffer_load_dwordx4 a[220:223], v13, s[36:39], s50 offen offset:3072 sc1
v_mfma_f32_16x16x32_bf16 v[80:83], a[184:187], v[60:63], v[80:83]
v_fmac_f32 v114, v122, v158
v_mfma_f32_16x16x32_bf16 v[84:87], a[164:167], v[48:51], v[84:87]
ds_read_b128 v[48:51], v1 offset:37888
v_readlane_b32 s67, v26, 7
v_mfma_f32_16x16x32_bf16 v[84:87], a[172:175], v[52:55], v[84:87]
ds_read_b128 v[52:55], v14 offset:37888
v_fmac_f32 v115, v123, v158
v_mfma_f32_16x16x32_bf16 v[84:87], a[180:183], v[56:59], v[84:87]
ds_read_b128 v[56:59], v15 offset:37888
s_add_u32 m0, s48, 12288
v_mfma_f32_16x16x32_bf16 v[84:87], a[188:191], v[60:63], v[84:87]
ds_read_b128 v[60:63], v24 offset:37888
s_waitcnt lgkmcnt(4)
v_mfma_f32_16x16x32_bf16 v[88:91], a[160:163], v[32:35], v[88:91]
buffer_load_dwordx4 v1, s[36:39], s67 offen offset:0 sc1 lds
v_mfma_f32_16x16x32_bf16 v[88:91], a[168:171], v[36:39], v[88:91]
v_fmac_f32 v64, v120, v152
v_fmac_f32 v65, v121, v152
v_mfma_f32_16x16x32_bf16 v[88:91], a[176:179], v[40:43], v[88:91]
buffer_load_dwordx4 v1, s[36:39], s67 offen offset:1024 sc1 lds
v_mfma_f32_16x16x32_bf16 v[88:91], a[184:187], v[44:47], v[88:91]
v_fmac_f32 v66, v122, v152
v_mfma_f32_16x16x32_bf16 v[92:95], a[164:167], v[32:35], v[92:95]
ds_read_b128 v[32:35], v1 offset:38912
v_mfma_f32_16x16x32_bf16 v[92:95], a[172:175], v[36:39], v[92:95]
ds_read_b128 v[36:39], v14 offset:38912
v_fmac_f32 v67, v123, v152
v_mfma_f32_16x16x32_bf16 v[92:95], a[180:183], v[40:43], v[92:95]
ds_read_b128 v[40:43], v15 offset:38912
v_mfma_f32_16x16x32_bf16 v[92:95], a[188:191], v[44:47], v[92:95]
ds_read_b128 v[44:47], v24 offset:38912
s_waitcnt lgkmcnt(4)
v_mfma_f32_16x16x32_bf16 v[96:99], a[160:163], v[48:51], v[96:99]
buffer_load_dwordx4 v1, s[36:39], s67 offen offset:2048 sc1 lds
v_mfma_f32_16x16x32_bf16 v[96:99], a[168:171], v[52:55], v[96:99]
v_fmac_f32 v72, v120, v153
v_fmac_f32 v73, v121, v153
v_mfma_f32_16x16x32_bf16 v[96:99], a[176:179], v[56:59], v[96:99]
buffer_load_dwordx4 v1, s[36:39], s67 offen offset:3072 sc1 lds
v_mfma_f32_16x16x32_bf16 v[96:99], a[184:187], v[60:63], v[96:99]
v_fmac_f32 v74, v122, v153
v_mfma_f32_16x16x32_bf16 v[100:103], a[164:167], v[48:51], v[100:103]
ds_read_b128 v[48:51], v1 offset:39936
v_mfma_f32_16x16x32_bf16 v[100:103], a[172:175], v[52:55], v[100:103]
ds_read_b128 v[52:55], v14 offset:39936
v_fmac_f32 v75, v123, v153
v_mfma_f32_16x16x32_bf16 v[100:103], a[180:183], v[56:59], v[100:103]
ds_read_b128 v[56:59], v15 offset:39936
s_add_u32 m0, s48, 16384
v_mfma_f32_16x16x32_bf16 v[100:103], a[188:191], v[60:63], v[100:103]
ds_read_b128 v[60:63], v24 offset:39936
s_waitcnt lgkmcnt(4)
v_mfma_f32_16x16x32_bf16 v[104:107], a[160:163], v[32:35], v[104:107]
buffer_load_dwordx4 v13, s[36:39], s67 offen offset:0 sc1 lds
v_mfma_f32_16x16x32_bf16 v[104:107], a[168:171], v[36:39], v[104:107]
v_fmac_f32 v80, v120, v154
v_fmac_f32 v81, v121, v154
v_mfma_f32_16x16x32_bf16 v[104:107], a[176:179], v[40:43], v[104:107]
v_mfma_f32_16x16x32_bf16 v[104:107], a[184:187], v[44:47], v[104:107]
s_waitcnt vmcnt(13) lgkmcnt(0)
s_barrier
v_mfma_f32_16x16x32_bf16 v[108:111], a[164:167], v[32:35], v[108:111]
ds_read_b128 v[32:35], v1 offset:5120
v_fmac_f32 v82, v122, v154
v_mfma_f32_16x16x32_bf16 v[108:111], a[172:175], v[36:39], v[108:111]
ds_read_b128 v[36:39], v14 offset:5120
v_fmac_f32 v83, v123, v154
v_mfma_f32_16x16x32_bf16 v[108:111], a[180:183], v[40:43], v[108:111]
ds_read_b128 v[40:43], v15 offset:5120
v_mfma_f32_16x16x32_bf16 v[108:111], a[188:191], v[44:47], v[108:111]
ds_read_b128 v[44:47], v24 offset:5120
v_mfma_f32_16x16x32_bf16 v[112:115], a[160:163], v[48:51], v[112:115]
buffer_load_dwordx4 v13, s[36:39], s67 offen offset:1024 sc1 lds
v_mfma_f32_16x16x32_bf16 v[112:115], a[168:171], v[52:55], v[112:115]
v_fmac_f32 v88, v120, v155
v_fmac_f32 v89, v121, v155
v_mfma_f32_16x16x32_bf16 v[112:115], a[176:179], v[56:59], v[112:115]
buffer_load_dwordx4 v13, s[36:39], s67 offen offset:2048 sc1 lds
v_mfma_f32_16x16x32_bf16 v[112:115], a[184:187], v[60:63], v[112:115]
v_fmac_f32 v90, v122, v155
v_mfma_f32_16x16x32_bf16 v[116:119], a[164:167], v[48:51], v[116:119]
ds_read_b128 v[48:51], v1 offset:6144
v_readlane_b32 s66, v25, 7
v_mfma_f32_16x16x32_bf16 v[116:119], a[172:175], v[52:55], v[116:119]
ds_read_b128 v[52:55], v14 offset:6144
v_fmac_f32 v91, v123, v155
v_mfma_f32_16x16x32_bf16 v[116:119], a[180:183], v[56:59], v[116:119]
ds_read_b128 v[56:59], v15 offset:6144
v_mfma_f32_16x16x32_bf16 v[116:119], a[188:191], v[60:63], v[116:119]
ds_read_b128 v[60:63], v24 offset:6144
s_waitcnt vmcnt(7) lgkmcnt(4)
v_mfma_f32_16x16x32_bf16 v[64:67], a[192:195], v[32:35], v[64:67]
buffer_load_dwordx4 a[224:227], v1, s[36:39], s66 offen offset:0 sc1
v_mfma_f32_16x16x32_bf16 v[64:67], a[200:203], v[36:39], v[64:67]
v_fmac_f32 v100, v124, v156
v_fmac_f32 v101, v125, v156
v_mfma_f32_16x16x32_bf16 v[64:67], a[208:211], v[40:43], v[64:67]
buffer_load_dwordx4 a[228:231], v1, s[36:39], s66 offen offset:1024 sc1
v_mfma_f32_16x16x32_bf16 v[64:67], a[216:219], v[44:47], v[64:67]
v_fmac_f32 v102, v126, v156
v_mfma_f32_16x16x32_bf16 v[68:71], a[196:199], v[32:35], v[68:71]
ds_read_b128 v[32:35], v1 offset:7168
v_mfma_f32_16x16x32_bf16 v[68:71], a[204:207], v[36:39], v[68:71]
ds_read_b128 v[36:39], v14 offset:7168
v_fmac_f32 v103, v127, v156
v_mfma_f32_16x16x32_bf16 v[68:71], a[212:215], v[40:43], v[68:71]
ds_read_b128 v[40:43], v15 offset:7168
v_mfma_f32_16x16x32_bf16 v[68:71], a[220:223], v[44:47], v[68:71]
ds_read_b128 v[44:47], v24 offset:7168
s_waitcnt lgkmcnt(4)
v_mfma_f32_16x16x32_bf16 v[72:75], a[192:195], v[48:51], v[72:75]
buffer_load_dwordx4 a[232:235], v1, s[36:39], s66 offen offset:2048 sc1
v_mfma_f32_16x16x32_bf16 v[72:75], a[200:203], v[52:55], v[72:75]
v_fmac_f32 v108, v124, v157
v_fmac_f32 v109, v125, v157
v_mfma_f32_16x16x32_bf16 v[72:75], a[208:211], v[56:59], v[72:75]
buffer_load_dwordx4 a[236:239], v1, s[36:39], s66 offen offset:3072 sc1
v_mfma_f32_16x16x32_bf16 v[72:75], a[216:219], v[60:63], v[72:75]
v_fmac_f32 v110, v126, v157
v_mfma_f32_16x16x32_bf16 v[76:79], a[196:199], v[48:51], v[76:79]
ds_read_b128 v[48:51], v1 offset:8192
v_mfma_f32_16x16x32_bf16 v[76:79], a[204:207], v[52:55], v[76:79]
ds_read_b128 v[52:55], v14 offset:8192
v_fmac_f32 v111, v127, v157
v_mfma_f32_16x16x32_bf16 v[76:79], a[212:215], v[56:59], v[76:79]
ds_read_b128 v[56:59], v15 offset:8192
v_mfma_f32_16x16x32_bf16 v[76:79], a[220:223], v[60:63], v[76:79]
ds_read_b128 v[60:63], v24 offset:8192
s_waitcnt lgkmcnt(4)
v_mfma_f32_16x16x32_bf16 v[80:83], a[192:195], v[32:35], v[80:83]
buffer_load_dwordx4 a[240:243], v13, s[36:39], s66 offen offset:0 sc1
v_mfma_f32_16x16x32_bf16 v[80:83], a[200:203], v[36:39], v[80:83]
v_fmac_f32 v116, v124, v158
v_fmac_f32 v117, v125, v158
v_mfma_f32_16x16x32_bf16 v[80:83], a[208:211], v[40:43], v[80:83]
buffer_load_dwordx4 a[244:247], v13, s[36:39], s66 offen offset:1024 sc1
v_mfma_f32_16x16x32_bf16 v[80:83], a[216:219], v[44:47], v[80:83]
v_fmac_f32 v118, v126, v158
v_mfma_f32_16x16x32_bf16 v[84:87], a[196:199], v[32:35], v[84:87]
ds_read_b128 v[32:35], v1 offset:9216
v_mfma_f32_16x16x32_bf16 v[84:87], a[204:207], v[36:39], v[84:87]
ds_read_b128 v[36:39], v14 offset:9216
v_fmac_f32 v119, v127, v158
v_mfma_f32_16x16x32_bf16 v[84:87], a[212:215], v[40:43], v[84:87]
ds_read_b128 v[40:43], v15 offset:9216
v_mfma_f32_16x16x32_bf16 v[84:87], a[220:223], v[44:47], v[84:87]
ds_read_b128 v[44:47], v24 offset:9216
s_waitcnt lgkmcnt(4)
v_mfma_f32_16x16x32_bf16 v[88:91], a[192:195], v[48:51], v[88:91]
buffer_load_dwordx4 a[248:251], v13, s[36:39], s66 offen offset:2048 sc1
v_mfma_f32_16x16x32_bf16 v[88:91], a[200:203], v[52:55], v[88:91]
v_fmac_f32 v68, v124, v152
v_fmac_f32 v69, v125, v152
v_mfma_f32_16x16x32_bf16 v[88:91], a[208:211], v[56:59], v[88:91]
buffer_load_dwordx4 a[252:255], v13, s[36:39], s66 offen offset:3072 sc1
v_mfma_f32_16x16x32_bf16 v[88:91], a[216:219], v[60:63], v[88:91]
v_fmac_f32 v70, v126, v152
v_mfma_f32_16x16x32_bf16 v[92:95], a[196:199], v[48:51], v[92:95]
ds_read_b128 v[48:51], v1 offset:10240
v_readlane_b32 s51, v26, 8
v_mfma_f32_16x16x32_bf16 v[92:95], a[204:207], v[52:55], v[92:95]
ds_read_b128 v[52:55], v14 offset:10240
v_fmac_f32 v71, v127, v152
v_mfma_f32_16x16x32_bf16 v[92:95], a[212:215], v[56:59], v[92:95]
ds_read_b128 v[56:59], v15 offset:10240
s_add_u32 m0, s48, 19456
v_mfma_f32_16x16x32_bf16 v[92:95], a[220:223], v[60:63], v[92:95]
ds_read_b128 v[60:63], v24 offset:10240
s_waitcnt lgkmcnt(4)
v_mfma_f32_16x16x32_bf16 v[96:99], a[192:195], v[32:35], v[96:99]
buffer_load_dwordx4 v1, s[36:39], s51 offen offset:0 sc1 lds
v_mfma_f32_16x16x32_bf16 v[96:99], a[200:203], v[36:39], v[96:99]
v_fmac_f32 v76, v124, v153
v_fmac_f32 v77, v125, v153
v_mfma_f32_16x16x32_bf16 v[96:99], a[208:211], v[40:43], v[96:99]
buffer_load_dwordx4 v1, s[36:39], s51 offen offset:1024 sc1 lds
v_mfma_f32_16x16x32_bf16 v[96:99], a[216:219], v[44:47], v[96:99]
v_fmac_f32 v78, v126, v153
v_mfma_f32_16x16x32_bf16 v[100:103], a[196:199], v[32:35], v[100:103]
ds_read_b128 v[32:35], v1 offset:11264
v_mfma_f32_16x16x32_bf16 v[100:103], a[204:207], v[36:39], v[100:103]
ds_read_b128 v[36:39], v14 offset:11264
v_fmac_f32 v79, v127, v153
v_mfma_f32_16x16x32_bf16 v[100:103], a[212:215], v[40:43], v[100:103]
ds_read_b128 v[40:43], v15 offset:11264
v_mfma_f32_16x16x32_bf16 v[100:103], a[220:223], v[44:47], v[100:103]
ds_read_b128 v[44:47], v24 offset:11264
s_waitcnt lgkmcnt(4)
v_mfma_f32_16x16x32_bf16 v[104:107], a[192:195], v[48:51], v[104:107]
buffer_load_dwordx4 v1, s[36:39], s51 offen offset:2048 sc1 lds
v_mfma_f32_16x16x32_bf16 v[104:107], a[200:203], v[52:55], v[104:107]
v_fmac_f32 v84, v124, v154
v_fmac_f32 v85, v125, v154
v_mfma_f32_16x16x32_bf16 v[104:107], a[208:211], v[56:59], v[104:107]
v_mfma_f32_16x16x32_bf16 v[104:107], a[216:219], v[60:63], v[104:107]
s_waitcnt vmcnt(11) lgkmcnt(0)
s_barrier
v_mfma_f32_16x16x32_bf16 v[108:111], a[196:199], v[48:51], v[108:111]
ds_read_b128 v[48:51], v1 offset:12288
v_fmac_f32 v86, v126, v154
v_mfma_f32_16x16x32_bf16 v[108:111], a[204:207], v[52:55], v[108:111]
ds_read_b128 v[52:55], v14 offset:12288
v_fmac_f32 v87, v127, v154
v_mfma_f32_16x16x32_bf16 v[108:111], a[212:215], v[56:59], v[108:111]
ds_read_b128 v[56:59], v15 offset:12288
v_mfma_f32_16x16x32_bf16 v[108:111], a[220:223], v[60:63], v[108:111]
ds_read_b128 v[60:63], v24 offset:12288
v_mfma_f32_16x16x32_bf16 v[112:115], a[192:195], v[32:35], v[112:115]
buffer_load_dwordx4 v1, s[36:39], s51 offen offset:3072 sc1 lds
v_mfma_f32_16x16x32_bf16 v[112:115], a[200:203], v[36:39], v[112:115]
v_fmac_f32 v92, v124, v155
v_fmac_f32 v93, v125, v155
s_add_u32 m0, s48, 23552
v_mfma_f32_16x16x32_bf16 v[112:115], a[208:211], v[40:43], v[112:115]
buffer_load_dwordx4 v13, s[36:39], s51 offen offset:0 sc1 lds
v_mfma_f32_16x16x32_bf16 v[112:115], a[216:219], v[44:47], v[112:115]
v_fmac_f32 v94, v126, v155
v_mfma_f32_16x16x32_bf16 v[116:119], a[196:199], v[32:35], v[116:119]
ds_read_b128 v[32:35], v1 offset:13312
v_mfma_f32_16x16x32_bf16 v[116:119], a[204:207], v[36:39], v[116:119]
ds_read_b128 v[36:39], v14 offset:13312
v_fmac_f32 v95, v127, v155
v_mfma_f32_16x16x32_bf16 v[116:119], a[212:215], v[40:43], v[116:119]
ds_read_b128 v[40:43], v15 offset:13312
v_mfma_f32_16x16x32_bf16 v[116:119], a[220:223], v[44:47], v[116:119]
ds_read_b128 v[44:47], v24 offset:13312
s_waitcnt vmcnt(5) lgkmcnt(4)
v_mfma_f32_16x16x32_bf16 v[64:67], a[224:227], v[48:51], v[64:67]
buffer_load_dwordx4 v13, s[36:39], s51 offen offset:1024 sc1 lds
v_mfma_f32_16x16x32_bf16 v[64:67], a[232:235], v[52:55], v[64:67]
v_mfma_f32_16x16x32_bf16 v[64:67], a[240:243], v[56:59], v[64:67]
buffer_load_dwordx4 v13, s[36:39], s51 offen offset:2048 sc1 lds
v_mfma_f32_16x16x32_bf16 v[64:67], a[248:251], v[60:63], v[64:67]
v_mfma_f32_16x16x32_bf16 v[68:71], a[228:231], v[48:51], v[68:71]
ds_read_b128 v[48:51], v1 offset:14336
v_mfma_f32_16x16x32_bf16 v[68:71], a[236:239], v[52:55], v[68:71]
ds_read_b128 v[52:55], v14 offset:14336
v_readlane_b32 s67, v26, 9
v_mfma_f32_16x16x32_bf16 v[68:71], a[244:247], v[56:59], v[68:71]
ds_read_b128 v[56:59], v15 offset:14336
s_add_u32 m0, s48, 26624
v_mfma_f32_16x16x32_bf16 v[68:71], a[252:255], v[60:63], v[68:71]
ds_read_b128 v[60:63], v24 offset:14336
s_waitcnt lgkmcnt(4)
v_mfma_f32_16x16x32_bf16 v[72:75], a[224:227], v[32:35], v[72:75]
buffer_load_dwordx4 v1, s[36:39], s67 offen offset:0 sc1 lds
v_mfma_f32_16x16x32_bf16 v[72:75], a[232:235], v[36:39], v[72:75]
v_mfma_f32_16x16x32_bf16 v[72:75], a[240:243], v[40:43], v[72:75]
buffer_load_dwordx4 v1, s[36:39], s67 offen offset:1024 sc1 lds
v_mfma_f32_16x16x32_bf16 v[72:75], a[248:251], v[44:47], v[72:75]
v_mfma_f32_16x16x32_bf16 v[76:79], a[228:231], v[32:35], v[76:79]
ds_read_b128 v[32:35], v1 offset:15360
v_mfma_f32_16x16x32_bf16 v[76:79], a[236:239], v[36:39], v[76:79]
ds_read_b128 v[36:39], v14 offset:15360
v_mfma_f32_16x16x32_bf16 v[76:79], a[244:247], v[40:43], v[76:79]
ds_read_b128 v[40:43], v15 offset:15360
v_mfma_f32_16x16x32_bf16 v[76:79], a[252:255], v[44:47], v[76:79]
ds_read_b128 v[44:47], v24 offset:15360
s_waitcnt lgkmcnt(4)
v_mfma_f32_16x16x32_bf16 v[80:83], a[224:227], v[48:51], v[80:83]
buffer_load_dwordx4 v1, s[36:39], s67 offen offset:2048 sc1 lds
v_mfma_f32_16x16x32_bf16 v[80:83], a[232:235], v[52:55], v[80:83]
v_mfma_f32_16x16x32_bf16 v[80:83], a[240:243], v[56:59], v[80:83]
buffer_load_dwordx4 v1, s[36:39], s67 offen offset:3072 sc1 lds
v_mfma_f32_16x16x32_bf16 v[80:83], a[248:251], v[60:63], v[80:83]
v_mfma_f32_16x16x32_bf16 v[84:87], a[228:231], v[48:51], v[84:87]
ds_read_b128 v[48:51], v1 offset:16384
v_mfma_f32_16x16x32_bf16 v[84:87], a[236:239], v[52:55], v[84:87]
ds_read_b128 v[52:55], v14 offset:16384
v_mfma_f32_16x16x32_bf16 v[84:87], a[244:247], v[56:59], v[84:87]
ds_read_b128 v[56:59], v15 offset:16384
s_add_u32 m0, s48, 30720
v_mfma_f32_16x16x32_bf16 v[84:87], a[252:255], v[60:63], v[84:87]
ds_read_b128 v[60:63], v24 offset:16384
s_waitcnt lgkmcnt(4)
v_mfma_f32_16x16x32_bf16 v[88:91], a[224:227], v[32:35], v[88:91]
buffer_load_dwordx4 v13, s[36:39], s67 offen offset:0 sc1 lds
v_mfma_f32_16x16x32_bf16 v[88:91], a[232:235], v[36:39], v[88:91]
v_mfma_f32_16x16x32_bf16 v[88:91], a[240:243], v[40:43], v[88:91]
buffer_load_dwordx4 v13, s[36:39], s67 offen offset:1024 sc1 lds
v_mfma_f32_16x16x32_bf16 v[88:91], a[248:251], v[44:47], v[88:91]
v_mfma_f32_16x16x32_bf16 v[92:95], a[228:231], v[32:35], v[92:95]
ds_read_b128 v[32:35], v1 offset:17408
v_mfma_f32_16x16x32_bf16 v[92:95], a[236:239], v[36:39], v[92:95]
ds_read_b128 v[36:39], v14 offset:17408
v_mfma_f32_16x16x32_bf16 v[92:95], a[244:247], v[40:43], v[92:95]
ds_read_b128 v[40:43], v15 offset:17408
v_readlane_b32 s51, v26, 10
v_mfma_f32_16x16x32_bf16 v[92:95], a[252:255], v[44:47], v[92:95]
ds_read_b128 v[44:47], v24 offset:17408
s_waitcnt lgkmcnt(4)
v_mfma_f32_16x16x32_bf16 v[96:99], a[224:227], v[48:51], v[96:99]
buffer_load_dwordx4 v13, s[36:39], s67 offen offset:2048 sc1 lds
v_mfma_f32_16x16x32_bf16 v[96:99], a[232:235], v[52:55], v[96:99]
s_add_u32 m0, s48, 33792
v_mfma_f32_16x16x32_bf16 v[96:99], a[240:243], v[56:59], v[96:99]
buffer_load_dwordx4 v1, s[36:39], s51 offen offset:0 sc1 lds
v_mfma_f32_16x16x32_bf16 v[96:99], a[248:251], v[60:63], v[96:99]
v_mfma_f32_16x16x32_bf16 v[100:103], a[228:231], v[48:51], v[100:103]
ds_read_b128 v[48:51], v1 offset:18432
v_mfma_f32_16x16x32_bf16 v[100:103], a[236:239], v[52:55], v[100:103]
ds_read_b128 v[52:55], v14 offset:18432
v_mfma_f32_16x16x32_bf16 v[100:103], a[244:247], v[56:59], v[100:103]
ds_read_b128 v[56:59], v15 offset:18432
v_mfma_f32_16x16x32_bf16 v[100:103], a[252:255], v[60:63], v[100:103]
ds_read_b128 v[60:63], v24 offset:18432
s_waitcnt lgkmcnt(4)
v_mfma_f32_16x16x32_bf16 v[104:107], a[224:227], v[32:35], v[104:107]
buffer_load_dwordx4 v1, s[36:39], s51 offen offset:1024 sc1 lds
v_mfma_f32_16x16x32_bf16 v[104:107], a[232:235], v[36:39], v[104:107]
v_mfma_f32_16x16x32_bf16 v[104:107], a[240:243], v[40:43], v[104:107]
v_mfma_f32_16x16x32_bf16 v[104:107], a[248:251], v[44:47], v[104:107]
s_waitcnt vmcnt(9) lgkmcnt(0)
TP45:
s_cbranch_execz TP4
TP46:
s_cbranch_execz TP54
s_barrier
v_mfma_f32_16x16x32_bf16 v[108:111], a[228:231], v[32:35], v[108:111]
ds_read_b128 v[32:35], v1 offset:19456
v_mfma_f32_16x16x32_bf16 v[108:111], a[236:239], v[36:39], v[108:111]
ds_read_b128 v[36:39], v14 offset:19456
v_mfma_f32_16x16x32_bf16 v[108:111], a[244:247], v[40:43], v[108:111]
ds_read_b128 v[40:43], v15 offset:19456
v_mfma_f32_16x16x32_bf16 v[108:111], a[252:255], v[44:47], v[108:111]
ds_read_b128 v[44:47], v24 offset:19456
v_mfma_f32_16x16x32_bf16 v[112:115], a[224:227], v[48:51], v[112:115]
buffer_load_dwordx4 v1, s[36:39], s51 offen offset:2048 sc1 lds
v_mfma_f32_16x16x32_bf16 v[112:115], a[232:235], v[52:55], v[112:115]
v_mfma_f32_16x16x32_bf16 v[112:115], a[240:243], v[56:59], v[112:115]
buffer_load_dwordx4 v1, s[36:39], s51 offen offset:3072 sc1 lds
v_mfma_f32_16x16x32_bf16 v[112:115], a[248:251], v[60:63], v[112:115]
v_mfma_f32_16x16x32_bf16 v[116:119], a[228:231], v[48:51], v[116:119]
ds_read_b128 v[48:51], v1 offset:20480
v_mfma_f32_16x16x32_bf16 v[116:119], a[236:239], v[52:55], v[116:119]
ds_read_b128 v[52:55], v14 offset:20480
v_mfma_f32_16x16x32_bf16 v[116:119], a[244:247], v[56:59], v[116:119]
ds_read_b128 v[56:59], v15 offset:20480
s_add_u32 m0, s48, 37888
v_mfma_f32_16x16x32_bf16 v[116:119], a[252:255], v[60:63], v[116:119]
ds_read_b128 v[60:63], v24 offset:20480
s_waitcnt lgkmcnt(4)
v_pk_mul_f32 v[176:177], v[64:65], v[64:65]
v_pk_mul_f32 v[178:179], v[66:67], v[66:67]
v_pk_fma_f32 v[176:177], v[176:177], v[144:145], v[136:137]
v_pk_fma_f32 v[178:179], v[178:179], v[146:147], v[138:139]
v_pk_mul_f32 v[176:177], v[176:177], v[64:65]
v_pk_mul_f32 v[178:179], v[178:179], v[66:67]
v_exp_f32 v176, v176
v_exp_f32 v177, v177
v_exp_f32 v178, v178
v_exp_f32 v179, v179
buffer_load_dwordx4 v13, s[36:39], s51 offen offset:0 sc1 lds
v_readlane_b32 s67, v26, 11
v_pk_fma_f32 v[176:177], v[176:177], v[128:129], v[128:129]
v_pk_fma_f32 v[178:179], v[178:179], v[130:131], v[130:131]
v_rcp_f32 v176, v176
v_rcp_f32 v177, v177
v_rcp_f32 v178, v178
v_rcp_f32 v179, v179
v_pk_mul_f32 v[64:65], v[64:65], v[176:177]
v_pk_mul_f32 v[66:67], v[66:67], v[178:179]
v_pk_add_f32 v[224:225], v[224:225], v[64:65]
v_pk_fma_f32 v[232:233], v[64:65], v[64:65], v[232:233]
v_pk_add_f32 v[226:227], v[226:227], v[66:67]
v_pk_fma_f32 v[234:235], v[66:67], v[66:67], v[234:235]
buffer_load_dwordx4 v13, s[36:39], s51 offen offset:1024 sc1 lds
v_pk_mul_f32 v[180:181], v[68:69], v[68:69]
v_pk_mul_f32 v[182:183], v[70:71], v[70:71]
v_pk_fma_f32 v[180:181], v[180:181], v[148:149], v[140:141]
v_pk_fma_f32 v[182:183], v[182:183], v[150:151], v[142:143]
v_pk_mul_f32 v[180:181], v[180:181], v[68:69]
v_pk_mul_f32 v[182:183], v[182:183], v[70:71]
v_exp_f32 v180, v180
v_exp_f32 v181, v181
v_exp_f32 v182, v182
v_exp_f32 v183, v183
buffer_load_dwordx4 v13, s[36:39], s51 offen offset:2048 sc1 lds
s_add_u32 m0, s48, 5120
v_pk_fma_f32 v[180:181], v[180:181], v[132:133], v[132:133]
v_pk_fma_f32 v[182:183], v[182:183], v[134:135], v[134:135]
v_rcp_f32 v180, v180
v_rcp_f32 v181, v181
v_rcp_f32 v182, v182
v_rcp_f32 v183, v183
v_pk_mul_f32 v[68:69], v[68:69], v[180:181]
v_pk_mul_f32 v[70:71], v[70:71], v[182:183]
v_pk_add_f32 v[228:229], v[228:229], v[68:69]
v_pk_fma_f32 v[236:237], v[68:69], v[68:69], v[236:237]
v_pk_add_f32 v[230:231], v[230:231], v[70:71]
v_pk_fma_f32 v[238:239], v[70:71], v[70:71], v[238:239]
buffer_load_dwordx4 v1, s[36:39], s67 offen offset:0 sc1 lds
v_pk_mul_f32 v[176:177], v[72:73], v[72:73]
v_pk_mul_f32 v[178:179], v[74:75], v[74:75]
v_pk_fma_f32 v[176:177], v[176:177], v[144:145], v[136:137]
v_pk_fma_f32 v[178:179], v[178:179], v[146:147], v[138:139]
v_pk_mul_f32 v[176:177], v[176:177], v[72:73]
v_pk_mul_f32 v[178:179], v[178:179], v[74:75]
v_exp_f32 v176, v176
v_exp_f32 v177, v177
v_exp_f32 v178, v178
v_exp_f32 v179, v179
buffer_load_dwordx4 v1, s[36:39], s67 offen offset:1024 sc1 lds
v_pk_fma_f32 v[176:177], v[176:177], v[128:129], v[128:129]
v_pk_fma_f32 v[178:179], v[178:179], v[130:131], v[130:131]
v_rcp_f32 v176, v176
v_rcp_f32 v177, v177
v_rcp_f32 v178, v178
v_rcp_f32 v179, v179
v_pk_mul_f32 v[72:73], v[72:73], v[176:177]
v_pk_mul_f32 v[74:75], v[74:75], v[178:179]
v_pk_add_f32 v[224:225], v[224:225], v[72:73]
v_pk_fma_f32 v[232:233], v[72:73], v[72:73], v[232:233]
v_pk_add_f32 v[226:227], v[226:227], v[74:75]
v_pk_fma_f32 v[234:235], v[74:75], v[74:75], v[234:235]
buffer_load_dwordx4 v1, s[36:39], s67 offen offset:2048 sc1 lds
v_pk_mul_f32 v[180:181], v[76:77], v[76:77]
v_pk_mul_f32 v[182:183], v[78:79], v[78:79]
v_pk_fma_f32 v[180:181], v[180:181], v[148:149], v[140:141]
v_pk_fma_f32 v[182:183], v[182:183], v[150:151], v[142:143]
v_pk_mul_f32 v[180:181], v[180:181], v[76:77]
v_pk_mul_f32 v[182:183], v[182:183], v[78:79]
v_exp_f32 v180, v180
v_exp_f32 v181, v181
v_exp_f32 v182, v182
v_exp_f32 v183, v183
buffer_load_dwordx4 v1, s[36:39], s67 offen offset:3072 sc1 lds
s_add_u32 m0, s48, 9216
v_pk_fma_f32 v[180:181], v[180:181], v[132:133], v[132:133]
v_pk_fma_f32 v[182:183], v[182:183], v[134:135], v[134:135]
v_rcp_f32 v180, v180
v_rcp_f32 v181, v181
v_rcp_f32 v182, v182
v_rcp_f32 v183, v183
v_pk_mul_f32 v[76:77], v[76:77], v[180:181]
v_pk_mul_f32 v[78:79], v[78:79], v[182:183]
v_pk_add_f32 v[228:229], v[228:229], v[76:77]
v_pk_fma_f32 v[236:237], v[76:77], v[76:77], v[236:237]
v_pk_add_f32 v[230:231], v[230:231], v[78:79]
v_pk_fma_f32 v[238:239], v[78:79], v[78:79], v[238:239]
buffer_load_dwordx4 v13, s[36:39], s67 offen offset:0 sc1 lds
v_readlane_b32 s51, v26, 12
v_pk_mul_f32 v[176:177], v[80:81], v[80:81]
v_pk_mul_f32 v[178:179], v[82:83], v[82:83]
v_pk_fma_f32 v[176:177], v[176:177], v[144:145], v[136:137]
v_pk_fma_f32 v[178:179], v[178:179], v[146:147], v[138:139]
v_pk_mul_f32 v[176:177], v[176:177], v[80:81]
v_pk_mul_f32 v[178:179], v[178:179], v[82:83]
v_exp_f32 v176, v176
v_exp_f32 v177, v177
v_exp_f32 v178, v178
v_exp_f32 v179, v179
buffer_load_dwordx4 v13, s[36:39], s67 offen offset:1024 sc1 lds
v_pk_fma_f32 v[176:177], v[176:177], v[128:129], v[128:129]
v_pk_fma_f32 v[178:179], v[178:179], v[130:131], v[130:131]
v_rcp_f32 v176, v176
v_rcp_f32 v177, v177
v_rcp_f32 v178, v178
v_rcp_f32 v179, v179
v_pk_mul_f32 v[80:81], v[80:81], v[176:177]
v_pk_mul_f32 v[82:83], v[82:83], v[178:179]
v_pk_add_f32 v[224:225], v[224:225], v[80:81]
v_pk_fma_f32 v[232:233], v[80:81], v[80:81], v[232:233]
v_pk_add_f32 v[226:227], v[226:227], v[82:83]
v_pk_fma_f32 v[234:235], v[82:83], v[82:83], v[234:235]
buffer_load_dwordx4 v13, s[36:39], s67 offen offset:2048 sc1 lds
s_add_u32 m0, s48, 12288
v_pk_mul_f32 v[180:181], v[84:85], v[84:85]
v_pk_mul_f32 v[182:183], v[86:87], v[86:87]
v_pk_fma_f32 v[180:181], v[180:181], v[148:149], v[140:141]
v_pk_fma_f32 v[182:183], v[182:183], v[150:151], v[142:143]
v_pk_mul_f32 v[180:181], v[180:181], v[84:85]
v_pk_mul_f32 v[182:183], v[182:183], v[86:87]
v_exp_f32 v180, v180
v_exp_f32 v181, v181
v_exp_f32 v182, v182
v_exp_f32 v183, v183
buffer_load_dwordx4 v1, s[36:39], s51 offen offset:0 sc1 lds
v_pk_fma_f32 v[180:181], v[180:181], v[132:133], v[132:133]
v_pk_fma_f32 v[182:183], v[182:183], v[134:135], v[134:135]
v_rcp_f32 v180, v180
v_rcp_f32 v181, v181
v_rcp_f32 v182, v182
v_rcp_f32 v183, v183
v_pk_mul_f32 v[84:85], v[84:85], v[180:181]
v_pk_mul_f32 v[86:87], v[86:87], v[182:183]
v_pk_add_f32 v[228:229], v[228:229], v[84:85]
v_pk_fma_f32 v[236:237], v[84:85], v[84:85], v[236:237]
v_pk_add_f32 v[230:231], v[230:231], v[86:87]
v_pk_fma_f32 v[238:239], v[86:87], v[86:87], v[238:239]
buffer_load_dwordx4 v1, s[36:39], s51 offen offset:1024 sc1 lds
v_pk_mul_f32 v[176:177], v[88:89], v[88:89]
v_pk_mul_f32 v[178:179], v[90:91], v[90:91]
v_pk_fma_f32 v[176:177], v[176:177], v[144:145], v[136:137]
v_pk_fma_f32 v[178:179], v[178:179], v[146:147], v[138:139]
v_pk_mul_f32 v[176:177], v[176:177], v[88:89]
v_pk_mul_f32 v[178:179], v[178:179], v[90:91]
v_exp_f32 v176, v176
v_exp_f32 v177, v177
v_exp_f32 v178, v178
v_exp_f32 v179, v179
buffer_load_dwordx4 v1, s[36:39], s51 offen offset:2048 sc1 lds
v_pk_fma_f32 v[176:177], v[176:177], v[128:129], v[128:129]
v_pk_fma_f32 v[178:179], v[178:179], v[130:131], v[130:131]
v_rcp_f32 v176, v176
v_rcp_f32 v177, v177
v_rcp_f32 v178, v178
v_rcp_f32 v179, v179
v_pk_mul_f32 v[88:89], v[88:89], v[176:177]
v_pk_mul_f32 v[90:91], v[90:91], v[178:179]
v_pk_add_f32 v[224:225], v[224:225], v[88:89]
v_pk_fma_f32 v[232:233], v[88:89], v[88:89], v[232:233]
v_pk_add_f32 v[226:227], v[226:227], v[90:91]
v_pk_fma_f32 v[234:235], v[90:91], v[90:91], v[234:235]
buffer_load_dwordx4 v1, s[36:39], s51 offen offset:3072 sc1 lds
s_add_u32 m0, s48, 16384
v_pk_mul_f32 v[180:181], v[92:93], v[92:93]
v_pk_mul_f32 v[182:183], v[94:95], v[94:95]
v_pk_fma_f32 v[180:181], v[180:181], v[148:149], v[140:141]
v_pk_fma_f32 v[182:183], v[182:183], v[150:151], v[142:143]
v_pk_mul_f32 v[180:181], v[180:181], v[92:93]
v_pk_mul_f32 v[182:183], v[182:183], v[94:95]
v_exp_f32 v180, v180
v_exp_f32 v181, v181
v_exp_f32 v182, v182
v_exp_f32 v183, v183
buffer_load_dwordx4 v13, s[36:39], s51 offen offset:0 sc1 lds
v_pk_fma_f32 v[180:181], v[180:181], v[132:133], v[132:133]
v_pk_fma_f32 v[182:183], v[182:183], v[134:135], v[134:135]
v_rcp_f32 v180, v180
v_rcp_f32 v181, v181
v_rcp_f32 v182, v182
v_rcp_f32 v183, v183
v_pk_mul_f32 v[92:93], v[92:93], v[180:181]
v_pk_mul_f32 v[94:95], v[94:95], v[182:183]
v_pk_add_f32 v[228:229], v[228:229], v[92:93]
v_pk_fma_f32 v[236:237], v[92:93], v[92:93], v[236:237]
v_pk_add_f32 v[230:231], v[230:231], v[94:95]
v_pk_fma_f32 v[238:239], v[94:95], v[94:95], v[238:239]
buffer_load_dwordx4 v13, s[36:39], s51 offen offset:1024 sc1 lds
v_pk_mul_f32 v[176:177], v[96:97], v[96:97]
v_pk_mul_f32 v[178:179], v[98:99], v[98:99]
v_pk_fma_f32 v[176:177], v[176:177], v[144:145], v[136:137]
v_pk_fma_f32 v[178:179], v[178:179], v[146:147], v[138:139]
v_pk_mul_f32 v[176:177], v[176:177], v[96:97]
v_pk_mul_f32 v[178:179], v[178:179], v[98:99]
v_exp_f32 v176, v176
v_exp_f32 v177, v177
v_exp_f32 v178, v178
v_exp_f32 v179, v179
buffer_load_dwordx4 v13, s[36:39], s51 offen offset:2048 sc1 lds
v_pk_fma_f32 v[176:177], v[176:177], v[128:129], v[128:129]
v_pk_fma_f32 v[178:179], v[178:179], v[130:131], v[130:131]
v_rcp_f32 v176, v176
v_rcp_f32 v177, v177
v_rcp_f32 v178, v178
v_rcp_f32 v179, v179
v_pk_mul_f32 v[96:97], v[96:97], v[176:177]
v_pk_mul_f32 v[98:99], v[98:99], v[178:179]
v_pk_add_f32 v[224:225], v[224:225], v[96:97]
v_pk_fma_f32 v[232:233], v[96:97], v[96:97], v[232:233]
v_pk_add_f32 v[226:227], v[226:227], v[98:99]
v_pk_fma_f32 v[234:235], v[98:99], v[98:99], v[234:235]
v_pk_mul_f32 v[180:181], v[100:101], v[100:101]
v_pk_mul_f32 v[182:183], v[102:103], v[102:103]
v_pk_fma_f32 v[180:181], v[180:181], v[148:149], v[140:141]
v_pk_fma_f32 v[182:183], v[182:183], v[150:151], v[142:143]
v_pk_mul_f32 v[180:181], v[180:181], v[100:101]
v_pk_mul_f32 v[182:183], v[182:183], v[102:103]
v_exp_f32 v180, v180
v_exp_f32 v181, v181
v_exp_f32 v182, v182
v_exp_f32 v183, v183
v_pk_fma_f32 v[180:181], v[180:181], v[132:133], v[132:133]
v_pk_fma_f32 v[182:183], v[182:183], v[134:135], v[134:135]
v_rcp_f32 v180, v180
v_rcp_f32 v181, v181
v_rcp_f32 v182, v182
v_rcp_f32 v183, v183
v_pk_mul_f32 v[100:101], v[100:101], v[180:181]
v_pk_mul_f32 v[102:103], v[102:103], v[182:183]
v_pk_add_f32 v[228:229], v[228:229], v[100:101]
v_pk_fma_f32 v[236:237], v[100:101], v[100:101], v[236:237]
v_pk_add_f32 v[230:231], v[230:231], v[102:103]
v_pk_fma_f32 v[238:239], v[102:103], v[102:103], v[238:239]
v_pk_mul_f32 v[176:177], v[104:105], v[104:105]
v_pk_mul_f32 v[178:179], v[106:107], v[106:107]
v_pk_fma_f32 v[176:177], v[176:177], v[144:145], v[136:137]
v_pk_fma_f32 v[178:179], v[178:179], v[146:147], v[138:139]
v_pk_mul_f32 v[176:177], v[176:177], v[104:105]
v_pk_mul_f32 v[178:179], v[178:179], v[106:107]
v_exp_f32 v176, v176
v_exp_f32 v177, v177
v_exp_f32 v178, v178
v_exp_f32 v179, v179
v_pk_fma_f32 v[176:177], v[176:177], v[128:129], v[128:129]
v_pk_fma_f32 v[178:179], v[178:179], v[130:131], v[130:131]
v_rcp_f32 v176, v176
v_rcp_f32 v177, v177
v_rcp_f32 v178, v178
v_rcp_f32 v179, v179
v_pk_mul_f32 v[104:105], v[104:105], v[176:177]
v_pk_mul_f32 v[106:107], v[106:107], v[178:179]
v_pk_add_f32 v[224:225], v[224:225], v[104:105]
v_pk_fma_f32 v[232:233], v[104:105], v[104:105], v[232:233]
v_pk_add_f32 v[226:227], v[226:227], v[106:107]
v_pk_fma_f32 v[234:235], v[106:107], v[106:107], v[234:235]
v_pk_mul_f32 v[180:181], v[108:109], v[108:109]
v_pk_mul_f32 v[182:183], v[110:111], v[110:111]
v_pk_fma_f32 v[180:181], v[180:181], v[148:149], v[140:141]
v_pk_fma_f32 v[182:183], v[182:183], v[150:151], v[142:143]
v_pk_mul_f32 v[180:181], v[180:181], v[108:109]
v_pk_mul_f32 v[182:183], v[182:183], v[110:111]
v_exp_f32 v180, v180
v_exp_f32 v181, v181
v_exp_f32 v182, v182
v_exp_f32 v183, v183
v_pk_fma_f32 v[180:181], v[180:181], v[132:133], v[132:133]
v_pk_fma_f32 v[182:183], v[182:183], v[134:135], v[134:135]
v_rcp_f32 v180, v180
v_rcp_f32 v181, v181
v_rcp_f32 v182, v182
v_rcp_f32 v183, v183
v_pk_mul_f32 v[108:109], v[108:109], v[180:181]
v_pk_mul_f32 v[110:111], v[110:111], v[182:183]
v_pk_add_f32 v[228:229], v[228:229], v[108:109]
v_pk_fma_f32 v[236:237], v[108:109], v[108:109], v[236:237]
v_pk_add_f32 v[230:231], v[230:231], v[110:111]
v_pk_fma_f32 v[238:239], v[110:111], v[110:111], v[238:239]
v_pk_mul_f32 v[176:177], v[112:113], v[112:113]
v_pk_mul_f32 v[178:179], v[114:115], v[114:115]
v_pk_fma_f32 v[176:177], v[176:177], v[144:145], v[136:137]
v_pk_fma_f32 v[178:179], v[178:179], v[146:147], v[138:139]
v_pk_mul_f32 v[176:177], v[176:177], v[112:113]
v_pk_mul_f32 v[178:179], v[178:179], v[114:115]
v_exp_f32 v176, v176
v_exp_f32 v177, v177
v_exp_f32 v178, v178
v_exp_f32 v179, v179
v_pk_fma_f32 v[176:177], v[176:177], v[128:129], v[128:129]
v_pk_fma_f32 v[178:179], v[178:179], v[130:131], v[130:131]
v_rcp_f32 v176, v176
v_rcp_f32 v177, v177
v_rcp_f32 v178, v178
v_rcp_f32 v179, v179
v_pk_mul_f32 v[112:113], v[112:113], v[176:177]
v_pk_mul_f32 v[114:115], v[114:115], v[178:179]
v_pk_add_f32 v[224:225], v[224:225], v[112:113]
v_pk_fma_f32 v[232:233], v[112:113], v[112:113], v[232:233]
v_pk_add_f32 v[226:227], v[226:227], v[114:115]
v_pk_fma_f32 v[234:235], v[114:115], v[114:115], v[234:235]
v_pk_mul_f32 v[180:181], v[116:117], v[116:117]
v_pk_mul_f32 v[182:183], v[118:119], v[118:119]
v_pk_fma_f32 v[180:181], v[180:181], v[148:149], v[140:141]
v_pk_fma_f32 v[182:183], v[182:183], v[150:151], v[142:143]
v_pk_mul_f32 v[180:181], v[180:181], v[116:117]
v_pk_mul_f32 v[182:183], v[182:183], v[118:119]
v_exp_f32 v180, v180
v_exp_f32 v181, v181
v_exp_f32 v182, v182
v_exp_f32 v183, v183
v_pk_fma_f32 v[180:181], v[180:181], v[132:133], v[132:133]
v_pk_fma_f32 v[182:183], v[182:183], v[134:135], v[134:135]
v_rcp_f32 v180, v180
v_rcp_f32 v181, v181
v_rcp_f32 v182, v182
v_rcp_f32 v183, v183
v_pk_mul_f32 v[116:117], v[116:117], v[180:181]
v_pk_mul_f32 v[118:119], v[118:119], v[182:183]
v_pk_add_f32 v[228:229], v[228:229], v[116:117]
v_pk_fma_f32 v[236:237], v[116:117], v[116:117], v[236:237]
v_pk_add_f32 v[230:231], v[230:231], v[118:119]
v_pk_fma_f32 v[238:239], v[118:119], v[118:119], v[238:239]
v_add_f32_dpp v224, v224, v224 row_ror:8 row_mask:0xf bank_mask:0x3
v_add_f32_dpp v225, v225, v225 row_ror:8 row_mask:0xf bank_mask:0x3
v_add_f32_dpp v226, v226, v226 row_ror:8 row_mask:0xf bank_mask:0x3
v_add_f32_dpp v227, v227, v227 row_ror:8 row_mask:0xf bank_mask:0x3
v_add_f32_dpp v232, v232, v232 row_ror:8 row_mask:0xf bank_mask:0x3
v_add_f32_dpp v233, v233, v233 row_ror:8 row_mask:0xf bank_mask:0x3
v_add_f32_dpp v234, v234, v234 row_ror:8 row_mask:0xf bank_mask:0x3
v_add_f32_dpp v235, v235, v235 row_ror:8 row_mask:0xf bank_mask:0x3
v_add_f32_dpp v224, v228, v228 row_ror:8 row_mask:0xf bank_mask:0xc
v_add_f32_dpp v225, v229, v229 row_ror:8 row_mask:0xf bank_mask:0xc
v_add_f32_dpp v226, v230, v230 row_ror:8 row_mask:0xf bank_mask:0xc
v_add_f32_dpp v227, v231, v231 row_ror:8 row_mask:0xf bank_mask:0xc
v_add_f32_dpp v232, v236, v236 row_ror:8 row_mask:0xf bank_mask:0xc
v_add_f32_dpp v233, v237, v237 row_ror:8 row_mask:0xf bank_mask:0xc
v_add_f32_dpp v234, v238, v238 row_ror:8 row_mask:0xf bank_mask:0xc
v_add_f32_dpp v235, v239, v239 row_ror:8 row_mask:0xf bank_mask:0xc
v_add_f32_dpp v224, v224, v224 row_half_mirror row_mask:0xf bank_mask:0x5
v_add_f32_dpp v225, v225, v225 row_half_mirror row_mask:0xf bank_mask:0x5
v_add_f32_dpp v226, v226, v226 row_half_mirror row_mask:0xf bank_mask:0x5
v_add_f32_dpp v227, v227, v227 row_half_mirror row_mask:0xf bank_mask:0x5
v_add_f32_dpp v224, v232, v232 row_half_mirror row_mask:0xf bank_mask:0xa
v_add_f32_dpp v225, v233, v233 row_half_mirror row_mask:0xf bank_mask:0xa
v_add_f32_dpp v226, v234, v234 row_half_mirror row_mask:0xf bank_mask:0xa
v_add_f32_dpp v227, v235, v235 row_half_mirror row_mask:0xf bank_mask:0xa
v_add_f32_dpp v224, v224, v224 quad_perm:[1,0,3,2] row_mask:0xf bank_mask:0xf
v_add_f32_dpp v225, v225, v225 quad_perm:[1,0,3,2] row_mask:0xf bank_mask:0xf
v_add_f32_dpp v226, v226, v226 quad_perm:[1,0,3,2] row_mask:0xf bank_mask:0xf
v_add_f32_dpp v227, v227, v227 quad_perm:[1,0,3,2] row_mask:0xf bank_mask:0xf
v_add_f32_dpp v224, v224, v224 quad_perm:[2,3,0,1] row_mask:0xf bank_mask:0xf
v_add_f32_dpp v225, v225, v225 quad_perm:[2,3,0,1] row_mask:0xf bank_mask:0xf
v_add_f32_dpp v226, v226, v226 quad_perm:[2,3,0,1] row_mask:0xf bank_mask:0xf
v_add_f32_dpp v227, v227, v227 quad_perm:[2,3,0,1] row_mask:0xf bank_mask:0xf
v_cndmask_b32 v224, v224, v225, s[54:55]
v_cndmask_b32 v224, v224, v226, s[56:57]
v_cndmask_b32 v224, v224, v227, s[58:59]
v_mov_b32 v226, v2
v_mov_b32 v227, v2
v_mov_b32_dpp v225, v224 row_shl:4 row_mask:0xf bank_mask:0xf
buffer_store_dwordx4 v[224:227], v243, s[36:39], s53 offen offset:0 sc1
v_mfma_f32_16x16x32_bf16 v[120:123], v[32:35], a[0:3], 0
v_mfma_f32_16x16x32_bf16 v[120:123], v[36:39], a[8:11], v[120:123]
v_mfma_f32_16x16x32_bf16 v[120:123], v[40:43], a[16:19], v[120:123]
v_mfma_f32_16x16x32_bf16 v[120:123], v[44:47], a[24:27], v[120:123]
v_mfma_f32_16x16x32_bf16 v[124:127], v[32:35], a[4:7], 0
ds_read_b128 v[32:35], v1 offset:21504
v_mfma_f32_16x16x32_bf16 v[124:127], v[36:39], a[12:15], v[124:127]
ds_read_b128 v[36:39], v14 offset:21504
v_mfma_f32_16x16x32_bf16 v[124:127], v[40:43], a[20:23], v[124:127]
ds_read_b128 v[40:43], v15 offset:21504
v_mfma_f32_16x16x32_bf16 v[124:127], v[44:47], a[28:31], v[124:127]
ds_read_b128 v[44:47], v24 offset:21504
s_waitcnt lgkmcnt(4)
v_mfma_f32_16x16x32_bf16 v[128:131], v[48:51], a[0:3], 0
v_mfma_f32_16x16x32_bf16 v[128:131], v[52:55], a[8:11], v[128:131]
v_mfma_f32_16x16x32_bf16 v[128:131], v[56:59], a[16:19], v[128:131]
v_mfma_f32_16x16x32_bf16 v[128:131], v[60:63], a[24:27], v[128:131]
v_mfma_f32_16x16x32_bf16 v[132:135], v[48:51], a[4:7], 0
ds_read_b128 v[48:51], v1 offset:22528
v_mfma_f32_16x16x32_bf16 v[132:135], v[52:55], a[12:15], v[132:135]
ds_read_b128 v[52:55], v14 offset:22528
v_mfma_f32_16x16x32_bf16 v[132:135], v[56:59], a[20:23], v[132:135]
ds_read_b128 v[56:59], v15 offset:22528
v_mfma_f32_16x16x32_bf16 v[132:135], v[60:63], a[28:31], v[132:135]
ds_read_b128 v[60:63], v24 offset:22528
s_waitcnt lgkmcnt(4)
v_mfma_f32_16x16x32_bf16 v[136:139], v[32:35], a[0:3], 0
v_mfma_f32_16x16x32_bf16 v[136:139], v[36:39], a[8:11], v[136:139]
v_mfma_f32_16x16x32_bf16 v[136:139], v[40:43], a[16:19], v[136:139]
v_mfma_f32_16x16x32_bf16 v[136:139], v[44:47], a[24:27], v[136:139]
v_mfma_f32_16x16x32_bf16 v[140:143], v[32:35], a[4:7], 0
ds_read_b128 v[32:35], v1 offset:23552
v_mfma_f32_16x16x32_bf16 v[140:143], v[36:39], a[12:15], v[140:143]
ds_read_b128 v[36:39], v14 offset:23552
v_mfma_f32_16x16x32_bf16 v[140:143], v[40:43], a[20:23], v[140:143]
ds_read_b128 v[40:43], v15 offset:23552
v_mfma_f32_16x16x32_bf16 v[140:143], v[44:47], a[28:31], v[140:143]
ds_read_b128 v[44:47], v24 offset:23552
s_waitcnt lgkmcnt(4)
v_mfma_f32_16x16x32_bf16 v[144:147], v[48:51], a[0:3], 0
v_mfma_f32_16x16x32_bf16 v[144:147], v[52:55], a[8:11], v[144:147]
v_mfma_f32_16x16x32_bf16 v[144:147], v[56:59], a[16:19], v[144:147]
v_mfma_f32_16x16x32_bf16 v[144:147], v[60:63], a[24:27], v[144:147]
v_mfma_f32_16x16x32_bf16 v[148:151], v[48:51], a[4:7], 0
ds_read_b128 v[48:51], v1 offset:24576
v_mfma_f32_16x16x32_bf16 v[148:151], v[52:55], a[12:15], v[148:151]
ds_read_b128 v[52:55], v14 offset:24576
v_mfma_f32_16x16x32_bf16 v[148:151], v[56:59], a[20:23], v[148:151]
ds_read_b128 v[56:59], v15 offset:24576
v_mfma_f32_16x16x32_bf16 v[148:151], v[60:63], a[28:31], v[148:151]
ds_read_b128 v[60:63], v24 offset:24576
s_waitcnt lgkmcnt(4)
v_mfma_f32_16x16x32_bf16 v[152:155], v[32:35], a[0:3], 0
v_mfma_f32_16x16x32_bf16 v[152:155], v[36:39], a[8:11], v[152:155]
v_mfma_f32_16x16x32_bf16 v[152:155], v[40:43], a[16:19], v[152:155]
v_mfma_f32_16x16x32_bf16 v[152:155], v[44:47], a[24:27], v[152:155]
v_mfma_f32_16x16x32_bf16 v[156:159], v[32:35], a[4:7], 0
ds_read_b128 v[32:35], v1 offset:25600
v_mfma_f32_16x16x32_bf16 v[156:159], v[36:39], a[12:15], v[156:159]
ds_read_b128 v[36:39], v14 offset:25600
v_mfma_f32_16x16x32_bf16 v[156:159], v[40:43], a[20:23], v[156:159]
ds_read_b128 v[40:43], v15 offset:25600
v_mfma_f32_16x16x32_bf16 v[156:159], v[44:47], a[28:31], v[156:159]
ds_read_b128 v[44:47], v24 offset:25600
s_waitcnt lgkmcnt(4)
v_mfma_f32_16x16x32_bf16 v[160:163], v[48:51], a[0:3], 0
v_mfma_f32_16x16x32_bf16 v[160:163], v[52:55], a[8:11], v[160:163]
v_mfma_f32_16x16x32_bf16 v[160:163], v[56:59], a[16:19], v[160:163]
v_mfma_f32_16x16x32_bf16 v[160:163], v[60:63], a[24:27], v[160:163]
s_waitcnt vmcnt(22) lgkmcnt(0)
s_barrier
v_mfma_f32_16x16x32_bf16 v[164:167], v[48:51], a[4:7], 0
ds_read_b128 v[48:51], v1 offset:26624
v_mfma_f32_16x16x32_bf16 v[164:167], v[52:55], a[12:15], v[164:167]
ds_read_b128 v[52:55], v14 offset:26624
v_readlane_b32 s67, v26, 13
v_mfma_f32_16x16x32_bf16 v[164:167], v[56:59], a[20:23], v[164:167]
ds_read_b128 v[56:59], v15 offset:26624
s_add_u32 m0, s48, 19456
v_mfma_f32_16x16x32_bf16 v[164:167], v[60:63], a[28:31], v[164:167]
ds_read_b128 v[60:63], v24 offset:26624
v_mfma_f32_16x16x32_bf16 v[168:171], v[32:35], a[0:3], 0
buffer_load_dwordx4 v1, s[36:39], s67 offen offset:0 sc1 lds
v_mfma_f32_16x16x32_bf16 v[168:171], v[36:39], a[8:11], v[168:171]
v_mfma_f32_16x16x32_bf16 v[168:171], v[40:43], a[16:19], v[168:171]
buffer_load_dwordx4 v1, s[36:39], s67 offen offset:1024 sc1 lds
v_mfma_f32_16x16x32_bf16 v[168:171], v[44:47], a[24:27], v[168:171]
v_mfma_f32_16x16x32_bf16 v[172:175], v[32:35], a[4:7], 0
ds_read_b128 v[32:35], v1 offset:27648
v_mfma_f32_16x16x32_bf16 v[172:175], v[36:39], a[12:15], v[172:175]
ds_read_b128 v[36:39], v14 offset:27648
v_mfma_f32_16x16x32_bf16 v[172:175], v[40:43], a[20:23], v[172:175]
ds_read_b128 v[40:43], v15 offset:27648
v_mfma_f32_16x16x32_bf16 v[172:175], v[44:47], a[28:31], v[172:175]
ds_read_b128 v[44:47], v24 offset:27648
s_waitcnt lgkmcnt(4)
v_mfma_f32_16x16x32_bf16 v[120:123], v[48:51], a[32:35], v[120:123]
buffer_load_dwordx4 v1, s[36:39], s67 offen offset:2048 sc1 lds
v_mfma_f32_16x16x32_bf16 v[120:123], v[52:55], a[40:43], v[120:123]
v_mfma_f32_16x16x32_bf16 v[120:123], v[56:59], a[48:51], v[120:123]
buffer_load_dwordx4 v1, s[36:39], s67 offen offset:3072 sc1 lds
v_mfma_f32_16x16x32_bf16 v[120:123], v[60:63], a[56:59], v[120:123]
v_mfma_f32_16x16x32_bf16 v[124:127], v[48:51], a[36:39], v[124:127]
ds_read_b128 v[48:51], v1 offset:28672
v_mfma_f32_16x16x32_bf16 v[124:127], v[52:55], a[44:47], v[124:127]
ds_read_b128 v[52:55], v14 offset:28672
v_mfma_f32_16x16x32_bf16 v[124:127], v[56:59], a[52:55], v[124:127]
ds_read_b128 v[56:59], v15 offset:28672
v_mfma_f32_16x16x32_bf16 v[124:127], v[60:63], a[60:63], v[124:127]
ds_read_b128 v[60:63], v24 offset:28672
s_waitcnt lgkmcnt(4)
v_mfma_f32_16x16x32_bf16 v[128:131], v[32:35], a[32:35], v[128:131]
buffer_load_dwordx4 v[192:195], v1, s[36:39], s60 offen offset:0 sc1
v_mfma_f32_16x16x32_bf16 v[128:131], v[36:39], a[40:43], v[128:131]
v_mfma_f32_16x16x32_bf16 v[128:131], v[40:43], a[48:51], v[128:131]
buffer_load_dwordx4 v[196:199], v1, s[36:39], s60 offen offset:1024 sc1
v_mfma_f32_16x16x32_bf16 v[128:131], v[44:47], a[56:59], v[128:131]
v_mfma_f32_16x16x32_bf16 v[132:135], v[32:35], a[36:39], v[132:135]
ds_read_b128 v[32:35], v1 offset:29696
v_mfma_f32_16x16x32_bf16 v[132:135], v[36:39], a[44:47], v[132:135]
ds_read_b128 v[36:39], v14 offset:29696
v_mfma_f32_16x16x32_bf16 v[132:135], v[40:43], a[52:55], v[132:135]
ds_read_b128 v[40:43], v15 offset:29696
v_mfma_f32_16x16x32_bf16 v[132:135], v[44:47], a[60:63], v[132:135]
ds_read_b128 v[44:47], v24 offset:29696
s_waitcnt lgkmcnt(4)
v_mfma_f32_16x16x32_bf16 v[136:139], v[48:51], a[32:35], v[136:139]
buffer_load_dwordx4 v[200:203], v1, s[36:39], s60 offen offset:2048 sc1
v_mfma_f32_16x16x32_bf16 v[136:139], v[52:55], a[40:43], v[136:139]
v_mfma_f32_16x16x32_bf16 v[136:139], v[56:59], a[48:51], v[136:139]
buffer_load_dwordx4 v[204:207], v1, s[36:39], s60 offen offset:3072 sc1
v_mfma_f32_16x16x32_bf16 v[136:139], v[60:63], a[56:59], v[136:139]
v_mfma_f32_16x16x32_bf16 v[140:143], v[48:51], a[36:39], v[140:143]
ds_read_b128 v[48:51], v1 offset:30720
v_mfma_f32_16x16x32_bf16 v[140:143], v[52:55], a[44:47], v[140:143]
ds_read_b128 v[52:55], v14 offset:30720
v_mfma_f32_16x16x32_bf16 v[140:143], v[56:59], a[52:55], v[140:143]
ds_read_b128 v[56:59], v15 offset:30720
v_mfma_f32_16x16x32_bf16 v[140:143], v[60:63], a[60:63], v[140:143]
ds_read_b128 v[60:63], v24 offset:30720
s_waitcnt lgkmcnt(4)
v_mfma_f32_16x16x32_bf16 v[144:147], v[32:35], a[32:35], v[144:147]
buffer_load_dwordx4 v[208:211], v13, s[36:39], s60 offen offset:0 sc1
v_mfma_f32_16x16x32_bf16 v[144:147], v[36:39], a[40:43], v[144:147]
v_mfma_f32_16x16x32_bf16 v[144:147], v[40:43], a[48:51], v[144:147]
buffer_load_dwordx4 v[212:215], v13, s[36:39], s60 offen offset:1024 sc1
v_mfma_f32_16x16x32_bf16 v[144:147], v[44:47], a[56:59], v[144:147]
v_mfma_f32_16x16x32_bf16 v[148:151], v[32:35], a[36:39], v[148:151]
ds_read_b128 v[32:35], v1 offset:31744
v_mfma_f32_16x16x32_bf16 v[148:151], v[36:39], a[44:47], v[148:151]
ds_read_b128 v[36:39], v14 offset:31744
v_mfma_f32_16x16x32_bf16 v[148:151], v[40:43], a[52:55], v[148:151]
ds_read_b128 v[40:43], v15 offset:31744
v_mfma_f32_16x16x32_bf16 v[148:151], v[44:47], a[60:63], v[148:151]
ds_read_b128 v[44:47], v24 offset:31744
s_waitcnt lgkmcnt(4)
v_mfma_f32_16x16x32_bf16 v[152:155], v[48:51], a[32:35], v[152:155]
buffer_load_dwordx4 v[216:219], v13, s[36:39], s60 offen offset:2048 sc1
v_mfma_f32_16x16x32_bf16 v[152:155], v[52:55], a[40:43], v[152:155]
v_mfma_f32_16x16x32_bf16 v[152:155], v[56:59], a[48:51], v[152:155]
buffer_load_dwordx4 v[220:223], v13, s[36:39], s60 offen offset:3072 sc1
v_mfma_f32_16x16x32_bf16 v[152:155], v[60:63], a[56:59], v[152:155]
v_mfma_f32_16x16x32_bf16 v[156:159], v[48:51], a[36:39], v[156:159]
ds_read_b128 v[48:51], v1 offset:32768
v_mfma_f32_16x16x32_bf16 v[156:159], v[52:55], a[44:47], v[156:159]
ds_read_b128 v[52:55], v14 offset:32768
v_mfma_f32_16x16x32_bf16 v[156:159], v[56:59], a[52:55], v[156:159]
ds_read_b128 v[56:59], v15 offset:32768
s_add_u32 m0, s48, 23552
v_mfma_f32_16x16x32_bf16 v[156:159], v[60:63], a[60:63], v[156:159]
ds_read_b128 v[60:63], v24 offset:32768
s_waitcnt lgkmcnt(4)
v_mfma_f32_16x16x32_bf16 v[160:163], v[32:35], a[32:35], v[160:163]
buffer_load_dwordx4 v13, s[36:39], s67 offen offset:0 sc1 lds
v_mfma_f32_16x16x32_bf16 v[160:163], v[36:39], a[40:43], v[160:163]
v_mfma_f32_16x16x32_bf16 v[160:163], v[40:43], a[48:51], v[160:163]
buffer_load_dwordx4 v13, s[36:39], s67 offen offset:1024 sc1 lds
v_mfma_f32_16x16x32_bf16 v[160:163], v[44:47], a[56:59], v[160:163]
s_waitcnt vmcnt(29) lgkmcnt(0)
s_barrier
v_mfma_f32_16x16x32_bf16 v[164:167], v[32:35], a[36:39], v[164:167]
ds_read_b128 v[32:35], v1 offset:33792
TP47:
s_cbranch_execz TP6
TP48:
s_cbranch_execz TP56
v_mfma_f32_16x16x32_bf16 v[164:167], v[36:39], a[44:47], v[164:167]
ds_read_b128 v[36:39], v14 offset:33792
v_mfma_f32_16x16x32_bf16 v[164:167], v[40:43], a[52:55], v[164:167]
ds_read_b128 v[40:43], v15 offset:33792
v_readlane_b32 s51, v26, 14
v_mfma_f32_16x16x32_bf16 v[164:167], v[44:47], a[60:63], v[164:167]
ds_read_b128 v[44:47], v24 offset:33792
v_mfma_f32_16x16x32_bf16 v[168:171], v[48:51], a[32:35], v[168:171]
buffer_load_dwordx4 v13, s[36:39], s67 offen offset:2048 sc1 lds
v_mfma_f32_16x16x32_bf16 v[168:171], v[52:55], a[40:43], v[168:171]
s_add_u32 m0, s48, 26624
v_mfma_f32_16x16x32_bf16 v[168:171], v[56:59], a[48:51], v[168:171]
buffer_load_dwordx4 v1, s[36:39], s51 offen offset:0 sc1 lds
v_mfma_f32_16x16x32_bf16 v[168:171], v[60:63], a[56:59], v[168:171]
v_mfma_f32_16x16x32_bf16 v[172:175], v[48:51], a[36:39], v[172:175]
ds_read_b128 v[48:51], v1 offset:34816
v_mfma_f32_16x16x32_bf16 v[172:175], v[52:55], a[44:47], v[172:175]
ds_read_b128 v[52:55], v14 offset:34816
v_mfma_f32_16x16x32_bf16 v[172:175], v[56:59], a[52:55], v[172:175]
ds_read_b128 v[56:59], v15 offset:34816
v_mfma_f32_16x16x32_bf16 v[172:175], v[60:63], a[60:63], v[172:175]
ds_read_b128 v[60:63], v24 offset:34816
s_waitcnt lgkmcnt(4)
v_mfma_f32_16x16x32_bf16 v[120:123], v[32:35], a[64:67], v[120:123]
buffer_load_dwordx4 v1, s[36:39], s51 offen offset:1024 sc1 lds
v_mfma_f32_16x16x32_bf16 v[120:123], v[36:39], a[72:75], v[120:123]
v_mfma_f32_16x16x32_bf16 v[120:123], v[40:43], a[80:83], v[120:123]
buffer_load_dwordx4 v1, s[36:39], s51 offen offset:2048 sc1 lds
v_mfma_f32_16x16x32_bf16 v[120:123], v[44:47], a[88:91], v[120:123]
v_mfma_f32_16x16x32_bf16 v[124:127], v[32:35], a[68:71], v[124:127]
ds_read_b128 v[32:35], v1 offset:35840
v_mfma_f32_16x16x32_bf16 v[124:127], v[36:39], a[76:79], v[124:127]
ds_read_b128 v[36:39], v14 offset:35840
v_mfma_f32_16x16x32_bf16 v[124:127], v[40:43], a[84:87], v[124:127]
ds_read_b128 v[40:43], v15 offset:35840
v_mfma_f32_16x16x32_bf16 v[124:127], v[44:47], a[92:95], v[124:127]
ds_read_b128 v[44:47], v24 offset:35840
s_waitcnt lgkmcnt(4)
v_mfma_f32_16x16x32_bf16 v[128:131], v[48:51], a[64:67], v[128:131]
buffer_load_dwordx4 v1, s[36:39], s51 offen offset:3072 sc1 lds
v_mfma_f32_16x16x32_bf16 v[128:131], v[52:55], a[72:75], v[128:131]
s_add_u32 m0, s48, 30720
v_mfma_f32_16x16x32_bf16 v[128:131], v[56:59], a[80:83], v[128:131]
buffer_load_dwordx4 v13, s[36:39], s51 offen offset:0 sc1 lds
v_mfma_f32_16x16x32_bf16 v[128:131], v[60:63], a[88:91], v[128:131]
v_mfma_f32_16x16x32_bf16 v[132:135], v[48:51], a[68:71], v[132:135]
ds_read_b128 v[48:51], v1 offset:36864
v_mfma_f32_16x16x32_bf16 v[132:135], v[52:55], a[76:79], v[132:135]
ds_read_b128 v[52:55], v14 offset:36864
v_readlane_b32 s50, v28, 0
v_mfma_f32_16x16x32_bf16 v[132:135], v[56:59], a[84:87], v[132:135]
ds_read_b128 v[56:59], v15 offset:36864
s_waitcnt vmcnt(8)
v_mfma_f32_16x16x32_bf16 v[132:135], v[60:63], a[92:95], v[132:135]
ds_read_b128 v[60:63], v24 offset:36864
s_waitcnt lgkmcnt(4)
v_mfma_f32_16x16x32_bf16 v[136:139], v[32:35], a[64:67], v[136:139]
buffer_load_dwordx4 v13, s[36:39], s51 offen offset:1024 sc1 lds
v_mfma_f32_16x16x32_bf16 v[136:139], v[36:39], a[72:75], v[136:139]
v_bitop3_b32 v3, v194, v2, v198 bitop3:0x7e
v_bitop3_b32 v3, v202, v2, v3 bitop3:0xbe
v_mfma_f32_16x16x32_bf16 v[136:139], v[40:43], a[80:83], v[136:139]
buffer_load_dwordx4 v13, s[36:39], s51 offen offset:2048 sc1 lds
v_mfma_f32_16x16x32_bf16 v[136:139], v[44:47], a[88:91], v[136:139]
v_bitop3_b32 v3, v206, v2, v3 bitop3:0xbe
v_bitop3_b32 v3, v210, v2, v3 bitop3:0xbe
v_mfma_f32_16x16x32_bf16 v[140:143], v[32:35], a[68:71], v[140:143]
ds_read_b128 v[32:35], v1 offset:37888
v_bitop3_b32 v3, v214, v2, v3 bitop3:0xbe
v_mfma_f32_16x16x32_bf16 v[140:143], v[36:39], a[76:79], v[140:143]
ds_read_b128 v[36:39], v14 offset:37888
v_bitop3_b32 v3, v218, v2, v3 bitop3:0xbe
v_mfma_f32_16x16x32_bf16 v[140:143], v[40:43], a[84:87], v[140:143]
ds_read_b128 v[40:43], v15 offset:37888
v_bitop3_b32 v3, v222, v2, v3 bitop3:0xbe
v_mfma_f32_16x16x32_bf16 v[140:143], v[44:47], a[92:95], v[140:143]
ds_read_b128 v[44:47], v24 offset:37888
s_waitcnt lgkmcnt(4)
v_mfma_f32_16x16x32_bf16 v[144:147], v[48:51], a[64:67], v[144:147]
buffer_load_dwordx4 a[0:3], v1, s[36:39], s50 offen offset:0 sc1
v_mfma_f32_16x16x32_bf16 v[144:147], v[52:55], a[72:75], v[144:147]
v_cmp_ne_u32 vcc, 0, v3
v_mfma_f32_16x16x32_bf16 v[144:147], v[56:59], a[80:83], v[144:147]
buffer_load_dwordx4 a[4:7], v1, s[36:39], s50 offen offset:1024 sc1
v_mfma_f32_16x16x32_bf16 v[144:147], v[60:63], a[88:91], v[144:147]
v_readlane_b32 s67, v26, 15
s_add_u32 m0, s48, 33792
v_mfma_f32_16x16x32_bf16 v[148:151], v[48:51], a[68:71], v[148:151]
ds_read_b128 v[48:51], v1 offset:38912
s_cbranch_vccnz RT_ZG
RT_ZG_B:
v_mfma_f32_16x16x32_bf16 v[148:151], v[52:55], a[76:79], v[148:151]
ds_read_b128 v[52:55], v14 offset:38912
v_add_f32 v192, v192, v208
v_mfma_f32_16x16x32_bf16 v[148:151], v[56:59], a[84:87], v[148:151]
ds_read_b128 v[56:59], v15 offset:38912
v_add_f32 v193, v193, v209
v_mfma_f32_16x16x32_bf16 v[148:151], v[60:63], a[92:95], v[148:151]
ds_read_b128 v[60:63], v24 offset:38912
s_waitcnt lgkmcnt(4)
v_mfma_f32_16x16x32_bf16 v[152:155], v[32:35], a[64:67], v[152:155]
buffer_load_dwordx4 a[8:11], v1, s[36:39], s50 offen offset:2048 sc1
v_mfma_f32_16x16x32_bf16 v[152:155], v[36:39], a[72:75], v[152:155]
v_add_f32 v196, v196, v212
v_add_f32 v197, v197, v213
v_mfma_f32_16x16x32_bf16 v[152:155], v[40:43], a[80:83], v[152:155]
buffer_load_dwordx4 a[12:15], v1, s[36:39], s50 offen offset:3072 sc1
v_mfma_f32_16x16x32_bf16 v[152:155], v[44:47], a[88:91], v[152:155]
v_add_f32 v200, v200, v216
v_add_f32 v201, v201, v217
v_mfma_f32_16x16x32_bf16 v[156:159], v[32:35], a[68:71], v[156:159]
ds_read_b128 v[32:35], v1 offset:39936
v_add_f32 v204, v204, v220
v_mfma_f32_16x16x32_bf16 v[156:159], v[36:39], a[76:79], v[156:159]
ds_read_b128 v[36:39], v14 offset:39936
v_add_f32 v205, v205, v221
v_mfma_f32_16x16x32_bf16 v[156:159], v[40:43], a[84:87], v[156:159]
ds_read_b128 v[40:43], v15 offset:39936
v_add_f32 v192, v192, v200
v_mfma_f32_16x16x32_bf16 v[156:159], v[44:47], a[92:95], v[156:159]
ds_read_b128 v[44:47], v24 offset:39936
s_waitcnt lgkmcnt(4)
v_mfma_f32_16x16x32_bf16 v[160:163], v[48:51], a[64:67], v[160:163]
buffer_load_dwordx4 a[16:19], v13, s[36:39], s50 offen offset:0 sc1
v_mfma_f32_16x16x32_bf16 v[160:163], v[52:55], a[72:75], v[160:163]
v_add_f32 v193, v193, v201
v_add_f32 v196, v196, v204
v_mfma_f32_16x16x32_bf16 v[160:163], v[56:59], a[80:83], v[160:163]
buffer_load_dwordx4 a[20:23], v13, s[36:39], s50 offen offset:1024 sc1
v_mfma_f32_16x16x32_bf16 v[160:163], v[60:63], a[88:91], v[160:163]
s_waitcnt lgkmcnt(0)
s_barrier
v_mfma_f32_16x16x32_bf16 v[164:167], v[48:51], a[68:71], v[164:167]
ds_read_b128 v[48:51], v1 offset:5120
v_add_f32 v197, v197, v205
v_mfma_f32_16x16x32_bf16 v[164:167], v[52:55], a[76:79], v[164:167]
ds_read_b128 v[52:55], v14 offset:5120
v_add_f32 v192, v192, v196
v_mfma_f32_16x16x32_bf16 v[164:167], v[56:59], a[84:87], v[164:167]
ds_read_b128 v[56:59], v15 offset:5120
v_add_f32 v193, v193, v197
v_mfma_f32_16x16x32_bf16 v[164:167], v[60:63], a[92:95], v[164:167]
ds_read_b128 v[60:63], v24 offset:5120
v_mfma_f32_16x16x32_bf16 v[168:171], v[32:35], a[64:67], v[168:171]
buffer_load_dwordx4 v1, s[36:39], s67 offen offset:0 sc1 lds
v_mfma_f32_16x16x32_bf16 v[168:171], v[36:39], a[72:75], v[168:171]
v_mov_b32 v194, v192
v_mov_b32 v195, v193
v_mfma_f32_16x16x32_bf16 v[168:171], v[40:43], a[80:83], v[168:171]
buffer_load_dwordx4 v1, s[36:39], s67 offen offset:1024 sc1 lds
v_mfma_f32_16x16x32_bf16 v[168:171], v[44:47], a[88:91], v[168:171]
v_permlane32_swap_b32 v194, v192
v_permlane32_swap_b32 v195, v193
v_mfma_f32_16x16x32_bf16 v[172:175], v[32:35], a[68:71], v[172:175]
ds_read_b128 v[32:35], v1 offset:6144
v_add_f32 v192, v194, v192
v_mfma_f32_16x16x32_bf16 v[172:175], v[36:39], a[76:79], v[172:175]
ds_read_b128 v[36:39], v14 offset:6144
v_add_f32 v193, v195, v193
v_mfma_f32_16x16x32_bf16 v[172:175], v[40:43], a[84:87], v[172:175]
ds_read_b128 v[40:43], v15 offset:6144
v_mul_f32 v192, 0xba124925, v192
v_mfma_f32_16x16x32_bf16 v[172:175], v[44:47], a[92:95], v[172:175]
ds_read_b128 v[44:47], v24 offset:6144
s_waitcnt lgkmcnt(4)
v_mfma_f32_16x16x32_bf16 v[120:123], v[48:51], a[96:99], v[120:123]
buffer_load_dwordx4 v1, s[36:39], s67 offen offset:2048 sc1 lds
v_mfma_f32_16x16x32_bf16 v[120:123], v[52:55], a[104:107], v[120:123]
v_mul_f32 v193, 0x3a124925, v193
v_fma_f32 v193, -v192, v192, v193
v_mfma_f32_16x16x32_bf16 v[120:123], v[56:59], a[112:115], v[120:123]
buffer_load_dwordx4 v1, s[36:39], s67 offen offset:3072 sc1 lds
v_mfma_f32_16x16x32_bf16 v[120:123], v[60:63], a[120:123], v[120:123]
v_max_f32 v193, 0, v193
v_add_f32 v193, 0x3727c5ac, v193
v_mfma_f32_16x16x32_bf16 v[124:127], v[48:51], a[100:103], v[124:127]
ds_read_b128 v[48:51], v1 offset:7168
v_mfma_f32_16x16x32_bf16 v[124:127], v[52:55], a[108:111], v[124:127]
ds_read_b128 v[52:55], v14 offset:7168
v_mfma_f32_16x16x32_bf16 v[124:127], v[56:59], a[116:119], v[124:127]
ds_read_b128 v[56:59], v15 offset:7168
s_add_u32 m0, s48, 37888
v_mfma_f32_16x16x32_bf16 v[124:127], v[60:63], a[124:127], v[124:127]
ds_read_b128 v[60:63], v24 offset:7168
s_waitcnt lgkmcnt(4)
v_mfma_f32_16x16x32_bf16 v[128:131], v[32:35], a[96:99], v[128:131]
buffer_load_dwordx4 v13, s[36:39], s67 offen offset:0 sc1 lds
v_mfma_f32_16x16x32_bf16 v[128:131], v[36:39], a[104:107], v[128:131]
v_rsq_f32 v194, v193
v_mfma_f32_16x16x32_bf16 v[128:131], v[40:43], a[112:115], v[128:131]
buffer_load_dwordx4 v13, s[36:39], s67 offen offset:1024 sc1 lds
v_mfma_f32_16x16x32_bf16 v[128:131], v[44:47], a[120:123], v[128:131]
v_mul_f32 v192, v192, v194
v_mfma_f32_16x16x32_bf16 v[132:135], v[32:35], a[100:103], v[132:135]
ds_read_b128 v[32:35], v1 offset:8192
ds_write_b32 v249, v194 offset:1536
v_mfma_f32_16x16x32_bf16 v[132:135], v[36:39], a[108:111], v[132:135]
ds_read_b128 v[36:39], v14 offset:8192
ds_write_b32 v249, v192 offset:1664
v_mfma_f32_16x16x32_bf16 v[132:135], v[40:43], a[116:119], v[132:135]
ds_read_b128 v[40:43], v15 offset:8192
ds_read_b128 v[224:227], v245 offset:1536
v_mfma_f32_16x16x32_bf16 v[132:135], v[44:47], a[124:127], v[132:135]
ds_read_b128 v[44:47], v24 offset:8192
s_waitcnt lgkmcnt(7)
v_mfma_f32_16x16x32_bf16 v[136:139], v[48:51], a[96:99], v[136:139]
buffer_load_dwordx4 v13, s[36:39], s67 offen offset:2048 sc1 lds
v_mfma_f32_16x16x32_bf16 v[136:139], v[52:55], a[104:107], v[136:139]
ds_read_b128 v[228:231], v245 offset:1600
ds_read_b128 v[232:235], v245 offset:1664
v_mfma_f32_16x16x32_bf16 v[136:139], v[56:59], a[112:115], v[136:139]
buffer_load_dwordx4 a[24:27], v13, s[36:39], s50 offen offset:2048 sc1
v_mfma_f32_16x16x32_bf16 v[136:139], v[60:63], a[120:123], v[136:139]
ds_read_b128 v[236:239], v245 offset:1728
v_mfma_f32_16x16x32_bf16 v[140:143], v[48:51], a[100:103], v[140:143]
ds_read_b128 v[48:51], v1 offset:9216
v_mfma_f32_16x16x32_bf16 v[140:143], v[52:55], a[108:111], v[140:143]
ds_read_b128 v[52:55], v14 offset:9216
v_mfma_f32_16x16x32_bf16 v[140:143], v[56:59], a[116:119], v[140:143]
ds_read_b128 v[56:59], v15 offset:9216
v_readlane_b32 s66, v28, 1
v_mfma_f32_16x16x32_bf16 v[140:143], v[60:63], a[124:127], v[140:143]
ds_read_b128 v[60:63], v24 offset:9216
s_waitcnt lgkmcnt(7)
v_mfma_f32_16x16x32_bf16 v[144:147], v[32:35], a[96:99], v[144:147]
buffer_load_dwordx4 a[28:31], v13, s[36:39], s50 offen offset:3072 sc1
v_mfma_f32_16x16x32_bf16 v[144:147], v[36:39], a[104:107], v[144:147]
v_mfma_f32_16x16x32_bf16 v[144:147], v[40:43], a[112:115], v[144:147]
buffer_load_dwordx4 a[32:35], v1, s[36:39], s66 offen offset:0 sc1
v_mfma_f32_16x16x32_bf16 v[144:147], v[44:47], a[120:123], v[144:147]
v_mfma_f32_16x16x32_bf16 v[148:151], v[32:35], a[100:103], v[148:151]
ds_read_b128 v[32:35], v1 offset:10240
v_mfma_f32_16x16x32_bf16 v[148:151], v[36:39], a[108:111], v[148:151]
ds_read_b128 v[36:39], v14 offset:10240
v_mfma_f32_16x16x32_bf16 v[148:151], v[40:43], a[116:119], v[148:151]
ds_read_b128 v[40:43], v15 offset:10240
v_mfma_f32_16x16x32_bf16 v[148:151], v[44:47], a[124:127], v[148:151]
ds_read_b128 v[44:47], v24 offset:10240
s_waitcnt lgkmcnt(4)
v_mfma_f32_16x16x32_bf16 v[152:155], v[48:51], a[96:99], v[152:155]
buffer_load_dwordx4 a[36:39], v1, s[36:39], s66 offen offset:1024 sc1
v_mfma_f32_16x16x32_bf16 v[152:155], v[52:55], a[104:107], v[152:155]
v_mfma_f32_16x16x32_bf16 v[152:155], v[56:59], a[112:115], v[152:155]
buffer_load_dwordx4 a[40:43], v1, s[36:39], s66 offen offset:2048 sc1
v_mfma_f32_16x16x32_bf16 v[152:155], v[60:63], a[120:123], v[152:155]
v_mfma_f32_16x16x32_bf16 v[156:159], v[48:51], a[100:103], v[156:159]
ds_read_b128 v[48:51], v1 offset:11264
v_mfma_f32_16x16x32_bf16 v[156:159], v[52:55], a[108:111], v[156:159]
ds_read_b128 v[52:55], v14 offset:11264
v_mfma_f32_16x16x32_bf16 v[156:159], v[56:59], a[116:119], v[156:159]
ds_read_b128 v[56:59], v15 offset:11264
v_mfma_f32_16x16x32_bf16 v[156:159], v[60:63], a[124:127], v[156:159]
ds_read_b128 v[60:63], v24 offset:11264
s_waitcnt lgkmcnt(4)
v_pk_fma_f32 v[64:65], v[64:65], v[224:225], v[232:233]
v_pk_fma_f32 v[66:67], v[66:67], v[226:227], v[234:235]
v_pk_fma_f32 v[68:69], v[68:69], v[228:229], v[236:237]
v_pk_fma_f32 v[70:71], v[70:71], v[230:231], v[238:239]
v_cvt_pk_bf16_f32 v64, v64, v65
v_cvt_pk_bf16_f32 v65, v66, v67
v_cvt_pk_bf16_f32 v66, v68, v69
v_cvt_pk_bf16_f32 v67, v70, v71
buffer_store_dwordx4 v[64:67], v1, s[36:39], s65 offen offset:0 sc1
v_pk_fma_f32 v[72:73], v[72:73], v[224:225], v[232:233]
v_pk_fma_f32 v[74:75], v[74:75], v[226:227], v[234:235]
v_pk_fma_f32 v[76:77], v[76:77], v[228:229], v[236:237]
v_pk_fma_f32 v[78:79], v[78:79], v[230:231], v[238:239]
v_cvt_pk_bf16_f32 v72, v72, v73
v_cvt_pk_bf16_f32 v73, v74, v75
v_cvt_pk_bf16_f32 v74, v76, v77
v_cvt_pk_bf16_f32 v75, v78, v79
buffer_store_dwordx4 v[72:75], v1, s[36:39], s65 offen offset:1024 sc1
v_pk_fma_f32 v[80:81], v[80:81], v[224:225], v[232:233]
v_pk_fma_f32 v[82:83], v[82:83], v[226:227], v[234:235]
v_pk_fma_f32 v[84:85], v[84:85], v[228:229], v[236:237]
v_pk_fma_f32 v[86:87], v[86:87], v[230:231], v[238:239]
v_cvt_pk_bf16_f32 v80, v80, v81
v_cvt_pk_bf16_f32 v81, v82, v83
v_cvt_pk_bf16_f32 v82, v84, v85
v_cvt_pk_bf16_f32 v83, v86, v87
buffer_store_dwordx4 v[80:83], v1, s[36:39], s65 offen offset:2048 sc1
v_pk_fma_f32 v[88:89], v[88:89], v[224:225], v[232:233]
v_pk_fma_f32 v[90:91], v[90:91], v[226:227], v[234:235]
v_pk_fma_f32 v[92:93], v[92:93], v[228:229], v[236:237]
v_pk_fma_f32 v[94:95], v[94:95], v[230:231], v[238:239]
v_cvt_pk_bf16_f32 v88, v88, v89
v_cvt_pk_bf16_f32 v89, v90, v91
v_cvt_pk_bf16_f32 v90, v92, v93
v_cvt_pk_bf16_f32 v91, v94, v95
buffer_store_dwordx4 v[88:91], v1, s[36:39], s65 offen offset:3072 sc1
v_pk_fma_f32 v[96:97], v[96:97], v[224:225], v[232:233]
v_pk_fma_f32 v[98:99], v[98:99], v[226:227], v[234:235]
v_pk_fma_f32 v[100:101], v[100:101], v[228:229], v[236:237]
v_pk_fma_f32 v[102:103], v[102:103], v[230:231], v[238:239]
v_cvt_pk_bf16_f32 v96, v96, v97
v_cvt_pk_bf16_f32 v97, v98, v99
v_cvt_pk_bf16_f32 v98, v100, v101
v_cvt_pk_bf16_f32 v99, v102, v103
buffer_store_dwordx4 v[96:99], v13, s[36:39], s65 offen offset:0 sc1
v_pk_fma_f32 v[104:105], v[104:105], v[224:225], v[232:233]
v_pk_fma_f32 v[106:107], v[106:107], v[226:227], v[234:235]
v_pk_fma_f32 v[108:109], v[108:109], v[228:229], v[236:237]
v_pk_fma_f32 v[110:111], v[110:111], v[230:231], v[238:239]
v_cvt_pk_bf16_f32 v104, v104, v105
v_cvt_pk_bf16_f32 v105, v106, v107
v_cvt_pk_bf16_f32 v106, v108, v109
v_cvt_pk_bf16_f32 v107, v110, v111
buffer_store_dwordx4 v[104:107], v13, s[36:39], s65 offen offset:1024 sc1
v_pk_fma_f32 v[112:113], v[112:113], v[224:225], v[232:233]
v_pk_fma_f32 v[114:115], v[114:115], v[226:227], v[234:235]
v_pk_fma_f32 v[116:117], v[116:117], v[228:229], v[236:237]
v_pk_fma_f32 v[118:119], v[118:119], v[230:231], v[238:239]
v_cvt_pk_bf16_f32 v112, v112, v113
v_cvt_pk_bf16_f32 v113, v114, v115
v_cvt_pk_bf16_f32 v114, v116, v117
v_cvt_pk_bf16_f32 v115, v118, v119
buffer_store_dwordx4 v[112:115], v13, s[36:39], s65 offen offset:2048 sc1
v_mfma_f32_16x16x32_bf16 v[160:163], v[32:35], a[96:99], v[160:163]
v_mfma_f32_16x16x32_bf16 v[160:163], v[36:39], a[104:107], v[160:163]
v_mfma_f32_16x16x32_bf16 v[160:163], v[40:43], a[112:115], v[160:163]
v_mfma_f32_16x16x32_bf16 v[160:163], v[44:47], a[120:123], v[160:163]
s_waitcnt lgkmcnt(0)
s_barrier
v_mfma_f32_16x16x32_bf16 v[164:167], v[32:35], a[100:103], v[164:167]
ds_read_b128 v[32:35], v1 offset:12288
ds_write_b128 v8, v[64:67] offset:5120
v_mfma_f32_16x16x32_bf16 v[164:167], v[36:39], a[108:111], v[164:167]
ds_read_b128 v[36:39], v14 offset:12288
v_mfma_f32_16x16x32_bf16 v[164:167], v[40:43], a[116:119], v[164:167]
ds_read_b128 v[40:43], v15 offset:12288
v_mfma_f32_16x16x32_bf16 v[164:167], v[44:47], a[124:127], v[164:167]
ds_read_b128 v[44:47], v24 offset:12288
v_mfma_f32_16x16x32_bf16 v[168:171], v[48:51], a[96:99], v[168:171]
v_mfma_f32_16x16x32_bf16 v[168:171], v[52:55], a[104:107], v[168:171]
v_mfma_f32_16x16x32_bf16 v[168:171], v[56:59], a[112:115], v[168:171]
v_mfma_f32_16x16x32_bf16 v[168:171], v[60:63], a[120:123], v[168:171]
v_mfma_f32_16x16x32_bf16 v[172:175], v[48:51], a[100:103], v[172:175]
ds_read_b128 v[48:51], v1 offset:13312
ds_write_b128 v8, v[72:75] offset:6144
v_mfma_f32_16x16x32_bf16 v[172:175], v[52:55], a[108:111], v[172:175]
ds_read_b128 v[52:55], v14 offset:13312
v_mfma_f32_16x16x32_bf16 v[172:175], v[56:59], a[116:119], v[172:175]
ds_read_b128 v[56:59], v15 offset:13312
v_mfma_f32_16x16x32_bf16 v[172:175], v[60:63], a[124:127], v[172:175]
ds_read_b128 v[60:63], v24 offset:13312
s_waitcnt lgkmcnt(5)
v_mfma_f32_16x16x32_bf16 v[120:123], v[32:35], a[128:131], v[120:123]
v_mfma_f32_16x16x32_bf16 v[120:123], v[36:39], a[136:139], v[120:123]
v_mfma_f32_16x16x32_bf16 v[120:123], v[40:43], a[144:147], v[120:123]
v_mfma_f32_16x16x32_bf16 v[120:123], v[44:47], a[152:155], v[120:123]
v_mfma_f32_16x16x32_bf16 v[124:127], v[32:35], a[132:135], v[124:127]
ds_read_b128 v[32:35], v1 offset:14336
ds_write_b128 v8, v[80:83] offset:7168
v_mfma_f32_16x16x32_bf16 v[124:127], v[36:39], a[140:143], v[124:127]
ds_read_b128 v[36:39], v14 offset:14336
v_mfma_f32_16x16x32_bf16 v[124:127], v[40:43], a[148:151], v[124:127]
ds_read_b128 v[40:43], v15 offset:14336
v_mfma_f32_16x16x32_bf16 v[124:127], v[44:47], a[156:159], v[124:127]
ds_read_b128 v[44:47], v24 offset:14336
s_waitcnt lgkmcnt(5)
v_mfma_f32_16x16x32_bf16 v[128:131], v[48:51], a[128:131], v[128:131]
v_mfma_f32_16x16x32_bf16 v[128:131], v[52:55], a[136:139], v[128:131]
v_mfma_f32_16x16x32_bf16 v[128:131], v[56:59], a[144:147], v[128:131]
v_mfma_f32_16x16x32_bf16 v[128:131], v[60:63], a[152:155], v[128:131]
v_mfma_f32_16x16x32_bf16 v[132:135], v[48:51], a[132:135], v[132:135]
ds_read_b128 v[48:51], v1 offset:15360
ds_write_b128 v8, v[88:91] offset:8192
v_mfma_f32_16x16x32_bf16 v[132:135], v[52:55], a[140:143], v[132:135]
ds_read_b128 v[52:55], v14 offset:15360
v_mfma_f32_16x16x32_bf16 v[132:135], v[56:59], a[148:151], v[132:135]
ds_read_b128 v[56:59], v15 offset:15360
v_mfma_f32_16x16x32_bf16 v[132:135], v[60:63], a[156:159], v[132:135]
ds_read_b128 v[60:63], v24 offset:15360
s_waitcnt lgkmcnt(5)
v_mfma_f32_16x16x32_bf16 v[136:139], v[32:35], a[128:131], v[136:139]
v_mfma_f32_16x16x32_bf16 v[136:139], v[36:39], a[136:139], v[136:139]
v_mfma_f32_16x16x32_bf16 v[136:139], v[40:43], a[144:147], v[136:139]
v_mfma_f32_16x16x32_bf16 v[136:139], v[44:47], a[152:155], v[136:139]
v_mfma_f32_16x16x32_bf16 v[140:143], v[32:35], a[132:135], v[140:143]
ds_read_b128 v[32:35], v1 offset:16384
ds_write_b128 v8, v[96:99] offset:9216
v_mfma_f32_16x16x32_bf16 v[140:143], v[36:39], a[140:143], v[140:143]
ds_read_b128 v[36:39], v14 offset:16384
v_mfma_f32_16x16x32_bf16 v[140:143], v[40:43], a[148:151], v[140:143]
ds_read_b128 v[40:43], v15 offset:16384
v_mfma_f32_16x16x32_bf16 v[140:143], v[44:47], a[156:159], v[140:143]
ds_read_b128 v[44:47], v24 offset:16384
s_waitcnt lgkmcnt(5)
v_mfma_f32_16x16x32_bf16 v[144:147], v[48:51], a[128:131], v[144:147]
v_mfma_f32_16x16x32_bf16 v[144:147], v[52:55], a[136:139], v[144:147]
v_mfma_f32_16x16x32_bf16 v[144:147], v[56:59], a[144:147], v[144:147]
v_mfma_f32_16x16x32_bf16 v[144:147], v[60:63], a[152:155], v[144:147]
v_mfma_f32_16x16x32_bf16 v[148:151], v[48:51], a[132:135], v[148:151]
ds_read_b128 v[48:51], v1 offset:17408
ds_write_b128 v8, v[104:107] offset:10240
v_mfma_f32_16x16x32_bf16 v[148:151], v[52:55], a[140:143], v[148:151]
ds_read_b128 v[52:55], v14 offset:17408
v_mfma_f32_16x16x32_bf16 v[148:151], v[56:59], a[148:151], v[148:151]
ds_read_b128 v[56:59], v15 offset:17408
v_mfma_f32_16x16x32_bf16 v[148:151], v[60:63], a[156:159], v[148:151]
ds_read_b128 v[60:63], v24 offset:17408
s_waitcnt lgkmcnt(5)
v_mfma_f32_16x16x32_bf16 v[152:155], v[32:35], a[128:131], v[152:155]
v_mfma_f32_16x16x32_bf16 v[152:155], v[36:39], a[136:139], v[152:155]
v_mfma_f32_16x16x32_bf16 v[152:155], v[40:43], a[144:147], v[152:155]
v_mfma_f32_16x16x32_bf16 v[152:155], v[44:47], a[152:155], v[152:155]
v_mfma_f32_16x16x32_bf16 v[156:159], v[32:35], a[132:135], v[156:159]
ds_read_b128 v[32:35], v1 offset:18432
ds_write_b128 v8, v[112:115] offset:11264
v_mfma_f32_16x16x32_bf16 v[156:159], v[36:39], a[140:143], v[156:159]
ds_read_b128 v[36:39], v14 offset:18432
v_mfma_f32_16x16x32_bf16 v[156:159], v[40:43], a[148:151], v[156:159]
ds_read_b128 v[40:43], v15 offset:18432
v_mfma_f32_16x16x32_bf16 v[156:159], v[44:47], a[156:159], v[156:159]
ds_read_b128 v[44:47], v24 offset:18432
s_waitcnt lgkmcnt(5)
v_mfma_f32_16x16x32_bf16 v[160:163], v[48:51], a[128:131], v[160:163]
v_mfma_f32_16x16x32_bf16 v[160:163], v[52:55], a[136:139], v[160:163]
ds_read_b128 v[176:179], v245 offset:256
v_mfma_f32_16x16x32_bf16 v[160:163], v[56:59], a[144:147], v[160:163]
v_mfma_f32_16x16x32_bf16 v[160:163], v[60:63], a[152:155], v[160:163]
s_waitcnt vmcnt(32) lgkmcnt(0)
s_barrier
v_mfma_f32_16x16x32_bf16 v[164:167], v[48:51], a[132:135], v[164:167]
ds_read_b128 v[48:51], v1 offset:19456
v_mfma_f32_16x16x32_bf16 v[164:167], v[52:55], a[140:143], v[164:167]
ds_read_b128 v[52:55], v14 offset:19456
v_mfma_f32_16x16x32_bf16 v[164:167], v[56:59], a[148:151], v[164:167]
ds_read_b128 v[56:59], v15 offset:19456
v_mfma_f32_16x16x32_bf16 v[164:167], v[60:63], a[156:159], v[164:167]
ds_read_b128 v[60:63], v24 offset:19456
v_mfma_f32_16x16x32_bf16 v[168:171], v[32:35], a[128:131], v[168:171]
v_mfma_f32_16x16x32_bf16 v[168:171], v[36:39], a[136:139], v[168:171]
v_mfma_f32_16x16x32_bf16 v[168:171], v[40:43], a[144:147], v[168:171]
v_mfma_f32_16x16x32_bf16 v[168:171], v[44:47], a[152:155], v[168:171]
v_mfma_f32_16x16x32_bf16 v[172:175], v[32:35], a[132:135], v[172:175]
ds_read_b128 v[32:35], v1 offset:20480
v_mfma_f32_16x16x32_bf16 v[172:175], v[36:39], a[140:143], v[172:175]
ds_read_b128 v[36:39], v14 offset:20480
v_mfma_f32_16x16x32_bf16 v[172:175], v[40:43], a[148:151], v[172:175]
ds_read_b128 v[40:43], v15 offset:20480
v_mfma_f32_16x16x32_bf16 v[172:175], v[44:47], a[156:159], v[172:175]
ds_read_b128 v[44:47], v24 offset:20480
s_waitcnt lgkmcnt(4)
v_mfma_f32_16x16x32_bf16 v[120:123], v[48:51], a[160:163], v[120:123]
v_fmac_f32 v152, v16, v176
v_mfma_f32_16x16x32_bf16 v[120:123], v[52:55], a[168:171], v[120:123]
v_fmac_f32 v153, v16, v177
v_mfma_f32_16x16x32_bf16 v[120:123], v[56:59], a[176:179], v[120:123]
ds_read_b128 v[180:183], v245 offset:384
v_mfma_f32_16x16x32_bf16 v[120:123], v[60:63], a[184:187], v[120:123]
v_fmac_f32 v154, v16, v178
v_mfma_f32_16x16x32_bf16 v[124:127], v[48:51], a[164:167], v[124:127]
ds_read_b128 v[48:51], v1 offset:21504
v_mfma_f32_16x16x32_bf16 v[124:127], v[52:55], a[172:175], v[124:127]
ds_read_b128 v[52:55], v14 offset:21504
v_fmac_f32 v155, v16, v179
v_mfma_f32_16x16x32_bf16 v[124:127], v[56:59], a[180:183], v[124:127]
ds_read_b128 v[56:59], v15 offset:21504
v_mfma_f32_16x16x32_bf16 v[124:127], v[60:63], a[188:191], v[124:127]
ds_read_b128 v[60:63], v24 offset:21504
s_waitcnt lgkmcnt(5)
v_mfma_f32_16x16x32_bf16 v[128:131], v[32:35], a[160:163], v[128:131]
s_waitcnt vmcnt(0)
buffer_atomic_swap v2, v6, s[36:39], s61 offen sc1
v_mfma_f32_16x16x32_bf16 v[128:131], v[36:39], a[168:171], v[128:131]
v_fmac_f32 v156, v17, v176
v_fmac_f32 v157, v17, v177
v_mfma_f32_16x16x32_bf16 v[128:131], v[40:43], a[176:179], v[128:131]
buffer_load_dwordx4 a[44:47], v1, s[36:39], s66 offen offset:3072 sc1
v_mfma_f32_16x16x32_bf16 v[128:131], v[44:47], a[184:187], v[128:131]
v_fmac_f32 v158, v17, v178
v_mfma_f32_16x16x32_bf16 v[132:135], v[32:35], a[164:167], v[132:135]
ds_read_b128 v[32:35], v1 offset:22528
v_mfma_f32_16x16x32_bf16 v[132:135], v[36:39], a[172:175], v[132:135]
ds_read_b128 v[36:39], v14 offset:22528
v_fmac_f32 v159, v17, v179
v_mfma_f32_16x16x32_bf16 v[132:135], v[40:43], a[180:183], v[132:135]
ds_read_b128 v[40:43], v15 offset:22528
v_mfma_f32_16x16x32_bf16 v[132:135], v[44:47], a[188:191], v[132:135]
ds_read_b128 v[44:47], v24 offset:22528
s_waitcnt lgkmcnt(4)
v_mfma_f32_16x16x32_bf16 v[136:139], v[48:51], a[160:163], v[136:139]
buffer_load_dwordx4 a[48:51], v13, s[36:39], s66 offen offset:0 sc1
v_mfma_f32_16x16x32_bf16 v[136:139], v[52:55], a[168:171], v[136:139]
v_fmac_f32 v168, v16, v180
v_fmac_f32 v169, v16, v181
v_mfma_f32_16x16x32_bf16 v[136:139], v[56:59], a[176:179], v[136:139]
buffer_load_dwordx4 a[52:55], v13, s[36:39], s66 offen offset:1024 sc1
v_mfma_f32_16x16x32_bf16 v[136:139], v[60:63], a[184:187], v[136:139]
v_fmac_f32 v170, v16, v182
v_mfma_f32_16x16x32_bf16 v[140:143], v[48:51], a[164:167], v[140:143]
ds_read_b128 v[48:51], v1 offset:23552
ds_read_b128 v[176:179], v245 offset:64
v_mfma_f32_16x16x32_bf16 v[140:143], v[52:55], a[172:175], v[140:143]
ds_read_b128 v[52:55], v14 offset:23552
v_fmac_f32 v171, v16, v183
v_mfma_f32_16x16x32_bf16 v[140:143], v[56:59], a[180:183], v[140:143]
ds_read_b128 v[56:59], v15 offset:23552
v_mfma_f32_16x16x32_bf16 v[140:143], v[60:63], a[188:191], v[140:143]
ds_read_b128 v[60:63], v24 offset:23552
s_waitcnt lgkmcnt(5)
v_mfma_f32_16x16x32_bf16 v[144:147], v[32:35], a[160:163], v[144:147]
buffer_load_dwordx4 a[56:59], v13, s[36:39], s66 offen offset:2048 sc1
v_mfma_f32_16x16x32_bf16 v[144:147], v[36:39], a[168:171], v[144:147]
v_fmac_f32 v172, v17, v180
v_fmac_f32 v173, v17, v181
v_mfma_f32_16x16x32_bf16 v[144:147], v[40:43], a[176:179], v[144:147]
buffer_load_dwordx4 a[60:63], v13, s[36:39], s66 offen offset:3072 sc1
v_mfma_f32_16x16x32_bf16 v[144:147], v[44:47], a[184:187], v[144:147]
v_fmac_f32 v174, v17, v182
v_mfma_f32_16x16x32_bf16 v[148:151], v[32:35], a[164:167], v[148:151]
ds_read_b128 v[32:35], v1 offset:24576
v_mfma_f32_16x16x32_bf16 v[148:151], v[36:39], a[172:175], v[148:151]
ds_read_b128 v[36:39], v14 offset:24576
v_readlane_b32 s50, v28, 2
v_mfma_f32_16x16x32_bf16 v[148:151], v[40:43], a[180:183], v[148:151]
ds_read_b128 v[40:43], v15 offset:24576
v_fmac_f32 v175, v17, v183
v_mfma_f32_16x16x32_bf16 v[148:151], v[44:47], a[188:191], v[148:151]
ds_read_b128 v[44:47], v24 offset:24576
s_waitcnt lgkmcnt(4)
v_mfma_f32_16x16x32_bf16 v[152:155], v[48:51], a[160:163], v[152:155]
buffer_load_dwordx4 a[64:67], v1, s[36:39], s50 offen offset:0 sc1
v_mfma_f32_16x16x32_bf16 v[152:155], v[52:55], a[168:171], v[152:155]
v_fmac_f32 v128, v16, v176
v_fmac_f32 v129, v16, v177
v_mfma_f32_16x16x32_bf16 v[152:155], v[56:59], a[176:179], v[152:155]
buffer_load_dwordx4 a[68:71], v1, s[36:39], s50 offen offset:1024 sc1
v_mfma_f32_16x16x32_bf16 v[152:155], v[60:63], a[184:187], v[152:155]
v_fmac_f32 v130, v16, v178
v_mfma_f32_16x16x32_bf16 v[156:159], v[48:51], a[164:167], v[156:159]
ds_read_b128 v[48:51], v1 offset:25600
ds_read_b128 v[180:183], v245 offset:192
v_mfma_f32_16x16x32_bf16 v[156:159], v[52:55], a[172:175], v[156:159]
ds_read_b128 v[52:55], v14 offset:25600
v_fmac_f32 v131, v16, v179
v_mfma_f32_16x16x32_bf16 v[156:159], v[56:59], a[180:183], v[156:159]
ds_read_b128 v[56:59], v15 offset:25600
v_mfma_f32_16x16x32_bf16 v[156:159], v[60:63], a[188:191], v[156:159]
ds_read_b128 v[60:63], v24 offset:25600
s_waitcnt lgkmcnt(5)
v_mfma_f32_16x16x32_bf16 v[160:163], v[32:35], a[160:163], v[160:163]
buffer_load_dwordx4 a[72:75], v1, s[36:39], s50 offen offset:2048 sc1
v_mfma_f32_16x16x32_bf16 v[160:163], v[36:39], a[168:171], v[160:163]
v_fmac_f32 v132, v17, v176
v_fmac_f32 v133, v17, v177
v_mfma_f32_16x16x32_bf16 v[160:163], v[40:43], a[176:179], v[160:163]
buffer_load_dwordx4 a[76:79], v1, s[36:39], s50 offen offset:3072 sc1
v_mfma_f32_16x16x32_bf16 v[160:163], v[44:47], a[184:187], v[160:163]
s_waitcnt lgkmcnt(0)
s_barrier
TP49:
s_cbranch_execz TP10
TP50:
s_cbranch_execz TP58
v_mfma_f32_16x16x32_bf16 v[164:167], v[32:35], a[164:167], v[164:167]
ds_read_b128 v[32:35], v1 offset:26624
v_fmac_f32 v134, v17, v178
v_mfma_f32_16x16x32_bf16 v[164:167], v[36:39], a[172:175], v[164:167]
ds_read_b128 v[36:39], v14 offset:26624
v_fmac_f32 v135, v17, v179
v_mfma_f32_16x16x32_bf16 v[164:167], v[40:43], a[180:183], v[164:167]
ds_read_b128 v[40:43], v15 offset:26624
v_mfma_f32_16x16x32_bf16 v[164:167], v[44:47], a[188:191], v[164:167]
ds_read_b128 v[44:47], v24 offset:26624
v_mfma_f32_16x16x32_bf16 v[168:171], v[48:51], a[160:163], v[168:171]
buffer_load_dwordx4 a[80:83], v13, s[36:39], s50 offen offset:0 sc1
v_mfma_f32_16x16x32_bf16 v[168:171], v[52:55], a[168:171], v[168:171]
v_fmac_f32 v144, v16, v180
v_fmac_f32 v145, v16, v181
v_mfma_f32_16x16x32_bf16 v[168:171], v[56:59], a[176:179], v[168:171]
buffer_load_dwordx4 a[84:87], v13, s[36:39], s50 offen offset:1024 sc1
v_mfma_f32_16x16x32_bf16 v[168:171], v[60:63], a[184:187], v[168:171]
v_fmac_f32 v146, v16, v182
v_mfma_f32_16x16x32_bf16 v[172:175], v[48:51], a[164:167], v[172:175]
ds_read_b128 v[48:51], v1 offset:27648
ds_read_b128 v[176:179], v245 offset:320
v_mfma_f32_16x16x32_bf16 v[172:175], v[52:55], a[172:175], v[172:175]
ds_read_b128 v[52:55], v14 offset:27648
v_fmac_f32 v147, v16, v183
v_mfma_f32_16x16x32_bf16 v[172:175], v[56:59], a[180:183], v[172:175]
ds_read_b128 v[56:59], v15 offset:27648
v_mfma_f32_16x16x32_bf16 v[172:175], v[60:63], a[188:191], v[172:175]
ds_read_b128 v[60:63], v24 offset:27648
s_waitcnt lgkmcnt(5)
v_mfma_f32_16x16x32_bf16 v[120:123], v[32:35], a[192:195], v[120:123]
buffer_load_dwordx4 a[88:91], v13, s[36:39], s50 offen offset:2048 sc1
v_mfma_f32_16x16x32_bf16 v[120:123], v[36:39], a[200:203], v[120:123]
v_mov_b32 v254, 0
v_fmac_f32 v148, v17, v180
v_mfma_f32_16x16x32_bf16 v[120:123], v[40:43], a[208:211], v[120:123]
buffer_atomic_or v254, v246, s[36:39], s62 offen sc0 sc1
v_mfma_f32_16x16x32_bf16 v[120:123], v[44:47], a[216:219], v[120:123]
v_fmac_f32 v149, v17, v181
v_fmac_f32 v150, v17, v182
v_mfma_f32_16x16x32_bf16 v[124:127], v[32:35], a[196:199], v[124:127]
ds_read_b128 v[32:35], v1 offset:28672
v_mfma_f32_16x16x32_bf16 v[124:127], v[36:39], a[204:207], v[124:127]
ds_read_b128 v[36:39], v14 offset:28672
v_fmac_f32 v151, v17, v183
v_mfma_f32_16x16x32_bf16 v[124:127], v[40:43], a[212:215], v[124:127]
ds_read_b128 v[40:43], v15 offset:28672
v_readlane_b32 s66, v28, 3
v_mfma_f32_16x16x32_bf16 v[124:127], v[44:47], a[220:223], v[124:127]
ds_read_b128 v[44:47], v24 offset:28672
s_waitcnt lgkmcnt(4)
v_mfma_f32_16x16x32_bf16 v[128:131], v[48:51], a[192:195], v[128:131]
buffer_load_dwordx4 a[92:95], v13, s[36:39], s50 offen offset:3072 sc1
v_mfma_f32_16x16x32_bf16 v[128:131], v[52:55], a[200:203], v[128:131]
v_fmac_f32 v160, v16, v176
v_fmac_f32 v161, v16, v177
v_mfma_f32_16x16x32_bf16 v[128:131], v[56:59], a[208:211], v[128:131]
buffer_load_dwordx4 a[96:99], v1, s[36:39], s66 offen offset:0 sc1
v_mfma_f32_16x16x32_bf16 v[128:131], v[60:63], a[216:219], v[128:131]
v_fmac_f32 v162, v16, v178
v_mfma_f32_16x16x32_bf16 v[132:135], v[48:51], a[196:199], v[132:135]
ds_read_b128 v[48:51], v1 offset:29696
ds_read_b128 v[180:183], v245 offset:0
v_mfma_f32_16x16x32_bf16 v[132:135], v[52:55], a[204:207], v[132:135]
ds_read_b128 v[52:55], v14 offset:29696
v_fmac_f32 v163, v16, v179
v_mfma_f32_16x16x32_bf16 v[132:135], v[56:59], a[212:215], v[132:135]
ds_read_b128 v[56:59], v15 offset:29696
v_mfma_f32_16x16x32_bf16 v[132:135], v[60:63], a[220:223], v[132:135]
ds_read_b128 v[60:63], v24 offset:29696
s_waitcnt lgkmcnt(5)
v_mfma_f32_16x16x32_bf16 v[136:139], v[32:35], a[192:195], v[136:139]
buffer_load_dwordx4 a[100:103], v1, s[36:39], s66 offen offset:1024 sc1
v_mfma_f32_16x16x32_bf16 v[136:139], v[36:39], a[200:203], v[136:139]
v_fmac_f32 v164, v17, v176
v_fmac_f32 v165, v17, v177
v_mfma_f32_16x16x32_bf16 v[136:139], v[40:43], a[208:211], v[136:139]
buffer_load_dwordx4 a[104:107], v1, s[36:39], s66 offen offset:2048 sc1
v_mfma_f32_16x16x32_bf16 v[136:139], v[44:47], a[216:219], v[136:139]
v_fmac_f32 v166, v17, v178
v_mfma_f32_16x16x32_bf16 v[140:143], v[32:35], a[196:199], v[140:143]
ds_read_b128 v[32:35], v1 offset:30720
v_mfma_f32_16x16x32_bf16 v[140:143], v[36:39], a[204:207], v[140:143]
ds_read_b128 v[36:39], v14 offset:30720
v_fmac_f32 v167, v17, v179
v_mfma_f32_16x16x32_bf16 v[140:143], v[40:43], a[212:215], v[140:143]
ds_read_b128 v[40:43], v15 offset:30720
v_mfma_f32_16x16x32_bf16 v[140:143], v[44:47], a[220:223], v[140:143]
ds_read_b128 v[44:47], v24 offset:30720
s_waitcnt lgkmcnt(4)
v_mfma_f32_16x16x32_bf16 v[144:147], v[48:51], a[192:195], v[144:147]
buffer_load_dwordx4 a[108:111], v1, s[36:39], s66 offen offset:3072 sc1
v_mfma_f32_16x16x32_bf16 v[144:147], v[52:55], a[200:203], v[144:147]
v_fmac_f32 v120, v16, v180
v_fmac_f32 v121, v16, v181
v_mfma_f32_16x16x32_bf16 v[144:147], v[56:59], a[208:211], v[144:147]
buffer_load_dwordx4 a[112:115], v13, s[36:39], s66 offen offset:0 sc1
v_mfma_f32_16x16x32_bf16 v[144:147], v[60:63], a[216:219], v[144:147]
v_fmac_f32 v122, v16, v182
v_mfma_f32_16x16x32_bf16 v[148:151], v[48:51], a[196:199], v[148:151]
ds_read_b128 v[48:51], v1 offset:31744
ds_read_b128 v[176:179], v245 offset:128
v_mfma_f32_16x16x32_bf16 v[148:151], v[52:55], a[204:207], v[148:151]
ds_read_b128 v[52:55], v14 offset:31744
v_fmac_f32 v123, v16, v183
v_mfma_f32_16x16x32_bf16 v[148:151], v[56:59], a[212:215], v[148:151]
ds_read_b128 v[56:59], v15 offset:31744
v_mfma_f32_16x16x32_bf16 v[148:151], v[60:63], a[220:223], v[148:151]
ds_read_b128 v[60:63], v24 offset:31744
s_waitcnt lgkmcnt(5)
v_mfma_f32_16x16x32_bf16 v[152:155], v[32:35], a[192:195], v[152:155]
buffer_load_dwordx4 a[116:119], v13, s[36:39], s66 offen offset:1024 sc1
v_mfma_f32_16x16x32_bf16 v[152:155], v[36:39], a[200:203], v[152:155]
v_fmac_f32 v124, v17, v180
v_fmac_f32 v125, v17, v181
v_mfma_f32_16x16x32_bf16 v[152:155], v[40:43], a[208:211], v[152:155]
buffer_load_dwordx4 a[120:123], v13, s[36:39], s66 offen offset:2048 sc1
v_mfma_f32_16x16x32_bf16 v[152:155], v[44:47], a[216:219], v[152:155]
v_fmac_f32 v126, v17, v182
v_mfma_f32_16x16x32_bf16 v[156:159], v[32:35], a[196:199], v[156:159]
ds_read_b128 v[32:35], v1 offset:32768
v_mfma_f32_16x16x32_bf16 v[156:159], v[36:39], a[204:207], v[156:159]
ds_read_b128 v[36:39], v14 offset:32768
v_fmac_f32 v127, v17, v183
v_mfma_f32_16x16x32_bf16 v[156:159], v[40:43], a[212:215], v[156:159]
ds_read_b128 v[40:43], v15 offset:32768
v_readlane_b32 s50, v28, 4
v_mfma_f32_16x16x32_bf16 v[156:159], v[44:47], a[220:223], v[156:159]
ds_read_b128 v[44:47], v24 offset:32768
s_waitcnt lgkmcnt(4)
v_mfma_f32_16x16x32_bf16 v[160:163], v[48:51], a[192:195], v[160:163]
buffer_load_dwordx4 a[124:127], v13, s[36:39], s66 offen offset:3072 sc1
v_mfma_f32_16x16x32_bf16 v[160:163], v[52:55], a[200:203], v[160:163]
v_fmac_f32 v136, v16, v176
v_fmac_f32 v137, v16, v177
v_mfma_f32_16x16x32_bf16 v[160:163], v[56:59], a[208:211], v[160:163]
buffer_load_dwordx4 a[128:131], v1, s[36:39], s50 offen offset:0 sc1
v_mfma_f32_16x16x32_bf16 v[160:163], v[60:63], a[216:219], v[160:163]
v_fmac_f32 v138, v16, v178
s_waitcnt lgkmcnt(0)
s_barrier
v_mfma_f32_16x16x32_bf16 v[164:167], v[48:51], a[196:199], v[164:167]
ds_read_b128 v[48:51], v1 offset:33792
v_mfma_f32_16x16x32_bf16 v[164:167], v[52:55], a[204:207], v[164:167]
ds_read_b128 v[52:55], v14 offset:33792
v_fmac_f32 v139, v16, v179
v_mfma_f32_16x16x32_bf16 v[164:167], v[56:59], a[212:215], v[164:167]
ds_read_b128 v[56:59], v15 offset:33792
v_mfma_f32_16x16x32_bf16 v[164:167], v[60:63], a[220:223], v[164:167]
ds_read_b128 v[60:63], v24 offset:33792
v_fmac_f32 v140, v17, v176
v_mfma_f32_16x16x32_bf16 v[168:171], v[32:35], a[192:195], v[168:171]
buffer_load_dwordx4 a[132:135], v1, s[36:39], s50 offen offset:1024 sc1
v_mfma_f32_16x16x32_bf16 v[168:171], v[36:39], a[200:203], v[168:171]
s_waitcnt vmcnt(11)
v_cmp_ne_u32 vcc, v254, v2
v_fmac_f32 v141, v17, v177
v_mfma_f32_16x16x32_bf16 v[168:171], v[40:43], a[208:211], v[168:171]
buffer_load_dwordx4 a[136:139], v1, s[36:39], s50 offen offset:2048 sc1
v_mfma_f32_16x16x32_bf16 v[168:171], v[44:47], a[216:219], v[168:171]
s_and_b64 vcc, vcc, 0xffff
v_fmac_f32 v142, v17, v178
v_mfma_f32_16x16x32_bf16 v[172:175], v[32:35], a[196:199], v[172:175]
ds_read_b128 v[32:35], v1 offset:34816
v_readlane_b32 s67, v27, 1
v_mfma_f32_16x16x32_bf16 v[172:175], v[36:39], a[204:207], v[172:175]
ds_read_b128 v[36:39], v14 offset:34816
s_cbranch_vccnz RT_F4
RT_F4_B:
v_fmac_f32 v143, v17, v179
v_mfma_f32_16x16x32_bf16 v[172:175], v[40:43], a[212:215], v[172:175]
ds_read_b128 v[40:43], v15 offset:34816
s_add_u32 m0, s48, 12288
v_mfma_f32_16x16x32_bf16 v[172:175], v[44:47], a[220:223], v[172:175]
ds_read_b128 v[44:47], v24 offset:34816
s_waitcnt lgkmcnt(4)
v_mfma_f32_16x16x32_bf16 v[120:123], v[48:51], a[224:227], v[120:123]
buffer_load_dwordx4 v1, s[36:39], s67 offen offset:0 sc1 lds
v_mfma_f32_16x16x32_bf16 v[120:123], v[52:55], a[232:235], v[120:123]
v_mfma_f32_16x16x32_bf16 v[120:123], v[56:59], a[240:243], v[120:123]
buffer_load_dwordx4 v1, s[36:39], s67 offen offset:1024 sc1 lds
v_mfma_f32_16x16x32_bf16 v[120:123], v[60:63], a[248:251], v[120:123]
v_mfma_f32_16x16x32_bf16 v[124:127], v[48:51], a[228:231], v[124:127]
ds_read_b128 v[48:51], v1 offset:35840
v_mfma_f32_16x16x32_bf16 v[124:127], v[52:55], a[236:239], v[124:127]
ds_read_b128 v[52:55], v14 offset:35840
v_mfma_f32_16x16x32_bf16 v[124:127], v[56:59], a[244:247], v[124:127]
ds_read_b128 v[56:59], v15 offset:35840
v_mfma_f32_16x16x32_bf16 v[124:127], v[60:63], a[252:255], v[124:127]
ds_read_b128 v[60:63], v24 offset:35840
s_waitcnt lgkmcnt(4)
v_mfma_f32_16x16x32_bf16 v[128:131], v[32:35], a[224:227], v[128:131]
buffer_load_dwordx4 v1, s[36:39], s67 offen offset:2048 sc1 lds
v_mfma_f32_16x16x32_bf16 v[128:131], v[36:39], a[232:235], v[128:131]
v_mfma_f32_16x16x32_bf16 v[128:131], v[40:43], a[240:243], v[128:131]
buffer_load_dwordx4 v1, s[36:39], s67 offen offset:3072 sc1 lds
v_mfma_f32_16x16x32_bf16 v[128:131], v[44:47], a[248:251], v[128:131]
v_mfma_f32_16x16x32_bf16 v[132:135], v[32:35], a[228:231], v[132:135]
ds_read_b128 v[32:35], v1 offset:36864
v_mfma_f32_16x16x32_bf16 v[132:135], v[36:39], a[236:239], v[132:135]
ds_read_b128 v[36:39], v14 offset:36864
v_mfma_f32_16x16x32_bf16 v[132:135], v[40:43], a[244:247], v[132:135]
ds_read_b128 v[40:43], v15 offset:36864
s_add_u32 m0, s48, 16384
v_mfma_f32_16x16x32_bf16 v[132:135], v[44:47], a[252:255], v[132:135]
ds_read_b128 v[44:47], v24 offset:36864
s_waitcnt lgkmcnt(4)
v_mfma_f32_16x16x32_bf16 v[136:139], v[48:51], a[224:227], v[136:139]
buffer_load_dwordx4 v13, s[36:39], s67 offen offset:0 sc1 lds
v_mfma_f32_16x16x32_bf16 v[136:139], v[52:55], a[232:235], v[136:139]
v_mfma_f32_16x16x32_bf16 v[136:139], v[56:59], a[240:243], v[136:139]
buffer_load_dwordx4 v13, s[36:39], s67 offen offset:1024 sc1 lds
v_mfma_f32_16x16x32_bf16 v[136:139], v[60:63], a[248:251], v[136:139]
v_mfma_f32_16x16x32_bf16 v[140:143], v[48:51], a[228:231], v[140:143]
ds_read_b128 v[48:51], v1 offset:37888
v_mfma_f32_16x16x32_bf16 v[140:143], v[52:55], a[236:239], v[140:143]
ds_read_b128 v[52:55], v14 offset:37888
v_mfma_f32_16x16x32_bf16 v[140:143], v[56:59], a[244:247], v[140:143]
ds_read_b128 v[56:59], v15 offset:37888
v_readlane_b32 s51, v27, 2
v_mfma_f32_16x16x32_bf16 v[140:143], v[60:63], a[252:255], v[140:143]
ds_read_b128 v[60:63], v24 offset:37888
s_waitcnt lgkmcnt(4)
v_mfma_f32_16x16x32_bf16 v[144:147], v[32:35], a[224:227], v[144:147]
buffer_load_dwordx4 v13, s[36:39], s67 offen offset:2048 sc1 lds
v_mfma_f32_16x16x32_bf16 v[144:147], v[36:39], a[232:235], v[144:147]
s_add_u32 m0, s48, 19456
v_mfma_f32_16x16x32_bf16 v[144:147], v[40:43], a[240:243], v[144:147]
buffer_load_dwordx4 v1, s[36:39], s51 offen offset:0 sc1 lds
v_mfma_f32_16x16x32_bf16 v[144:147], v[44:47], a[248:251], v[144:147]
v_mfma_f32_16x16x32_bf16 v[148:151], v[32:35], a[228:231], v[148:151]
ds_read_b128 v[32:35], v1 offset:38912
v_mfma_f32_16x16x32_bf16 v[148:151], v[36:39], a[236:239], v[148:151]
ds_read_b128 v[36:39], v14 offset:38912
v_mfma_f32_16x16x32_bf16 v[148:151], v[40:43], a[244:247], v[148:151]
ds_read_b128 v[40:43], v15 offset:38912
v_mfma_f32_16x16x32_bf16 v[148:151], v[44:47], a[252:255], v[148:151]
ds_read_b128 v[44:47], v24 offset:38912
s_waitcnt lgkmcnt(4)
v_mfma_f32_16x16x32_bf16 v[152:155], v[48:51], a[224:227], v[152:155]
buffer_load_dwordx4 v1, s[36:39], s51 offen offset:1024 sc1 lds
v_mfma_f32_16x16x32_bf16 v[152:155], v[52:55], a[232:235], v[152:155]
v_mfma_f32_16x16x32_bf16 v[152:155], v[56:59], a[240:243], v[152:155]
buffer_load_dwordx4 v1, s[36:39], s51 offen offset:2048 sc1 lds
v_mfma_f32_16x16x32_bf16 v[152:155], v[60:63], a[248:251], v[152:155]
v_mfma_f32_16x16x32_bf16 v[156:159], v[48:51], a[228:231], v[156:159]
ds_read_b128 v[48:51], v1 offset:39936
v_mfma_f32_16x16x32_bf16 v[156:159], v[52:55], a[236:239], v[156:159]
ds_read_b128 v[52:55], v14 offset:39936
v_mfma_f32_16x16x32_bf16 v[156:159], v[56:59], a[244:247], v[156:159]
ds_read_b128 v[56:59], v15 offset:39936
v_mfma_f32_16x16x32_bf16 v[156:159], v[60:63], a[252:255], v[156:159]
ds_read_b128 v[60:63], v24 offset:39936
s_waitcnt lgkmcnt(4)
v_mfma_f32_16x16x32_bf16 v[160:163], v[32:35], a[224:227], v[160:163]
buffer_load_dwordx4 v1, s[36:39], s51 offen offset:3072 sc1 lds
v_mfma_f32_16x16x32_bf16 v[160:163], v[36:39], a[232:235], v[160:163]
s_add_u32 m0, s48, 23552
v_mfma_f32_16x16x32_bf16 v[160:163], v[40:43], a[240:243], v[160:163]
buffer_load_dwordx4 v13, s[36:39], s51 offen offset:0 sc1 lds
v_mfma_f32_16x16x32_bf16 v[160:163], v[44:47], a[248:251], v[160:163]
s_waitcnt lgkmcnt(0)
s_barrier
v_mfma_f32_16x16x32_bf16 v[164:167], v[32:35], a[228:231], v[164:167]
ds_read_b128 v[32:35], v1 offset:5120
v_mfma_f32_16x16x32_bf16 v[164:167], v[36:39], a[236:239], v[164:167]
ds_read_b128 v[36:39], v14 offset:5120
v_mfma_f32_16x16x32_bf16 v[164:167], v[40:43], a[244:247], v[164:167]
ds_read_b128 v[40:43], v15 offset:5120
v_mfma_f32_16x16x32_bf16 v[164:167], v[44:47], a[252:255], v[164:167]
ds_read_b128 v[44:47], v24 offset:5120
v_mfma_f32_16x16x32_bf16 v[168:171], v[48:51], a[224:227], v[168:171]
buffer_load_dwordx4 v13, s[36:39], s51 offen offset:1024 sc1 lds
v_mfma_f32_16x16x32_bf16 v[168:171], v[52:55], a[232:235], v[168:171]
v_mfma_f32_16x16x32_bf16 v[168:171], v[56:59], a[240:243], v[168:171]
buffer_load_dwordx4 v13, s[36:39], s51 offen offset:2048 sc1 lds
v_mfma_f32_16x16x32_bf16 v[168:171], v[60:63], a[248:251], v[168:171]
v_mfma_f32_16x16x32_bf16 v[172:175], v[48:51], a[228:231], v[172:175]
ds_read_b128 v[48:51], v1 offset:6144
v_mfma_f32_16x16x32_bf16 v[172:175], v[52:55], a[236:239], v[172:175]
ds_read_b128 v[52:55], v14 offset:6144
v_readlane_b32 s67, v27, 3
v_mfma_f32_16x16x32_bf16 v[172:175], v[56:59], a[244:247], v[172:175]
ds_read_b128 v[56:59], v15 offset:6144
s_add_u32 m0, s48, 26624
v_mfma_f32_16x16x32_bf16 v[172:175], v[60:63], a[252:255], v[172:175]
ds_read_b128 v[60:63], v24 offset:6144
s_waitcnt lgkmcnt(4)
v_mfma_f32_16x16x32_bf16 v[64:67], v[32:35], a[0:3], v[184:187]
buffer_load_dwordx4 v1, s[36:39], s67 offen offset:0 sc1 lds
v_mfma_f32_16x16x32_bf16 v[64:67], v[36:39], a[8:11], v[64:67]
v_mul_f32 v176, v120, v120
v_mul_f32 v177, v121, v121
v_mfma_f32_16x16x32_bf16 v[64:67], v[40:43], a[16:19], v[64:67]
buffer_load_dwordx4 v1, s[36:39], s67 offen offset:1024 sc1 lds
v_mfma_f32_16x16x32_bf16 v[64:67], v[44:47], a[24:27], v[64:67]
v_mul_f32 v178, v122, v122
v_mfma_f32_16x16x32_bf16 v[68:71], v[32:35], a[4:7], v[188:191]
ds_read_b128 v[32:35], v1 offset:7168
v_mul_f32 v179, v123, v123
v_mfma_f32_16x16x32_bf16 v[68:71], v[36:39], a[12:15], v[68:71]
ds_read_b128 v[36:39], v14 offset:7168
v_mfma_f32_16x16x32_bf16 v[68:71], v[40:43], a[20:23], v[68:71]
ds_read_b128 v[40:43], v15 offset:7168
v_mul_f32 v180, v124, v124
v_mfma_f32_16x16x32_bf16 v[68:71], v[44:47], a[28:31], v[68:71]
ds_read_b128 v[44:47], v24 offset:7168
s_waitcnt lgkmcnt(4)
v_mfma_f32_16x16x32_bf16 v[72:75], v[48:51], a[0:3], v[184:187]
buffer_load_dwordx4 v1, s[36:39], s67 offen offset:2048 sc1 lds
v_mfma_f32_16x16x32_bf16 v[72:75], v[52:55], a[8:11], v[72:75]
v_mul_f32 v181, v125, v125
v_mul_f32 v182, v126, v126
v_mfma_f32_16x16x32_bf16 v[72:75], v[56:59], a[16:19], v[72:75]
buffer_load_dwordx4 v1, s[36:39], s67 offen offset:3072 sc1 lds
v_mfma_f32_16x16x32_bf16 v[72:75], v[60:63], a[24:27], v[72:75]
v_mul_f32 v183, v127, v127
v_mfma_f32_16x16x32_bf16 v[76:79], v[48:51], a[4:7], v[188:191]
ds_read_b128 v[48:51], v1 offset:8192
v_fma_f32 v176, v176, v22, v20
v_mfma_f32_16x16x32_bf16 v[76:79], v[52:55], a[12:15], v[76:79]
ds_read_b128 v[52:55], v14 offset:8192
v_fma_f32 v177, v177, v22, v20
v_mfma_f32_16x16x32_bf16 v[76:79], v[56:59], a[20:23], v[76:79]
ds_read_b128 v[56:59], v15 offset:8192
s_add_u32 m0, s48, 30720
v_mfma_f32_16x16x32_bf16 v[76:79], v[60:63], a[28:31], v[76:79]
ds_read_b128 v[60:63], v24 offset:8192
s_waitcnt lgkmcnt(4)
v_mfma_f32_16x16x32_bf16 v[80:83], v[32:35], a[0:3], v[184:187]
buffer_load_dwordx4 v13, s[36:39], s67 offen offset:0 sc1 lds
v_mfma_f32_16x16x32_bf16 v[80:83], v[36:39], a[8:11], v[80:83]
v_fma_f32 v178, v178, v22, v20
v_fma_f32 v179, v179, v22, v20
v_mfma_f32_16x16x32_bf16 v[80:83], v[40:43], a[16:19], v[80:83]
buffer_load_dwordx4 v13, s[36:39], s67 offen offset:1024 sc1 lds
v_mfma_f32_16x16x32_bf16 v[80:83], v[44:47], a[24:27], v[80:83]
v_fma_f32 v180, v180, v23, v21
v_fma_f32 v181, v181, v23, v21
v_mfma_f32_16x16x32_bf16 v[84:87], v[32:35], a[4:7], v[188:191]
ds_read_b128 v[32:35], v1 offset:9216
v_mfma_f32_16x16x32_bf16 v[84:87], v[36:39], a[12:15], v[84:87]
ds_read_b128 v[36:39], v14 offset:9216
v_fma_f32 v182, v182, v23, v21
v_mfma_f32_16x16x32_bf16 v[84:87], v[40:43], a[20:23], v[84:87]
ds_read_b128 v[40:43], v15 offset:9216
v_readlane_b32 s51, v27, 4
v_mfma_f32_16x16x32_bf16 v[84:87], v[44:47], a[28:31], v[84:87]
ds_read_b128 v[44:47], v24 offset:9216
s_waitcnt lgkmcnt(4)
v_mfma_f32_16x16x32_bf16 v[88:91], v[48:51], a[0:3], v[184:187]
buffer_load_dwordx4 v13, s[36:39], s67 offen offset:2048 sc1 lds
v_mfma_f32_16x16x32_bf16 v[88:91], v[52:55], a[8:11], v[88:91]
s_add_u32 m0, s48, 33792
v_fma_f32 v183, v183, v23, v21
v_mfma_f32_16x16x32_bf16 v[88:91], v[56:59], a[16:19], v[88:91]
buffer_load_dwordx4 v1, s[36:39], s51 offen offset:0 sc1 lds
v_mfma_f32_16x16x32_bf16 v[88:91], v[60:63], a[24:27], v[88:91]
v_mul_f32 v176, v176, v120
v_mul_f32 v177, v177, v121
v_mfma_f32_16x16x32_bf16 v[92:95], v[48:51], a[4:7], v[188:191]
ds_read_b128 v[48:51], v1 offset:10240
v_mul_f32 v178, v178, v122
v_mfma_f32_16x16x32_bf16 v[92:95], v[52:55], a[12:15], v[92:95]
ds_read_b128 v[52:55], v14 offset:10240
v_mul_f32 v179, v179, v123
v_mfma_f32_16x16x32_bf16 v[92:95], v[56:59], a[20:23], v[92:95]
ds_read_b128 v[56:59], v15 offset:10240
v_mul_f32 v180, v180, v124
v_mfma_f32_16x16x32_bf16 v[92:95], v[60:63], a[28:31], v[92:95]
ds_read_b128 v[60:63], v24 offset:10240
s_waitcnt lgkmcnt(4)
v_mfma_f32_16x16x32_bf16 v[96:99], v[32:35], a[0:3], v[184:187]
buffer_load_dwordx4 v1, s[36:39], s51 offen offset:1024 sc1 lds
v_mfma_f32_16x16x32_bf16 v[96:99], v[36:39], a[8:11], v[96:99]
v_mul_f32 v181, v181, v125
v_mul_f32 v182, v182, v126
v_mfma_f32_16x16x32_bf16 v[96:99], v[40:43], a[16:19], v[96:99]
buffer_load_dwordx4 v1, s[36:39], s51 offen offset:2048 sc1 lds
v_mfma_f32_16x16x32_bf16 v[96:99], v[44:47], a[24:27], v[96:99]
v_mul_f32 v183, v183, v127
v_mfma_f32_16x16x32_bf16 v[100:103], v[32:35], a[4:7], v[188:191]
ds_read_b128 v[32:35], v1 offset:11264
v_mfma_f32_16x16x32_bf16 v[100:103], v[36:39], a[12:15], v[100:103]
ds_read_b128 v[36:39], v14 offset:11264
v_mfma_f32_16x16x32_bf16 v[100:103], v[40:43], a[20:23], v[100:103]
ds_read_b128 v[40:43], v15 offset:11264
v_mfma_f32_16x16x32_bf16 v[100:103], v[44:47], a[28:31], v[100:103]
ds_read_b128 v[44:47], v24 offset:11264
s_waitcnt lgkmcnt(4)
v_mfma_f32_16x16x32_bf16 v[104:107], v[48:51], a[0:3], v[184:187]
buffer_load_dwordx4 v1, s[36:39], s51 offen offset:3072 sc1 lds
v_mfma_f32_16x16x32_bf16 v[104:107], v[52:55], a[8:11], v[104:107]
s_add_u32 m0, s48, 37888
v_mfma_f32_16x16x32_bf16 v[104:107], v[56:59], a[16:19], v[104:107]
buffer_load_dwordx4 v13, s[36:39], s51 offen offset:0 sc1 lds
v_mfma_f32_16x16x32_bf16 v[104:107], v[60:63], a[24:27], v[104:107]
s_waitcnt vmcnt(19) lgkmcnt(0)
s_barrier
v_mfma_f32_16x16x32_bf16 v[108:111], v[48:51], a[4:7], v[188:191]
ds_read_b128 v[48:51], v1 offset:12288
v_mfma_f32_16x16x32_bf16 v[108:111], v[52:55], a[12:15], v[108:111]
ds_read_b128 v[52:55], v14 offset:12288
v_mfma_f32_16x16x32_bf16 v[108:111], v[56:59], a[20:23], v[108:111]
ds_read_b128 v[56:59], v15 offset:12288
v_mfma_f32_16x16x32_bf16 v[108:111], v[60:63], a[28:31], v[108:111]
ds_read_b128 v[60:63], v24 offset:12288
v_mfma_f32_16x16x32_bf16 v[112:115], v[32:35], a[0:3], v[184:187]
buffer_load_dwordx4 v13, s[36:39], s51 offen offset:1024 sc1 lds
v_mfma_f32_16x16x32_bf16 v[112:115], v[36:39], a[8:11], v[112:115]
v_exp_f32 v176, v176
v_mfma_f32_16x16x32_bf16 v[112:115], v[40:43], a[16:19], v[112:115]
buffer_load_dwordx4 v13, s[36:39], s51 offen offset:2048 sc1 lds
v_mfma_f32_16x16x32_bf16 v[112:115], v[44:47], a[24:27], v[112:115]
v_exp_f32 v177, v177
v_mfma_f32_16x16x32_bf16 v[116:119], v[32:35], a[4:7], v[188:191]
ds_read_b128 v[32:35], v1 offset:13312
v_fma_f32 v176, v176, v18, v18
v_mfma_f32_16x16x32_bf16 v[116:119], v[36:39], a[12:15], v[116:119]
ds_read_b128 v[36:39], v14 offset:13312
v_fma_f32 v177, v177, v18, v18
v_mfma_f32_16x16x32_bf16 v[116:119], v[40:43], a[20:23], v[116:119]
ds_read_b128 v[40:43], v15 offset:13312
v_mfma_f32_16x16x32_bf16 v[116:119], v[44:47], a[28:31], v[116:119]
ds_read_b128 v[44:47], v24 offset:13312
s_waitcnt lgkmcnt(4)
v_mfma_f32_16x16x32_bf16 v[64:67], v[48:51], a[32:35], v[64:67]
buffer_load_dwordx4 a[140:143], v1, s[36:39], s50 offen offset:3072 sc1
v_mfma_f32_16x16x32_bf16 v[64:67], v[52:55], a[40:43], v[64:67]
v_exp_f32 v178, v178
v_mfma_f32_16x16x32_bf16 v[64:67], v[56:59], a[48:51], v[64:67]
buffer_load_dwordx4 a[144:147], v13, s[36:39], s50 offen offset:0 sc1
v_mfma_f32_16x16x32_bf16 v[64:67], v[60:63], a[56:59], v[64:67]
v_exp_f32 v179, v179
v_mfma_f32_16x16x32_bf16 v[68:71], v[48:51], a[36:39], v[68:71]
ds_read_b128 v[48:51], v1 offset:14336
v_fma_f32 v178, v178, v18, v18
v_mfma_f32_16x16x32_bf16 v[68:71], v[52:55], a[44:47], v[68:71]
ds_read_b128 v[52:55], v14 offset:14336
v_fma_f32 v179, v179, v18, v18
v_mfma_f32_16x16x32_bf16 v[68:71], v[56:59], a[52:55], v[68:71]
ds_read_b128 v[56:59], v15 offset:14336
v_mfma_f32_16x16x32_bf16 v[68:71], v[60:63], a[60:63], v[68:71]
ds_read_b128 v[60:63], v24 offset:14336
s_waitcnt lgkmcnt(4)
v_mfma_f32_16x16x32_bf16 v[72:75], v[32:35], a[32:35], v[72:75]
buffer_load_dwordx4 a[148:151], v13, s[36:39], s50 offen offset:1024 sc1
v_mfma_f32_16x16x32_bf16 v[72:75], v[36:39], a[40:43], v[72:75]
v_exp_f32 v180, v180
v_mfma_f32_16x16x32_bf16 v[72:75], v[40:43], a[48:51], v[72:75]
buffer_load_dwordx4 a[152:155], v13, s[36:39], s50 offen offset:2048 sc1
v_mfma_f32_16x16x32_bf16 v[72:75], v[44:47], a[56:59], v[72:75]
v_exp_f32 v181, v181
v_mfma_f32_16x16x32_bf16 v[76:79], v[32:35], a[36:39], v[76:79]
ds_read_b128 v[32:35], v1 offset:15360
v_fma_f32 v180, v180, v19, v19
v_mfma_f32_16x16x32_bf16 v[76:79], v[36:39], a[44:47], v[76:79]
ds_read_b128 v[36:39], v14 offset:15360
v_fma_f32 v181, v181, v19, v19
v_mfma_f32_16x16x32_bf16 v[76:79], v[40:43], a[52:55], v[76:79]
ds_read_b128 v[40:43], v15 offset:15360
v_readlane_b32 s67, v27, 5
v_mfma_f32_16x16x32_bf16 v[76:79], v[44:47], a[60:63], v[76:79]
ds_read_b128 v[44:47], v24 offset:15360
s_waitcnt lgkmcnt(4)
v_mfma_f32_16x16x32_bf16 v[80:83], v[48:51], a[32:35], v[80:83]
buffer_load_dwordx4 a[156:159], v13, s[36:39], s50 offen offset:3072 sc1
v_mfma_f32_16x16x32_bf16 v[80:83], v[52:55], a[40:43], v[80:83]
s_add_u32 m0, s48, 5120
v_mfma_f32_16x16x32_bf16 v[80:83], v[56:59], a[48:51], v[80:83]
buffer_load_dwordx4 v1, s[36:39], s67 offen offset:0 sc1 lds
v_mfma_f32_16x16x32_bf16 v[80:83], v[60:63], a[56:59], v[80:83]
v_exp_f32 v182, v182
v_mfma_f32_16x16x32_bf16 v[84:87], v[48:51], a[36:39], v[84:87]
ds_read_b128 v[48:51], v1 offset:16384
v_fma_f32 v182, v182, v19, v19
v_mfma_f32_16x16x32_bf16 v[84:87], v[52:55], a[44:47], v[84:87]
ds_read_b128 v[52:55], v14 offset:16384
v_mfma_f32_16x16x32_bf16 v[84:87], v[56:59], a[52:55], v[84:87]
ds_read_b128 v[56:59], v15 offset:16384
v_mfma_f32_16x16x32_bf16 v[84:87], v[60:63], a[60:63], v[84:87]
ds_read_b128 v[60:63], v24 offset:16384
s_waitcnt lgkmcnt(4)
v_mfma_f32_16x16x32_bf16 v[88:91], v[32:35], a[32:35], v[88:91]
buffer_load_dwordx4 v1, s[36:39], s67 offen offset:1024 sc1 lds
v_mfma_f32_16x16x32_bf16 v[88:91], v[36:39], a[40:43], v[88:91]
v_exp_f32 v183, v183
v_mfma_f32_16x16x32_bf16 v[88:91], v[40:43], a[48:51], v[88:91]
buffer_load_dwordx4 v1, s[36:39], s67 offen offset:2048 sc1 lds
v_mfma_f32_16x16x32_bf16 v[88:91], v[44:47], a[56:59], v[88:91]
v_fma_f32 v183, v183, v19, v19
v_mfma_f32_16x16x32_bf16 v[92:95], v[32:35], a[36:39], v[92:95]
ds_read_b128 v[32:35], v1 offset:17408
v_mfma_f32_16x16x32_bf16 v[92:95], v[36:39], a[44:47], v[92:95]
ds_read_b128 v[36:39], v14 offset:17408
v_mfma_f32_16x16x32_bf16 v[92:95], v[40:43], a[52:55], v[92:95]
ds_read_b128 v[40:43], v15 offset:17408
v_mfma_f32_16x16x32_bf16 v[92:95], v[44:47], a[60:63], v[92:95]
ds_read_b128 v[44:47], v24 offset:17408
s_waitcnt lgkmcnt(4)
v_mfma_f32_16x16x32_bf16 v[96:99], v[48:51], a[32:35], v[96:99]
buffer_load_dwordx4 v1, s[36:39], s67 offen offset:3072 sc1 lds
v_mfma_f32_16x16x32_bf16 v[96:99], v[52:55], a[40:43], v[96:99]
s_add_u32 m0, s48, 9216
v_mfma_f32_16x16x32_bf16 v[96:99], v[56:59], a[48:51], v[96:99]
buffer_load_dwordx4 v13, s[36:39], s67 offen offset:0 sc1 lds
v_mfma_f32_16x16x32_bf16 v[96:99], v[60:63], a[56:59], v[96:99]
v_rcp_f32 v176, v176
v_mfma_f32_16x16x32_bf16 v[100:103], v[48:51], a[36:39], v[100:103]
ds_read_b128 v[48:51], v1 offset:18432
v_mul_f32 v120, v120, v176
v_mfma_f32_16x16x32_bf16 v[100:103], v[52:55], a[44:47], v[100:103]
ds_read_b128 v[52:55], v14 offset:18432
v_mul_f32 v176, v128, v128
v_mfma_f32_16x16x32_bf16 v[100:103], v[56:59], a[52:55], v[100:103]
ds_read_b128 v[56:59], v15 offset:18432
v_fma_f32 v176, v176, v22, v20
v_mfma_f32_16x16x32_bf16 v[100:103], v[60:63], a[60:63], v[100:103]
ds_read_b128 v[60:63], v24 offset:18432
s_waitcnt lgkmcnt(4)
v_mfma_f32_16x16x32_bf16 v[104:107], v[32:35], a[32:35], v[104:107]
buffer_load_dwordx4 v13, s[36:39], s67 offen offset:1024 sc1 lds
v_mfma_f32_16x16x32_bf16 v[104:107], v[36:39], a[40:43], v[104:107]
v_rcp_f32 v177, v177
v_mfma_f32_16x16x32_bf16 v[104:107], v[40:43], a[48:51], v[104:107]
buffer_load_dwordx4 v13, s[36:39], s67 offen offset:2048 sc1 lds
v_mfma_f32_16x16x32_bf16 v[104:107], v[44:47], a[56:59], v[104:107]
s_waitcnt vmcnt(26) lgkmcnt(0)
s_barrier
v_mfma_f32_16x16x32_bf16 v[108:111], v[32:35], a[36:39], v[108:111]
ds_read_b128 v[32:35], v1 offset:19456
v_mul_f32 v121, v121, v177
v_mfma_f32_16x16x32_bf16 v[108:111], v[36:39], a[44:47], v[108:111]
ds_read_b128 v[36:39], v14 offset:19456
v_readlane_b32 s66, v28, 5
v_mfma_f32_16x16x32_bf16 v[108:111], v[40:43], a[52:55], v[108:111]
ds_read_b128 v[40:43], v15 offset:19456
v_mul_f32 v177, v129, v129
v_mfma_f32_16x16x32_bf16 v[108:111], v[44:47], a[60:63], v[108:111]
ds_read_b128 v[44:47], v24 offset:19456
v_mfma_f32_16x16x32_bf16 v[112:115], v[48:51], a[32:35], v[112:115]
buffer_load_dwordx4 a[160:163], v1, s[36:39], s66 offen offset:0 sc1
v_mfma_f32_16x16x32_bf16 v[112:115], v[52:55], a[40:43], v[112:115]
v_rcp_f32 v178, v178
v_mfma_f32_16x16x32_bf16 v[112:115], v[56:59], a[48:51], v[112:115]
buffer_load_dwordx4 a[164:167], v1, s[36:39], s66 offen offset:1024 sc1
v_mfma_f32_16x16x32_bf16 v[112:115], v[60:63], a[56:59], v[112:115]
v_rcp_f32 v179, v179
v_mfma_f32_16x16x32_bf16 v[116:119], v[48:51], a[36:39], v[116:119]
ds_read_b128 v[48:51], v1 offset:20480
v_mul_f32 v122, v122, v178
v_mfma_f32_16x16x32_bf16 v[116:119], v[52:55], a[44:47], v[116:119]
ds_read_b128 v[52:55], v14 offset:20480
v_mul_f32 v123, v123, v179
v_mfma_f32_16x16x32_bf16 v[116:119], v[56:59], a[52:55], v[116:119]
ds_read_b128 v[56:59], v15 offset:20480
v_mul_f32 v178, v130, v130
v_mfma_f32_16x16x32_bf16 v[116:119], v[60:63], a[60:63], v[116:119]
ds_read_b128 v[60:63], v24 offset:20480
s_waitcnt lgkmcnt(4)
v_mfma_f32_16x16x32_bf16 v[64:67], v[32:35], a[64:67], v[64:67]
buffer_load_dwordx4 a[168:171], v1, s[36:39], s66 offen offset:2048 sc1
v_mfma_f32_16x16x32_bf16 v[64:67], v[36:39], a[72:75], v[64:67]
s_mul_i32 s53, s63, 56
v_mul_f32 v179, v131, v131
v_mfma_f32_16x16x32_bf16 v[64:67], v[40:43], a[80:83], v[64:67]
TP51:
s_cbranch_execz TP2
TP52:
s_cbranch_execz TP60
buffer_load_dwordx4 a[172:175], v1, s[36:39], s66 offen offset:3072 sc1
v_mfma_f32_16x16x32_bf16 v[64:67], v[44:47], a[88:91], v[64:67]
v_rcp_f32 v180, v180
v_mfma_f32_16x16x32_bf16 v[68:71], v[32:35], a[68:71], v[68:71]
ds_read_b128 v[32:35], v1 offset:21504
s_add_u32 s53, s53, 50331648
v_mfma_f32_16x16x32_bf16 v[68:71], v[36:39], a[76:79], v[68:71]
ds_read_b128 v[36:39], v14 offset:21504
v_mul_f32 v124, v124, v180
v_mfma_f32_16x16x32_bf16 v[68:71], v[40:43], a[84:87], v[68:71]
ds_read_b128 v[40:43], v15 offset:21504
v_mul_f32 v180, v132, v132
v_mfma_f32_16x16x32_bf16 v[68:71], v[44:47], a[92:95], v[68:71]
ds_read_b128 v[44:47], v24 offset:21504
s_waitcnt lgkmcnt(4)
v_mfma_f32_16x16x32_bf16 v[72:75], v[48:51], a[64:67], v[72:75]
buffer_load_dwordx4 a[176:179], v13, s[36:39], s66 offen offset:0 sc1
v_mfma_f32_16x16x32_bf16 v[72:75], v[52:55], a[72:75], v[72:75]
s_and_b32 s60, s45, 1
v_fma_f32 v177, v177, v22, v20
v_mfma_f32_16x16x32_bf16 v[72:75], v[56:59], a[80:83], v[72:75]
buffer_load_dwordx4 a[180:183], v13, s[36:39], s66 offen offset:1024 sc1
v_mfma_f32_16x16x32_bf16 v[72:75], v[60:63], a[88:91], v[72:75]
v_rcp_f32 v181, v181
v_mfma_f32_16x16x32_bf16 v[76:79], v[48:51], a[68:71], v[76:79]
ds_read_b128 v[48:51], v1 offset:22528
v_mul_f32 v125, v125, v181
v_mfma_f32_16x16x32_bf16 v[76:79], v[52:55], a[76:79], v[76:79]
ds_read_b128 v[52:55], v14 offset:22528
v_mul_f32 v181, v133, v133
v_mfma_f32_16x16x32_bf16 v[76:79], v[56:59], a[84:87], v[76:79]
ds_read_b128 v[56:59], v15 offset:22528
s_and_b32 s3, s40, 1
v_mfma_f32_16x16x32_bf16 v[76:79], v[60:63], a[92:95], v[76:79]
ds_read_b128 v[60:63], v24 offset:22528
s_waitcnt lgkmcnt(4)
v_mfma_f32_16x16x32_bf16 v[80:83], v[32:35], a[64:67], v[80:83]
buffer_load_dwordx4 a[184:187], v13, s[36:39], s66 offen offset:2048 sc1
v_mfma_f32_16x16x32_bf16 v[80:83], v[36:39], a[72:75], v[80:83]
v_rcp_f32 v182, v182
v_mfma_f32_16x16x32_bf16 v[80:83], v[40:43], a[80:83], v[80:83]
buffer_load_dwordx4 a[188:191], v13, s[36:39], s66 offen offset:3072 sc1
v_mfma_f32_16x16x32_bf16 v[80:83], v[44:47], a[88:91], v[80:83]
s_lshl1_add_u32 s3, s3, s60
v_mul_f32 v126, v126, v182
v_mfma_f32_16x16x32_bf16 v[84:87], v[32:35], a[68:71], v[84:87]
ds_read_b128 v[32:35], v1 offset:23552
v_mul_f32 v182, v134, v134
v_mfma_f32_16x16x32_bf16 v[84:87], v[36:39], a[76:79], v[84:87]
ds_read_b128 v[36:39], v14 offset:23552
v_readlane_b32 s51, v27, 6
v_mfma_f32_16x16x32_bf16 v[84:87], v[40:43], a[84:87], v[84:87]
ds_read_b128 v[40:43], v15 offset:23552
s_add_u32 m0, s48, 12288
v_mfma_f32_16x16x32_bf16 v[84:87], v[44:47], a[92:95], v[84:87]
ds_read_b128 v[44:47], v24 offset:23552
s_waitcnt lgkmcnt(4)
v_mfma_f32_16x16x32_bf16 v[88:91], v[48:51], a[64:67], v[88:91]
buffer_load_dwordx4 v1, s[36:39], s51 offen offset:0 sc1 lds
v_mfma_f32_16x16x32_bf16 v[88:91], v[52:55], a[72:75], v[88:91]
s_lshl2_add_u32 s3, s44, s3
v_fma_f32 v178, v178, v22, v20
v_mfma_f32_16x16x32_bf16 v[88:91], v[56:59], a[80:83], v[88:91]
buffer_load_dwordx4 v1, s[36:39], s51 offen offset:1024 sc1 lds
v_mfma_f32_16x16x32_bf16 v[88:91], v[60:63], a[88:91], v[88:91]
v_rcp_f32 v183, v183
v_mfma_f32_16x16x32_bf16 v[92:95], v[48:51], a[68:71], v[92:95]
ds_read_b128 v[48:51], v1 offset:24576
v_mul_f32 v127, v127, v183
v_mfma_f32_16x16x32_bf16 v[92:95], v[52:55], a[76:79], v[92:95]
ds_read_b128 v[52:55], v14 offset:24576
s_lshr_b32 s61, s40, 1
v_mfma_f32_16x16x32_bf16 v[92:95], v[56:59], a[84:87], v[92:95]
ds_read_b128 v[56:59], v15 offset:24576
v_mul_f32 v183, v135, v135
v_mfma_f32_16x16x32_bf16 v[92:95], v[60:63], a[92:95], v[92:95]
ds_read_b128 v[60:63], v24 offset:24576
s_waitcnt lgkmcnt(4)
v_mfma_f32_16x16x32_bf16 v[96:99], v[32:35], a[64:67], v[96:99]
buffer_load_dwordx4 v1, s[36:39], s51 offen offset:2048 sc1 lds
v_mfma_f32_16x16x32_bf16 v[96:99], v[36:39], a[72:75], v[96:99]
v_fma_f32 v179, v179, v22, v20
v_fma_f32 v180, v180, v23, v21
v_mfma_f32_16x16x32_bf16 v[96:99], v[40:43], a[80:83], v[96:99]
buffer_load_dwordx4 v1, s[36:39], s51 offen offset:3072 sc1 lds
v_mfma_f32_16x16x32_bf16 v[96:99], v[44:47], a[88:91], v[96:99]
s_lshl4_add_u32 s3, s3, s61
v_fma_f32 v181, v181, v23, v21
v_mfma_f32_16x16x32_bf16 v[100:103], v[32:35], a[68:71], v[100:103]
ds_read_b128 v[32:35], v1 offset:25600
v_fma_f32 v182, v182, v23, v21
v_mfma_f32_16x16x32_bf16 v[100:103], v[36:39], a[76:79], v[100:103]
ds_read_b128 v[36:39], v14 offset:25600
s_add_u32 m0, s48, 16384
v_mfma_f32_16x16x32_bf16 v[100:103], v[40:43], a[84:87], v[100:103]
ds_read_b128 v[40:43], v15 offset:25600
s_lshl_b32 s3, s3, 5
v_mfma_f32_16x16x32_bf16 v[100:103], v[44:47], a[92:95], v[100:103]
ds_read_b128 v[44:47], v24 offset:25600
s_waitcnt lgkmcnt(4)
v_mfma_f32_16x16x32_bf16 v[104:107], v[48:51], a[64:67], v[104:107]
buffer_load_dwordx4 v13, s[36:39], s51 offen offset:0 sc1 lds
v_mfma_f32_16x16x32_bf16 v[104:107], v[52:55], a[72:75], v[104:107]
v_fma_f32 v183, v183, v23, v21
v_mul_f32 v176, v176, v128
v_mfma_f32_16x16x32_bf16 v[104:107], v[56:59], a[80:83], v[104:107]
buffer_load_dwordx4 v13, s[36:39], s51 offen offset:1024 sc1 lds
v_mfma_f32_16x16x32_bf16 v[104:107], v[60:63], a[88:91], v[104:107]
s_waitcnt vmcnt(33) lgkmcnt(0)
s_barrier
v_mfma_f32_16x16x32_bf16 v[108:111], v[48:51], a[68:71], v[108:111]
ds_read_b128 v[48:51], v1 offset:26624
s_lshr_b32 s65, s45, 1
v_mfma_f32_16x16x32_bf16 v[108:111], v[52:55], a[76:79], v[108:111]
ds_read_b128 v[52:55], v14 offset:26624
v_mul_f32 v177, v177, v129
v_mfma_f32_16x16x32_bf16 v[108:111], v[56:59], a[84:87], v[108:111]
ds_read_b128 v[56:59], v15 offset:26624
v_readlane_b32 s50, v28, 6
v_mfma_f32_16x16x32_bf16 v[108:111], v[60:63], a[92:95], v[108:111]
ds_read_b128 v[60:63], v24 offset:26624
v_mfma_f32_16x16x32_bf16 v[112:115], v[32:35], a[64:67], v[112:115]
buffer_load_dwordx4 v13, s[36:39], s51 offen offset:2048 sc1 lds
v_mfma_f32_16x16x32_bf16 v[112:115], v[36:39], a[72:75], v[112:115]
s_add_u32 s3, s3, s65
v_mul_f32 v178, v178, v130
v_mfma_f32_16x16x32_bf16 v[112:115], v[40:43], a[80:83], v[112:115]
buffer_load_dwordx4 a[192:195], v1, s[36:39], s50 offen offset:0 sc1
v_mfma_f32_16x16x32_bf16 v[112:115], v[44:47], a[88:91], v[112:115]
v_mul_f32 v179, v179, v131
v_mul_f32 v180, v180, v132
v_mfma_f32_16x16x32_bf16 v[116:119], v[32:35], a[68:71], v[116:119]
ds_read_b128 v[32:35], v1 offset:27648
v_mul_f32 v181, v181, v133
v_mfma_f32_16x16x32_bf16 v[116:119], v[36:39], a[76:79], v[116:119]
ds_read_b128 v[36:39], v14 offset:27648
s_lshl_b32 s3, s3, 2
v_mfma_f32_16x16x32_bf16 v[116:119], v[40:43], a[84:87], v[116:119]
ds_read_b128 v[40:43], v15 offset:27648
v_mul_f32 v182, v182, v134
v_mfma_f32_16x16x32_bf16 v[116:119], v[44:47], a[92:95], v[116:119]
ds_read_b128 v[44:47], v24 offset:27648
s_waitcnt lgkmcnt(4)
v_mfma_f32_16x16x32_bf16 v[64:67], v[48:51], a[96:99], v[64:67]
buffer_load_dwordx4 a[196:199], v1, s[36:39], s50 offen offset:1024 sc1
v_mfma_f32_16x16x32_bf16 v[64:67], v[52:55], a[104:107], v[64:67]
v_mul_f32 v183, v183, v135
v_mfma_f32_16x16x32_bf16 v[64:67], v[56:59], a[112:115], v[64:67]
buffer_load_dwordx4 a[200:203], v1, s[36:39], s50 offen offset:2048 sc1
v_mfma_f32_16x16x32_bf16 v[64:67], v[60:63], a[120:123], v[64:67]
s_add_u32 s61, s3, 655360
v_mfma_f32_16x16x32_bf16 v[68:71], v[48:51], a[100:103], v[68:71]
ds_read_b128 v[48:51], v1 offset:28672
v_mfma_f32_16x16x32_bf16 v[68:71], v[52:55], a[108:111], v[68:71]
ds_read_b128 v[52:55], v14 offset:28672
v_mfma_f32_16x16x32_bf16 v[68:71], v[56:59], a[116:119], v[68:71]
ds_read_b128 v[56:59], v15 offset:28672
v_mfma_f32_16x16x32_bf16 v[68:71], v[60:63], a[124:127], v[68:71]
ds_read_b128 v[60:63], v24 offset:28672
s_waitcnt lgkmcnt(4)
v_mfma_f32_16x16x32_bf16 v[72:75], v[32:35], a[96:99], v[72:75]
buffer_load_dwordx4 a[204:207], v1, s[36:39], s50 offen offset:3072 sc1
v_mfma_f32_16x16x32_bf16 v[72:75], v[36:39], a[104:107], v[72:75]
s_add_u32 s62, s63, 655360
v_mfma_f32_16x16x32_bf16 v[72:75], v[40:43], a[112:115], v[72:75]
buffer_load_dwordx4 a[208:211], v13, s[36:39], s50 offen offset:0 sc1
v_mfma_f32_16x16x32_bf16 v[72:75], v[44:47], a[120:123], v[72:75]
v_exp_f32 v176, v176
v_mfma_f32_16x16x32_bf16 v[76:79], v[32:35], a[100:103], v[76:79]
ds_read_b128 v[32:35], v1 offset:29696
s_lshl1_add_u32 s60, s44, s60
v_mfma_f32_16x16x32_bf16 v[76:79], v[36:39], a[108:111], v[76:79]
ds_read_b128 v[36:39], v14 offset:29696
v_fma_f32 v176, v176, v18, v18
v_mfma_f32_16x16x32_bf16 v[76:79], v[40:43], a[116:119], v[76:79]
ds_read_b128 v[40:43], v15 offset:29696
v_mfma_f32_16x16x32_bf16 v[76:79], v[44:47], a[124:127], v[76:79]
ds_read_b128 v[44:47], v24 offset:29696
s_waitcnt lgkmcnt(4)
v_mfma_f32_16x16x32_bf16 v[80:83], v[48:51], a[96:99], v[80:83]
buffer_load_dwordx4 a[212:215], v13, s[36:39], s50 offen offset:1024 sc1
v_mfma_f32_16x16x32_bf16 v[80:83], v[52:55], a[104:107], v[80:83]
s_lshl_b32 s60, s60, 17
v_mfma_f32_16x16x32_bf16 v[80:83], v[56:59], a[112:115], v[80:83]
buffer_load_dwordx4 a[216:219], v13, s[36:39], s50 offen offset:2048 sc1
v_mfma_f32_16x16x32_bf16 v[80:83], v[60:63], a[120:123], v[80:83]
v_exp_f32 v177, v177
v_mfma_f32_16x16x32_bf16 v[84:87], v[48:51], a[100:103], v[84:87]
ds_read_b128 v[48:51], v1 offset:30720
v_fma_f32 v177, v177, v18, v18
v_mfma_f32_16x16x32_bf16 v[84:87], v[52:55], a[108:111], v[84:87]
ds_read_b128 v[52:55], v14 offset:30720
s_lshl2_add_u32 s65, s65, s40
v_mfma_f32_16x16x32_bf16 v[84:87], v[56:59], a[116:119], v[84:87]
ds_read_b128 v[56:59], v15 offset:30720
v_readlane_b32 s67, v27, 7
v_mfma_f32_16x16x32_bf16 v[84:87], v[60:63], a[124:127], v[84:87]
ds_read_b128 v[60:63], v24 offset:30720
s_waitcnt lgkmcnt(4)
v_mfma_f32_16x16x32_bf16 v[88:91], v[32:35], a[96:99], v[88:91]
buffer_load_dwordx4 a[220:223], v13, s[36:39], s50 offen offset:3072 sc1
v_mfma_f32_16x16x32_bf16 v[88:91], v[36:39], a[104:107], v[88:91]
s_add_u32 m0, s48, 19456
v_mfma_f32_16x16x32_bf16 v[88:91], v[40:43], a[112:115], v[88:91]
buffer_load_dwordx4 v1, s[36:39], s67 offen offset:0 sc1 lds
v_mfma_f32_16x16x32_bf16 v[88:91], v[44:47], a[120:123], v[88:91]
s_lshl_b32 s3, s65, 6
v_mfma_f32_16x16x32_bf16 v[92:95], v[32:35], a[100:103], v[92:95]
ds_read_b128 v[32:35], v1 offset:31744
v_mfma_f32_16x16x32_bf16 v[92:95], v[36:39], a[108:111], v[92:95]
ds_read_b128 v[36:39], v14 offset:31744
v_mfma_f32_16x16x32_bf16 v[92:95], v[40:43], a[116:119], v[92:95]
ds_read_b128 v[40:43], v15 offset:31744
v_mfma_f32_16x16x32_bf16 v[92:95], v[44:47], a[124:127], v[92:95]
ds_read_b128 v[44:47], v24 offset:31744
s_waitcnt lgkmcnt(4)
v_mfma_f32_16x16x32_bf16 v[96:99], v[48:51], a[96:99], v[96:99]
buffer_load_dwordx4 v1, s[36:39], s67 offen offset:1024 sc1 lds
v_mfma_f32_16x16x32_bf16 v[96:99], v[52:55], a[104:107], v[96:99]
s_add_u32 s64, s60, s3
v_mfma_f32_16x16x32_bf16 v[96:99], v[56:59], a[112:115], v[96:99]
buffer_load_dwordx4 v1, s[36:39], s67 offen offset:2048 sc1 lds
v_mfma_f32_16x16x32_bf16 v[96:99], v[60:63], a[120:123], v[96:99]
v_exp_f32 v178, v178
v_mfma_f32_16x16x32_bf16 v[100:103], v[48:51], a[100:103], v[100:103]
ds_read_b128 v[48:51], v1 offset:32768
s_lshl_b32 s3, s65, 11
v_mfma_f32_16x16x32_bf16 v[100:103], v[52:55], a[108:111], v[100:103]
ds_read_b128 v[52:55], v14 offset:32768
v_fma_f32 v178, v178, v18, v18
v_mfma_f32_16x16x32_bf16 v[100:103], v[56:59], a[116:119], v[100:103]
ds_read_b128 v[56:59], v15 offset:32768
v_mfma_f32_16x16x32_bf16 v[100:103], v[60:63], a[124:127], v[100:103]
ds_read_b128 v[60:63], v24 offset:32768
s_waitcnt lgkmcnt(4)
v_mfma_f32_16x16x32_bf16 v[104:107], v[32:35], a[96:99], v[104:107]
buffer_load_dwordx4 v1, s[36:39], s67 offen offset:3072 sc1 lds
v_mfma_f32_16x16x32_bf16 v[104:107], v[36:39], a[104:107], v[104:107]
s_add_u32 s60, s60, s3
s_add_u32 m0, s48, 23552
v_mfma_f32_16x16x32_bf16 v[104:107], v[40:43], a[112:115], v[104:107]
buffer_load_dwordx4 v13, s[36:39], s67 offen offset:0 sc1 lds
v_mfma_f32_16x16x32_bf16 v[104:107], v[44:47], a[120:123], v[104:107]
s_waitcnt vmcnt(40) lgkmcnt(0)
s_barrier
v_mfma_f32_16x16x32_bf16 v[108:111], v[32:35], a[100:103], v[108:111]
ds_read_b128 v[32:35], v1 offset:33792
v_mfma_f32_16x16x32_bf16 v[108:111], v[36:39], a[108:111], v[108:111]
ds_read_b128 v[36:39], v14 offset:33792
v_mfma_f32_16x16x32_bf16 v[108:111], v[40:43], a[116:119], v[108:111]
ds_read_b128 v[40:43], v15 offset:33792
s_add_u32 s60, s60, 16777216
v_mfma_f32_16x16x32_bf16 v[108:111], v[44:47], a[124:127], v[108:111]
ds_read_b128 v[44:47], v24 offset:33792
v_mfma_f32_16x16x32_bf16 v[112:115], v[48:51], a[96:99], v[112:115]
buffer_load_dwordx4 v13, s[36:39], s67 offen offset:1024 sc1 lds
v_mfma_f32_16x16x32_bf16 v[112:115], v[52:55], a[104:107], v[112:115]
v_exp_f32 v179, v179
v_mfma_f32_16x16x32_bf16 v[112:115], v[56:59], a[112:115], v[112:115]
buffer_load_dwordx4 v13, s[36:39], s67 offen offset:2048 sc1 lds
v_mfma_f32_16x16x32_bf16 v[112:115], v[60:63], a[120:123], v[112:115]
s_add_u32 s65, s60, 65536
v_fma_f32 v179, v179, v18, v18
v_mfma_f32_16x16x32_bf16 v[116:119], v[48:51], a[100:103], v[116:119]
ds_read_b128 v[48:51], v1 offset:34816
v_mfma_f32_16x16x32_bf16 v[116:119], v[52:55], a[108:111], v[116:119]
ds_read_b128 v[52:55], v14 offset:34816
v_readlane_b32 s66, v28, 7
v_mfma_f32_16x16x32_bf16 v[116:119], v[56:59], a[116:119], v[116:119]
ds_read_b128 v[56:59], v15 offset:34816
v_mfma_f32_16x16x32_bf16 v[116:119], v[60:63], a[124:127], v[116:119]
ds_read_b128 v[60:63], v24 offset:34816
s_waitcnt vmcnt(37) lgkmcnt(4)
v_mfma_f32_16x16x32_bf16 v[64:67], v[32:35], a[128:131], v[64:67]
buffer_load_dwordx4 a[224:227], v1, s[36:39], s66 offen offset:0 sc1
v_mfma_f32_16x16x32_bf16 v[64:67], v[36:39], a[136:139], v[64:67]
v_exp_f32 v180, v180
v_mfma_f32_16x16x32_bf16 v[64:67], v[40:43], a[144:147], v[64:67]
buffer_load_dwordx4 a[228:231], v1, s[36:39], s66 offen offset:1024 sc1
v_mfma_f32_16x16x32_bf16 v[64:67], v[44:47], a[152:155], v[64:67]
v_exp_f32 v181, v181
v_mfma_f32_16x16x32_bf16 v[68:71], v[32:35], a[132:135], v[68:71]
ds_read_b128 v[32:35], v1 offset:35840
v_fma_f32 v180, v180, v19, v19
v_mfma_f32_16x16x32_bf16 v[68:71], v[36:39], a[140:143], v[68:71]
ds_read_b128 v[36:39], v14 offset:35840
v_fma_f32 v181, v181, v19, v19
v_mfma_f32_16x16x32_bf16 v[68:71], v[40:43], a[148:151], v[68:71]
ds_read_b128 v[40:43], v15 offset:35840
v_mfma_f32_16x16x32_bf16 v[68:71], v[44:47], a[156:159], v[68:71]
ds_read_b128 v[44:47], v24 offset:35840
s_waitcnt lgkmcnt(4)
v_mfma_f32_16x16x32_bf16 v[72:75], v[48:51], a[128:131], v[72:75]
buffer_load_dwordx4 a[232:235], v1, s[36:39], s66 offen offset:2048 sc1
v_mfma_f32_16x16x32_bf16 v[72:75], v[52:55], a[136:139], v[72:75]
v_exp_f32 v182, v182
v_mfma_f32_16x16x32_bf16 v[72:75], v[56:59], a[144:147], v[72:75]
buffer_load_dwordx4 a[236:239], v1, s[36:39], s66 offen offset:3072 sc1
v_mfma_f32_16x16x32_bf16 v[72:75], v[60:63], a[152:155], v[72:75]
v_exp_f32 v183, v183
v_mfma_f32_16x16x32_bf16 v[76:79], v[48:51], a[132:135], v[76:79]
ds_read_b128 v[48:51], v1 offset:36864
v_fma_f32 v182, v182, v19, v19
v_mfma_f32_16x16x32_bf16 v[76:79], v[52:55], a[140:143], v[76:79]
ds_read_b128 v[52:55], v14 offset:36864
v_fma_f32 v183, v183, v19, v19
v_mfma_f32_16x16x32_bf16 v[76:79], v[56:59], a[148:151], v[76:79]
ds_read_b128 v[56:59], v15 offset:36864
v_mfma_f32_16x16x32_bf16 v[76:79], v[60:63], a[156:159], v[76:79]
ds_read_b128 v[60:63], v24 offset:36864
s_waitcnt lgkmcnt(4)
v_mfma_f32_16x16x32_bf16 v[80:83], v[32:35], a[128:131], v[80:83]
buffer_load_dwordx4 a[240:243], v13, s[36:39], s66 offen offset:0 sc1
v_mfma_f32_16x16x32_bf16 v[80:83], v[36:39], a[136:139], v[80:83]
v_rcp_f32 v176, v176
v_mfma_f32_16x16x32_bf16 v[80:83], v[40:43], a[144:147], v[80:83]
buffer_load_dwordx4 a[244:247], v13, s[36:39], s66 offen offset:1024 sc1
v_mfma_f32_16x16x32_bf16 v[80:83], v[44:47], a[152:155], v[80:83]
v_rcp_f32 v177, v177
v_mfma_f32_16x16x32_bf16 v[84:87], v[32:35], a[132:135], v[84:87]
ds_read_b128 v[32:35], v1 offset:37888
v_mul_f32 v128, v128, v176
v_mfma_f32_16x16x32_bf16 v[84:87], v[36:39], a[140:143], v[84:87]
ds_read_b128 v[36:39], v14 offset:37888
v_mul_f32 v129, v129, v177
v_mfma_f32_16x16x32_bf16 v[84:87], v[40:43], a[148:151], v[84:87]
ds_read_b128 v[40:43], v15 offset:37888
v_mul_f32 v176, v136, v136
v_mfma_f32_16x16x32_bf16 v[84:87], v[44:47], a[156:159], v[84:87]
ds_read_b128 v[44:47], v24 offset:37888
s_waitcnt lgkmcnt(4)
v_mfma_f32_16x16x32_bf16 v[88:91], v[48:51], a[128:131], v[88:91]
buffer_load_dwordx4 a[248:251], v13, s[36:39], s66 offen offset:2048 sc1
v_mfma_f32_16x16x32_bf16 v[88:91], v[52:55], a[136:139], v[88:91]
v_rcp_f32 v178, v178
v_mfma_f32_16x16x32_bf16 v[88:91], v[56:59], a[144:147], v[88:91]
buffer_load_dwordx4 a[252:255], v13, s[36:39], s66 offen offset:3072 sc1
v_mfma_f32_16x16x32_bf16 v[88:91], v[60:63], a[152:155], v[88:91]
v_rcp_f32 v179, v179
v_mfma_f32_16x16x32_bf16 v[92:95], v[48:51], a[132:135], v[92:95]
ds_read_b128 v[48:51], v1 offset:38912
v_mul_f32 v130, v130, v178
v_mfma_f32_16x16x32_bf16 v[92:95], v[52:55], a[140:143], v[92:95]
ds_read_b128 v[52:55], v14 offset:38912
v_readlane_b32 s51, v27, 8
v_mfma_f32_16x16x32_bf16 v[92:95], v[56:59], a[148:151], v[92:95]
ds_read_b128 v[56:59], v15 offset:38912
s_add_u32 m0, s48, 26624
v_mfma_f32_16x16x32_bf16 v[92:95], v[60:63], a[156:159], v[92:95]
ds_read_b128 v[60:63], v24 offset:38912
s_waitcnt lgkmcnt(4)
v_mfma_f32_16x16x32_bf16 v[96:99], v[32:35], a[128:131], v[96:99]
buffer_load_dwordx4 v1, s[36:39], s51 offen offset:0 sc1 lds
v_mfma_f32_16x16x32_bf16 v[96:99], v[36:39], a[136:139], v[96:99]
v_rcp_f32 v180, v180
v_mfma_f32_16x16x32_bf16 v[96:99], v[40:43], a[144:147], v[96:99]
buffer_load_dwordx4 v1, s[36:39], s51 offen offset:1024 sc1 lds
v_mfma_f32_16x16x32_bf16 v[96:99], v[44:47], a[152:155], v[96:99]
v_rcp_f32 v181, v181
v_mfma_f32_16x16x32_bf16 v[100:103], v[32:35], a[132:135], v[100:103]
ds_read_b128 v[32:35], v1 offset:39936
v_mul_f32 v131, v131, v179
v_mfma_f32_16x16x32_bf16 v[100:103], v[36:39], a[140:143], v[100:103]
ds_read_b128 v[36:39], v14 offset:39936
v_mul_f32 v132, v132, v180
v_mfma_f32_16x16x32_bf16 v[100:103], v[40:43], a[148:151], v[100:103]
ds_read_b128 v[40:43], v15 offset:39936
v_mul_f32 v133, v133, v181
v_mfma_f32_16x16x32_bf16 v[100:103], v[44:47], a[156:159], v[100:103]
ds_read_b128 v[44:47], v24 offset:39936
s_waitcnt lgkmcnt(4)
v_mfma_f32_16x16x32_bf16 v[104:107], v[48:51], a[128:131], v[104:107]
buffer_load_dwordx4 v1, s[36:39], s51 offen offset:2048 sc1 lds
v_mfma_f32_16x16x32_bf16 v[104:107], v[52:55], a[136:139], v[104:107]
v_rcp_f32 v182, v182
v_mfma_f32_16x16x32_bf16 v[104:107], v[56:59], a[144:147], v[104:107]
buffer_load_dwordx4 v1, s[36:39], s51 offen offset:3072 sc1 lds
v_mfma_f32_16x16x32_bf16 v[104:107], v[60:63], a[152:155], v[104:107]
s_waitcnt vmcnt(42) lgkmcnt(0)
s_barrier
v_mfma_f32_16x16x32_bf16 v[108:111], v[48:51], a[132:135], v[108:111]
ds_read_b128 v[48:51], v1 offset:5120
v_mul_f32 v134, v134, v182
v_mfma_f32_16x16x32_bf16 v[108:111], v[52:55], a[140:143], v[108:111]
ds_read_b128 v[52:55], v14 offset:5120
v_mul_f32 v177, v137, v137
v_mfma_f32_16x16x32_bf16 v[108:111], v[56:59], a[148:151], v[108:111]
ds_read_b128 v[56:59], v15 offset:5120
s_add_u32 m0, s48, 30720
v_mfma_f32_16x16x32_bf16 v[108:111], v[60:63], a[156:159], v[108:111]
ds_read_b128 v[60:63], v24 offset:5120
v_mfma_f32_16x16x32_bf16 v[112:115], v[32:35], a[128:131], v[112:115]
buffer_load_dwordx4 v13, s[36:39], s51 offen offset:0 sc1 lds
v_mfma_f32_16x16x32_bf16 v[112:115], v[36:39], a[136:139], v[112:115]
v_rcp_f32 v183, v183
v_mfma_f32_16x16x32_bf16 v[112:115], v[40:43], a[144:147], v[112:115]
buffer_load_dwordx4 v13, s[36:39], s51 offen offset:1024 sc1 lds
v_mfma_f32_16x16x32_bf16 v[112:115], v[44:47], a[152:155], v[112:115]
v_mul_f32 v135, v135, v183
v_mul_f32 v178, v138, v138
v_mfma_f32_16x16x32_bf16 v[116:119], v[32:35], a[132:135], v[116:119]
ds_read_b128 v[32:35], v1 offset:6144
v_mul_f32 v179, v139, v139
v_mfma_f32_16x16x32_bf16 v[116:119], v[36:39], a[140:143], v[116:119]
ds_read_b128 v[36:39], v14 offset:6144
v_mul_f32 v180, v140, v140
v_mfma_f32_16x16x32_bf16 v[116:119], v[40:43], a[148:151], v[116:119]
ds_read_b128 v[40:43], v15 offset:6144
v_readlane_b32 s50, v28, 8
v_mfma_f32_16x16x32_bf16 v[116:119], v[44:47], a[156:159], v[116:119]
ds_read_b128 v[44:47], v24 offset:6144
s_waitcnt vmcnt(36) lgkmcnt(4)
v_mfma_f32_16x16x32_bf16 v[64:67], v[48:51], a[160:163], v[64:67]
buffer_load_dwordx4 v13, s[36:39], s51 offen offset:2048 sc1 lds
v_mfma_f32_16x16x32_bf16 v[64:67], v[52:55], a[168:171], v[64:67]
v_mul_f32 v181, v141, v141
v_mul_f32 v182, v142, v142
v_mfma_f32_16x16x32_bf16 v[64:67], v[56:59], a[176:179], v[64:67]
buffer_load_dwordx4 a[0:3], v1, s[36:39], s50 offen offset:0 sc1
v_mfma_f32_16x16x32_bf16 v[64:67], v[60:63], a[184:187], v[64:67]
v_mul_f32 v183, v143, v143
v_fma_f32 v176, v176, v22, v20
v_mfma_f32_16x16x32_bf16 v[68:71], v[48:51], a[164:167], v[68:71]
ds_read_b128 v[48:51], v1 offset:7168
v_fma_f32 v177, v177, v22, v20
v_mfma_f32_16x16x32_bf16 v[68:71], v[52:55], a[172:175], v[68:71]
ds_read_b128 v[52:55], v14 offset:7168
v_fma_f32 v178, v178, v22, v20
v_mfma_f32_16x16x32_bf16 v[68:71], v[56:59], a[180:183], v[68:71]
ds_read_b128 v[56:59], v15 offset:7168
v_fma_f32 v179, v179, v22, v20
v_mfma_f32_16x16x32_bf16 v[68:71], v[60:63], a[188:191], v[68:71]
ds_read_b128 v[60:63], v24 offset:7168
s_waitcnt lgkmcnt(4)
v_mfma_f32_16x16x32_bf16 v[72:75], v[32:35], a[160:163], v[72:75]
buffer_load_dwordx4 a[4:7], v1, s[36:39], s50 offen offset:1024 sc1
v_mfma_f32_16x16x32_bf16 v[72:75], v[36:39], a[168:171], v[72:75]
v_fma_f32 v180, v180, v23, v21
v_fma_f32 v181, v181, v23, v21
v_mfma_f32_16x16x32_bf16 v[72:75], v[40:43], a[176:179], v[72:75]
buffer_load_dwordx4 a[8:11], v1, s[36:39], s50 offen offset:2048 sc1
v_mfma_f32_16x16x32_bf16 v[72:75], v[44:47], a[184:187], v[72:75]
v_fma_f32 v182, v182, v23, v21
v_fma_f32 v183, v183, v23, v21
v_mfma_f32_16x16x32_bf16 v[76:79], v[32:35], a[164:167], v[76:79]
ds_read_b128 v[32:35], v1 offset:8192
v_mul_f32 v176, v176, v136
v_mfma_f32_16x16x32_bf16 v[76:79], v[36:39], a[172:175], v[76:79]
ds_read_b128 v[36:39], v14 offset:8192
v_mul_f32 v177, v177, v137
v_mfma_f32_16x16x32_bf16 v[76:79], v[40:43], a[180:183], v[76:79]
ds_read_b128 v[40:43], v15 offset:8192
v_mul_f32 v178, v178, v138
v_mfma_f32_16x16x32_bf16 v[76:79], v[44:47], a[188:191], v[76:79]
ds_read_b128 v[44:47], v24 offset:8192
s_waitcnt lgkmcnt(4)
v_mfma_f32_16x16x32_bf16 v[80:83], v[48:51], a[160:163], v[80:83]
buffer_load_dwordx4 a[12:15], v1, s[36:39], s50 offen offset:3072 sc1
v_mfma_f32_16x16x32_bf16 v[80:83], v[52:55], a[168:171], v[80:83]
v_mul_f32 v179, v179, v139
v_mul_f32 v180, v180, v140
v_mfma_f32_16x16x32_bf16 v[80:83], v[56:59], a[176:179], v[80:83]
buffer_load_dwordx4 a[16:19], v13, s[36:39], s50 offen offset:0 sc1
v_mfma_f32_16x16x32_bf16 v[80:83], v[60:63], a[184:187], v[80:83]
v_mul_f32 v181, v181, v141
v_mul_f32 v182, v182, v142
v_mfma_f32_16x16x32_bf16 v[84:87], v[48:51], a[164:167], v[84:87]
ds_read_b128 v[48:51], v1 offset:9216
v_mul_f32 v183, v183, v143
v_mfma_f32_16x16x32_bf16 v[84:87], v[52:55], a[172:175], v[84:87]
ds_read_b128 v[52:55], v14 offset:9216
v_mfma_f32_16x16x32_bf16 v[84:87], v[56:59], a[180:183], v[84:87]
ds_read_b128 v[56:59], v15 offset:9216
v_mfma_f32_16x16x32_bf16 v[84:87], v[60:63], a[188:191], v[84:87]
ds_read_b128 v[60:63], v24 offset:9216
s_waitcnt lgkmcnt(4)
v_mfma_f32_16x16x32_bf16 v[88:91], v[32:35], a[160:163], v[88:91]
buffer_load_dwordx4 a[20:23], v13, s[36:39], s50 offen offset:1024 sc1
v_mfma_f32_16x16x32_bf16 v[88:91], v[36:39], a[168:171], v[88:91]
v_exp_f32 v176, v176
v_mfma_f32_16x16x32_bf16 v[88:91], v[40:43], a[176:179], v[88:91]
buffer_load_dwordx4 a[24:27], v13, s[36:39], s50 offen offset:2048 sc1
v_mfma_f32_16x16x32_bf16 v[88:91], v[44:47], a[184:187], v[88:91]
v_exp_f32 v177, v177
v_mfma_f32_16x16x32_bf16 v[92:95], v[32:35], a[164:167], v[92:95]
ds_read_b128 v[32:35], v1 offset:10240
v_fma_f32 v176, v176, v18, v18
v_mfma_f32_16x16x32_bf16 v[92:95], v[36:39], a[172:175], v[92:95]
ds_read_b128 v[36:39], v14 offset:10240
v_fma_f32 v177, v177, v18, v18
v_mfma_f32_16x16x32_bf16 v[92:95], v[40:43], a[180:183], v[92:95]
ds_read_b128 v[40:43], v15 offset:10240
v_readlane_b32 s67, v27, 9
v_mfma_f32_16x16x32_bf16 v[92:95], v[44:47], a[188:191], v[92:95]
ds_read_b128 v[44:47], v24 offset:10240
s_waitcnt lgkmcnt(4)
v_mfma_f32_16x16x32_bf16 v[96:99], v[48:51], a[160:163], v[96:99]
buffer_load_dwordx4 a[28:31], v13, s[36:39], s50 offen offset:3072 sc1
v_mfma_f32_16x16x32_bf16 v[96:99], v[52:55], a[168:171], v[96:99]
s_add_u32 m0, s48, 33792
v_mfma_f32_16x16x32_bf16 v[96:99], v[56:59], a[176:179], v[96:99]
buffer_load_dwordx4 v1, s[36:39], s67 offen offset:0 sc1 lds
v_mfma_f32_16x16x32_bf16 v[96:99], v[60:63], a[184:187], v[96:99]
v_exp_f32 v178, v178
v_mfma_f32_16x16x32_bf16 v[100:103], v[48:51], a[164:167], v[100:103]
ds_read_b128 v[48:51], v1 offset:11264
v_fma_f32 v178, v178, v18, v18
v_mfma_f32_16x16x32_bf16 v[100:103], v[52:55], a[172:175], v[100:103]
ds_read_b128 v[52:55], v14 offset:11264
v_mfma_f32_16x16x32_bf16 v[100:103], v[56:59], a[180:183], v[100:103]
ds_read_b128 v[56:59], v15 offset:11264
v_mfma_f32_16x16x32_bf16 v[100:103], v[60:63], a[188:191], v[100:103]
ds_read_b128 v[60:63], v24 offset:11264
s_waitcnt lgkmcnt(4)
v_mfma_f32_16x16x32_bf16 v[104:107], v[32:35], a[160:163], v[104:107]
buffer_load_dwordx4 v1, s[36:39], s67 offen offset:1024 sc1 lds
v_mfma_f32_16x16x32_bf16 v[104:107], v[36:39], a[168:171], v[104:107]
v_exp_f32 v179, v179
v_mfma_f32_16x16x32_bf16 v[104:107], v[40:43], a[176:179], v[104:107]
buffer_load_dwordx4 v1, s[36:39], s67 offen offset:2048 sc1 lds
v_mfma_f32_16x16x32_bf16 v[104:107], v[44:47], a[184:187], v[104:107]
s_waitcnt vmcnt(41) lgkmcnt(0)
s_barrier
v_mfma_f32_16x16x32_bf16 v[108:111], v[32:35], a[164:167], v[108:111]
ds_read_b128 v[32:35], v1 offset:12288
v_fma_f32 v179, v179, v18, v18
v_mfma_f32_16x16x32_bf16 v[108:111], v[36:39], a[172:175], v[108:111]
ds_read_b128 v[36:39], v14 offset:12288
v_mfma_f32_16x16x32_bf16 v[108:111], v[40:43], a[180:183], v[108:111]
ds_read_b128 v[40:43], v15 offset:12288
v_mfma_f32_16x16x32_bf16 v[108:111], v[44:47], a[188:191], v[108:111]
ds_read_b128 v[44:47], v24 offset:12288
v_mfma_f32_16x16x32_bf16 v[112:115], v[48:51], a[160:163], v[112:115]
buffer_load_dwordx4 v1, s[36:39], s67 offen offset:3072 sc1 lds
v_mfma_f32_16x16x32_bf16 v[112:115], v[52:55], a[168:171], v[112:115]
s_add_u32 m0, s48, 37888
v_mfma_f32_16x16x32_bf16 v[112:115], v[56:59], a[176:179], v[112:115]
buffer_load_dwordx4 v13, s[36:39], s67 offen offset:0 sc1 lds
v_mfma_f32_16x16x32_bf16 v[112:115], v[60:63], a[184:187], v[112:115]
v_exp_f32 v180, v180
v_mfma_f32_16x16x32_bf16 v[116:119], v[48:51], a[164:167], v[116:119]
ds_read_b128 v[48:51], v1 offset:13312
v_fma_f32 v180, v180, v19, v19
v_mfma_f32_16x16x32_bf16 v[116:119], v[52:55], a[172:175], v[116:119]
ds_read_b128 v[52:55], v14 offset:13312
v_mfma_f32_16x16x32_bf16 v[116:119], v[56:59], a[180:183], v[116:119]
ds_read_b128 v[56:59], v15 offset:13312
v_mfma_f32_16x16x32_bf16 v[116:119], v[60:63], a[188:191], v[116:119]
ds_read_b128 v[60:63], v24 offset:13312
s_waitcnt vmcnt(35) lgkmcnt(4)
v_mfma_f32_16x16x32_bf16 v[64:67], v[32:35], a[192:195], v[64:67]
buffer_load_dwordx4 v13, s[36:39], s67 offen offset:1024 sc1 lds
v_mfma_f32_16x16x32_bf16 v[64:67], v[36:39], a[200:203], v[64:67]
v_exp_f32 v181, v181
v_mfma_f32_16x16x32_bf16 v[64:67], v[40:43], a[208:211], v[64:67]
buffer_load_dwordx4 v13, s[36:39], s67 offen offset:2048 sc1 lds
v_mfma_f32_16x16x32_bf16 v[64:67], v[44:47], a[216:219], v[64:67]
v_exp_f32 v182, v182
v_mfma_f32_16x16x32_bf16 v[68:71], v[32:35], a[196:199], v[68:71]
ds_read_b128 v[32:35], v1 offset:14336
v_fma_f32 v181, v181, v19, v19
v_mfma_f32_16x16x32_bf16 v[68:71], v[36:39], a[204:207], v[68:71]
ds_read_b128 v[36:39], v14 offset:14336
v_readlane_b32 s66, v28, 9
v_mfma_f32_16x16x32_bf16 v[68:71], v[40:43], a[212:215], v[68:71]
ds_read_b128 v[40:43], v15 offset:14336
v_fma_f32 v182, v182, v19, v19
v_mfma_f32_16x16x32_bf16 v[68:71], v[44:47], a[220:223], v[68:71]
ds_read_b128 v[44:47], v24 offset:14336
TP53:
s_cbranch_execz TP4
TP54:
s_cbranch_execz TP62
s_waitcnt lgkmcnt(4)
v_mfma_f32_16x16x32_bf16 v[72:75], v[48:51], a[192:195], v[72:75]
buffer_load_dwordx4 a[32:35], v1, s[36:39], s66 offen offset:0 sc1
v_mfma_f32_16x16x32_bf16 v[72:75], v[52:55], a[200:203], v[72:75]
v_exp_f32 v183, v183
v_mfma_f32_16x16x32_bf16 v[72:75], v[56:59], a[208:211], v[72:75]
buffer_load_dwordx4 a[36:39], v1, s[36:39], s66 offen offset:1024 sc1
v_mfma_f32_16x16x32_bf16 v[72:75], v[60:63], a[216:219], v[72:75]
v_fma_f32 v183, v183, v19, v19
v_mfma_f32_16x16x32_bf16 v[76:79], v[48:51], a[196:199], v[76:79]
ds_read_b128 v[48:51], v1 offset:15360
v_mfma_f32_16x16x32_bf16 v[76:79], v[52:55], a[204:207], v[76:79]
ds_read_b128 v[52:55], v14 offset:15360
v_mfma_f32_16x16x32_bf16 v[76:79], v[56:59], a[212:215], v[76:79]
ds_read_b128 v[56:59], v15 offset:15360
v_mfma_f32_16x16x32_bf16 v[76:79], v[60:63], a[220:223], v[76:79]
ds_read_b128 v[60:63], v24 offset:15360
s_waitcnt lgkmcnt(4)
v_mfma_f32_16x16x32_bf16 v[80:83], v[32:35], a[192:195], v[80:83]
buffer_load_dwordx4 a[40:43], v1, s[36:39], s66 offen offset:2048 sc1
v_mfma_f32_16x16x32_bf16 v[80:83], v[36:39], a[200:203], v[80:83]
v_rcp_f32 v176, v176
v_mfma_f32_16x16x32_bf16 v[80:83], v[40:43], a[208:211], v[80:83]
buffer_load_dwordx4 a[44:47], v1, s[36:39], s66 offen offset:3072 sc1
v_mfma_f32_16x16x32_bf16 v[80:83], v[44:47], a[216:219], v[80:83]
v_rcp_f32 v177, v177
v_mfma_f32_16x16x32_bf16 v[84:87], v[32:35], a[196:199], v[84:87]
ds_read_b128 v[32:35], v1 offset:16384
v_mul_f32 v136, v136, v176
v_mfma_f32_16x16x32_bf16 v[84:87], v[36:39], a[204:207], v[84:87]
ds_read_b128 v[36:39], v14 offset:16384
v_mul_f32 v137, v137, v177
v_mfma_f32_16x16x32_bf16 v[84:87], v[40:43], a[212:215], v[84:87]
ds_read_b128 v[40:43], v15 offset:16384
v_mul_f32 v176, v144, v144
v_mfma_f32_16x16x32_bf16 v[84:87], v[44:47], a[220:223], v[84:87]
ds_read_b128 v[44:47], v24 offset:16384
s_waitcnt lgkmcnt(4)
v_mfma_f32_16x16x32_bf16 v[88:91], v[48:51], a[192:195], v[88:91]
buffer_load_dwordx4 a[48:51], v13, s[36:39], s66 offen offset:0 sc1
v_mfma_f32_16x16x32_bf16 v[88:91], v[52:55], a[200:203], v[88:91]
v_rcp_f32 v178, v178
v_mfma_f32_16x16x32_bf16 v[88:91], v[56:59], a[208:211], v[88:91]
buffer_load_dwordx4 a[52:55], v13, s[36:39], s66 offen offset:1024 sc1
v_mfma_f32_16x16x32_bf16 v[88:91], v[60:63], a[216:219], v[88:91]
v_rcp_f32 v179, v179
v_mfma_f32_16x16x32_bf16 v[92:95], v[48:51], a[196:199], v[92:95]
ds_read_b128 v[48:51], v1 offset:17408
v_mul_f32 v138, v138, v178
v_mfma_f32_16x16x32_bf16 v[92:95], v[52:55], a[204:207], v[92:95]
ds_read_b128 v[52:55], v14 offset:17408
v_mul_f32 v139, v139, v179
v_mfma_f32_16x16x32_bf16 v[92:95], v[56:59], a[212:215], v[92:95]
ds_read_b128 v[56:59], v15 offset:17408
v_mul_f32 v177, v145, v145
v_mfma_f32_16x16x32_bf16 v[92:95], v[60:63], a[220:223], v[92:95]
ds_read_b128 v[60:63], v24 offset:17408
s_waitcnt lgkmcnt(4)
v_mfma_f32_16x16x32_bf16 v[96:99], v[32:35], a[192:195], v[96:99]
buffer_load_dwordx4 a[56:59], v13, s[36:39], s66 offen offset:2048 sc1
v_mfma_f32_16x16x32_bf16 v[96:99], v[36:39], a[200:203], v[96:99]
v_rcp_f32 v180, v180
v_mfma_f32_16x16x32_bf16 v[96:99], v[40:43], a[208:211], v[96:99]
buffer_load_dwordx4 a[60:63], v13, s[36:39], s66 offen offset:3072 sc1
v_mfma_f32_16x16x32_bf16 v[96:99], v[44:47], a[216:219], v[96:99]
v_rcp_f32 v181, v181
v_mfma_f32_16x16x32_bf16 v[100:103], v[32:35], a[196:199], v[100:103]
ds_read_b128 v[32:35], v1 offset:18432
v_mul_f32 v140, v140, v180
v_mfma_f32_16x16x32_bf16 v[100:103], v[36:39], a[204:207], v[100:103]
ds_read_b128 v[36:39], v14 offset:18432
v_readlane_b32 s51, v27, 10
v_mfma_f32_16x16x32_bf16 v[100:103], v[40:43], a[212:215], v[100:103]
ds_read_b128 v[40:43], v15 offset:18432
s_add_u32 m0, s48, 5120
v_mfma_f32_16x16x32_bf16 v[100:103], v[44:47], a[220:223], v[100:103]
ds_read_b128 v[44:47], v24 offset:18432
s_waitcnt lgkmcnt(4)
v_mfma_f32_16x16x32_bf16 v[104:107], v[48:51], a[192:195], v[104:107]
buffer_load_dwordx4 v1, s[36:39], s51 offen offset:0 sc1 lds
v_mfma_f32_16x16x32_bf16 v[104:107], v[52:55], a[200:203], v[104:107]
v_rcp_f32 v182, v182
v_mfma_f32_16x16x32_bf16 v[104:107], v[56:59], a[208:211], v[104:107]
buffer_load_dwordx4 v1, s[36:39], s51 offen offset:1024 sc1 lds
v_mfma_f32_16x16x32_bf16 v[104:107], v[60:63], a[216:219], v[104:107]
s_waitcnt vmcnt(40) lgkmcnt(0)
s_barrier
v_mfma_f32_16x16x32_bf16 v[108:111], v[48:51], a[196:199], v[108:111]
ds_read_b128 v[48:51], v1 offset:19456
v_mul_f32 v141, v141, v181
v_mfma_f32_16x16x32_bf16 v[108:111], v[52:55], a[204:207], v[108:111]
ds_read_b128 v[52:55], v14 offset:19456
v_mul_f32 v142, v142, v182
v_mfma_f32_16x16x32_bf16 v[108:111], v[56:59], a[212:215], v[108:111]
ds_read_b128 v[56:59], v15 offset:19456
v_mul_f32 v178, v146, v146
v_mfma_f32_16x16x32_bf16 v[108:111], v[60:63], a[220:223], v[108:111]
ds_read_b128 v[60:63], v24 offset:19456
v_mfma_f32_16x16x32_bf16 v[112:115], v[32:35], a[192:195], v[112:115]
buffer_load_dwordx4 v1, s[36:39], s51 offen offset:2048 sc1 lds
v_mfma_f32_16x16x32_bf16 v[112:115], v[36:39], a[200:203], v[112:115]
v_rcp_f32 v183, v183
v_mfma_f32_16x16x32_bf16 v[112:115], v[40:43], a[208:211], v[112:115]
buffer_load_dwordx4 v1, s[36:39], s51 offen offset:3072 sc1 lds
v_mfma_f32_16x16x32_bf16 v[112:115], v[44:47], a[216:219], v[112:115]
v_mul_f32 v143, v143, v183
v_mul_f32 v179, v147, v147
v_mfma_f32_16x16x32_bf16 v[116:119], v[32:35], a[196:199], v[116:119]
ds_read_b128 v[32:35], v1 offset:20480
v_mul_f32 v180, v148, v148
v_mfma_f32_16x16x32_bf16 v[116:119], v[36:39], a[204:207], v[116:119]
ds_read_b128 v[36:39], v14 offset:20480
v_mul_f32 v181, v149, v149
v_mfma_f32_16x16x32_bf16 v[116:119], v[40:43], a[212:215], v[116:119]
ds_read_b128 v[40:43], v15 offset:20480
s_add_u32 m0, s48, 9216
v_mfma_f32_16x16x32_bf16 v[116:119], v[44:47], a[220:223], v[116:119]
ds_read_b128 v[44:47], v24 offset:20480
s_waitcnt vmcnt(34) lgkmcnt(4)
v_mfma_f32_16x16x32_bf16 v[64:67], v[48:51], a[224:227], v[64:67]
buffer_load_dwordx4 v13, s[36:39], s51 offen offset:0 sc1 lds
v_mfma_f32_16x16x32_bf16 v[64:67], v[52:55], a[232:235], v[64:67]
v_mul_f32 v182, v150, v150
v_mul_f32 v183, v151, v151
v_mfma_f32_16x16x32_bf16 v[64:67], v[56:59], a[240:243], v[64:67]
buffer_load_dwordx4 v13, s[36:39], s51 offen offset:1024 sc1 lds
v_mfma_f32_16x16x32_bf16 v[64:67], v[60:63], a[248:251], v[64:67]
v_fma_f32 v176, v176, v22, v20
v_fma_f32 v177, v177, v22, v20
v_mfma_f32_16x16x32_bf16 v[68:71], v[48:51], a[228:231], v[68:71]
ds_read_b128 v[48:51], v1 offset:21504
v_fma_f32 v178, v178, v22, v20
v_mfma_f32_16x16x32_bf16 v[68:71], v[52:55], a[236:239], v[68:71]
ds_read_b128 v[52:55], v14 offset:21504
v_fma_f32 v179, v179, v22, v20
v_mfma_f32_16x16x32_bf16 v[68:71], v[56:59], a[244:247], v[68:71]
ds_read_b128 v[56:59], v15 offset:21504
v_readlane_b32 s50, v28, 10
v_mfma_f32_16x16x32_bf16 v[68:71], v[60:63], a[252:255], v[68:71]
ds_read_b128 v[60:63], v24 offset:21504
s_waitcnt lgkmcnt(4)
v_mfma_f32_16x16x32_bf16 v[72:75], v[32:35], a[224:227], v[72:75]
buffer_load_dwordx4 v13, s[36:39], s51 offen offset:2048 sc1 lds
v_mfma_f32_16x16x32_bf16 v[72:75], v[36:39], a[232:235], v[72:75]
v_fma_f32 v180, v180, v23, v21
v_fma_f32 v181, v181, v23, v21
v_mfma_f32_16x16x32_bf16 v[72:75], v[40:43], a[240:243], v[72:75]
buffer_load_dwordx4 a[64:67], v1, s[36:39], s50 offen offset:0 sc1
v_mfma_f32_16x16x32_bf16 v[72:75], v[44:47], a[248:251], v[72:75]
v_fma_f32 v182, v182, v23, v21
v_fma_f32 v183, v183, v23, v21
v_mfma_f32_16x16x32_bf16 v[76:79], v[32:35], a[228:231], v[76:79]
ds_read_b128 v[32:35], v1 offset:22528
v_mul_f32 v176, v176, v144
v_mfma_f32_16x16x32_bf16 v[76:79], v[36:39], a[236:239], v[76:79]
ds_read_b128 v[36:39], v14 offset:22528
v_mul_f32 v177, v177, v145
v_mfma_f32_16x16x32_bf16 v[76:79], v[40:43], a[244:247], v[76:79]
ds_read_b128 v[40:43], v15 offset:22528
v_mul_f32 v178, v178, v146
v_mfma_f32_16x16x32_bf16 v[76:79], v[44:47], a[252:255], v[76:79]
ds_read_b128 v[44:47], v24 offset:22528
s_waitcnt lgkmcnt(4)
v_mfma_f32_16x16x32_bf16 v[80:83], v[48:51], a[224:227], v[80:83]
buffer_load_dwordx4 a[68:71], v1, s[36:39], s50 offen offset:1024 sc1
v_mfma_f32_16x16x32_bf16 v[80:83], v[52:55], a[232:235], v[80:83]
v_mul_f32 v179, v179, v147
v_mul_f32 v180, v180, v148
v_mfma_f32_16x16x32_bf16 v[80:83], v[56:59], a[240:243], v[80:83]
buffer_load_dwordx4 a[72:75], v1, s[36:39], s50 offen offset:2048 sc1
v_mfma_f32_16x16x32_bf16 v[80:83], v[60:63], a[248:251], v[80:83]
v_mul_f32 v181, v181, v149
v_mul_f32 v182, v182, v150
v_mfma_f32_16x16x32_bf16 v[84:87], v[48:51], a[228:231], v[84:87]
ds_read_b128 v[48:51], v1 offset:23552
v_mul_f32 v183, v183, v151
v_mfma_f32_16x16x32_bf16 v[84:87], v[52:55], a[236:239], v[84:87]
ds_read_b128 v[52:55], v14 offset:23552
v_mfma_f32_16x16x32_bf16 v[84:87], v[56:59], a[244:247], v[84:87]
ds_read_b128 v[56:59], v15 offset:23552
v_mfma_f32_16x16x32_bf16 v[84:87], v[60:63], a[252:255], v[84:87]
ds_read_b128 v[60:63], v24 offset:23552
s_waitcnt lgkmcnt(4)
v_mfma_f32_16x16x32_bf16 v[88:91], v[32:35], a[224:227], v[88:91]
buffer_load_dwordx4 a[76:79], v1, s[36:39], s50 offen offset:3072 sc1
v_mfma_f32_16x16x32_bf16 v[88:91], v[36:39], a[232:235], v[88:91]
v_exp_f32 v176, v176
v_mfma_f32_16x16x32_bf16 v[88:91], v[40:43], a[240:243], v[88:91]
buffer_load_dwordx4 a[80:83], v13, s[36:39], s50 offen offset:0 sc1
v_mfma_f32_16x16x32_bf16 v[88:91], v[44:47], a[248:251], v[88:91]
v_exp_f32 v177, v177
v_mfma_f32_16x16x32_bf16 v[92:95], v[32:35], a[228:231], v[92:95]
ds_read_b128 v[32:35], v1 offset:24576
v_fma_f32 v176, v176, v18, v18
v_mfma_f32_16x16x32_bf16 v[92:95], v[36:39], a[236:239], v[92:95]
ds_read_b128 v[36:39], v14 offset:24576
v_fma_f32 v177, v177, v18, v18
v_mfma_f32_16x16x32_bf16 v[92:95], v[40:43], a[244:247], v[92:95]
ds_read_b128 v[40:43], v15 offset:24576
v_mfma_f32_16x16x32_bf16 v[92:95], v[44:47], a[252:255], v[92:95]
ds_read_b128 v[44:47], v24 offset:24576
s_waitcnt lgkmcnt(4)
v_mfma_f32_16x16x32_bf16 v[96:99], v[48:51], a[224:227], v[96:99]
buffer_load_dwordx4 a[84:87], v13, s[36:39], s50 offen offset:1024 sc1
v_mfma_f32_16x16x32_bf16 v[96:99], v[52:55], a[232:235], v[96:99]
v_exp_f32 v178, v178
v_mfma_f32_16x16x32_bf16 v[96:99], v[56:59], a[240:243], v[96:99]
buffer_load_dwordx4 a[88:91], v13, s[36:39], s50 offen offset:2048 sc1
v_mfma_f32_16x16x32_bf16 v[96:99], v[60:63], a[248:251], v[96:99]
v_exp_f32 v179, v179
v_mfma_f32_16x16x32_bf16 v[100:103], v[48:51], a[228:231], v[100:103]
ds_read_b128 v[48:51], v1 offset:25600
v_fma_f32 v178, v178, v18, v18
v_mfma_f32_16x16x32_bf16 v[100:103], v[52:55], a[236:239], v[100:103]
ds_read_b128 v[52:55], v14 offset:25600
v_fma_f32 v179, v179, v18, v18
v_mfma_f32_16x16x32_bf16 v[100:103], v[56:59], a[244:247], v[100:103]
ds_read_b128 v[56:59], v15 offset:25600
v_readlane_b32 s67, v27, 11
v_mfma_f32_16x16x32_bf16 v[100:103], v[60:63], a[252:255], v[100:103]
ds_read_b128 v[60:63], v24 offset:25600
s_waitcnt lgkmcnt(4)
v_mfma_f32_16x16x32_bf16 v[104:107], v[32:35], a[224:227], v[104:107]
buffer_load_dwordx4 a[92:95], v13, s[36:39], s50 offen offset:3072 sc1
v_mfma_f32_16x16x32_bf16 v[104:107], v[36:39], a[232:235], v[104:107]
s_add_u32 m0, s48, 12288
v_mfma_f32_16x16x32_bf16 v[104:107], v[40:43], a[240:243], v[104:107]
buffer_load_dwordx4 v1, s[36:39], s67 offen offset:0 sc1 lds
v_mfma_f32_16x16x32_bf16 v[104:107], v[44:47], a[248:251], v[104:107]
s_waitcnt vmcnt(39) lgkmcnt(0)
s_barrier
v_mfma_f32_16x16x32_bf16 v[108:111], v[32:35], a[228:231], v[108:111]
ds_read_b128 v[32:35], v1 offset:26624
v_mfma_f32_16x16x32_bf16 v[108:111], v[36:39], a[236:239], v[108:111]
ds_read_b128 v[36:39], v14 offset:26624
v_mfma_f32_16x16x32_bf16 v[108:111], v[40:43], a[244:247], v[108:111]
ds_read_b128 v[40:43], v15 offset:26624
v_mfma_f32_16x16x32_bf16 v[108:111], v[44:47], a[252:255], v[108:111]
ds_read_b128 v[44:47], v24 offset:26624
v_mfma_f32_16x16x32_bf16 v[112:115], v[48:51], a[224:227], v[112:115]
buffer_load_dwordx4 v1, s[36:39], s67 offen offset:1024 sc1 lds
v_mfma_f32_16x16x32_bf16 v[112:115], v[52:55], a[232:235], v[112:115]
v_exp_f32 v180, v180
v_mfma_f32_16x16x32_bf16 v[112:115], v[56:59], a[240:243], v[112:115]
buffer_load_dwordx4 v1, s[36:39], s67 offen offset:2048 sc1 lds
v_mfma_f32_16x16x32_bf16 v[112:115], v[60:63], a[248:251], v[112:115]
v_exp_f32 v181, v181
v_mfma_f32_16x16x32_bf16 v[116:119], v[48:51], a[228:231], v[116:119]
ds_read_b128 v[48:51], v1 offset:27648
v_fma_f32 v180, v180, v19, v19
v_mfma_f32_16x16x32_bf16 v[116:119], v[52:55], a[236:239], v[116:119]
ds_read_b128 v[52:55], v14 offset:27648
v_fma_f32 v181, v181, v19, v19
v_mfma_f32_16x16x32_bf16 v[116:119], v[56:59], a[244:247], v[116:119]
ds_read_b128 v[56:59], v15 offset:27648
v_mfma_f32_16x16x32_bf16 v[116:119], v[60:63], a[252:255], v[116:119]
ds_read_b128 v[60:63], v24 offset:27648
s_waitcnt vmcnt(33) lgkmcnt(4)
v_mfma_f32_16x16x32_bf16 v[64:67], v[32:35], a[0:3], v[64:67]
buffer_load_dwordx4 v1, s[36:39], s67 offen offset:3072 sc1 lds
v_mfma_f32_16x16x32_bf16 v[64:67], v[36:39], a[8:11], v[64:67]
s_add_u32 m0, s48, 16384
v_mfma_f32_16x16x32_bf16 v[64:67], v[40:43], a[16:19], v[64:67]
buffer_load_dwordx4 v13, s[36:39], s67 offen offset:0 sc1 lds
v_mfma_f32_16x16x32_bf16 v[64:67], v[44:47], a[24:27], v[64:67]
v_exp_f32 v182, v182
v_mfma_f32_16x16x32_bf16 v[68:71], v[32:35], a[4:7], v[68:71]
ds_read_b128 v[32:35], v1 offset:28672
v_fma_f32 v182, v182, v19, v19
v_mfma_f32_16x16x32_bf16 v[68:71], v[36:39], a[12:15], v[68:71]
ds_read_b128 v[36:39], v14 offset:28672
v_mfma_f32_16x16x32_bf16 v[68:71], v[40:43], a[20:23], v[68:71]
ds_read_b128 v[40:43], v15 offset:28672
v_mfma_f32_16x16x32_bf16 v[68:71], v[44:47], a[28:31], v[68:71]
ds_read_b128 v[44:47], v24 offset:28672
s_waitcnt lgkmcnt(4)
v_mfma_f32_16x16x32_bf16 v[72:75], v[48:51], a[0:3], v[72:75]
buffer_load_dwordx4 v13, s[36:39], s67 offen offset:1024 sc1 lds
v_mfma_f32_16x16x32_bf16 v[72:75], v[52:55], a[8:11], v[72:75]
v_exp_f32 v183, v183
v_mfma_f32_16x16x32_bf16 v[72:75], v[56:59], a[16:19], v[72:75]
buffer_load_dwordx4 v13, s[36:39], s67 offen offset:2048 sc1 lds
v_mfma_f32_16x16x32_bf16 v[72:75], v[60:63], a[24:27], v[72:75]
v_fma_f32 v183, v183, v19, v19
v_mfma_f32_16x16x32_bf16 v[76:79], v[48:51], a[4:7], v[76:79]
ds_read_b128 v[48:51], v1 offset:29696
v_mfma_f32_16x16x32_bf16 v[76:79], v[52:55], a[12:15], v[76:79]
ds_read_b128 v[52:55], v14 offset:29696
v_readlane_b32 s66, v28, 11
v_mfma_f32_16x16x32_bf16 v[76:79], v[56:59], a[20:23], v[76:79]
ds_read_b128 v[56:59], v15 offset:29696
v_mfma_f32_16x16x32_bf16 v[76:79], v[60:63], a[28:31], v[76:79]
ds_read_b128 v[60:63], v24 offset:29696
s_waitcnt lgkmcnt(4)
v_mfma_f32_16x16x32_bf16 v[80:83], v[32:35], a[0:3], v[80:83]
buffer_load_dwordx4 a[96:99], v1, s[36:39], s66 offen offset:0 sc1
v_mfma_f32_16x16x32_bf16 v[80:83], v[36:39], a[8:11], v[80:83]
v_rcp_f32 v176, v176
v_mfma_f32_16x16x32_bf16 v[80:83], v[40:43], a[16:19], v[80:83]
buffer_load_dwordx4 a[100:103], v1, s[36:39], s66 offen offset:1024 sc1
v_mfma_f32_16x16x32_bf16 v[80:83], v[44:47], a[24:27], v[80:83]
v_rcp_f32 v177, v177
v_mfma_f32_16x16x32_bf16 v[84:87], v[32:35], a[4:7], v[84:87]
ds_read_b128 v[32:35], v1 offset:30720
v_mul_f32 v144, v144, v176
v_mfma_f32_16x16x32_bf16 v[84:87], v[36:39], a[12:15], v[84:87]
ds_read_b128 v[36:39], v14 offset:30720
v_mul_f32 v145, v145, v177
v_mfma_f32_16x16x32_bf16 v[84:87], v[40:43], a[20:23], v[84:87]
ds_read_b128 v[40:43], v15 offset:30720
v_mul_f32 v176, v152, v152
v_mfma_f32_16x16x32_bf16 v[84:87], v[44:47], a[28:31], v[84:87]
ds_read_b128 v[44:47], v24 offset:30720
s_waitcnt lgkmcnt(4)
v_mfma_f32_16x16x32_bf16 v[88:91], v[48:51], a[0:3], v[88:91]
buffer_load_dwordx4 a[104:107], v1, s[36:39], s66 offen offset:2048 sc1
v_mfma_f32_16x16x32_bf16 v[88:91], v[52:55], a[8:11], v[88:91]
v_rcp_f32 v178, v178
v_mfma_f32_16x16x32_bf16 v[88:91], v[56:59], a[16:19], v[88:91]
buffer_load_dwordx4 a[108:111], v1, s[36:39], s66 offen offset:3072 sc1
v_mfma_f32_16x16x32_bf16 v[88:91], v[60:63], a[24:27], v[88:91]
v_rcp_f32 v179, v179
v_mfma_f32_16x16x32_bf16 v[92:95], v[48:51], a[4:7], v[92:95]
ds_read_b128 v[48:51], v1 offset:31744
v_mul_f32 v146, v146, v178
v_mfma_f32_16x16x32_bf16 v[92:95], v[52:55], a[12:15], v[92:95]
ds_read_b128 v[52:55], v14 offset:31744
v_mul_f32 v147, v147, v179
v_mfma_f32_16x16x32_bf16 v[92:95], v[56:59], a[20:23], v[92:95]
ds_read_b128 v[56:59], v15 offset:31744
v_mul_f32 v177, v153, v153
v_mfma_f32_16x16x32_bf16 v[92:95], v[60:63], a[28:31], v[92:95]
ds_read_b128 v[60:63], v24 offset:31744
s_waitcnt lgkmcnt(4)
v_mfma_f32_16x16x32_bf16 v[96:99], v[32:35], a[0:3], v[96:99]
buffer_load_dwordx4 a[112:115], v13, s[36:39], s66 offen offset:0 sc1
v_mfma_f32_16x16x32_bf16 v[96:99], v[36:39], a[8:11], v[96:99]
v_rcp_f32 v180, v180
v_mfma_f32_16x16x32_bf16 v[96:99], v[40:43], a[16:19], v[96:99]
buffer_load_dwordx4 a[116:119], v13, s[36:39], s66 offen offset:1024 sc1
v_mfma_f32_16x16x32_bf16 v[96:99], v[44:47], a[24:27], v[96:99]
v_rcp_f32 v181, v181
v_mfma_f32_16x16x32_bf16 v[100:103], v[32:35], a[4:7], v[100:103]
ds_read_b128 v[32:35], v1 offset:32768
v_mul_f32 v148, v148, v180
v_mfma_f32_16x16x32_bf16 v[100:103], v[36:39], a[12:15], v[100:103]
ds_read_b128 v[36:39], v14 offset:32768
v_mul_f32 v149, v149, v181
v_mfma_f32_16x16x32_bf16 v[100:103], v[40:43], a[20:23], v[100:103]
ds_read_b128 v[40:43], v15 offset:32768
v_mul_f32 v178, v154, v154
v_mfma_f32_16x16x32_bf16 v[100:103], v[44:47], a[28:31], v[100:103]
ds_read_b128 v[44:47], v24 offset:32768
s_waitcnt lgkmcnt(4)
v_mfma_f32_16x16x32_bf16 v[104:107], v[48:51], a[0:3], v[104:107]
buffer_load_dwordx4 a[120:123], v13, s[36:39], s66 offen offset:2048 sc1
v_mfma_f32_16x16x32_bf16 v[104:107], v[52:55], a[8:11], v[104:107]
v_rcp_f32 v182, v182
v_mfma_f32_16x16x32_bf16 v[104:107], v[56:59], a[16:19], v[104:107]
buffer_load_dwordx4 a[124:127], v13, s[36:39], s66 offen offset:3072 sc1
v_mfma_f32_16x16x32_bf16 v[104:107], v[60:63], a[24:27], v[104:107]
s_waitcnt vmcnt(38) lgkmcnt(0)
s_barrier
v_mfma_f32_16x16x32_bf16 v[108:111], v[48:51], a[4:7], v[108:111]
ds_read_b128 v[48:51], v1 offset:33792
v_mul_f32 v150, v150, v182
v_mfma_f32_16x16x32_bf16 v[108:111], v[52:55], a[12:15], v[108:111]
ds_read_b128 v[52:55], v14 offset:33792
v_readlane_b32 s51, v27, 12
v_mfma_f32_16x16x32_bf16 v[108:111], v[56:59], a[20:23], v[108:111]
ds_read_b128 v[56:59], v15 offset:33792
s_add_u32 m0, s48, 19456
v_mfma_f32_16x16x32_bf16 v[108:111], v[60:63], a[28:31], v[108:111]
ds_read_b128 v[60:63], v24 offset:33792
v_mfma_f32_16x16x32_bf16 v[112:115], v[32:35], a[0:3], v[112:115]
buffer_load_dwordx4 v1, s[36:39], s51 offen offset:0 sc1 lds
v_mfma_f32_16x16x32_bf16 v[112:115], v[36:39], a[8:11], v[112:115]
v_rcp_f32 v183, v183
v_mfma_f32_16x16x32_bf16 v[112:115], v[40:43], a[16:19], v[112:115]
buffer_load_dwordx4 v1, s[36:39], s51 offen offset:1024 sc1 lds
v_mfma_f32_16x16x32_bf16 v[112:115], v[44:47], a[24:27], v[112:115]
v_mul_f32 v151, v151, v183
v_mul_f32 v179, v155, v155
v_mfma_f32_16x16x32_bf16 v[116:119], v[32:35], a[4:7], v[116:119]
ds_read_b128 v[32:35], v1 offset:34816
v_mul_f32 v180, v156, v156
v_mfma_f32_16x16x32_bf16 v[116:119], v[36:39], a[12:15], v[116:119]
ds_read_b128 v[36:39], v14 offset:34816
v_mul_f32 v181, v157, v157
v_mfma_f32_16x16x32_bf16 v[116:119], v[40:43], a[20:23], v[116:119]
ds_read_b128 v[40:43], v15 offset:34816
v_mul_f32 v182, v158, v158
v_mfma_f32_16x16x32_bf16 v[116:119], v[44:47], a[28:31], v[116:119]
ds_read_b128 v[44:47], v24 offset:34816
s_waitcnt vmcnt(32) lgkmcnt(4)
v_mfma_f32_16x16x32_bf16 v[64:67], v[48:51], a[32:35], v[64:67]
buffer_load_dwordx4 v1, s[36:39], s51 offen offset:2048 sc1 lds
v_mfma_f32_16x16x32_bf16 v[64:67], v[52:55], a[40:43], v[64:67]
v_mul_f32 v183, v159, v159
v_fma_f32 v176, v176, v22, v20
v_mfma_f32_16x16x32_bf16 v[64:67], v[56:59], a[48:51], v[64:67]
buffer_load_dwordx4 v1, s[36:39], s51 offen offset:3072 sc1 lds
v_mfma_f32_16x16x32_bf16 v[64:67], v[60:63], a[56:59], v[64:67]
v_fma_f32 v177, v177, v22, v20
v_fma_f32 v178, v178, v22, v20
v_mfma_f32_16x16x32_bf16 v[68:71], v[48:51], a[36:39], v[68:71]
ds_read_b128 v[48:51], v1 offset:35840
v_fma_f32 v179, v179, v22, v20
v_mfma_f32_16x16x32_bf16 v[68:71], v[52:55], a[44:47], v[68:71]
ds_read_b128 v[52:55], v14 offset:35840
v_fma_f32 v180, v180, v23, v21
v_mfma_f32_16x16x32_bf16 v[68:71], v[56:59], a[52:55], v[68:71]
ds_read_b128 v[56:59], v15 offset:35840
s_add_u32 m0, s48, 23552
v_mfma_f32_16x16x32_bf16 v[68:71], v[60:63], a[60:63], v[68:71]
ds_read_b128 v[60:63], v24 offset:35840
s_waitcnt lgkmcnt(4)
v_mfma_f32_16x16x32_bf16 v[72:75], v[32:35], a[32:35], v[72:75]
buffer_load_dwordx4 v13, s[36:39], s51 offen offset:0 sc1 lds
v_mfma_f32_16x16x32_bf16 v[72:75], v[36:39], a[40:43], v[72:75]
v_fma_f32 v181, v181, v23, v21
v_fma_f32 v182, v182, v23, v21
v_mfma_f32_16x16x32_bf16 v[72:75], v[40:43], a[48:51], v[72:75]
buffer_load_dwordx4 v13, s[36:39], s51 offen offset:1024 sc1 lds
v_mfma_f32_16x16x32_bf16 v[72:75], v[44:47], a[56:59], v[72:75]
v_fma_f32 v183, v183, v23, v21
v_mul_f32 v176, v176, v152
v_mfma_f32_16x16x32_bf16 v[76:79], v[32:35], a[36:39], v[76:79]
ds_read_b128 v[32:35], v1 offset:36864
v_mul_f32 v177, v177, v153
v_mfma_f32_16x16x32_bf16 v[76:79], v[36:39], a[44:47], v[76:79]
ds_read_b128 v[36:39], v14 offset:36864
v_mul_f32 v178, v178, v154
v_mfma_f32_16x16x32_bf16 v[76:79], v[40:43], a[52:55], v[76:79]
ds_read_b128 v[40:43], v15 offset:36864
v_readlane_b32 s50, v28, 12
v_mfma_f32_16x16x32_bf16 v[76:79], v[44:47], a[60:63], v[76:79]
ds_read_b128 v[44:47], v24 offset:36864
s_waitcnt lgkmcnt(4)
v_mfma_f32_16x16x32_bf16 v[80:83], v[48:51], a[32:35], v[80:83]
buffer_load_dwordx4 v13, s[36:39], s51 offen offset:2048 sc1 lds
v_mfma_f32_16x16x32_bf16 v[80:83], v[52:55], a[40:43], v[80:83]
v_mul_f32 v179, v179, v155
v_mul_f32 v180, v180, v156
v_mfma_f32_16x16x32_bf16 v[80:83], v[56:59], a[48:51], v[80:83]
buffer_load_dwordx4 a[128:131], v1, s[36:39], s50 offen offset:0 sc1
v_mfma_f32_16x16x32_bf16 v[80:83], v[60:63], a[56:59], v[80:83]
v_mul_f32 v181, v181, v157
v_mul_f32 v182, v182, v158
v_mfma_f32_16x16x32_bf16 v[84:87], v[48:51], a[36:39], v[84:87]
ds_read_b128 v[48:51], v1 offset:37888
v_mul_f32 v183, v183, v159
v_mfma_f32_16x16x32_bf16 v[84:87], v[52:55], a[44:47], v[84:87]
ds_read_b128 v[52:55], v14 offset:37888
v_mfma_f32_16x16x32_bf16 v[84:87], v[56:59], a[52:55], v[84:87]
ds_read_b128 v[56:59], v15 offset:37888
v_mfma_f32_16x16x32_bf16 v[84:87], v[60:63], a[60:63], v[84:87]
ds_read_b128 v[60:63], v24 offset:37888
s_waitcnt lgkmcnt(4)
v_mfma_f32_16x16x32_bf16 v[88:91], v[32:35], a[32:35], v[88:91]
buffer_load_dwordx4 a[132:135], v1, s[36:39], s50 offen offset:1024 sc1
v_mfma_f32_16x16x32_bf16 v[88:91], v[36:39], a[40:43], v[88:91]
v_exp_f32 v176, v176
v_mfma_f32_16x16x32_bf16 v[88:91], v[40:43], a[48:51], v[88:91]
buffer_load_dwordx4 a[136:139], v1, s[36:39], s50 offen offset:2048 sc1
v_mfma_f32_16x16x32_bf16 v[88:91], v[44:47], a[56:59], v[88:91]
v_exp_f32 v177, v177
v_mfma_f32_16x16x32_bf16 v[92:95], v[32:35], a[36:39], v[92:95]
ds_read_b128 v[32:35], v1 offset:38912
v_fma_f32 v176, v176, v18, v18
v_mfma_f32_16x16x32_bf16 v[92:95], v[36:39], a[44:47], v[92:95]
ds_read_b128 v[36:39], v14 offset:38912
v_fma_f32 v177, v177, v18, v18
v_mfma_f32_16x16x32_bf16 v[92:95], v[40:43], a[52:55], v[92:95]
ds_read_b128 v[40:43], v15 offset:38912
v_mfma_f32_16x16x32_bf16 v[92:95], v[44:47], a[60:63], v[92:95]
ds_read_b128 v[44:47], v24 offset:38912
s_waitcnt lgkmcnt(4)
v_mfma_f32_16x16x32_bf16 v[96:99], v[48:51], a[32:35], v[96:99]
buffer_load_dwordx4 a[140:143], v1, s[36:39], s50 offen offset:3072 sc1
v_mfma_f32_16x16x32_bf16 v[96:99], v[52:55], a[40:43], v[96:99]
v_exp_f32 v178, v178
v_mfma_f32_16x16x32_bf16 v[96:99], v[56:59], a[48:51], v[96:99]
buffer_load_dwordx4 a[144:147], v13, s[36:39], s50 offen offset:0 sc1
v_mfma_f32_16x16x32_bf16 v[96:99], v[60:63], a[56:59], v[96:99]
v_exp_f32 v179, v179
v_mfma_f32_16x16x32_bf16 v[100:103], v[48:51], a[36:39], v[100:103]
ds_read_b128 v[48:51], v1 offset:39936
v_fma_f32 v178, v178, v18, v18
v_mfma_f32_16x16x32_bf16 v[100:103], v[52:55], a[44:47], v[100:103]
ds_read_b128 v[52:55], v14 offset:39936
v_fma_f32 v179, v179, v18, v18
v_mfma_f32_16x16x32_bf16 v[100:103], v[56:59], a[52:55], v[100:103]
ds_read_b128 v[56:59], v15 offset:39936
v_mfma_f32_16x16x32_bf16 v[100:103], v[60:63], a[60:63], v[100:103]
ds_read_b128 v[60:63], v24 offset:39936
s_waitcnt lgkmcnt(4)
v_mfma_f32_16x16x32_bf16 v[104:107], v[32:35], a[32:35], v[104:107]
buffer_load_dwordx4 a[148:151], v13, s[36:39], s50 offen offset:1024 sc1
v_mfma_f32_16x16x32_bf16 v[104:107], v[36:39], a[40:43], v[104:107]
v_exp_f32 v180, v180
v_mfma_f32_16x16x32_bf16 v[104:107], v[40:43], a[48:51], v[104:107]
buffer_load_dwordx4 a[152:155], v13, s[36:39], s50 offen offset:2048 sc1
v_mfma_f32_16x16x32_bf16 v[104:107], v[44:47], a[56:59], v[104:107]
s_waitcnt vmcnt(37) lgkmcnt(0)
s_barrier
v_mfma_f32_16x16x32_bf16 v[108:111], v[32:35], a[36:39], v[108:111]
ds_read_b128 v[32:35], v1 offset:5120
v_fma_f32 v180, v180, v19, v19
v_mfma_f32_16x16x32_bf16 v[108:111], v[36:39], a[44:47], v[108:111]
ds_read_b128 v[36:39], v14 offset:5120
v_mfma_f32_16x16x32_bf16 v[108:111], v[40:43], a[52:55], v[108:111]
ds_read_b128 v[40:43], v15 offset:5120
v_readlane_b32 s67, v27, 13
v_mfma_f32_16x16x32_bf16 v[108:111], v[44:47], a[60:63], v[108:111]
ds_read_b128 v[44:47], v24 offset:5120
v_mfma_f32_16x16x32_bf16 v[112:115], v[48:51], a[32:35], v[112:115]
buffer_load_dwordx4 a[156:159], v13, s[36:39], s50 offen offset:3072 sc1
v_mfma_f32_16x16x32_bf16 v[112:115], v[52:55], a[40:43], v[112:115]
s_add_u32 m0, s48, 26624
v_mfma_f32_16x16x32_bf16 v[112:115], v[56:59], a[48:51], v[112:115]
buffer_load_dwordx4 v1, s[36:39], s67 offen offset:0 sc1 lds
v_mfma_f32_16x16x32_bf16 v[112:115], v[60:63], a[56:59], v[112:115]
v_exp_f32 v181, v181
v_mfma_f32_16x16x32_bf16 v[116:119], v[48:51], a[36:39], v[116:119]
ds_read_b128 v[48:51], v1 offset:6144
v_fma_f32 v181, v181, v19, v19
v_mfma_f32_16x16x32_bf16 v[116:119], v[52:55], a[44:47], v[116:119]
ds_read_b128 v[52:55], v14 offset:6144
v_mfma_f32_16x16x32_bf16 v[116:119], v[56:59], a[52:55], v[116:119]
ds_read_b128 v[56:59], v15 offset:6144
v_mfma_f32_16x16x32_bf16 v[116:119], v[60:63], a[60:63], v[116:119]
ds_read_b128 v[60:63], v24 offset:6144
s_waitcnt vmcnt(31) lgkmcnt(4)
v_mfma_f32_16x16x32_bf16 v[64:67], v[32:35], a[64:67], v[64:67]
buffer_load_dwordx4 v1, s[36:39], s67 offen offset:1024 sc1 lds
v_mfma_f32_16x16x32_bf16 v[64:67], v[36:39], a[72:75], v[64:67]
v_exp_f32 v182, v182
v_mfma_f32_16x16x32_bf16 v[64:67], v[40:43], a[80:83], v[64:67]
buffer_load_dwordx4 v1, s[36:39], s67 offen offset:2048 sc1 lds
v_mfma_f32_16x16x32_bf16 v[64:67], v[44:47], a[88:91], v[64:67]
v_exp_f32 v183, v183
v_mfma_f32_16x16x32_bf16 v[68:71], v[32:35], a[68:71], v[68:71]
ds_read_b128 v[32:35], v1 offset:7168
v_fma_f32 v182, v182, v19, v19
v_mfma_f32_16x16x32_bf16 v[68:71], v[36:39], a[76:79], v[68:71]
ds_read_b128 v[36:39], v14 offset:7168
v_fma_f32 v183, v183, v19, v19
v_mfma_f32_16x16x32_bf16 v[68:71], v[40:43], a[84:87], v[68:71]
ds_read_b128 v[40:43], v15 offset:7168
v_mfma_f32_16x16x32_bf16 v[68:71], v[44:47], a[92:95], v[68:71]
ds_read_b128 v[44:47], v24 offset:7168
s_waitcnt lgkmcnt(4)
v_mfma_f32_16x16x32_bf16 v[72:75], v[48:51], a[64:67], v[72:75]
buffer_load_dwordx4 v1, s[36:39], s67 offen offset:3072 sc1 lds
v_mfma_f32_16x16x32_bf16 v[72:75], v[52:55], a[72:75], v[72:75]
s_add_u32 m0, s48, 30720
v_mfma_f32_16x16x32_bf16 v[72:75], v[56:59], a[80:83], v[72:75]
buffer_load_dwordx4 v13, s[36:39], s67 offen offset:0 sc1 lds
v_mfma_f32_16x16x32_bf16 v[72:75], v[60:63], a[88:91], v[72:75]
v_rcp_f32 v176, v176
v_mfma_f32_16x16x32_bf16 v[76:79], v[48:51], a[68:71], v[76:79]
ds_read_b128 v[48:51], v1 offset:8192
v_mul_f32 v152, v152, v176
v_mfma_f32_16x16x32_bf16 v[76:79], v[52:55], a[76:79], v[76:79]
ds_read_b128 v[52:55], v14 offset:8192
v_mul_f32 v176, v160, v160
v_mfma_f32_16x16x32_bf16 v[76:79], v[56:59], a[84:87], v[76:79]
ds_read_b128 v[56:59], v15 offset:8192
v_fma_f32 v176, v176, v22, v20
TP55:
s_cbranch_execz TP6
TP56:
s_cbranch_execz TR2
v_mfma_f32_16x16x32_bf16 v[76:79], v[60:63], a[92:95], v[76:79]
ds_read_b128 v[60:63], v24 offset:8192
s_waitcnt lgkmcnt(4)
v_mfma_f32_16x16x32_bf16 v[80:83], v[32:35], a[64:67], v[80:83]
buffer_load_dwordx4 v13, s[36:39], s67 offen offset:1024 sc1 lds
v_mfma_f32_16x16x32_bf16 v[80:83], v[36:39], a[72:75], v[80:83]
v_rcp_f32 v177, v177
v_mfma_f32_16x16x32_bf16 v[80:83], v[40:43], a[80:83], v[80:83]
buffer_load_dwordx4 v13, s[36:39], s67 offen offset:2048 sc1 lds
v_mfma_f32_16x16x32_bf16 v[80:83], v[44:47], a[88:91], v[80:83]
v_rcp_f32 v178, v178
v_mfma_f32_16x16x32_bf16 v[84:87], v[32:35], a[68:71], v[84:87]
ds_read_b128 v[32:35], v1 offset:9216
v_mul_f32 v153, v153, v177
v_mfma_f32_16x16x32_bf16 v[84:87], v[36:39], a[76:79], v[84:87]
ds_read_b128 v[36:39], v14 offset:9216
v_readlane_b32 s66, v28, 13
v_mfma_f32_16x16x32_bf16 v[84:87], v[40:43], a[84:87], v[84:87]
ds_read_b128 v[40:43], v15 offset:9216
v_mul_f32 v154, v154, v178
v_mfma_f32_16x16x32_bf16 v[84:87], v[44:47], a[92:95], v[84:87]
ds_read_b128 v[44:47], v24 offset:9216
s_waitcnt lgkmcnt(4)
v_mfma_f32_16x16x32_bf16 v[88:91], v[48:51], a[64:67], v[88:91]
buffer_load_dwordx4 a[160:163], v1, s[36:39], s66 offen offset:0 sc1
v_mfma_f32_16x16x32_bf16 v[88:91], v[52:55], a[72:75], v[88:91]
v_rcp_f32 v179, v179
v_mfma_f32_16x16x32_bf16 v[88:91], v[56:59], a[80:83], v[88:91]
buffer_load_dwordx4 a[164:167], v1, s[36:39], s66 offen offset:1024 sc1
v_mfma_f32_16x16x32_bf16 v[88:91], v[60:63], a[88:91], v[88:91]
v_rcp_f32 v180, v180
v_mfma_f32_16x16x32_bf16 v[92:95], v[48:51], a[68:71], v[92:95]
ds_read_b128 v[48:51], v1 offset:10240
v_mul_f32 v155, v155, v179
v_mfma_f32_16x16x32_bf16 v[92:95], v[52:55], a[76:79], v[92:95]
ds_read_b128 v[52:55], v14 offset:10240
v_mul_f32 v156, v156, v180
v_mfma_f32_16x16x32_bf16 v[92:95], v[56:59], a[84:87], v[92:95]
ds_read_b128 v[56:59], v15 offset:10240
v_mul_f32 v177, v161, v161
v_mfma_f32_16x16x32_bf16 v[92:95], v[60:63], a[92:95], v[92:95]
ds_read_b128 v[60:63], v24 offset:10240
s_waitcnt lgkmcnt(4)
v_mfma_f32_16x16x32_bf16 v[96:99], v[32:35], a[64:67], v[96:99]
buffer_load_dwordx4 a[168:171], v1, s[36:39], s66 offen offset:2048 sc1
v_mfma_f32_16x16x32_bf16 v[96:99], v[36:39], a[72:75], v[96:99]
v_rcp_f32 v181, v181
v_mfma_f32_16x16x32_bf16 v[96:99], v[40:43], a[80:83], v[96:99]
buffer_load_dwordx4 a[172:175], v1, s[36:39], s66 offen offset:3072 sc1
v_mfma_f32_16x16x32_bf16 v[96:99], v[44:47], a[88:91], v[96:99]
v_rcp_f32 v182, v182
v_mfma_f32_16x16x32_bf16 v[100:103], v[32:35], a[68:71], v[100:103]
ds_read_b128 v[32:35], v1 offset:11264
v_mul_f32 v157, v157, v181
v_mfma_f32_16x16x32_bf16 v[100:103], v[36:39], a[76:79], v[100:103]
ds_read_b128 v[36:39], v14 offset:11264
v_mul_f32 v158, v158, v182
v_mfma_f32_16x16x32_bf16 v[100:103], v[40:43], a[84:87], v[100:103]
ds_read_b128 v[40:43], v15 offset:11264
v_mul_f32 v178, v162, v162
v_mfma_f32_16x16x32_bf16 v[100:103], v[44:47], a[92:95], v[100:103]
ds_read_b128 v[44:47], v24 offset:11264
s_waitcnt lgkmcnt(4)
v_mfma_f32_16x16x32_bf16 v[104:107], v[48:51], a[64:67], v[104:107]
buffer_load_dwordx4 a[176:179], v13, s[36:39], s66 offen offset:0 sc1
v_mfma_f32_16x16x32_bf16 v[104:107], v[52:55], a[72:75], v[104:107]
v_rcp_f32 v183, v183
v_mfma_f32_16x16x32_bf16 v[104:107], v[56:59], a[80:83], v[104:107]
buffer_load_dwordx4 a[180:183], v13, s[36:39], s66 offen offset:1024 sc1
v_mfma_f32_16x16x32_bf16 v[104:107], v[60:63], a[88:91], v[104:107]
s_waitcnt vmcnt(36) lgkmcnt(0)
s_barrier
v_mfma_f32_16x16x32_bf16 v[108:111], v[48:51], a[68:71], v[108:111]
ds_read_b128 v[48:51], v1 offset:12288
v_mul_f32 v159, v159, v183
v_mfma_f32_16x16x32_bf16 v[108:111], v[52:55], a[76:79], v[108:111]
ds_read_b128 v[52:55], v14 offset:12288
v_mul_f32 v179, v163, v163
v_mfma_f32_16x16x32_bf16 v[108:111], v[56:59], a[84:87], v[108:111]
ds_read_b128 v[56:59], v15 offset:12288
v_mul_f32 v180, v164, v164
v_mfma_f32_16x16x32_bf16 v[108:111], v[60:63], a[92:95], v[108:111]
ds_read_b128 v[60:63], v24 offset:12288
v_mfma_f32_16x16x32_bf16 v[112:115], v[32:35], a[64:67], v[112:115]
buffer_load_dwordx4 a[184:187], v13, s[36:39], s66 offen offset:2048 sc1
v_mfma_f32_16x16x32_bf16 v[112:115], v[36:39], a[72:75], v[112:115]
v_mul_f32 v181, v165, v165
v_mul_f32 v182, v166, v166
v_mfma_f32_16x16x32_bf16 v[112:115], v[40:43], a[80:83], v[112:115]
buffer_load_dwordx4 a[188:191], v13, s[36:39], s66 offen offset:3072 sc1
v_mfma_f32_16x16x32_bf16 v[112:115], v[44:47], a[88:91], v[112:115]
v_mul_f32 v183, v167, v167
v_fma_f32 v177, v177, v22, v20
v_mfma_f32_16x16x32_bf16 v[116:119], v[32:35], a[68:71], v[116:119]
ds_read_b128 v[32:35], v1 offset:13312
v_fma_f32 v178, v178, v22, v20
v_mfma_f32_16x16x32_bf16 v[116:119], v[36:39], a[76:79], v[116:119]
ds_read_b128 v[36:39], v14 offset:13312
v_readlane_b32 s51, v27, 14
v_mfma_f32_16x16x32_bf16 v[116:119], v[40:43], a[84:87], v[116:119]
ds_read_b128 v[40:43], v15 offset:13312
s_add_u32 m0, s48, 33792
v_mfma_f32_16x16x32_bf16 v[116:119], v[44:47], a[92:95], v[116:119]
ds_read_b128 v[44:47], v24 offset:13312
s_waitcnt vmcnt(30) lgkmcnt(4)
v_mfma_f32_16x16x32_bf16 v[64:67], v[48:51], a[96:99], v[64:67]
buffer_load_dwordx4 v1, s[36:39], s51 offen offset:0 sc1 lds
v_mfma_f32_16x16x32_bf16 v[64:67], v[52:55], a[104:107], v[64:67]
v_fma_f32 v179, v179, v22, v20
v_fma_f32 v180, v180, v23, v21
v_mfma_f32_16x16x32_bf16 v[64:67], v[56:59], a[112:115], v[64:67]
buffer_load_dwordx4 v1, s[36:39], s51 offen offset:1024 sc1 lds
v_mfma_f32_16x16x32_bf16 v[64:67], v[60:63], a[120:123], v[64:67]
v_fma_f32 v181, v181, v23, v21
v_fma_f32 v182, v182, v23, v21
v_mfma_f32_16x16x32_bf16 v[68:71], v[48:51], a[100:103], v[68:71]
ds_read_b128 v[48:51], v1 offset:14336
v_fma_f32 v183, v183, v23, v21
v_mfma_f32_16x16x32_bf16 v[68:71], v[52:55], a[108:111], v[68:71]
ds_read_b128 v[52:55], v14 offset:14336
v_mul_f32 v176, v176, v160
v_mfma_f32_16x16x32_bf16 v[68:71], v[56:59], a[116:119], v[68:71]
ds_read_b128 v[56:59], v15 offset:14336
v_mul_f32 v177, v177, v161
v_mfma_f32_16x16x32_bf16 v[68:71], v[60:63], a[124:127], v[68:71]
ds_read_b128 v[60:63], v24 offset:14336
s_waitcnt lgkmcnt(4)
v_mfma_f32_16x16x32_bf16 v[72:75], v[32:35], a[96:99], v[72:75]
buffer_load_dwordx4 v1, s[36:39], s51 offen offset:2048 sc1 lds
v_mfma_f32_16x16x32_bf16 v[72:75], v[36:39], a[104:107], v[72:75]
v_mul_f32 v178, v178, v162
v_mul_f32 v179, v179, v163
v_mfma_f32_16x16x32_bf16 v[72:75], v[40:43], a[112:115], v[72:75]
buffer_load_dwordx4 v1, s[36:39], s51 offen offset:3072 sc1 lds
v_mfma_f32_16x16x32_bf16 v[72:75], v[44:47], a[120:123], v[72:75]
v_mul_f32 v180, v180, v164
v_mul_f32 v181, v181, v165
v_mfma_f32_16x16x32_bf16 v[76:79], v[32:35], a[100:103], v[76:79]
ds_read_b128 v[32:35], v1 offset:15360
v_mul_f32 v182, v182, v166
v_mfma_f32_16x16x32_bf16 v[76:79], v[36:39], a[108:111], v[76:79]
ds_read_b128 v[36:39], v14 offset:15360
v_mul_f32 v183, v183, v167
v_mfma_f32_16x16x32_bf16 v[76:79], v[40:43], a[116:119], v[76:79]
ds_read_b128 v[40:43], v15 offset:15360
s_add_u32 m0, s48, 37888
v_mfma_f32_16x16x32_bf16 v[76:79], v[44:47], a[124:127], v[76:79]
ds_read_b128 v[44:47], v24 offset:15360
s_waitcnt lgkmcnt(4)
v_mfma_f32_16x16x32_bf16 v[80:83], v[48:51], a[96:99], v[80:83]
buffer_load_dwordx4 v13, s[36:39], s51 offen offset:0 sc1 lds
v_mfma_f32_16x16x32_bf16 v[80:83], v[52:55], a[104:107], v[80:83]
v_exp_f32 v176, v176
v_mfma_f32_16x16x32_bf16 v[80:83], v[56:59], a[112:115], v[80:83]
buffer_load_dwordx4 v13, s[36:39], s51 offen offset:1024 sc1 lds
v_mfma_f32_16x16x32_bf16 v[80:83], v[60:63], a[120:123], v[80:83]
v_exp_f32 v177, v177
v_mfma_f32_16x16x32_bf16 v[84:87], v[48:51], a[100:103], v[84:87]
ds_read_b128 v[48:51], v1 offset:16384
v_fma_f32 v176, v176, v18, v18
v_mfma_f32_16x16x32_bf16 v[84:87], v[52:55], a[108:111], v[84:87]
ds_read_b128 v[52:55], v14 offset:16384
v_fma_f32 v177, v177, v18, v18
v_mfma_f32_16x16x32_bf16 v[84:87], v[56:59], a[116:119], v[84:87]
ds_read_b128 v[56:59], v15 offset:16384
v_readlane_b32 s50, v28, 14
v_mfma_f32_16x16x32_bf16 v[84:87], v[60:63], a[124:127], v[84:87]
ds_read_b128 v[60:63], v24 offset:16384
s_waitcnt lgkmcnt(4)
v_mfma_f32_16x16x32_bf16 v[88:91], v[32:35], a[96:99], v[88:91]
buffer_load_dwordx4 v13, s[36:39], s51 offen offset:2048 sc1 lds
v_mfma_f32_16x16x32_bf16 v[88:91], v[36:39], a[104:107], v[88:91]
v_exp_f32 v178, v178
v_mfma_f32_16x16x32_bf16 v[88:91], v[40:43], a[112:115], v[88:91]
buffer_load_dwordx4 a[192:195], v1, s[36:39], s50 offen offset:0 sc1
v_mfma_f32_16x16x32_bf16 v[88:91], v[44:47], a[120:123], v[88:91]
v_exp_f32 v179, v179
v_mfma_f32_16x16x32_bf16 v[92:95], v[32:35], a[100:103], v[92:95]
ds_read_b128 v[32:35], v1 offset:17408
v_fma_f32 v178, v178, v18, v18
v_mfma_f32_16x16x32_bf16 v[92:95], v[36:39], a[108:111], v[92:95]
ds_read_b128 v[36:39], v14 offset:17408
v_fma_f32 v179, v179, v18, v18
v_mfma_f32_16x16x32_bf16 v[92:95], v[40:43], a[116:119], v[92:95]
ds_read_b128 v[40:43], v15 offset:17408
v_mfma_f32_16x16x32_bf16 v[92:95], v[44:47], a[124:127], v[92:95]
ds_read_b128 v[44:47], v24 offset:17408
s_waitcnt lgkmcnt(4)
v_mfma_f32_16x16x32_bf16 v[96:99], v[48:51], a[96:99], v[96:99]
buffer_load_dwordx4 a[196:199], v1, s[36:39], s50 offen offset:1024 sc1
v_mfma_f32_16x16x32_bf16 v[96:99], v[52:55], a[104:107], v[96:99]
v_exp_f32 v180, v180
v_mfma_f32_16x16x32_bf16 v[96:99], v[56:59], a[112:115], v[96:99]
buffer_load_dwordx4 a[200:203], v1, s[36:39], s50 offen offset:2048 sc1
v_mfma_f32_16x16x32_bf16 v[96:99], v[60:63], a[120:123], v[96:99]
v_exp_f32 v181, v181
v_mfma_f32_16x16x32_bf16 v[100:103], v[48:51], a[100:103], v[100:103]
ds_read_b128 v[48:51], v1 offset:18432
v_fma_f32 v180, v180, v19, v19
v_mfma_f32_16x16x32_bf16 v[100:103], v[52:55], a[108:111], v[100:103]
ds_read_b128 v[52:55], v14 offset:18432
v_fma_f32 v181, v181, v19, v19
v_mfma_f32_16x16x32_bf16 v[100:103], v[56:59], a[116:119], v[100:103]
ds_read_b128 v[56:59], v15 offset:18432
v_mfma_f32_16x16x32_bf16 v[100:103], v[60:63], a[124:127], v[100:103]
ds_read_b128 v[60:63], v24 offset:18432
s_waitcnt lgkmcnt(4)
v_mfma_f32_16x16x32_bf16 v[104:107], v[32:35], a[96:99], v[104:107]
buffer_load_dwordx4 a[204:207], v1, s[36:39], s50 offen offset:3072 sc1
v_mfma_f32_16x16x32_bf16 v[104:107], v[36:39], a[104:107], v[104:107]
v_exp_f32 v182, v182
v_mfma_f32_16x16x32_bf16 v[104:107], v[40:43], a[112:115], v[104:107]
buffer_load_dwordx4 a[208:211], v13, s[36:39], s50 offen offset:0 sc1
v_mfma_f32_16x16x32_bf16 v[104:107], v[44:47], a[120:123], v[104:107]
s_waitcnt vmcnt(35) lgkmcnt(0)
s_barrier
v_mfma_f32_16x16x32_bf16 v[108:111], v[32:35], a[100:103], v[108:111]
ds_read_b128 v[32:35], v1 offset:19456
v_fma_f32 v182, v182, v19, v19
v_mfma_f32_16x16x32_bf16 v[108:111], v[36:39], a[108:111], v[108:111]
ds_read_b128 v[36:39], v14 offset:19456
v_mfma_f32_16x16x32_bf16 v[108:111], v[40:43], a[116:119], v[108:111]
ds_read_b128 v[40:43], v15 offset:19456
v_mfma_f32_16x16x32_bf16 v[108:111], v[44:47], a[124:127], v[108:111]
ds_read_b128 v[44:47], v24 offset:19456
v_mfma_f32_16x16x32_bf16 v[112:115], v[48:51], a[96:99], v[112:115]
buffer_load_dwordx4 a[212:215], v13, s[36:39], s50 offen offset:1024 sc1
v_mfma_f32_16x16x32_bf16 v[112:115], v[52:55], a[104:107], v[112:115]
v_exp_f32 v183, v183
v_mfma_f32_16x16x32_bf16 v[112:115], v[56:59], a[112:115], v[112:115]
buffer_load_dwordx4 a[216:219], v13, s[36:39], s50 offen offset:2048 sc1
v_mfma_f32_16x16x32_bf16 v[112:115], v[60:63], a[120:123], v[112:115]
v_fma_f32 v183, v183, v19, v19
v_mfma_f32_16x16x32_bf16 v[116:119], v[48:51], a[100:103], v[116:119]
ds_read_b128 v[48:51], v1 offset:20480
v_mfma_f32_16x16x32_bf16 v[116:119], v[52:55], a[108:111], v[116:119]
ds_read_b128 v[52:55], v14 offset:20480
v_mfma_f32_16x16x32_bf16 v[116:119], v[56:59], a[116:119], v[116:119]
ds_read_b128 v[56:59], v15 offset:20480
v_readlane_b32 s67, v27, 15
v_mfma_f32_16x16x32_bf16 v[116:119], v[60:63], a[124:127], v[116:119]
ds_read_b128 v[60:63], v24 offset:20480
s_waitcnt vmcnt(29) lgkmcnt(4)
v_mfma_f32_16x16x32_bf16 v[64:67], v[32:35], a[128:131], v[64:67]
buffer_load_dwordx4 a[220:223], v13, s[36:39], s50 offen offset:3072 sc1
v_mfma_f32_16x16x32_bf16 v[64:67], v[36:39], a[136:139], v[64:67]
s_add_u32 m0, s48, 5120
v_mfma_f32_16x16x32_bf16 v[64:67], v[40:43], a[144:147], v[64:67]
buffer_load_dwordx4 v1, s[36:39], s67 offen offset:0 sc1 lds
v_mfma_f32_16x16x32_bf16 v[64:67], v[44:47], a[152:155], v[64:67]
v_rcp_f32 v176, v176
v_mfma_f32_16x16x32_bf16 v[68:71], v[32:35], a[132:135], v[68:71]
ds_read_b128 v[32:35], v1 offset:21504
v_mul_f32 v160, v160, v176
v_mfma_f32_16x16x32_bf16 v[68:71], v[36:39], a[140:143], v[68:71]
ds_read_b128 v[36:39], v14 offset:21504
v_mul_f32 v176, v168, v168
v_mfma_f32_16x16x32_bf16 v[68:71], v[40:43], a[148:151], v[68:71]
ds_read_b128 v[40:43], v15 offset:21504
v_fma_f32 v176, v176, v22, v20
v_mfma_f32_16x16x32_bf16 v[68:71], v[44:47], a[156:159], v[68:71]
ds_read_b128 v[44:47], v24 offset:21504
s_waitcnt lgkmcnt(4)
v_mfma_f32_16x16x32_bf16 v[72:75], v[48:51], a[128:131], v[72:75]
buffer_load_dwordx4 v1, s[36:39], s67 offen offset:1024 sc1 lds
v_mfma_f32_16x16x32_bf16 v[72:75], v[52:55], a[136:139], v[72:75]
v_rcp_f32 v177, v177
v_mfma_f32_16x16x32_bf16 v[72:75], v[56:59], a[144:147], v[72:75]
buffer_load_dwordx4 v1, s[36:39], s67 offen offset:2048 sc1 lds
v_mfma_f32_16x16x32_bf16 v[72:75], v[60:63], a[152:155], v[72:75]
v_rcp_f32 v178, v178
v_mfma_f32_16x16x32_bf16 v[76:79], v[48:51], a[132:135], v[76:79]
ds_read_b128 v[48:51], v1 offset:22528
v_mul_f32 v161, v161, v177
v_mfma_f32_16x16x32_bf16 v[76:79], v[52:55], a[140:143], v[76:79]
ds_read_b128 v[52:55], v14 offset:22528
v_mul_f32 v162, v162, v178
v_mfma_f32_16x16x32_bf16 v[76:79], v[56:59], a[148:151], v[76:79]
ds_read_b128 v[56:59], v15 offset:22528
v_mul_f32 v177, v169, v169
v_mfma_f32_16x16x32_bf16 v[76:79], v[60:63], a[156:159], v[76:79]
ds_read_b128 v[60:63], v24 offset:22528
s_waitcnt lgkmcnt(4)
v_mfma_f32_16x16x32_bf16 v[80:83], v[32:35], a[128:131], v[80:83]
buffer_load_dwordx4 v1, s[36:39], s67 offen offset:3072 sc1 lds
v_mfma_f32_16x16x32_bf16 v[80:83], v[36:39], a[136:139], v[80:83]
s_add_u32 m0, s48, 9216
v_mul_f32 v178, v170, v170
v_mfma_f32_16x16x32_bf16 v[80:83], v[40:43], a[144:147], v[80:83]
buffer_load_dwordx4 v13, s[36:39], s67 offen offset:0 sc1 lds
v_mfma_f32_16x16x32_bf16 v[80:83], v[44:47], a[152:155], v[80:83]
v_rcp_f32 v179, v179
v_mfma_f32_16x16x32_bf16 v[84:87], v[32:35], a[132:135], v[84:87]
ds_read_b128 v[32:35], v1 offset:23552
v_mul_f32 v163, v163, v179
v_mfma_f32_16x16x32_bf16 v[84:87], v[36:39], a[140:143], v[84:87]
ds_read_b128 v[36:39], v14 offset:23552
v_mul_f32 v179, v171, v171
v_mfma_f32_16x16x32_bf16 v[84:87], v[40:43], a[148:151], v[84:87]
ds_read_b128 v[40:43], v15 offset:23552
v_fma_f32 v177, v177, v22, v20
v_mfma_f32_16x16x32_bf16 v[84:87], v[44:47], a[156:159], v[84:87]
ds_read_b128 v[44:47], v24 offset:23552
s_waitcnt lgkmcnt(4)
v_mfma_f32_16x16x32_bf16 v[88:91], v[48:51], a[128:131], v[88:91]
buffer_load_dwordx4 v13, s[36:39], s67 offen offset:1024 sc1 lds
v_mfma_f32_16x16x32_bf16 v[88:91], v[52:55], a[136:139], v[88:91]
v_rcp_f32 v180, v180
v_mfma_f32_16x16x32_bf16 v[88:91], v[56:59], a[144:147], v[88:91]
buffer_load_dwordx4 v13, s[36:39], s67 offen offset:2048 sc1 lds
v_mfma_f32_16x16x32_bf16 v[88:91], v[60:63], a[152:155], v[88:91]
v_rcp_f32 v181, v181
v_mfma_f32_16x16x32_bf16 v[92:95], v[48:51], a[132:135], v[92:95]
ds_read_b128 v[48:51], v1 offset:24576
v_mul_f32 v164, v164, v180
v_mfma_f32_16x16x32_bf16 v[92:95], v[52:55], a[140:143], v[92:95]
ds_read_b128 v[52:55], v14 offset:24576
v_readlane_b32 s66, v28, 15
v_mfma_f32_16x16x32_bf16 v[92:95], v[56:59], a[148:151], v[92:95]
ds_read_b128 v[56:59], v15 offset:24576
v_mul_f32 v165, v165, v181
v_mfma_f32_16x16x32_bf16 v[92:95], v[60:63], a[156:159], v[92:95]
ds_read_b128 v[60:63], v24 offset:24576
s_waitcnt lgkmcnt(4)
v_mfma_f32_16x16x32_bf16 v[96:99], v[32:35], a[128:131], v[96:99]
buffer_load_dwordx4 a[224:227], v1, s[36:39], s66 offen offset:0 sc1
v_mfma_f32_16x16x32_bf16 v[96:99], v[36:39], a[136:139], v[96:99]
v_rcp_f32 v182, v182
v_mfma_f32_16x16x32_bf16 v[96:99], v[40:43], a[144:147], v[96:99]
buffer_load_dwordx4 a[228:231], v1, s[36:39], s66 offen offset:1024 sc1
v_mfma_f32_16x16x32_bf16 v[96:99], v[44:47], a[152:155], v[96:99]
v_rcp_f32 v183, v183
v_mfma_f32_16x16x32_bf16 v[100:103], v[32:35], a[132:135], v[100:103]
ds_read_b128 v[32:35], v1 offset:25600
v_mul_f32 v166, v166, v182
v_mfma_f32_16x16x32_bf16 v[100:103], v[36:39], a[140:143], v[100:103]
ds_read_b128 v[36:39], v14 offset:25600
v_mul_f32 v167, v167, v183
v_mfma_f32_16x16x32_bf16 v[100:103], v[40:43], a[148:151], v[100:103]
ds_read_b128 v[40:43], v15 offset:25600
v_mul_f32 v180, v172, v172
v_mfma_f32_16x16x32_bf16 v[100:103], v[44:47], a[156:159], v[100:103]
ds_read_b128 v[44:47], v24 offset:25600
s_waitcnt lgkmcnt(4)
v_mfma_f32_16x16x32_bf16 v[104:107], v[48:51], a[128:131], v[104:107]
buffer_load_dwordx4 a[232:235], v1, s[36:39], s66 offen offset:2048 sc1
v_mfma_f32_16x16x32_bf16 v[104:107], v[52:55], a[136:139], v[104:107]
v_mul_f32 v181, v173, v173
v_mul_f32 v182, v174, v174
v_mfma_f32_16x16x32_bf16 v[104:107], v[56:59], a[144:147], v[104:107]
buffer_load_dwordx4 a[236:239], v1, s[36:39], s66 offen offset:3072 sc1
v_mfma_f32_16x16x32_bf16 v[104:107], v[60:63], a[152:155], v[104:107]
s_waitcnt vmcnt(34) lgkmcnt(0)
s_barrier
v_mfma_f32_16x16x32_bf16 v[108:111], v[48:51], a[132:135], v[108:111]
ds_read_b128 v[48:51], v1 offset:26624
v_mul_f32 v183, v175, v175
v_mfma_f32_16x16x32_bf16 v[108:111], v[52:55], a[140:143], v[108:111]
ds_read_b128 v[52:55], v14 offset:26624
v_fma_f32 v178, v178, v22, v20
v_mfma_f32_16x16x32_bf16 v[108:111], v[56:59], a[148:151], v[108:111]
ds_read_b128 v[56:59], v15 offset:26624
v_fma_f32 v179, v179, v22, v20
v_mfma_f32_16x16x32_bf16 v[108:111], v[60:63], a[156:159], v[108:111]
ds_read_b128 v[60:63], v24 offset:26624
v_mfma_f32_16x16x32_bf16 v[112:115], v[32:35], a[128:131], v[112:115]
buffer_load_dwordx4 a[240:243], v13, s[36:39], s66 offen offset:0 sc1
v_mfma_f32_16x16x32_bf16 v[112:115], v[36:39], a[136:139], v[112:115]
v_fma_f32 v180, v180, v23, v21
v_fma_f32 v181, v181, v23, v21
v_mfma_f32_16x16x32_bf16 v[112:115], v[40:43], a[144:147], v[112:115]
buffer_load_dwordx4 a[244:247], v13, s[36:39], s66 offen offset:1024 sc1
v_mfma_f32_16x16x32_bf16 v[112:115], v[44:47], a[152:155], v[112:115]
v_fma_f32 v182, v182, v23, v21
v_fma_f32 v183, v183, v23, v21
v_mfma_f32_16x16x32_bf16 v[116:119], v[32:35], a[132:135], v[116:119]
ds_read_b128 v[32:35], v1 offset:27648
v_mul_f32 v176, v176, v168
v_mfma_f32_16x16x32_bf16 v[116:119], v[36:39], a[140:143], v[116:119]
ds_read_b128 v[36:39], v14 offset:27648
v_mul_f32 v177, v177, v169
v_mfma_f32_16x16x32_bf16 v[116:119], v[40:43], a[148:151], v[116:119]
ds_read_b128 v[40:43], v15 offset:27648
v_mul_f32 v178, v178, v170
v_mfma_f32_16x16x32_bf16 v[116:119], v[44:47], a[156:159], v[116:119]
ds_read_b128 v[44:47], v24 offset:27648
s_waitcnt vmcnt(28) lgkmcnt(4)
v_mfma_f32_16x16x32_bf16 v[64:67], v[48:51], a[160:163], v[64:67]
buffer_load_dwordx4 a[248:251], v13, s[36:39], s66 offen offset:2048 sc1
v_mfma_f32_16x16x32_bf16 v[64:67], v[52:55], a[168:171], v[64:67]
v_mul_f32 v179, v179, v171
v_mul_f32 v180, v180, v172
v_mfma_f32_16x16x32_bf16 v[64:67], v[56:59], a[176:179], v[64:67]
buffer_load_dwordx4 a[252:255], v13, s[36:39], s66 offen offset:3072 sc1
v_mfma_f32_16x16x32_bf16 v[64:67], v[60:63], a[184:187], v[64:67]
v_mul_f32 v181, v181, v173
v_mul_f32 v182, v182, v174
v_mfma_f32_16x16x32_bf16 v[68:71], v[48:51], a[164:167], v[68:71]
ds_read_b128 v[48:51], v1 offset:28672
v_mul_f32 v183, v183, v175
v_mfma_f32_16x16x32_bf16 v[68:71], v[52:55], a[172:175], v[68:71]
ds_read_b128 v[52:55], v14 offset:28672
v_readlane_b32 s50, v30, 0
v_mfma_f32_16x16x32_bf16 v[68:71], v[56:59], a[180:183], v[68:71]
ds_read_b128 v[56:59], v15 offset:28672
v_mfma_f32_16x16x32_bf16 v[68:71], v[60:63], a[188:191], v[68:71]
ds_read_b128 v[60:63], v24 offset:28672
s_waitcnt lgkmcnt(4)
v_mfma_f32_16x16x32_bf16 v[72:75], v[32:35], a[160:163], v[72:75]
buffer_load_dwordx4 v[192:195], v1, s[36:39], s50 offen offset:0 sc1
v_mfma_f32_16x16x32_bf16 v[72:75], v[36:39], a[168:171], v[72:75]
v_exp_f32 v176, v176
v_mfma_f32_16x16x32_bf16 v[72:75], v[40:43], a[176:179], v[72:75]
buffer_load_dwordx4 v[196:199], v1, s[36:39], s50 offen offset:1024 sc1
v_mfma_f32_16x16x32_bf16 v[72:75], v[44:47], a[184:187], v[72:75]
v_exp_f32 v177, v177
v_mfma_f32_16x16x32_bf16 v[76:79], v[32:35], a[164:167], v[76:79]
ds_read_b128 v[32:35], v1 offset:29696
v_fma_f32 v176, v176, v18, v18
v_mfma_f32_16x16x32_bf16 v[76:79], v[36:39], a[172:175], v[76:79]
ds_read_b128 v[36:39], v14 offset:29696
v_fma_f32 v177, v177, v18, v18
v_mfma_f32_16x16x32_bf16 v[76:79], v[40:43], a[180:183], v[76:79]
ds_read_b128 v[40:43], v15 offset:29696
v_mfma_f32_16x16x32_bf16 v[76:79], v[44:47], a[188:191], v[76:79]
ds_read_b128 v[44:47], v24 offset:29696
s_waitcnt lgkmcnt(4)
v_mfma_f32_16x16x32_bf16 v[80:83], v[48:51], a[160:163], v[80:83]
buffer_load_dwordx4 v[200:203], v13, s[36:39], s50 offen offset:0 sc1
v_mfma_f32_16x16x32_bf16 v[80:83], v[52:55], a[168:171], v[80:83]
v_exp_f32 v178, v178
v_mfma_f32_16x16x32_bf16 v[80:83], v[56:59], a[176:179], v[80:83]
buffer_load_dwordx4 v[204:207], v13, s[36:39], s50 offen offset:1024 sc1
v_mfma_f32_16x16x32_bf16 v[80:83], v[60:63], a[184:187], v[80:83]
v_exp_f32 v179, v179
v_mfma_f32_16x16x32_bf16 v[84:87], v[48:51], a[164:167], v[84:87]
ds_read_b128 v[48:51], v1 offset:30720
v_fma_f32 v178, v178, v18, v18
v_mfma_f32_16x16x32_bf16 v[84:87], v[52:55], a[172:175], v[84:87]
ds_read_b128 v[52:55], v14 offset:30720
s_add_u32 s66, s50, 8192
v_mfma_f32_16x16x32_bf16 v[84:87], v[56:59], a[180:183], v[84:87]
ds_read_b128 v[56:59], v15 offset:30720
v_fma_f32 v179, v179, v18, v18
v_mfma_f32_16x16x32_bf16 v[84:87], v[60:63], a[188:191], v[84:87]
ds_read_b128 v[60:63], v24 offset:30720
s_waitcnt lgkmcnt(4)
v_mfma_f32_16x16x32_bf16 v[88:91], v[32:35], a[160:163], v[88:91]
buffer_load_dwordx4 v[208:211], v1, s[36:39], s66 offen offset:0 sc1
v_mfma_f32_16x16x32_bf16 v[88:91], v[36:39], a[168:171], v[88:91]
v_exp_f32 v180, v180
v_mfma_f32_16x16x32_bf16 v[88:91], v[40:43], a[176:179], v[88:91]
buffer_load_dwordx4 v[212:215], v1, s[36:39], s66 offen offset:1024 sc1
v_mfma_f32_16x16x32_bf16 v[88:91], v[44:47], a[184:187], v[88:91]
v_exp_f32 v181, v181
v_mfma_f32_16x16x32_bf16 v[92:95], v[32:35], a[164:167], v[92:95]
ds_read_b128 v[32:35], v1 offset:31744
v_fma_f32 v180, v180, v19, v19
v_mfma_f32_16x16x32_bf16 v[92:95], v[36:39], a[172:175], v[92:95]
ds_read_b128 v[36:39], v14 offset:31744
v_fma_f32 v181, v181, v19, v19
v_mfma_f32_16x16x32_bf16 v[92:95], v[40:43], a[180:183], v[92:95]
ds_read_b128 v[40:43], v15 offset:31744
v_mfma_f32_16x16x32_bf16 v[92:95], v[44:47], a[188:191], v[92:95]
ds_read_b128 v[44:47], v24 offset:31744
s_waitcnt lgkmcnt(4)
v_mfma_f32_16x16x32_bf16 v[96:99], v[48:51], a[160:163], v[96:99]
buffer_load_dwordx4 v[216:219], v13, s[36:39], s66 offen offset:0 sc1
v_mfma_f32_16x16x32_bf16 v[96:99], v[52:55], a[168:171], v[96:99]
v_exp_f32 v182, v182
v_mfma_f32_16x16x32_bf16 v[96:99], v[56:59], a[176:179], v[96:99]
buffer_load_dwordx4 v[220:223], v13, s[36:39], s66 offen offset:1024 sc1
v_mfma_f32_16x16x32_bf16 v[96:99], v[60:63], a[184:187], v[96:99]
v_exp_f32 v183, v183
v_mfma_f32_16x16x32_bf16 v[100:103], v[48:51], a[164:167], v[100:103]
ds_read_b128 v[48:51], v1 offset:32768
v_fma_f32 v182, v182, v19, v19
v_mfma_f32_16x16x32_bf16 v[100:103], v[52:55], a[172:175], v[100:103]
ds_read_b128 v[52:55], v14 offset:32768
s_add_u32 s50, s66, 8192
v_mfma_f32_16x16x32_bf16 v[100:103], v[56:59], a[180:183], v[100:103]
ds_read_b128 v[56:59], v15 offset:32768
v_fma_f32 v183, v183, v19, v19
v_mfma_f32_16x16x32_bf16 v[100:103], v[60:63], a[188:191], v[100:103]
ds_read_b128 v[60:63], v24 offset:32768
s_waitcnt lgkmcnt(4)
v_mfma_f32_16x16x32_bf16 v[104:107], v[32:35], a[160:163], v[104:107]
buffer_load_dwordx4 v[224:227], v1, s[36:39], s50 offen offset:0 sc1
v_mfma_f32_16x16x32_bf16 v[104:107], v[36:39], a[168:171], v[104:107]
v_rcp_f32 v176, v176
v_mfma_f32_16x16x32_bf16 v[104:107], v[40:43], a[176:179], v[104:107]
buffer_load_dwordx4 v[228:231], v1, s[36:39], s50 offen offset:1024 sc1
v_mfma_f32_16x16x32_bf16 v[104:107], v[44:47], a[184:187], v[104:107]
s_waitcnt vmcnt(33) lgkmcnt(0)
s_barrier
v_mfma_f32_16x16x32_bf16 v[108:111], v[32:35], a[164:167], v[108:111]
ds_read_b128 v[32:35], v1 offset:33792
v_mul_f32 v168, v168, v176
v_mfma_f32_16x16x32_bf16 v[108:111], v[36:39], a[172:175], v[108:111]
ds_read_b128 v[36:39], v14 offset:33792
v_mfma_f32_16x16x32_bf16 v[108:111], v[40:43], a[180:183], v[108:111]
ds_read_b128 v[40:43], v15 offset:33792
v_mfma_f32_16x16x32_bf16 v[108:111], v[44:47], a[188:191], v[108:111]
ds_read_b128 v[44:47], v24 offset:33792
v_mfma_f32_16x16x32_bf16 v[112:115], v[48:51], a[160:163], v[112:115]
buffer_load_dwordx4 v[232:235], v13, s[36:39], s50 offen offset:0 sc1
v_mfma_f32_16x16x32_bf16 v[112:115], v[52:55], a[168:171], v[112:115]
v_rcp_f32 v177, v177
v_mfma_f32_16x16x32_bf16 v[112:115], v[56:59], a[176:179], v[112:115]
buffer_load_dwordx4 v[236:239], v13, s[36:39], s50 offen offset:1024 sc1
v_mfma_f32_16x16x32_bf16 v[112:115], v[60:63], a[184:187], v[112:115]
v_rcp_f32 v178, v178
v_mfma_f32_16x16x32_bf16 v[116:119], v[48:51], a[164:167], v[116:119]
ds_read_b128 v[48:51], v1 offset:34816
v_mul_f32 v169, v169, v177
v_mfma_f32_16x16x32_bf16 v[116:119], v[52:55], a[172:175], v[116:119]
ds_read_b128 v[52:55], v14 offset:34816
s_add_u32 s66, s50, 8192
v_mfma_f32_16x16x32_bf16 v[116:119], v[56:59], a[180:183], v[116:119]
ds_read_b128 v[56:59], v15 offset:34816
v_mul_f32 v170, v170, v178
v_mfma_f32_16x16x32_bf16 v[116:119], v[60:63], a[188:191], v[116:119]
ds_read_b128 v[60:63], v24 offset:34816
s_waitcnt vmcnt(27) lgkmcnt(4)
v_mfma_f32_16x16x32_bf16 v[64:67], v[32:35], a[192:195], v[64:67]
buffer_load_dwordx4 a[0:3], v1, s[36:39], s66 offen offset:0 sc1
v_mfma_f32_16x16x32_bf16 v[64:67], v[36:39], a[200:203], v[64:67]
v_rcp_f32 v179, v179
v_mfma_f32_16x16x32_bf16 v[64:67], v[40:43], a[208:211], v[64:67]
buffer_load_dwordx4 a[4:7], v1, s[36:39], s66 offen offset:1024 sc1
v_mfma_f32_16x16x32_bf16 v[64:67], v[44:47], a[216:219], v[64:67]
v_rcp_f32 v180, v180
v_mfma_f32_16x16x32_bf16 v[68:71], v[32:35], a[196:199], v[68:71]
ds_read_b128 v[32:35], v1 offset:35840
v_mul_f32 v171, v171, v179
v_mfma_f32_16x16x32_bf16 v[68:71], v[36:39], a[204:207], v[68:71]
ds_read_b128 v[36:39], v14 offset:35840
v_readlane_b32 s50, v30, 1
v_mfma_f32_16x16x32_bf16 v[68:71], v[40:43], a[212:215], v[68:71]
ds_read_b128 v[40:43], v15 offset:35840
v_mul_f32 v172, v172, v180
v_mfma_f32_16x16x32_bf16 v[68:71], v[44:47], a[220:223], v[68:71]
ds_read_b128 v[44:47], v24 offset:35840
s_waitcnt lgkmcnt(4)
v_mfma_f32_16x16x32_bf16 v[72:75], v[48:51], a[192:195], v[72:75]
buffer_load_dwordx4 a[8:11], v1, s[36:39], s50 offen offset:0 sc1
v_mfma_f32_16x16x32_bf16 v[72:75], v[52:55], a[200:203], v[72:75]
v_rcp_f32 v181, v181
v_mfma_f32_16x16x32_bf16 v[72:75], v[56:59], a[208:211], v[72:75]
buffer_load_dwordx4 a[12:15], v1, s[36:39], s50 offen offset:1024 sc1
v_mfma_f32_16x16x32_bf16 v[72:75], v[60:63], a[216:219], v[72:75]
v_rcp_f32 v182, v182
v_mfma_f32_16x16x32_bf16 v[76:79], v[48:51], a[196:199], v[76:79]
ds_read_b128 v[48:51], v1 offset:36864
v_mul_f32 v173, v173, v181
v_mfma_f32_16x16x32_bf16 v[76:79], v[52:55], a[204:207], v[76:79]
ds_read_b128 v[52:55], v14 offset:36864
v_mul_f32 v174, v174, v182
v_mfma_f32_16x16x32_bf16 v[76:79], v[56:59], a[212:215], v[76:79]
ds_read_b128 v[56:59], v15 offset:36864
v_mfma_f32_16x16x32_bf16 v[76:79], v[60:63], a[220:223], v[76:79]
ds_read_b128 v[60:63], v24 offset:36864
s_waitcnt lgkmcnt(4)
v_mfma_f32_16x16x32_bf16 v[80:83], v[32:35], a[192:195], v[80:83]
buffer_load_dwordx4 a[16:19], v13, s[36:39], s50 offen offset:0 sc1
v_mfma_f32_16x16x32_bf16 v[80:83], v[36:39], a[200:203], v[80:83]
v_rcp_f32 v183, v183
v_mfma_f32_16x16x32_bf16 v[80:83], v[40:43], a[208:211], v[80:83]
buffer_load_dwordx4 a[20:23], v13, s[36:39], s50 offen offset:1024 sc1
v_mfma_f32_16x16x32_bf16 v[80:83], v[44:47], a[216:219], v[80:83]
v_mul_f32 v175, v175, v183
v_mfma_f32_16x16x32_bf16 v[84:87], v[32:35], a[196:199], v[84:87]
ds_read_b128 v[32:35], v1 offset:37888
v_mfma_f32_16x16x32_bf16 v[84:87], v[36:39], a[204:207], v[84:87]
TP57:
s_cbranch_execz TP10
TP58:
s_cbranch_execz TR2
ds_read_b128 v[36:39], v14 offset:37888
s_add_u32 s66, s50, 8192
v_mfma_f32_16x16x32_bf16 v[84:87], v[40:43], a[212:215], v[84:87]
ds_read_b128 v[40:43], v15 offset:37888
v_mfma_f32_16x16x32_bf16 v[84:87], v[44:47], a[220:223], v[84:87]
ds_read_b128 v[44:47], v24 offset:37888
s_waitcnt lgkmcnt(4)
v_mfma_f32_16x16x32_bf16 v[88:91], v[48:51], a[192:195], v[88:91]
buffer_load_dwordx4 a[24:27], v1, s[36:39], s66 offen offset:0 sc1
v_mfma_f32_16x16x32_bf16 v[88:91], v[52:55], a[200:203], v[88:91]
v_mfma_f32_16x16x32_bf16 v[88:91], v[56:59], a[208:211], v[88:91]
buffer_load_dwordx4 a[28:31], v1, s[36:39], s66 offen offset:1024 sc1
v_mfma_f32_16x16x32_bf16 v[88:91], v[60:63], a[216:219], v[88:91]
v_mfma_f32_16x16x32_bf16 v[92:95], v[48:51], a[196:199], v[92:95]
ds_read_b128 v[48:51], v1 offset:38912
v_mfma_f32_16x16x32_bf16 v[92:95], v[52:55], a[204:207], v[92:95]
ds_read_b128 v[52:55], v14 offset:38912
v_mfma_f32_16x16x32_bf16 v[92:95], v[56:59], a[212:215], v[92:95]
ds_read_b128 v[56:59], v15 offset:38912
v_mfma_f32_16x16x32_bf16 v[92:95], v[60:63], a[220:223], v[92:95]
ds_read_b128 v[60:63], v24 offset:38912
s_waitcnt lgkmcnt(4)
v_mfma_f32_16x16x32_bf16 v[96:99], v[32:35], a[192:195], v[96:99]
buffer_load_dwordx4 v[176:179], v1, s[36:39], s60 offen offset:0 sc1
v_mfma_f32_16x16x32_bf16 v[96:99], v[36:39], a[200:203], v[96:99]
v_mfma_f32_16x16x32_bf16 v[96:99], v[40:43], a[208:211], v[96:99]
buffer_load_dwordx4 v[180:183], v1, s[36:39], s60 offen offset:1024 sc1
v_mfma_f32_16x16x32_bf16 v[96:99], v[44:47], a[216:219], v[96:99]
v_mfma_f32_16x16x32_bf16 v[100:103], v[32:35], a[196:199], v[100:103]
ds_read_b128 v[32:35], v1 offset:39936
v_mfma_f32_16x16x32_bf16 v[100:103], v[36:39], a[204:207], v[100:103]
ds_read_b128 v[36:39], v14 offset:39936
v_mfma_f32_16x16x32_bf16 v[100:103], v[40:43], a[212:215], v[100:103]
ds_read_b128 v[40:43], v15 offset:39936
v_mfma_f32_16x16x32_bf16 v[100:103], v[44:47], a[220:223], v[100:103]
ds_read_b128 v[44:47], v24 offset:39936
s_waitcnt lgkmcnt(4)
v_mfma_f32_16x16x32_bf16 v[104:107], v[48:51], a[192:195], v[104:107]
buffer_load_dwordx4 v[184:187], v1, s[36:39], s65 offen offset:0 sc1
v_mfma_f32_16x16x32_bf16 v[104:107], v[52:55], a[200:203], v[104:107]
v_mfma_f32_16x16x32_bf16 v[104:107], v[56:59], a[208:211], v[104:107]
buffer_load_dwordx4 v[188:191], v1, s[36:39], s65 offen offset:1024 sc1
v_mfma_f32_16x16x32_bf16 v[104:107], v[60:63], a[216:219], v[104:107]
s_waitcnt vmcnt(32) lgkmcnt(0)
s_barrier
v_mfma_f32_16x16x32_bf16 v[108:111], v[48:51], a[196:199], v[108:111]
ds_read_b128 v[48:51], v1 offset:5120
v_mfma_f32_16x16x32_bf16 v[108:111], v[52:55], a[204:207], v[108:111]
ds_read_b128 v[52:55], v14 offset:5120
v_mfma_f32_16x16x32_bf16 v[108:111], v[56:59], a[212:215], v[108:111]
ds_read_b128 v[56:59], v15 offset:5120
v_mfma_f32_16x16x32_bf16 v[108:111], v[60:63], a[220:223], v[108:111]
ds_read_b128 v[60:63], v24 offset:5120
v_mfma_f32_16x16x32_bf16 v[112:115], v[32:35], a[192:195], v[112:115]
buffer_load_dwordx4 a[32:35], v13, s[36:39], s66 offen offset:0 sc1
v_mfma_f32_16x16x32_bf16 v[112:115], v[36:39], a[200:203], v[112:115]
v_mfma_f32_16x16x32_bf16 v[112:115], v[40:43], a[208:211], v[112:115]
buffer_load_dwordx4 a[36:39], v13, s[36:39], s66 offen offset:1024 sc1
v_mfma_f32_16x16x32_bf16 v[112:115], v[44:47], a[216:219], v[112:115]
v_mfma_f32_16x16x32_bf16 v[116:119], v[32:35], a[196:199], v[116:119]
ds_read_b128 v[32:35], v1 offset:6144
v_mfma_f32_16x16x32_bf16 v[116:119], v[36:39], a[204:207], v[116:119]
ds_read_b128 v[36:39], v14 offset:6144
s_add_u32 s50, s66, 8192
v_mfma_f32_16x16x32_bf16 v[116:119], v[40:43], a[212:215], v[116:119]
ds_read_b128 v[40:43], v15 offset:6144
v_mfma_f32_16x16x32_bf16 v[116:119], v[44:47], a[220:223], v[116:119]
ds_read_b128 v[44:47], v24 offset:6144
s_waitcnt vmcnt(26) lgkmcnt(4)
v_mfma_f32_16x16x32_bf16 v[64:67], v[48:51], a[224:227], v[64:67]
buffer_load_dwordx4 a[40:43], v1, s[36:39], s50 offen offset:0 sc1
v_mfma_f32_16x16x32_bf16 v[64:67], v[52:55], a[232:235], v[64:67]
v_mfma_f32_16x16x32_bf16 v[64:67], v[56:59], a[240:243], v[64:67]
buffer_load_dwordx4 a[44:47], v1, s[36:39], s50 offen offset:1024 sc1
v_mfma_f32_16x16x32_bf16 v[64:67], v[60:63], a[248:251], v[64:67]
v_mfma_f32_16x16x32_bf16 v[68:71], v[48:51], a[228:231], v[68:71]
ds_read_b128 v[48:51], v1 offset:7168
v_mfma_f32_16x16x32_bf16 v[68:71], v[52:55], a[236:239], v[68:71]
ds_read_b128 v[52:55], v14 offset:7168
v_mfma_f32_16x16x32_bf16 v[68:71], v[56:59], a[244:247], v[68:71]
ds_read_b128 v[56:59], v15 offset:7168
v_mfma_f32_16x16x32_bf16 v[68:71], v[60:63], a[252:255], v[68:71]
ds_read_b128 v[60:63], v24 offset:7168
s_waitcnt lgkmcnt(4)
v_mfma_f32_16x16x32_bf16 v[72:75], v[32:35], a[224:227], v[72:75]
buffer_load_dwordx4 a[48:51], v13, s[36:39], s50 offen offset:0 sc1
v_mfma_f32_16x16x32_bf16 v[72:75], v[36:39], a[232:235], v[72:75]
v_mfma_f32_16x16x32_bf16 v[72:75], v[40:43], a[240:243], v[72:75]
v_mul_f32 v120, v120, v64
v_mfma_f32_16x16x32_bf16 v[72:75], v[44:47], a[248:251], v[72:75]
v_mul_f32 v121, v121, v65
v_mul_f32 v122, v122, v66
v_mfma_f32_16x16x32_bf16 v[76:79], v[32:35], a[228:231], v[76:79]
ds_read_b128 v[32:35], v1 offset:8192
v_mul_f32 v123, v123, v67
v_mfma_f32_16x16x32_bf16 v[76:79], v[36:39], a[236:239], v[76:79]
ds_read_b128 v[36:39], v14 offset:8192
v_mul_f32 v124, v124, v68
v_mfma_f32_16x16x32_bf16 v[76:79], v[40:43], a[244:247], v[76:79]
ds_read_b128 v[40:43], v15 offset:8192
v_mul_f32 v125, v125, v69
v_mfma_f32_16x16x32_bf16 v[76:79], v[44:47], a[252:255], v[76:79]
ds_read_b128 v[44:47], v24 offset:8192
s_waitcnt lgkmcnt(4)
v_mfma_f32_16x16x32_bf16 v[80:83], v[48:51], a[224:227], v[80:83]
v_mul_f32 v126, v126, v70
v_mfma_f32_16x16x32_bf16 v[80:83], v[52:55], a[232:235], v[80:83]
v_mul_f32 v127, v127, v71
v_mfma_f32_16x16x32_bf16 v[80:83], v[56:59], a[240:243], v[80:83]
v_mul_f32 v128, v128, v72
v_mfma_f32_16x16x32_bf16 v[80:83], v[60:63], a[248:251], v[80:83]
v_mul_f32 v129, v129, v73
v_mul_f32 v130, v130, v74
v_mfma_f32_16x16x32_bf16 v[84:87], v[48:51], a[228:231], v[84:87]
ds_read_b128 v[48:51], v1 offset:9216
v_mul_f32 v131, v131, v75
v_mfma_f32_16x16x32_bf16 v[84:87], v[52:55], a[236:239], v[84:87]
ds_read_b128 v[52:55], v14 offset:9216
v_mul_f32 v132, v132, v76
v_mfma_f32_16x16x32_bf16 v[84:87], v[56:59], a[244:247], v[84:87]
ds_read_b128 v[56:59], v15 offset:9216
v_mul_f32 v133, v133, v77
v_mfma_f32_16x16x32_bf16 v[84:87], v[60:63], a[252:255], v[84:87]
ds_read_b128 v[60:63], v24 offset:9216
s_waitcnt lgkmcnt(4)
v_mfma_f32_16x16x32_bf16 v[88:91], v[32:35], a[224:227], v[88:91]
v_mul_f32 v134, v134, v78
v_mfma_f32_16x16x32_bf16 v[88:91], v[36:39], a[232:235], v[88:91]
v_mul_f32 v135, v135, v79
v_cvt_pk_bf16_f32 v120, v120, v121
v_mfma_f32_16x16x32_bf16 v[88:91], v[40:43], a[240:243], v[88:91]
v_cvt_pk_bf16_f32 v121, v122, v123
v_mfma_f32_16x16x32_bf16 v[88:91], v[44:47], a[248:251], v[88:91]
v_cvt_pk_bf16_f32 v122, v128, v129
v_cvt_pk_bf16_f32 v123, v130, v131
v_mfma_f32_16x16x32_bf16 v[92:95], v[32:35], a[228:231], v[92:95]
ds_read_b128 v[32:35], v1 offset:10240
v_mfma_f32_16x16x32_bf16 v[92:95], v[36:39], a[236:239], v[92:95]
ds_read_b128 v[36:39], v14 offset:10240
v_mfma_f32_16x16x32_bf16 v[92:95], v[40:43], a[244:247], v[92:95]
ds_read_b128 v[40:43], v15 offset:10240
v_mfma_f32_16x16x32_bf16 v[92:95], v[44:47], a[252:255], v[92:95]
ds_read_b128 v[44:47], v24 offset:10240
s_waitcnt lgkmcnt(4)
v_mfma_f32_16x16x32_bf16 v[96:99], v[48:51], a[224:227], v[96:99]
buffer_store_dwordx4 v[120:123], v1, s[36:39], s53 offen offset:0 sc1
v_mfma_f32_16x16x32_bf16 v[96:99], v[52:55], a[232:235], v[96:99]
v_cvt_pk_bf16_f32 v124, v124, v125
v_cvt_pk_bf16_f32 v125, v126, v127
v_mfma_f32_16x16x32_bf16 v[96:99], v[56:59], a[240:243], v[96:99]
v_cvt_pk_bf16_f32 v126, v132, v133
v_mfma_f32_16x16x32_bf16 v[96:99], v[60:63], a[248:251], v[96:99]
v_cvt_pk_bf16_f32 v127, v134, v135
v_mfma_f32_16x16x32_bf16 v[100:103], v[48:51], a[228:231], v[100:103]
ds_read_b128 v[48:51], v1 offset:11264
v_mfma_f32_16x16x32_bf16 v[100:103], v[52:55], a[236:239], v[100:103]
ds_read_b128 v[52:55], v14 offset:11264
v_mfma_f32_16x16x32_bf16 v[100:103], v[56:59], a[244:247], v[100:103]
ds_read_b128 v[56:59], v15 offset:11264
s_add_u32 s66, s50, 8192
v_mfma_f32_16x16x32_bf16 v[100:103], v[60:63], a[252:255], v[100:103]
ds_read_b128 v[60:63], v24 offset:11264
s_waitcnt lgkmcnt(4)
v_mfma_f32_16x16x32_bf16 v[104:107], v[32:35], a[224:227], v[104:107]
buffer_store_dwordx4 v[124:127], v1, s[36:39], s53 offen offset:1024 sc1
v_mfma_f32_16x16x32_bf16 v[104:107], v[36:39], a[232:235], v[104:107]
v_mul_f32 v136, v136, v80
v_mul_f32 v137, v137, v81
v_mfma_f32_16x16x32_bf16 v[104:107], v[40:43], a[240:243], v[104:107]
v_mul_f32 v138, v138, v82
v_mfma_f32_16x16x32_bf16 v[104:107], v[44:47], a[248:251], v[104:107]
s_waitcnt lgkmcnt(0)
s_barrier
v_mfma_f32_16x16x32_bf16 v[108:111], v[32:35], a[228:231], v[108:111]
v_mul_f32 v139, v139, v83
v_mul_f32 v140, v140, v84
v_mfma_f32_16x16x32_bf16 v[108:111], v[36:39], a[236:239], v[108:111]
v_mul_f32 v141, v141, v85
v_mul_f32 v142, v142, v86
v_mfma_f32_16x16x32_bf16 v[108:111], v[40:43], a[244:247], v[108:111]
v_mul_f32 v143, v143, v87
v_mul_f32 v144, v144, v88
v_mul_f32 v145, v145, v89
v_mul_f32 v146, v146, v90
v_mul_f32 v147, v147, v91
v_mul_f32 v148, v148, v92
v_mul_f32 v149, v149, v93
v_mfma_f32_16x16x32_bf16 v[108:111], v[44:47], a[252:255], v[108:111]
v_mul_f32 v150, v150, v94
v_mul_f32 v151, v151, v95
v_cvt_pk_bf16_f32 v136, v136, v137
v_cvt_pk_bf16_f32 v137, v138, v139
v_cvt_pk_bf16_f32 v138, v144, v145
v_cvt_pk_bf16_f32 v139, v146, v147
v_mfma_f32_16x16x32_bf16 v[112:115], v[48:51], a[224:227], v[112:115]
buffer_store_dwordx4 v[136:139], v1, s[36:39], s53 offen offset:2048 sc1
v_mfma_f32_16x16x32_bf16 v[112:115], v[52:55], a[232:235], v[112:115]
v_cvt_pk_bf16_f32 v140, v140, v141
v_cvt_pk_bf16_f32 v141, v142, v143
v_cvt_pk_bf16_f32 v142, v148, v149
v_cvt_pk_bf16_f32 v143, v150, v151
v_mfma_f32_16x16x32_bf16 v[112:115], v[56:59], a[240:243], v[112:115]
buffer_store_dwordx4 v[140:143], v1, s[36:39], s53 offen offset:3072 sc1
v_mfma_f32_16x16x32_bf16 v[112:115], v[60:63], a[248:251], v[112:115]
v_mul_f32 v152, v152, v96
v_mul_f32 v153, v153, v97
v_mfma_f32_16x16x32_bf16 v[116:119], v[48:51], a[228:231], v[116:119]
v_mul_f32 v154, v154, v98
v_mul_f32 v155, v155, v99
v_mfma_f32_16x16x32_bf16 v[116:119], v[52:55], a[236:239], v[116:119]
v_mul_f32 v156, v156, v100
v_mul_f32 v157, v157, v101
v_mfma_f32_16x16x32_bf16 v[116:119], v[56:59], a[244:247], v[116:119]
v_mul_f32 v158, v158, v102
v_mul_f32 v159, v159, v103
v_mul_f32 v160, v160, v104
v_mul_f32 v161, v161, v105
v_mul_f32 v162, v162, v106
v_mfma_f32_16x16x32_bf16 v[116:119], v[60:63], a[252:255], v[116:119]
v_mul_f32 v163, v163, v107
v_mul_f32 v164, v164, v108
v_mul_f32 v165, v165, v109
v_mul_f32 v166, v166, v110
v_mul_f32 v167, v167, v111
v_cvt_pk_bf16_f32 v152, v152, v153
v_cvt_pk_bf16_f32 v153, v154, v155
v_cvt_pk_bf16_f32 v154, v160, v161
v_cvt_pk_bf16_f32 v155, v162, v163
buffer_store_dwordx4 v[152:155], v13, s[36:39], s53 offen offset:0 sc1
v_mul_f32 v168, v168, v112
v_mul_f32 v169, v169, v113
v_mul_f32 v170, v170, v114
v_mul_f32 v171, v171, v115
v_cvt_pk_bf16_f32 v156, v156, v157
v_cvt_pk_bf16_f32 v157, v158, v159
v_cvt_pk_bf16_f32 v158, v164, v165
v_cvt_pk_bf16_f32 v159, v166, v167
buffer_store_dwordx4 v[156:159], v13, s[36:39], s53 offen offset:1024 sc1
v_mul_f32 v172, v172, v116
v_mul_f32 v173, v173, v117
v_mul_f32 v174, v174, v118
v_mul_f32 v175, v175, v119
v_cvt_pk_bf16_f32 v168, v168, v169
v_cvt_pk_bf16_f32 v169, v170, v171
v_cvt_pk_bf16_f32 v170, v172, v173
v_cvt_pk_bf16_f32 v171, v174, v175
buffer_store_dwordx4 v[168:171], v13, s[36:39], s53 offen offset:2048 sc1
buffer_load_dwordx4 a[52:55], v13, s[36:39], s50 offen offset:1024 sc1
v_readlane_b32 s50, v30, 2
buffer_load_dwordx4 a[56:59], v1, s[36:39], s66 offen offset:0 sc1
buffer_load_dwordx4 a[60:63], v1, s[36:39], s66 offen offset:1024 sc1
s_nop 2
buffer_load_dwordx4 a[64:67], v1, s[36:39], s50 offen offset:0 sc1
buffer_load_dwordx4 a[68:71], v1, s[36:39], s50 offen offset:1024 sc1
s_add_u32 s66, s50, 8192
buffer_load_dwordx4 a[72:75], v13, s[36:39], s50 offen offset:0 sc1
buffer_load_dwordx4 a[76:79], v13, s[36:39], s50 offen offset:1024 sc1
buffer_load_dwordx4 a[80:83], v1, s[36:39], s66 offen offset:0 sc1
buffer_load_dwordx4 a[84:87], v1, s[36:39], s66 offen offset:1024 sc1
s_add_u32 s50, s66, 8192
buffer_load_dwordx4 a[88:91], v13, s[36:39], s66 offen offset:0 sc1
v_mov_b32 v254, 0
buffer_load_dwordx4 a[92:95], v13, s[36:39], s66 offen offset:1024 sc1
s_waitcnt vmcnt(11)
buffer_atomic_swap v2, v241, s[36:39], s61 offen sc1
buffer_load_dwordx4 a[96:99], v1, s[36:39], s50 offen offset:0 sc1
buffer_atomic_or v254, v246, s[36:39], s62 offen sc0 sc1
buffer_load_dwordx4 a[100:103], v1, s[36:39], s50 offen offset:1024 sc1
s_add_u32 s66, s50, 8192
buffer_load_dwordx4 a[104:107], v13, s[36:39], s50 offen offset:0 sc1
buffer_load_dwordx4 a[108:111], v13, s[36:39], s50 offen offset:1024 sc1
v_readlane_b32 s50, v30, 3
buffer_load_dwordx4 a[112:115], v1, s[36:39], s66 offen offset:0 sc1
v_mov_b32 v255, 0
buffer_atomic_or v255, v246, s[36:39], s62 offen sc0 sc1
buffer_load_dwordx4 a[116:119], v1, s[36:39], s66 offen offset:1024 sc1
s_nop 0
buffer_load_dwordx4 a[120:123], v1, s[36:39], s50 offen offset:0 sc1
buffer_load_dwordx4 a[124:127], v1, s[36:39], s50 offen offset:1024 sc1
v_readlane_b32 s51, v29, 0
buffer_load_dwordx4 a[128:131], v13, s[36:39], s50 offen offset:0 sc1
v_add_u32 v16, 8, v1
v_add_u32 v17, 8, v15
v_lshlrev_b32 v64, 16, v176
v_and_b32 v65, 0xffff0000, v176
v_lshlrev_b32 v66, 16, v177
v_and_b32 v67, 0xffff0000, v177
v_lshlrev_b32 v68, 16, v178
v_and_b32 v69, 0xffff0000, v178
v_lshlrev_b32 v70, 16, v179
v_and_b32 v71, 0xffff0000, v179
v_lshlrev_b32 v72, 16, v180
v_and_b32 v73, 0xffff0000, v180
v_lshlrev_b32 v74, 16, v181
v_and_b32 v75, 0xffff0000, v181
v_lshlrev_b32 v76, 16, v182
v_and_b32 v77, 0xffff0000, v182
v_lshlrev_b32 v78, 16, v183
v_and_b32 v79, 0xffff0000, v183
v_lshlrev_b32 v80, 16, v184
v_and_b32 v81, 0xffff0000, v184
v_lshlrev_b32 v82, 16, v185
v_and_b32 v83, 0xffff0000, v185
v_lshlrev_b32 v84, 16, v186
v_and_b32 v85, 0xffff0000, v186
v_lshlrev_b32 v86, 16, v187
v_and_b32 v87, 0xffff0000, v187
v_lshlrev_b32 v88, 16, v188
v_and_b32 v89, 0xffff0000, v188
v_lshlrev_b32 v90, 16, v189
v_and_b32 v91, 0xffff0000, v189
v_lshlrev_b32 v92, 16, v190
v_and_b32 v93, 0xffff0000, v190
v_lshlrev_b32 v94, 16, v191
v_and_b32 v95, 0xffff0000, v191
s_waitcnt vmcnt(9)
v_cmp_ne_u32 vcc, v254, v2
s_nop 0
s_and_b64 vcc, vcc, 0xff
s_nop 2
s_cbranch_vccnz RT_F5
RT_F5_B:
s_add_u32 m0, s48, 12288
s_nop 0
buffer_load_dwordx4 v1, s[36:39], s51 offen offset:0 sc1 lds
buffer_load_dwordx4 v1, s[36:39], s51 offen offset:1024 sc1 lds
buffer_load_dwordx4 v1, s[36:39], s51 offen offset:2048 sc1 lds
buffer_load_dwordx4 v1, s[36:39], s51 offen offset:3072 sc1 lds
s_add_u32 m0, s48, 16384
s_nop 0
buffer_load_dwordx4 v13, s[36:39], s51 offen offset:0 sc1 lds
v_readlane_b32 s67, v29, 1
buffer_load_dwordx4 v13, s[36:39], s51 offen offset:1024 sc1 lds
buffer_load_dwordx4 v13, s[36:39], s51 offen offset:2048 sc1 lds
s_add_u32 m0, s48, 19456
s_nop 1
buffer_load_dwordx4 v1, s[36:39], s67 offen offset:0 sc1 lds
buffer_load_dwordx4 v1, s[36:39], s67 offen offset:1024 sc1 lds
buffer_load_dwordx4 v1, s[36:39], s67 offen offset:2048 sc1 lds
buffer_load_dwordx4 v1, s[36:39], s67 offen offset:3072 sc1 lds
s_add_u32 m0, s48, 23552
s_nop 0
buffer_load_dwordx4 v13, s[36:39], s67 offen offset:0 sc1 lds
v_readlane_b32 s51, v29, 2
buffer_load_dwordx4 v13, s[36:39], s67 offen offset:1024 sc1 lds
buffer_load_dwordx4 v13, s[36:39], s67 offen offset:2048 sc1 lds
s_add_u32 m0, s48, 26624
s_nop 1
buffer_load_dwordx4 v1, s[36:39], s51 offen offset:0 sc1 lds
buffer_load_dwordx4 v1, s[36:39], s51 offen offset:1024 sc1 lds
buffer_load_dwordx4 v1, s[36:39], s51 offen offset:2048 sc1 lds
buffer_load_dwordx4 v1, s[36:39], s51 offen offset:3072 sc1 lds
s_add_u32 m0, s48, 30720
s_nop 0
buffer_load_dwordx4 v13, s[36:39], s51 offen offset:0 sc1 lds
v_readlane_b32 s67, v29, 3
buffer_load_dwordx4 v13, s[36:39], s51 offen offset:1024 sc1 lds
buffer_load_dwordx4 v13, s[36:39], s51 offen offset:2048 sc1 lds
s_add_u32 m0, s48, 33792
s_nop 1
buffer_load_dwordx4 v1, s[36:39], s67 offen offset:0 sc1 lds
s_waitcnt vmcnt(15)
s_barrier
ds_read_b128 v[32:35], v1 offset:12288
ds_read_b128 v[36:39], v1 offset:13312
ds_read_b128 v[40:43], v15 offset:12288
ds_read_b128 v[44:47], v15 offset:13312
ds_read_b128 v[48:51], v1 offset:14336
ds_read_b128 v[52:55], v1 offset:15360
ds_read_b128 v[56:59], v15 offset:14336
ds_read_b128 v[60:63], v15 offset:15360
s_waitcnt lgkmcnt(4)
v_mfma_f32_16x16x32_bf16 v[64:67], v[192:195], v[32:35], v[64:67]
buffer_load_dwordx4 v1, s[36:39], s67 offen offset:1024 sc1 lds
v_mfma_f32_16x16x32_bf16 v[72:75], v[192:195], v[36:39], v[72:75]
v_mfma_f32_16x16x32_bf16 v[80:83], v[192:195], v[40:43], v[80:83]
buffer_load_dwordx4 v1, s[36:39], s67 offen offset:2048 sc1 lds
v_mfma_f32_16x16x32_bf16 v[88:91], v[192:195], v[44:47], v[88:91]
v_mfma_f32_16x16x32_bf16 v[68:71], v[196:199], v[32:35], v[68:71]
ds_read_b128 v[32:35], v1 offset:16384
v_mfma_f32_16x16x32_bf16 v[76:79], v[196:199], v[36:39], v[76:79]
ds_read_b128 v[36:39], v1 offset:17408
v_mfma_f32_16x16x32_bf16 v[84:87], v[196:199], v[40:43], v[84:87]
ds_read_b128 v[40:43], v15 offset:16384
v_mfma_f32_16x16x32_bf16 v[92:95], v[196:199], v[44:47], v[92:95]
ds_read_b128 v[44:47], v15 offset:17408
s_waitcnt lgkmcnt(4)
v_mfma_f32_16x16x32_bf16 v[64:67], v[200:203], v[48:51], v[64:67]
buffer_load_dwordx4 v1, s[36:39], s67 offen offset:3072 sc1 lds
v_mfma_f32_16x16x32_bf16 v[72:75], v[200:203], v[52:55], v[72:75]
s_add_u32 m0, s48, 37888
v_mfma_f32_16x16x32_bf16 v[80:83], v[200:203], v[56:59], v[80:83]
buffer_load_dwordx4 v13, s[36:39], s67 offen offset:0 sc1 lds
v_mfma_f32_16x16x32_bf16 v[88:91], v[200:203], v[60:63], v[88:91]
v_mfma_f32_16x16x32_bf16 v[68:71], v[204:207], v[48:51], v[68:71]
ds_read_b128 v[48:51], v14 offset:12288
v_mfma_f32_16x16x32_bf16 v[76:79], v[204:207], v[52:55], v[76:79]
ds_read_b128 v[52:55], v14 offset:13312
v_mfma_f32_16x16x32_bf16 v[84:87], v[204:207], v[56:59], v[84:87]
ds_read_b128 v[56:59], v24 offset:12288
v_mfma_f32_16x16x32_bf16 v[92:95], v[204:207], v[60:63], v[92:95]
ds_read_b128 v[60:63], v24 offset:13312
s_waitcnt lgkmcnt(4)
v_mfma_f32_16x16x32_bf16 v[64:67], v[208:211], v[32:35], v[64:67]
buffer_load_dwordx4 v13, s[36:39], s67 offen offset:1024 sc1 lds
v_mfma_f32_16x16x32_bf16 v[72:75], v[208:211], v[36:39], v[72:75]
v_mfma_f32_16x16x32_bf16 v[80:83], v[208:211], v[40:43], v[80:83]
buffer_load_dwordx4 v13, s[36:39], s67 offen offset:2048 sc1 lds
v_mfma_f32_16x16x32_bf16 v[88:91], v[208:211], v[44:47], v[88:91]
v_mfma_f32_16x16x32_bf16 v[68:71], v[212:215], v[32:35], v[68:71]
ds_read_b128 v[32:35], v14 offset:14336
v_mfma_f32_16x16x32_bf16 v[76:79], v[212:215], v[36:39], v[76:79]
ds_read_b128 v[36:39], v14 offset:15360
v_mfma_f32_16x16x32_bf16 v[84:87], v[212:215], v[40:43], v[84:87]
ds_read_b128 v[40:43], v24 offset:14336
s_add_u32 s66, s50, 8192
v_mfma_f32_16x16x32_bf16 v[92:95], v[212:215], v[44:47], v[92:95]
ds_read_b128 v[44:47], v24 offset:15360
s_waitcnt lgkmcnt(4)
v_mfma_f32_16x16x32_bf16 v[64:67], v[216:219], v[48:51], v[64:67]
buffer_load_dwordx4 a[132:135], v13, s[36:39], s50 offen offset:1024 sc1
v_mfma_f32_16x16x32_bf16 v[72:75], v[216:219], v[52:55], v[72:75]
v_mfma_f32_16x16x32_bf16 v[80:83], v[216:219], v[56:59], v[80:83]
buffer_load_dwordx4 a[136:139], v1, s[36:39], s66 offen offset:0 sc1
v_mfma_f32_16x16x32_bf16 v[88:91], v[216:219], v[60:63], v[88:91]
v_mfma_f32_16x16x32_bf16 v[68:71], v[220:223], v[48:51], v[68:71]
ds_read_b128 v[48:51], v14 offset:16384
v_mfma_f32_16x16x32_bf16 v[76:79], v[220:223], v[52:55], v[76:79]
ds_read_b128 v[52:55], v14 offset:17408
v_mfma_f32_16x16x32_bf16 v[84:87], v[220:223], v[56:59], v[84:87]
ds_read_b128 v[56:59], v24 offset:16384
v_mfma_f32_16x16x32_bf16 v[92:95], v[220:223], v[60:63], v[92:95]
ds_read_b128 v[60:63], v24 offset:17408
s_waitcnt lgkmcnt(4)
v_mfma_f32_16x16x32_bf16 v[64:67], v[224:227], v[32:35], v[64:67]
buffer_load_dwordx4 a[140:143], v1, s[36:39], s66 offen offset:1024 sc1
v_mfma_f32_16x16x32_bf16 v[72:75], v[224:227], v[36:39], v[72:75]
v_mfma_f32_16x16x32_bf16 v[80:83], v[224:227], v[40:43], v[80:83]
buffer_load_dwordx4 a[144:147], v13, s[36:39], s66 offen offset:0 sc1
v_mfma_f32_16x16x32_bf16 v[88:91], v[224:227], v[44:47], v[88:91]
v_mfma_f32_16x16x32_bf16 v[68:71], v[228:231], v[32:35], v[68:71]
ds_read2st64_b64 v[32:35], v1 offset0:36 offset1:116
v_mfma_f32_16x16x32_bf16 v[76:79], v[228:231], v[36:39], v[76:79]
ds_read2st64_b64 v[36:39], v16 offset0:36 offset1:116
v_mfma_f32_16x16x32_bf16 v[84:87], v[228:231], v[40:43], v[84:87]
ds_read2st64_b64 v[40:43], v15 offset0:36 offset1:116
s_add_u32 s50, s66, 8192
v_mfma_f32_16x16x32_bf16 v[92:95], v[228:231], v[44:47], v[92:95]
ds_read2st64_b64 v[44:47], v17 offset0:36 offset1:116
s_waitcnt lgkmcnt(4)
v_mfma_f32_16x16x32_bf16 v[64:67], v[232:235], v[48:51], v[64:67]
buffer_load_dwordx4 a[148:151], v13, s[36:39], s66 offen offset:1024 sc1
v_mfma_f32_16x16x32_bf16 v[72:75], v[232:235], v[52:55], v[72:75]
v_mfma_f32_16x16x32_bf16 v[80:83], v[232:235], v[56:59], v[80:83]
buffer_load_dwordx4 a[152:155], v1, s[36:39], s50 offen offset:0 sc1
v_mfma_f32_16x16x32_bf16 v[88:91], v[232:235], v[60:63], v[88:91]
s_waitcnt vmcnt(20) lgkmcnt(0)
s_barrier
v_mfma_f32_16x16x32_bf16 v[68:71], v[236:239], v[48:51], v[68:71]
ds_read_b128 v[48:51], v1 offset:19456
v_mfma_f32_16x16x32_bf16 v[76:79], v[236:239], v[52:55], v[76:79]
ds_read_b128 v[52:55], v1 offset:20480
v_mfma_f32_16x16x32_bf16 v[84:87], v[236:239], v[56:59], v[84:87]
ds_read_b128 v[56:59], v15 offset:19456
v_mfma_f32_16x16x32_bf16 v[92:95], v[236:239], v[60:63], v[92:95]
ds_read_b128 v[60:63], v15 offset:20480
v_mfma_f32_16x16x32_bf16 v[64:67], a[0:3], v[32:35], v[64:67]
buffer_load_dwordx4 a[156:159], v1, s[36:39], s50 offen offset:1024 sc1
v_mfma_f32_16x16x32_bf16 v[72:75], a[0:3], v[36:39], v[72:75]
v_mfma_f32_16x16x32_bf16 v[80:83], a[0:3], v[40:43], v[80:83]
buffer_load_dwordx4 a[160:163], v13, s[36:39], s50 offen offset:0 sc1
v_mfma_f32_16x16x32_bf16 v[88:91], a[0:3], v[44:47], v[88:91]
v_mfma_f32_16x16x32_bf16 v[68:71], a[4:7], v[32:35], v[68:71]
ds_read_b128 v[32:35], v1 offset:21504
v_mfma_f32_16x16x32_bf16 v[76:79], a[4:7], v[36:39], v[76:79]
ds_read_b128 v[36:39], v1 offset:22528
v_mfma_f32_16x16x32_bf16 v[84:87], a[4:7], v[40:43], v[84:87]
ds_read_b128 v[40:43], v15 offset:21504
v_readlane_b32 s51, v29, 4
v_mfma_f32_16x16x32_bf16 v[92:95], a[4:7], v[44:47], v[92:95]
ds_read_b128 v[44:47], v15 offset:22528
s_waitcnt lgkmcnt(4)
v_mfma_f32_16x16x32_bf16 v[64:67], a[8:11], v[48:51], v[64:67]
buffer_load_dwordx4 a[164:167], v13, s[36:39], s50 offen offset:1024 sc1
v_mfma_f32_16x16x32_bf16 v[72:75], a[8:11], v[52:55], v[72:75]
s_add_u32 s53, s64, 8192
s_add_u32 m0, s48, 5120
v_mfma_f32_16x16x32_bf16 v[80:83], a[8:11], v[56:59], v[80:83]
buffer_load_dwordx4 v1, s[36:39], s51 offen offset:0 sc1 lds
v_mfma_f32_16x16x32_bf16 v[88:91], a[8:11], v[60:63], v[88:91]
v_mfma_f32_16x16x32_bf16 v[68:71], a[12:15], v[48:51], v[68:71]
ds_read_b128 v[48:51], v1 offset:23552
v_mfma_f32_16x16x32_bf16 v[76:79], a[12:15], v[52:55], v[76:79]
ds_read_b128 v[52:55], v1 offset:24576
v_mfma_f32_16x16x32_bf16 v[84:87], a[12:15], v[56:59], v[84:87]
ds_read_b128 v[56:59], v15 offset:23552
v_mfma_f32_16x16x32_bf16 v[92:95], a[12:15], v[60:63], v[92:95]
ds_read_b128 v[60:63], v15 offset:24576
s_waitcnt lgkmcnt(4)
v_mfma_f32_16x16x32_bf16 v[64:67], a[16:19], v[32:35], v[64:67]
buffer_load_dwordx4 v1, s[36:39], s51 offen offset:1024 sc1 lds
v_mfma_f32_16x16x32_bf16 v[72:75], a[16:19], v[36:39], v[72:75]
v_mfma_f32_16x16x32_bf16 v[80:83], a[16:19], v[40:43], v[80:83]
buffer_load_dwordx4 v1, s[36:39], s51 offen offset:2048 sc1 lds
v_mfma_f32_16x16x32_bf16 v[88:91], a[16:19], v[44:47], v[88:91]
v_mfma_f32_16x16x32_bf16 v[68:71], a[20:23], v[32:35], v[68:71]
ds_read_b128 v[32:35], v14 offset:19456
v_mfma_f32_16x16x32_bf16 v[76:79], a[20:23], v[36:39], v[76:79]
ds_read_b128 v[36:39], v14 offset:20480
v_mfma_f32_16x16x32_bf16 v[84:87], a[20:23], v[40:43], v[84:87]
ds_read_b128 v[40:43], v24 offset:19456
v_mfma_f32_16x16x32_bf16 v[92:95], a[20:23], v[44:47], v[92:95]
ds_read_b128 v[44:47], v24 offset:20480
s_waitcnt lgkmcnt(4)
v_mfma_f32_16x16x32_bf16 v[64:67], a[24:27], v[48:51], v[64:67]
buffer_load_dwordx4 v1, s[36:39], s51 offen offset:3072 sc1 lds
v_mfma_f32_16x16x32_bf16 v[72:75], a[24:27], v[52:55], v[72:75]
s_add_u32 m0, s48, 9216
v_mfma_f32_16x16x32_bf16 v[80:83], a[24:27], v[56:59], v[80:83]
buffer_load_dwordx4 v13, s[36:39], s51 offen offset:0 sc1 lds
v_mfma_f32_16x16x32_bf16 v[88:91], a[24:27], v[60:63], v[88:91]
s_add_u32 s60, s64, 65536
v_mfma_f32_16x16x32_bf16 v[68:71], a[28:31], v[48:51], v[68:71]
ds_read_b128 v[48:51], v14 offset:21504
v_mfma_f32_16x16x32_bf16 v[76:79], a[28:31], v[52:55], v[76:79]
ds_read_b128 v[52:55], v14 offset:22528
v_mfma_f32_16x16x32_bf16 v[84:87], a[28:31], v[56:59], v[84:87]
ds_read_b128 v[56:59], v24 offset:21504
v_mfma_f32_16x16x32_bf16 v[92:95], a[28:31], v[60:63], v[92:95]
ds_read_b128 v[60:63], v24 offset:22528
s_waitcnt lgkmcnt(4)
v_mfma_f32_16x16x32_bf16 v[64:67], a[32:35], v[32:35], v[64:67]
buffer_load_dwordx4 v13, s[36:39], s51 offen offset:1024 sc1 lds
v_mfma_f32_16x16x32_bf16 v[72:75], a[32:35], v[36:39], v[72:75]
v_mfma_f32_16x16x32_bf16 v[80:83], a[32:35], v[40:43], v[80:83]
buffer_load_dwordx4 v13, s[36:39], s51 offen offset:2048 sc1 lds
v_mfma_f32_16x16x32_bf16 v[88:91], a[32:35], v[44:47], v[88:91]
v_mfma_f32_16x16x32_bf16 v[68:71], a[36:39], v[32:35], v[68:71]
ds_read_b128 v[32:35], v14 offset:23552
v_mfma_f32_16x16x32_bf16 v[76:79], a[36:39], v[36:39], v[76:79]
ds_read_b128 v[36:39], v14 offset:24576
s_add_u32 s66, s50, 8192
v_mfma_f32_16x16x32_bf16 v[84:87], a[36:39], v[40:43], v[84:87]
ds_read_b128 v[40:43], v24 offset:23552
v_mfma_f32_16x16x32_bf16 v[92:95], a[36:39], v[44:47], v[92:95]
ds_read_b128 v[44:47], v24 offset:24576
s_waitcnt lgkmcnt(4)
v_mfma_f32_16x16x32_bf16 v[64:67], a[40:43], v[48:51], v[64:67]
buffer_load_dwordx4 a[168:171], v1, s[36:39], s66 offen offset:0 sc1
v_mfma_f32_16x16x32_bf16 v[72:75], a[40:43], v[52:55], v[72:75]
v_mfma_f32_16x16x32_bf16 v[80:83], a[40:43], v[56:59], v[80:83]
buffer_load_dwordx4 a[172:175], v1, s[36:39], s66 offen offset:1024 sc1
v_mfma_f32_16x16x32_bf16 v[88:91], a[40:43], v[60:63], v[88:91]
v_mfma_f32_16x16x32_bf16 v[68:71], a[44:47], v[48:51], v[68:71]
ds_read2st64_b64 v[48:51], v1 offset0:50 offset1:130
v_readlane_b32 s50, v30, 4
v_mfma_f32_16x16x32_bf16 v[76:79], a[44:47], v[52:55], v[76:79]
ds_read2st64_b64 v[52:55], v16 offset0:50 offset1:130
s_add_u32 s61, s64, 73728
v_mfma_f32_16x16x32_bf16 v[84:87], a[44:47], v[56:59], v[84:87]
ds_read2st64_b64 v[56:59], v15 offset0:50 offset1:130
v_mfma_f32_16x16x32_bf16 v[92:95], a[44:47], v[60:63], v[92:95]
ds_read2st64_b64 v[60:63], v17 offset0:50 offset1:130
s_waitcnt lgkmcnt(4)
v_mfma_f32_16x16x32_bf16 v[64:67], a[48:51], v[32:35], v[64:67]
buffer_load_dwordx4 a[176:179], v1, s[36:39], s50 offen offset:0 sc1
v_mfma_f32_16x16x32_bf16 v[72:75], a[48:51], v[36:39], v[72:75]
v_mfma_f32_16x16x32_bf16 v[80:83], a[48:51], v[40:43], v[80:83]
buffer_load_dwordx4 a[180:183], v1, s[36:39], s50 offen offset:1024 sc1
v_mfma_f32_16x16x32_bf16 v[88:91], a[48:51], v[44:47], v[88:91]
s_waitcnt vmcnt(27) lgkmcnt(0)
s_barrier
v_mfma_f32_16x16x32_bf16 v[68:71], a[52:55], v[32:35], v[68:71]
TP59:
s_cbranch_execz TP2
TP60:
s_cbranch_execz TR2
ds_read_b128 v[32:35], v1 offset:26624
v_mfma_f32_16x16x32_bf16 v[76:79], a[52:55], v[36:39], v[76:79]
ds_read_b128 v[36:39], v1 offset:27648
v_mfma_f32_16x16x32_bf16 v[84:87], a[52:55], v[40:43], v[84:87]
ds_read_b128 v[40:43], v15 offset:26624
v_mfma_f32_16x16x32_bf16 v[92:95], a[52:55], v[44:47], v[92:95]
ds_read_b128 v[44:47], v15 offset:27648
v_mfma_f32_16x16x32_bf16 v[64:67], a[56:59], v[48:51], v[64:67]
buffer_load_dwordx4 a[184:187], v13, s[36:39], s50 offen offset:0 sc1
v_mfma_f32_16x16x32_bf16 v[72:75], a[56:59], v[52:55], v[72:75]
v_mfma_f32_16x16x32_bf16 v[80:83], a[56:59], v[56:59], v[80:83]
buffer_load_dwordx4 a[188:191], v13, s[36:39], s50 offen offset:1024 sc1
v_mfma_f32_16x16x32_bf16 v[88:91], a[56:59], v[60:63], v[88:91]
v_mfma_f32_16x16x32_bf16 v[68:71], a[60:63], v[48:51], v[68:71]
ds_read_b128 v[48:51], v1 offset:28672
v_mfma_f32_16x16x32_bf16 v[76:79], a[60:63], v[52:55], v[76:79]
ds_read_b128 v[52:55], v1 offset:29696
s_add_u32 s66, s50, 8192
v_mfma_f32_16x16x32_bf16 v[84:87], a[60:63], v[56:59], v[84:87]
ds_read_b128 v[56:59], v15 offset:28672
v_mfma_f32_16x16x32_bf16 v[92:95], a[60:63], v[60:63], v[92:95]
ds_read_b128 v[60:63], v15 offset:29696
s_waitcnt lgkmcnt(4)
v_mfma_f32_16x16x32_bf16 v[64:67], a[64:67], v[32:35], v[64:67]
buffer_load_dwordx4 a[192:195], v1, s[36:39], s66 offen offset:0 sc1
v_mfma_f32_16x16x32_bf16 v[72:75], a[64:67], v[36:39], v[72:75]
v_mfma_f32_16x16x32_bf16 v[80:83], a[64:67], v[40:43], v[80:83]
buffer_load_dwordx4 a[196:199], v1, s[36:39], s66 offen offset:1024 sc1
v_mfma_f32_16x16x32_bf16 v[88:91], a[64:67], v[44:47], v[88:91]
v_mfma_f32_16x16x32_bf16 v[68:71], a[68:71], v[32:35], v[68:71]
ds_read_b128 v[32:35], v1 offset:30720
v_mfma_f32_16x16x32_bf16 v[76:79], a[68:71], v[36:39], v[76:79]
ds_read_b128 v[36:39], v1 offset:31744
v_mfma_f32_16x16x32_bf16 v[84:87], a[68:71], v[40:43], v[84:87]
ds_read_b128 v[40:43], v15 offset:30720
v_mfma_f32_16x16x32_bf16 v[92:95], a[68:71], v[44:47], v[92:95]
ds_read_b128 v[44:47], v15 offset:31744
s_waitcnt lgkmcnt(4)
v_mfma_f32_16x16x32_bf16 v[64:67], a[72:75], v[48:51], v[64:67]
buffer_load_dwordx4 a[200:203], v13, s[36:39], s66 offen offset:0 sc1
v_mfma_f32_16x16x32_bf16 v[72:75], a[72:75], v[52:55], v[72:75]
v_mfma_f32_16x16x32_bf16 v[80:83], a[72:75], v[56:59], v[80:83]
buffer_load_dwordx4 a[204:207], v13, s[36:39], s66 offen offset:1024 sc1
v_mfma_f32_16x16x32_bf16 v[88:91], a[72:75], v[60:63], v[88:91]
v_mfma_f32_16x16x32_bf16 v[68:71], a[76:79], v[48:51], v[68:71]
ds_read_b128 v[48:51], v14 offset:26624
v_mfma_f32_16x16x32_bf16 v[76:79], a[76:79], v[52:55], v[76:79]
ds_read_b128 v[52:55], v14 offset:27648
s_add_u32 s50, s66, 8192
v_mfma_f32_16x16x32_bf16 v[84:87], a[76:79], v[56:59], v[84:87]
ds_read_b128 v[56:59], v24 offset:26624
v_mfma_f32_16x16x32_bf16 v[92:95], a[76:79], v[60:63], v[92:95]
ds_read_b128 v[60:63], v24 offset:27648
s_waitcnt lgkmcnt(4)
v_mfma_f32_16x16x32_bf16 v[64:67], a[80:83], v[32:35], v[64:67]
buffer_load_dwordx4 a[208:211], v1, s[36:39], s50 offen offset:0 sc1
v_mfma_f32_16x16x32_bf16 v[72:75], a[80:83], v[36:39], v[72:75]
v_mfma_f32_16x16x32_bf16 v[80:83], a[80:83], v[40:43], v[80:83]
buffer_load_dwordx4 a[212:215], v1, s[36:39], s50 offen offset:1024 sc1
v_mfma_f32_16x16x32_bf16 v[88:91], a[80:83], v[44:47], v[88:91]
v_mfma_f32_16x16x32_bf16 v[68:71], a[84:87], v[32:35], v[68:71]
ds_read_b128 v[32:35], v14 offset:28672
v_mfma_f32_16x16x32_bf16 v[76:79], a[84:87], v[36:39], v[76:79]
ds_read_b128 v[36:39], v14 offset:29696
v_mfma_f32_16x16x32_bf16 v[84:87], a[84:87], v[40:43], v[84:87]
ds_read_b128 v[40:43], v24 offset:28672
v_mfma_f32_16x16x32_bf16 v[92:95], a[84:87], v[44:47], v[92:95]
ds_read_b128 v[44:47], v24 offset:29696
s_waitcnt lgkmcnt(4)
v_mfma_f32_16x16x32_bf16 v[64:67], a[88:91], v[48:51], v[64:67]
buffer_load_dwordx4 a[216:219], v13, s[36:39], s50 offen offset:0 sc1
v_mfma_f32_16x16x32_bf16 v[72:75], a[88:91], v[52:55], v[72:75]
v_mfma_f32_16x16x32_bf16 v[80:83], a[88:91], v[56:59], v[80:83]
buffer_load_dwordx4 a[220:223], v13, s[36:39], s50 offen offset:1024 sc1
v_mfma_f32_16x16x32_bf16 v[88:91], a[88:91], v[60:63], v[88:91]
v_mfma_f32_16x16x32_bf16 v[68:71], a[92:95], v[48:51], v[68:71]
ds_read_b128 v[48:51], v14 offset:30720
v_mfma_f32_16x16x32_bf16 v[76:79], a[92:95], v[52:55], v[76:79]
ds_read_b128 v[52:55], v14 offset:31744
v_readlane_b32 s67, v29, 5
v_mfma_f32_16x16x32_bf16 v[84:87], a[92:95], v[56:59], v[84:87]
ds_read_b128 v[56:59], v24 offset:30720
s_add_u32 m0, s48, 12288
v_mfma_f32_16x16x32_bf16 v[92:95], a[92:95], v[60:63], v[92:95]
ds_read_b128 v[60:63], v24 offset:31744
s_waitcnt lgkmcnt(4)
v_mfma_f32_16x16x32_bf16 v[64:67], a[96:99], v[32:35], v[64:67]
buffer_load_dwordx4 v1, s[36:39], s67 offen offset:0 sc1 lds
v_mfma_f32_16x16x32_bf16 v[72:75], a[96:99], v[36:39], v[72:75]
v_mfma_f32_16x16x32_bf16 v[80:83], a[96:99], v[40:43], v[80:83]
buffer_load_dwordx4 v1, s[36:39], s67 offen offset:1024 sc1 lds
v_mfma_f32_16x16x32_bf16 v[88:91], a[96:99], v[44:47], v[88:91]
v_mfma_f32_16x16x32_bf16 v[68:71], a[100:103], v[32:35], v[68:71]
ds_read2st64_b64 v[32:35], v1 offset0:64 offset1:144
v_mfma_f32_16x16x32_bf16 v[76:79], a[100:103], v[36:39], v[76:79]
ds_read2st64_b64 v[36:39], v16 offset0:64 offset1:144
v_mfma_f32_16x16x32_bf16 v[84:87], a[100:103], v[40:43], v[84:87]
ds_read2st64_b64 v[40:43], v15 offset0:64 offset1:144
v_mfma_f32_16x16x32_bf16 v[92:95], a[100:103], v[44:47], v[92:95]
ds_read2st64_b64 v[44:47], v17 offset0:64 offset1:144
s_waitcnt lgkmcnt(4)
v_mfma_f32_16x16x32_bf16 v[64:67], a[104:107], v[48:51], v[64:67]
buffer_load_dwordx4 v1, s[36:39], s67 offen offset:2048 sc1 lds
v_mfma_f32_16x16x32_bf16 v[72:75], a[104:107], v[52:55], v[72:75]
v_mfma_f32_16x16x32_bf16 v[80:83], a[104:107], v[56:59], v[80:83]
buffer_load_dwordx4 v1, s[36:39], s67 offen offset:3072 sc1 lds
v_mfma_f32_16x16x32_bf16 v[88:91], a[104:107], v[60:63], v[88:91]
s_waitcnt vmcnt(34) lgkmcnt(0)
s_barrier
v_mfma_f32_16x16x32_bf16 v[68:71], a[108:111], v[48:51], v[68:71]
ds_read_b128 v[48:51], v1 offset:33792
v_mfma_f32_16x16x32_bf16 v[76:79], a[108:111], v[52:55], v[76:79]
ds_read_b128 v[52:55], v1 offset:34816
v_mfma_f32_16x16x32_bf16 v[84:87], a[108:111], v[56:59], v[84:87]
ds_read_b128 v[56:59], v15 offset:33792
s_add_u32 m0, s48, 16384
v_mfma_f32_16x16x32_bf16 v[92:95], a[108:111], v[60:63], v[92:95]
ds_read_b128 v[60:63], v15 offset:34816
v_mfma_f32_16x16x32_bf16 v[64:67], a[112:115], v[32:35], v[64:67]
buffer_load_dwordx4 v13, s[36:39], s67 offen offset:0 sc1 lds
v_mfma_f32_16x16x32_bf16 v[72:75], a[112:115], v[36:39], v[72:75]
v_mfma_f32_16x16x32_bf16 v[80:83], a[112:115], v[40:43], v[80:83]
buffer_load_dwordx4 v13, s[36:39], s67 offen offset:1024 sc1 lds
v_mfma_f32_16x16x32_bf16 v[88:91], a[112:115], v[44:47], v[88:91]
v_mfma_f32_16x16x32_bf16 v[68:71], a[116:119], v[32:35], v[68:71]
ds_read_b128 v[32:35], v1 offset:35840
v_mfma_f32_16x16x32_bf16 v[76:79], a[116:119], v[36:39], v[76:79]
ds_read_b128 v[36:39], v1 offset:36864
v_mfma_f32_16x16x32_bf16 v[84:87], a[116:119], v[40:43], v[84:87]
ds_read_b128 v[40:43], v15 offset:35840
s_add_u32 s66, s50, 8192
v_mfma_f32_16x16x32_bf16 v[92:95], a[116:119], v[44:47], v[92:95]
ds_read_b128 v[44:47], v15 offset:36864
s_waitcnt lgkmcnt(4)
v_mfma_f32_16x16x32_bf16 v[64:67], a[120:123], v[48:51], v[64:67]
buffer_load_dwordx4 v13, s[36:39], s67 offen offset:2048 sc1 lds
v_mfma_f32_16x16x32_bf16 v[72:75], a[120:123], v[52:55], v[72:75]
v_mfma_f32_16x16x32_bf16 v[80:83], a[120:123], v[56:59], v[80:83]
buffer_load_dwordx4 a[224:227], v1, s[36:39], s66 offen offset:0 sc1
v_mfma_f32_16x16x32_bf16 v[88:91], a[120:123], v[60:63], v[88:91]
v_mfma_f32_16x16x32_bf16 v[68:71], a[124:127], v[48:51], v[68:71]
ds_read_b128 v[48:51], v1 offset:37888
v_mfma_f32_16x16x32_bf16 v[76:79], a[124:127], v[52:55], v[76:79]
ds_read_b128 v[52:55], v1 offset:38912
v_mfma_f32_16x16x32_bf16 v[84:87], a[124:127], v[56:59], v[84:87]
ds_read_b128 v[56:59], v15 offset:37888
v_readlane_b32 s50, v30, 5
v_mfma_f32_16x16x32_bf16 v[92:95], a[124:127], v[60:63], v[92:95]
ds_read_b128 v[60:63], v15 offset:38912
s_waitcnt vmcnt(37) lgkmcnt(4)
v_mfma_f32_16x16x32_bf16 v[64:67], a[128:131], v[32:35], v[64:67]
buffer_load_dwordx4 a[228:231], v1, s[36:39], s66 offen offset:1024 sc1
v_mfma_f32_16x16x32_bf16 v[72:75], a[128:131], v[36:39], v[72:75]
v_mfma_f32_16x16x32_bf16 v[80:83], a[128:131], v[40:43], v[80:83]
buffer_load_dwordx4 a[232:235], v1, s[36:39], s50 offen offset:0 sc1
v_mfma_f32_16x16x32_bf16 v[88:91], a[128:131], v[44:47], v[88:91]
v_mfma_f32_16x16x32_bf16 v[68:71], a[132:135], v[32:35], v[68:71]
ds_read_b128 v[32:35], v14 offset:33792
v_mfma_f32_16x16x32_bf16 v[76:79], a[132:135], v[36:39], v[76:79]
ds_read_b128 v[36:39], v14 offset:34816
v_mfma_f32_16x16x32_bf16 v[84:87], a[132:135], v[40:43], v[84:87]
ds_read_b128 v[40:43], v24 offset:33792
v_mfma_f32_16x16x32_bf16 v[92:95], a[132:135], v[44:47], v[92:95]
ds_read_b128 v[44:47], v24 offset:34816
s_waitcnt vmcnt(37) lgkmcnt(4)
v_mfma_f32_16x16x32_bf16 v[64:67], a[136:139], v[48:51], v[64:67]
buffer_load_dwordx4 a[236:239], v1, s[36:39], s50 offen offset:1024 sc1
v_mfma_f32_16x16x32_bf16 v[72:75], a[136:139], v[52:55], v[72:75]
v_mfma_f32_16x16x32_bf16 v[80:83], a[136:139], v[56:59], v[80:83]
buffer_load_dwordx4 a[240:243], v13, s[36:39], s50 offen offset:0 sc1
v_mfma_f32_16x16x32_bf16 v[88:91], a[136:139], v[60:63], v[88:91]
v_mfma_f32_16x16x32_bf16 v[68:71], a[140:143], v[48:51], v[68:71]
ds_read_b128 v[48:51], v14 offset:35840
v_mfma_f32_16x16x32_bf16 v[76:79], a[140:143], v[52:55], v[76:79]
ds_read_b128 v[52:55], v14 offset:36864
v_mfma_f32_16x16x32_bf16 v[84:87], a[140:143], v[56:59], v[84:87]
ds_read_b128 v[56:59], v24 offset:35840
s_add_u32 s66, s50, 8192
v_mfma_f32_16x16x32_bf16 v[92:95], a[140:143], v[60:63], v[92:95]
ds_read_b128 v[60:63], v24 offset:36864
s_waitcnt vmcnt(37) lgkmcnt(4)
v_mfma_f32_16x16x32_bf16 v[64:67], a[144:147], v[32:35], v[64:67]
buffer_load_dwordx4 a[244:247], v13, s[36:39], s50 offen offset:1024 sc1
v_mfma_f32_16x16x32_bf16 v[72:75], a[144:147], v[36:39], v[72:75]
v_mfma_f32_16x16x32_bf16 v[80:83], a[144:147], v[40:43], v[80:83]
buffer_load_dwordx4 a[248:251], v1, s[36:39], s66 offen offset:0 sc1
v_mfma_f32_16x16x32_bf16 v[88:91], a[144:147], v[44:47], v[88:91]
v_mfma_f32_16x16x32_bf16 v[68:71], a[148:151], v[32:35], v[68:71]
ds_read_b128 v[32:35], v14 offset:37888
v_mfma_f32_16x16x32_bf16 v[76:79], a[148:151], v[36:39], v[76:79]
ds_read_b128 v[36:39], v14 offset:38912
v_mfma_f32_16x16x32_bf16 v[84:87], a[148:151], v[40:43], v[84:87]
ds_read_b128 v[40:43], v24 offset:37888
v_mfma_f32_16x16x32_bf16 v[92:95], a[148:151], v[44:47], v[92:95]
ds_read_b128 v[44:47], v24 offset:38912
s_waitcnt vmcnt(37) lgkmcnt(4)
v_mfma_f32_16x16x32_bf16 v[64:67], a[152:155], v[48:51], v[64:67]
buffer_load_dwordx4 a[252:255], v1, s[36:39], s66 offen offset:1024 sc1
v_mfma_f32_16x16x32_bf16 v[72:75], a[152:155], v[52:55], v[72:75]
v_mfma_f32_16x16x32_bf16 v[80:83], a[152:155], v[56:59], v[80:83]
buffer_load_dwordx4 v[96:99], v13, s[36:39], s66 offen offset:0 sc1
v_mfma_f32_16x16x32_bf16 v[88:91], a[152:155], v[60:63], v[88:91]
v_mfma_f32_16x16x32_bf16 v[68:71], a[156:159], v[48:51], v[68:71]
ds_read2st64_b64 v[48:51], v1 offset0:78 offset1:158
v_mfma_f32_16x16x32_bf16 v[76:79], a[156:159], v[52:55], v[76:79]
ds_read2st64_b64 v[52:55], v16 offset0:78 offset1:158
v_mfma_f32_16x16x32_bf16 v[84:87], a[156:159], v[56:59], v[84:87]
ds_read2st64_b64 v[56:59], v15 offset0:78 offset1:158
s_add_u32 s50, s66, 8192
v_mfma_f32_16x16x32_bf16 v[92:95], a[156:159], v[60:63], v[92:95]
ds_read2st64_b64 v[60:63], v17 offset0:78 offset1:158
s_waitcnt vmcnt(37) lgkmcnt(4)
v_mfma_f32_16x16x32_bf16 v[64:67], a[160:163], v[32:35], v[64:67]
buffer_load_dwordx4 v[100:103], v13, s[36:39], s66 offen offset:1024 sc1
v_mfma_f32_16x16x32_bf16 v[72:75], a[160:163], v[36:39], v[72:75]
v_mfma_f32_16x16x32_bf16 v[80:83], a[160:163], v[40:43], v[80:83]
buffer_load_dwordx4 v[104:107], v1, s[36:39], s50 offen offset:0 sc1
v_mfma_f32_16x16x32_bf16 v[88:91], a[160:163], v[44:47], v[88:91]
s_waitcnt vmcnt(32) lgkmcnt(0)
s_barrier
v_mfma_f32_16x16x32_bf16 v[68:71], a[164:167], v[32:35], v[68:71]
ds_read_b128 v[32:35], v1 offset:5120
v_mfma_f32_16x16x32_bf16 v[76:79], a[164:167], v[36:39], v[76:79]
ds_read_b128 v[36:39], v1 offset:6144
v_mfma_f32_16x16x32_bf16 v[84:87], a[164:167], v[40:43], v[84:87]
ds_read_b128 v[40:43], v15 offset:5120
v_mfma_f32_16x16x32_bf16 v[92:95], a[164:167], v[44:47], v[92:95]
ds_read_b128 v[44:47], v15 offset:6144
s_waitcnt vmcnt(30)
v_mfma_f32_16x16x32_bf16 v[64:67], a[168:171], v[48:51], v[64:67]
buffer_load_dwordx4 v[108:111], v1, s[36:39], s50 offen offset:1024 sc1
v_mfma_f32_16x16x32_bf16 v[72:75], a[168:171], v[52:55], v[72:75]
v_mfma_f32_16x16x32_bf16 v[80:83], a[168:171], v[56:59], v[80:83]
buffer_load_dwordx4 v[112:115], v13, s[36:39], s50 offen offset:0 sc1
v_mfma_f32_16x16x32_bf16 v[88:91], a[168:171], v[60:63], v[88:91]
v_mfma_f32_16x16x32_bf16 v[68:71], a[172:175], v[48:51], v[68:71]
ds_read_b128 v[48:51], v1 offset:7168
v_mfma_f32_16x16x32_bf16 v[76:79], a[172:175], v[52:55], v[76:79]
ds_read_b128 v[52:55], v1 offset:8192
v_mfma_f32_16x16x32_bf16 v[84:87], a[172:175], v[56:59], v[84:87]
ds_read_b128 v[56:59], v15 offset:7168
v_readlane_b32 s51, v29, 6
v_mfma_f32_16x16x32_bf16 v[92:95], a[172:175], v[60:63], v[92:95]
ds_read_b128 v[60:63], v15 offset:8192
s_waitcnt vmcnt(30) lgkmcnt(4)
v_mfma_f32_16x16x32_bf16 v[64:67], a[176:179], v[32:35], v[64:67]
buffer_load_dwordx4 v[116:119], v13, s[36:39], s50 offen offset:1024 sc1
v_mfma_f32_16x16x32_bf16 v[72:75], a[176:179], v[36:39], v[72:75]
s_add_u32 m0, s48, 19456
v_mfma_f32_16x16x32_bf16 v[80:83], a[176:179], v[40:43], v[80:83]
buffer_load_dwordx4 v1, s[36:39], s51 offen offset:0 sc1 lds
v_mfma_f32_16x16x32_bf16 v[88:91], a[176:179], v[44:47], v[88:91]
v_mfma_f32_16x16x32_bf16 v[68:71], a[180:183], v[32:35], v[68:71]
ds_read_b128 v[32:35], v1 offset:9216
v_mfma_f32_16x16x32_bf16 v[76:79], a[180:183], v[36:39], v[76:79]
ds_read_b128 v[36:39], v1 offset:10240
v_mfma_f32_16x16x32_bf16 v[84:87], a[180:183], v[40:43], v[84:87]
ds_read_b128 v[40:43], v15 offset:9216
v_mfma_f32_16x16x32_bf16 v[92:95], a[180:183], v[44:47], v[92:95]
ds_read_b128 v[44:47], v15 offset:10240
s_waitcnt vmcnt(30) lgkmcnt(4)
v_mfma_f32_16x16x32_bf16 v[64:67], a[184:187], v[48:51], v[64:67]
buffer_load_dwordx4 v1, s[36:39], s51 offen offset:1024 sc1 lds
v_mfma_f32_16x16x32_bf16 v[72:75], a[184:187], v[52:55], v[72:75]
v_mfma_f32_16x16x32_bf16 v[80:83], a[184:187], v[56:59], v[80:83]
buffer_load_dwordx4 v1, s[36:39], s51 offen offset:2048 sc1 lds
v_mfma_f32_16x16x32_bf16 v[88:91], a[184:187], v[60:63], v[88:91]
v_mfma_f32_16x16x32_bf16 v[68:71], a[188:191], v[48:51], v[68:71]
ds_read_b128 v[48:51], v14 offset:5120
v_mfma_f32_16x16x32_bf16 v[76:79], a[188:191], v[52:55], v[76:79]
ds_read_b128 v[52:55], v14 offset:6144
v_mfma_f32_16x16x32_bf16 v[84:87], a[188:191], v[56:59], v[84:87]
ds_read_b128 v[56:59], v24 offset:5120
v_mfma_f32_16x16x32_bf16 v[92:95], a[188:191], v[60:63], v[92:95]
ds_read_b128 v[60:63], v24 offset:6144
s_waitcnt vmcnt(30) lgkmcnt(4)
v_mfma_f32_16x16x32_bf16 v[64:67], a[192:195], v[32:35], v[64:67]
buffer_load_dwordx4 v1, s[36:39], s51 offen offset:3072 sc1 lds
v_mfma_f32_16x16x32_bf16 v[72:75], a[192:195], v[36:39], v[72:75]
s_add_u32 m0, s48, 23552
v_mfma_f32_16x16x32_bf16 v[80:83], a[192:195], v[40:43], v[80:83]
buffer_load_dwordx4 v13, s[36:39], s51 offen offset:0 sc1 lds
v_mfma_f32_16x16x32_bf16 v[88:91], a[192:195], v[44:47], v[88:91]
v_mfma_f32_16x16x32_bf16 v[68:71], a[196:199], v[32:35], v[68:71]
ds_read_b128 v[32:35], v14 offset:7168
v_mfma_f32_16x16x32_bf16 v[76:79], a[196:199], v[36:39], v[76:79]
ds_read_b128 v[36:39], v14 offset:8192
v_mfma_f32_16x16x32_bf16 v[84:87], a[196:199], v[40:43], v[84:87]
ds_read_b128 v[40:43], v24 offset:7168
v_mfma_f32_16x16x32_bf16 v[92:95], a[196:199], v[44:47], v[92:95]
ds_read_b128 v[44:47], v24 offset:8192
s_waitcnt vmcnt(30) lgkmcnt(4)
v_mfma_f32_16x16x32_bf16 v[64:67], a[200:203], v[48:51], v[64:67]
buffer_load_dwordx4 v13, s[36:39], s51 offen offset:1024 sc1 lds
v_mfma_f32_16x16x32_bf16 v[72:75], a[200:203], v[52:55], v[72:75]
v_mfma_f32_16x16x32_bf16 v[80:83], a[200:203], v[56:59], v[80:83]
buffer_load_dwordx4 v13, s[36:39], s51 offen offset:2048 sc1 lds
v_mfma_f32_16x16x32_bf16 v[88:91], a[200:203], v[60:63], v[88:91]
v_mfma_f32_16x16x32_bf16 v[68:71], a[204:207], v[48:51], v[68:71]
ds_read_b128 v[48:51], v14 offset:9216
v_mfma_f32_16x16x32_bf16 v[76:79], a[204:207], v[52:55], v[76:79]
ds_read_b128 v[52:55], v14 offset:10240
s_add_u32 s66, s50, 8192
v_mfma_f32_16x16x32_bf16 v[84:87], a[204:207], v[56:59], v[84:87]
ds_read_b128 v[56:59], v24 offset:9216
v_mfma_f32_16x16x32_bf16 v[92:95], a[204:207], v[60:63], v[92:95]
ds_read_b128 v[60:63], v24 offset:10240
s_waitcnt vmcnt(30) lgkmcnt(4)
v_mfma_f32_16x16x32_bf16 v[64:67], a[208:211], v[32:35], v[64:67]
buffer_load_dwordx4 v[120:123], v1, s[36:39], s66 offen offset:0 sc1
v_mfma_f32_16x16x32_bf16 v[72:75], a[208:211], v[36:39], v[72:75]
v_mfma_f32_16x16x32_bf16 v[80:83], a[208:211], v[40:43], v[80:83]
buffer_load_dwordx4 v[124:127], v1, s[36:39], s66 offen offset:1024 sc1
v_mfma_f32_16x16x32_bf16 v[88:91], a[208:211], v[44:47], v[88:91]
v_mfma_f32_16x16x32_bf16 v[68:71], a[212:215], v[32:35], v[68:71]
ds_read2st64_b64 v[32:35], v1 offset0:22 offset1:102
v_mfma_f32_16x16x32_bf16 v[76:79], a[212:215], v[36:39], v[76:79]
ds_read2st64_b64 v[36:39], v16 offset0:22 offset1:102
v_readlane_b32 s50, v30, 6
v_mfma_f32_16x16x32_bf16 v[84:87], a[212:215], v[40:43], v[84:87]
ds_read2st64_b64 v[40:43], v15 offset0:22 offset1:102
v_mfma_f32_16x16x32_bf16 v[92:95], a[212:215], v[44:47], v[92:95]
ds_read2st64_b64 v[44:47], v17 offset0:22 offset1:102
s_waitcnt vmcnt(30) lgkmcnt(4)
v_mfma_f32_16x16x32_bf16 v[64:67], a[216:219], v[48:51], v[64:67]
buffer_load_dwordx4 v[128:131], v1, s[36:39], s50 offen offset:0 sc1
v_mfma_f32_16x16x32_bf16 v[72:75], a[216:219], v[52:55], v[72:75]
v_mfma_f32_16x16x32_bf16 v[80:83], a[216:219], v[56:59], v[80:83]
buffer_load_dwordx4 v[132:135], v1, s[36:39], s50 offen offset:1024 sc1
v_mfma_f32_16x16x32_bf16 v[88:91], a[216:219], v[60:63], v[88:91]
s_waitcnt vmcnt(25) lgkmcnt(0)
s_barrier
v_mfma_f32_16x16x32_bf16 v[68:71], a[220:223], v[48:51], v[68:71]
ds_read_b128 v[48:51], v1 offset:12288
v_mfma_f32_16x16x32_bf16 v[76:79], a[220:223], v[52:55], v[76:79]
ds_read_b128 v[52:55], v1 offset:13312
v_mfma_f32_16x16x32_bf16 v[84:87], a[220:223], v[56:59], v[84:87]
ds_read_b128 v[56:59], v15 offset:12288
v_mfma_f32_16x16x32_bf16 v[92:95], a[220:223], v[60:63], v[92:95]
ds_read_b128 v[60:63], v15 offset:13312
s_waitcnt vmcnt(23)
v_mfma_f32_16x16x32_bf16 v[64:67], a[224:227], v[32:35], v[64:67]
buffer_load_dwordx4 v[136:139], v13, s[36:39], s50 offen offset:0 sc1
v_mfma_f32_16x16x32_bf16 v[72:75], a[224:227], v[36:39], v[72:75]
v_mfma_f32_16x16x32_bf16 v[80:83], a[224:227], v[40:43], v[80:83]
buffer_load_dwordx4 v[140:143], v13, s[36:39], s50 offen offset:1024 sc1
v_mfma_f32_16x16x32_bf16 v[88:91], a[224:227], v[44:47], v[88:91]
v_mfma_f32_16x16x32_bf16 v[68:71], a[228:231], v[32:35], v[68:71]
ds_read_b128 v[32:35], v1 offset:14336
v_mfma_f32_16x16x32_bf16 v[76:79], a[228:231], v[36:39], v[76:79]
ds_read_b128 v[36:39], v1 offset:15360
s_add_u32 s66, s50, 8192
v_mfma_f32_16x16x32_bf16 v[84:87], a[228:231], v[40:43], v[84:87]
ds_read_b128 v[40:43], v15 offset:14336
v_mfma_f32_16x16x32_bf16 v[92:95], a[228:231], v[44:47], v[92:95]
ds_read_b128 v[44:47], v15 offset:15360
s_waitcnt vmcnt(23) lgkmcnt(4)
v_mfma_f32_16x16x32_bf16 v[64:67], a[232:235], v[48:51], v[64:67]
buffer_load_dwordx4 v[144:147], v1, s[36:39], s66 offen offset:0 sc1
v_mfma_f32_16x16x32_bf16 v[72:75], a[232:235], v[52:55], v[72:75]
v_mfma_f32_16x16x32_bf16 v[80:83], a[232:235], v[56:59], v[80:83]
buffer_load_dwordx4 v[148:151], v1, s[36:39], s66 offen offset:1024 sc1
v_mfma_f32_16x16x32_bf16 v[88:91], a[232:235], v[60:63], v[88:91]
v_mfma_f32_16x16x32_bf16 v[68:71], a[236:239], v[48:51], v[68:71]
ds_read_b128 v[48:51], v1 offset:16384
v_mfma_f32_16x16x32_bf16 v[76:79], a[236:239], v[52:55], v[76:79]
ds_read_b128 v[52:55], v1 offset:17408
v_mfma_f32_16x16x32_bf16 v[84:87], a[236:239], v[56:59], v[84:87]
ds_read_b128 v[56:59], v15 offset:16384
v_mfma_f32_16x16x32_bf16 v[92:95], a[236:239], v[60:63], v[92:95]
ds_read_b128 v[60:63], v15 offset:17408
s_waitcnt vmcnt(23) lgkmcnt(4)
v_mfma_f32_16x16x32_bf16 v[64:67], a[240:243], v[32:35], v[64:67]
buffer_load_dwordx4 v[152:155], v13, s[36:39], s66 offen offset:0 sc1
v_mfma_f32_16x16x32_bf16 v[72:75], a[240:243], v[36:39], v[72:75]
v_mfma_f32_16x16x32_bf16 v[80:83], a[240:243], v[40:43], v[80:83]
buffer_load_dwordx4 v[156:159], v13, s[36:39], s66 offen offset:1024 sc1
v_mfma_f32_16x16x32_bf16 v[88:91], a[240:243], v[44:47], v[88:91]
v_mfma_f32_16x16x32_bf16 v[68:71], a[244:247], v[32:35], v[68:71]
ds_read_b128 v[32:35], v14 offset:12288
v_mfma_f32_16x16x32_bf16 v[76:79], a[244:247], v[36:39], v[76:79]
ds_read_b128 v[36:39], v14 offset:13312
s_add_u32 s50, s66, 8192
v_mfma_f32_16x16x32_bf16 v[84:87], a[244:247], v[40:43], v[84:87]
ds_read_b128 v[40:43], v24 offset:12288
v_mfma_f32_16x16x32_bf16 v[92:95], a[244:247], v[44:47], v[92:95]
ds_read_b128 v[44:47], v24 offset:13312
s_waitcnt vmcnt(23) lgkmcnt(4)
v_mfma_f32_16x16x32_bf16 v[64:67], a[248:251], v[48:51], v[64:67]
buffer_load_dwordx4 v[160:163], v1, s[36:39], s50 offen offset:0 sc1
v_mfma_f32_16x16x32_bf16 v[72:75], a[248:251], v[52:55], v[72:75]
v_mfma_f32_16x16x32_bf16 v[80:83], a[248:251], v[56:59], v[80:83]
buffer_load_dwordx4 v[164:167], v1, s[36:39], s50 offen offset:1024 sc1
v_mfma_f32_16x16x32_bf16 v[88:91], a[248:251], v[60:63], v[88:91]
v_mfma_f32_16x16x32_bf16 v[68:71], a[252:255], v[48:51], v[68:71]
ds_read_b128 v[48:51], v14 offset:14336
v_mfma_f32_16x16x32_bf16 v[76:79], a[252:255], v[52:55], v[76:79]
ds_read_b128 v[52:55], v14 offset:15360
v_mfma_f32_16x16x32_bf16 v[84:87], a[252:255], v[56:59], v[84:87]
ds_read_b128 v[56:59], v24 offset:14336
v_mfma_f32_16x16x32_bf16 v[92:95], a[252:255], v[60:63], v[92:95]
ds_read_b128 v[60:63], v24 offset:15360
s_waitcnt vmcnt(23) lgkmcnt(4)
v_mfma_f32_16x16x32_bf16 v[64:67], v[96:99], v[32:35], v[64:67]
buffer_load_dwordx4 v[168:171], v13, s[36:39], s50 offen offset:0 sc1
v_mfma_f32_16x16x32_bf16 v[72:75], v[96:99], v[36:39], v[72:75]
v_mfma_f32_16x16x32_bf16 v[80:83], v[96:99], v[40:43], v[80:83]
buffer_load_dwordx4 v[172:175], v13, s[36:39], s50 offen offset:1024 sc1
v_mfma_f32_16x16x32_bf16 v[88:91], v[96:99], v[44:47], v[88:91]
v_mfma_f32_16x16x32_bf16 v[68:71], v[100:103], v[32:35], v[68:71]
ds_read_b128 v[32:35], v14 offset:16384
v_mfma_f32_16x16x32_bf16 v[76:79], v[100:103], v[36:39], v[76:79]
ds_read_b128 v[36:39], v14 offset:17408
v_readlane_b32 s67, v29, 7
v_mfma_f32_16x16x32_bf16 v[84:87], v[100:103], v[40:43], v[84:87]
ds_read_b128 v[40:43], v24 offset:16384
s_add_u32 m0, s48, 26624
v_mfma_f32_16x16x32_bf16 v[92:95], v[100:103], v[44:47], v[92:95]
ds_read_b128 v[44:47], v24 offset:17408
s_waitcnt vmcnt(23) lgkmcnt(4)
v_mfma_f32_16x16x32_bf16 v[64:67], v[104:107], v[48:51], v[64:67]
buffer_load_dwordx4 v1, s[36:39], s67 offen offset:0 sc1 lds
v_mfma_f32_16x16x32_bf16 v[72:75], v[104:107], v[52:55], v[72:75]
v_mfma_f32_16x16x32_bf16 v[80:83], v[104:107], v[56:59], v[80:83]
buffer_load_dwordx4 v1, s[36:39], s67 offen offset:1024 sc1 lds
v_mfma_f32_16x16x32_bf16 v[88:91], v[104:107], v[60:63], v[88:91]
v_mfma_f32_16x16x32_bf16 v[68:71], v[108:111], v[48:51], v[68:71]
ds_read2st64_b64 v[48:51], v1 offset0:36 offset1:116
v_mfma_f32_16x16x32_bf16 v[76:79], v[108:111], v[52:55], v[76:79]
ds_read2st64_b64 v[52:55], v16 offset0:36 offset1:116
v_mfma_f32_16x16x32_bf16 v[84:87], v[108:111], v[56:59], v[84:87]
ds_read2st64_b64 v[56:59], v15 offset0:36 offset1:116
v_mfma_f32_16x16x32_bf16 v[92:95], v[108:111], v[60:63], v[92:95]
ds_read2st64_b64 v[60:63], v17 offset0:36 offset1:116
s_waitcnt vmcnt(23) lgkmcnt(4)
v_mfma_f32_16x16x32_bf16 v[64:67], v[112:115], v[32:35], v[64:67]
buffer_load_dwordx4 v1, s[36:39], s67 offen offset:2048 sc1 lds
v_mfma_f32_16x16x32_bf16 v[72:75], v[112:115], v[36:39], v[72:75]
v_mfma_f32_16x16x32_bf16 v[80:83], v[112:115], v[40:43], v[80:83]
buffer_load_dwordx4 v1, s[36:39], s67 offen offset:3072 sc1 lds
v_mfma_f32_16x16x32_bf16 v[88:91], v[112:115], v[44:47], v[88:91]
s_waitcnt vmcnt(18) lgkmcnt(0)
s_barrier
v_mfma_f32_16x16x32_bf16 v[68:71], v[116:119], v[32:35], v[68:71]
ds_read_b128 v[32:35], v1 offset:19456
v_mfma_f32_16x16x32_bf16 v[76:79], v[116:119], v[36:39], v[76:79]
ds_read_b128 v[36:39], v1 offset:20480
v_mfma_f32_16x16x32_bf16 v[84:87], v[116:119], v[40:43], v[84:87]
ds_read_b128 v[40:43], v15 offset:19456
s_add_u32 m0, s48, 30720
v_mfma_f32_16x16x32_bf16 v[92:95], v[116:119], v[44:47], v[92:95]
ds_read_b128 v[44:47], v15 offset:20480
s_waitcnt vmcnt(16)
v_mfma_f32_16x16x32_bf16 v[64:67], v[120:123], v[48:51], v[64:67]
buffer_load_dwordx4 v13, s[36:39], s67 offen offset:0 sc1 lds
v_mfma_f32_16x16x32_bf16 v[72:75], v[120:123], v[52:55], v[72:75]
v_mfma_f32_16x16x32_bf16 v[80:83], v[120:123], v[56:59], v[80:83]
buffer_load_dwordx4 v13, s[36:39], s67 offen offset:1024 sc1 lds
v_mfma_f32_16x16x32_bf16 v[88:91], v[120:123], v[60:63], v[88:91]
v_mfma_f32_16x16x32_bf16 v[68:71], v[124:127], v[48:51], v[68:71]
ds_read_b128 v[48:51], v1 offset:21504
v_mfma_f32_16x16x32_bf16 v[76:79], v[124:127], v[52:55], v[76:79]
ds_read_b128 v[52:55], v1 offset:22528
v_mfma_f32_16x16x32_bf16 v[84:87], v[124:127], v[56:59], v[84:87]
ds_read_b128 v[56:59], v15 offset:21504
s_add_u32 s66, s50, 8192
v_mfma_f32_16x16x32_bf16 v[92:95], v[124:127], v[60:63], v[92:95]
ds_read_b128 v[60:63], v15 offset:22528
s_waitcnt vmcnt(16) lgkmcnt(4)
v_mfma_f32_16x16x32_bf16 v[64:67], v[128:131], v[32:35], v[64:67]
buffer_load_dwordx4 v13, s[36:39], s67 offen offset:2048 sc1 lds
v_mfma_f32_16x16x32_bf16 v[72:75], v[128:131], v[36:39], v[72:75]
v_mfma_f32_16x16x32_bf16 v[80:83], v[128:131], v[40:43], v[80:83]
buffer_load_dwordx4 v[192:195], v1, s[36:39], s66 offen offset:0 sc1
v_mfma_f32_16x16x32_bf16 v[88:91], v[128:131], v[44:47], v[88:91]
v_mfma_f32_16x16x32_bf16 v[68:71], v[132:135], v[32:35], v[68:71]
ds_read_b128 v[32:35], v1 offset:23552
v_mfma_f32_16x16x32_bf16 v[76:79], v[132:135], v[36:39], v[76:79]
ds_read_b128 v[36:39], v1 offset:24576
v_mfma_f32_16x16x32_bf16 v[84:87], v[132:135], v[40:43], v[84:87]
ds_read_b128 v[40:43], v15 offset:23552
v_readlane_b32 s50, v30, 7
v_mfma_f32_16x16x32_bf16 v[92:95], v[132:135], v[44:47], v[92:95]
ds_read_b128 v[44:47], v15 offset:24576
s_waitcnt vmcnt(16) lgkmcnt(4)
v_mfma_f32_16x16x32_bf16 v[64:67], v[136:139], v[48:51], v[64:67]
buffer_load_dwordx4 v[196:199], v1, s[36:39], s66 offen offset:1024 sc1
v_mfma_f32_16x16x32_bf16 v[72:75], v[136:139], v[52:55], v[72:75]
v_mfma_f32_16x16x32_bf16 v[80:83], v[136:139], v[56:59], v[80:83]
buffer_load_dwordx4 v[200:203], v1, s[36:39], s50 offen offset:0 sc1
v_mfma_f32_16x16x32_bf16 v[88:91], v[136:139], v[60:63], v[88:91]
v_mfma_f32_16x16x32_bf16 v[68:71], v[140:143], v[48:51], v[68:71]
ds_read_b128 v[48:51], v14 offset:19456
v_mfma_f32_16x16x32_bf16 v[76:79], v[140:143], v[52:55], v[76:79]
ds_read_b128 v[52:55], v14 offset:20480
v_mfma_f32_16x16x32_bf16 v[84:87], v[140:143], v[56:59], v[84:87]
ds_read_b128 v[56:59], v24 offset:19456
v_mfma_f32_16x16x32_bf16 v[92:95], v[140:143], v[60:63], v[92:95]
ds_read_b128 v[60:63], v24 offset:20480
s_waitcnt vmcnt(16) lgkmcnt(4)
v_mfma_f32_16x16x32_bf16 v[64:67], v[144:147], v[32:35], v[64:67]
buffer_load_dwordx4 v[204:207], v1, s[36:39], s50 offen offset:1024 sc1
v_mfma_f32_16x16x32_bf16 v[72:75], v[144:147], v[36:39], v[72:75]
v_mfma_f32_16x16x32_bf16 v[80:83], v[144:147], v[40:43], v[80:83]
buffer_load_dwordx4 v[208:211], v13, s[36:39], s50 offen offset:0 sc1
v_mfma_f32_16x16x32_bf16 v[88:91], v[144:147], v[44:47], v[88:91]
v_mfma_f32_16x16x32_bf16 v[68:71], v[148:151], v[32:35], v[68:71]
ds_read_b128 v[32:35], v14 offset:21504
v_mfma_f32_16x16x32_bf16 v[76:79], v[148:151], v[36:39], v[76:79]
ds_read_b128 v[36:39], v14 offset:22528
v_mfma_f32_16x16x32_bf16 v[84:87], v[148:151], v[40:43], v[84:87]
ds_read_b128 v[40:43], v24 offset:21504
s_add_u32 s66, s50, 8192
v_mfma_f32_16x16x32_bf16 v[92:95], v[148:151], v[44:47], v[92:95]
ds_read_b128 v[44:47], v24 offset:22528
s_waitcnt vmcnt(16) lgkmcnt(4)
v_mfma_f32_16x16x32_bf16 v[64:67], v[152:155], v[48:51], v[64:67]
buffer_load_dwordx4 v[212:215], v13, s[36:39], s50 offen offset:1024 sc1
v_mfma_f32_16x16x32_bf16 v[72:75], v[152:155], v[52:55], v[72:75]
v_mfma_f32_16x16x32_bf16 v[80:83], v[152:155], v[56:59], v[80:83]
buffer_load_dwordx4 v[216:219], v1, s[36:39], s66 offen offset:0 sc1
v_mfma_f32_16x16x32_bf16 v[88:91], v[152:155], v[60:63], v[88:91]
v_mfma_f32_16x16x32_bf16 v[68:71], v[156:159], v[48:51], v[68:71]
ds_read_b128 v[48:51], v14 offset:23552
v_mfma_f32_16x16x32_bf16 v[76:79], v[156:159], v[52:55], v[76:79]
ds_read_b128 v[52:55], v14 offset:24576
v_mfma_f32_16x16x32_bf16 v[84:87], v[156:159], v[56:59], v[84:87]
ds_read_b128 v[56:59], v24 offset:23552
v_mfma_f32_16x16x32_bf16 v[92:95], v[156:159], v[60:63], v[92:95]
ds_read_b128 v[60:63], v24 offset:24576
TP61:
s_cbranch_execz TP4
TP62:
s_cbranch_execz TR2
s_waitcnt vmcnt(16) lgkmcnt(4)
v_mfma_f32_16x16x32_bf16 v[64:67], v[160:163], v[32:35], v[64:67]
buffer_load_dwordx4 v[220:223], v1, s[36:39], s66 offen offset:1024 sc1
v_mfma_f32_16x16x32_bf16 v[72:75], v[160:163], v[36:39], v[72:75]
v_mfma_f32_16x16x32_bf16 v[80:83], v[160:163], v[40:43], v[80:83]
buffer_load_dwordx4 v[224:227], v13, s[36:39], s66 offen offset:0 sc1
v_mfma_f32_16x16x32_bf16 v[88:91], v[160:163], v[44:47], v[88:91]
v_mfma_f32_16x16x32_bf16 v[68:71], v[164:167], v[32:35], v[68:71]
ds_read2st64_b64 v[32:35], v1 offset0:50 offset1:130
v_mfma_f32_16x16x32_bf16 v[76:79], v[164:167], v[36:39], v[76:79]
ds_read2st64_b64 v[36:39], v16 offset0:50 offset1:130
v_mfma_f32_16x16x32_bf16 v[84:87], v[164:167], v[40:43], v[84:87]
ds_read2st64_b64 v[40:43], v15 offset0:50 offset1:130
s_add_u32 s50, s66, 8192
v_mfma_f32_16x16x32_bf16 v[92:95], v[164:167], v[44:47], v[92:95]
ds_read2st64_b64 v[44:47], v17 offset0:50 offset1:130
s_waitcnt vmcnt(16) lgkmcnt(4)
v_mfma_f32_16x16x32_bf16 v[64:67], v[168:171], v[48:51], v[64:67]
buffer_load_dwordx4 v[228:231], v13, s[36:39], s66 offen offset:1024 sc1
v_mfma_f32_16x16x32_bf16 v[72:75], v[168:171], v[52:55], v[72:75]
v_mfma_f32_16x16x32_bf16 v[80:83], v[168:171], v[56:59], v[80:83]
buffer_load_dwordx4 v[232:235], v1, s[36:39], s50 offen offset:0 sc1
v_mfma_f32_16x16x32_bf16 v[88:91], v[168:171], v[60:63], v[88:91]
s_waitcnt vmcnt(11) lgkmcnt(0)
s_barrier
v_mfma_f32_16x16x32_bf16 v[68:71], v[172:175], v[48:51], v[68:71]
ds_read_b128 v[48:51], v1 offset:26624
v_mfma_f32_16x16x32_bf16 v[76:79], v[172:175], v[52:55], v[76:79]
ds_read_b128 v[52:55], v1 offset:27648
v_mfma_f32_16x16x32_bf16 v[84:87], v[172:175], v[56:59], v[84:87]
ds_read_b128 v[56:59], v15 offset:26624
v_mfma_f32_16x16x32_bf16 v[92:95], v[172:175], v[60:63], v[92:95]
ds_read_b128 v[60:63], v15 offset:27648
s_waitcnt vmcnt(9)
v_mfma_f32_16x16x32_bf16 v[64:67], v[192:195], v[32:35], v[64:67]
buffer_load_dwordx4 v[236:239], v1, s[36:39], s50 offen offset:1024 sc1
v_mfma_f32_16x16x32_bf16 v[72:75], v[192:195], v[36:39], v[72:75]
v_mfma_f32_16x16x32_bf16 v[80:83], v[192:195], v[40:43], v[80:83]
buffer_load_dwordx4 a[0:3], v13, s[36:39], s50 offen offset:0 sc1
v_mfma_f32_16x16x32_bf16 v[88:91], v[192:195], v[44:47], v[88:91]
v_mfma_f32_16x16x32_bf16 v[68:71], v[196:199], v[32:35], v[68:71]
ds_read_b128 v[32:35], v1 offset:28672
v_mfma_f32_16x16x32_bf16 v[76:79], v[196:199], v[36:39], v[76:79]
ds_read_b128 v[36:39], v1 offset:29696
v_mfma_f32_16x16x32_bf16 v[84:87], v[196:199], v[40:43], v[84:87]
ds_read_b128 v[40:43], v15 offset:28672
s_add_u32 s66, s50, 8192
v_mfma_f32_16x16x32_bf16 v[92:95], v[196:199], v[44:47], v[92:95]
ds_read_b128 v[44:47], v15 offset:29696
s_waitcnt vmcnt(9) lgkmcnt(4)
v_mfma_f32_16x16x32_bf16 v[64:67], v[200:203], v[48:51], v[64:67]
buffer_load_dwordx4 a[4:7], v13, s[36:39], s50 offen offset:1024 sc1
v_mfma_f32_16x16x32_bf16 v[72:75], v[200:203], v[52:55], v[72:75]
v_mfma_f32_16x16x32_bf16 v[80:83], v[200:203], v[56:59], v[80:83]
buffer_load_dwordx4 a[8:11], v1, s[36:39], s66 offen offset:0 sc1
v_mfma_f32_16x16x32_bf16 v[88:91], v[200:203], v[60:63], v[88:91]
v_mfma_f32_16x16x32_bf16 v[68:71], v[204:207], v[48:51], v[68:71]
ds_read_b128 v[48:51], v1 offset:30720
v_mfma_f32_16x16x32_bf16 v[76:79], v[204:207], v[52:55], v[76:79]
ds_read_b128 v[52:55], v1 offset:31744
v_mfma_f32_16x16x32_bf16 v[84:87], v[204:207], v[56:59], v[84:87]
ds_read_b128 v[56:59], v15 offset:30720
v_mfma_f32_16x16x32_bf16 v[92:95], v[204:207], v[60:63], v[92:95]
ds_read_b128 v[60:63], v15 offset:31744
s_waitcnt vmcnt(9) lgkmcnt(4)
v_mfma_f32_16x16x32_bf16 v[64:67], v[208:211], v[32:35], v[64:67]
buffer_load_dwordx4 a[12:15], v1, s[36:39], s66 offen offset:1024 sc1
v_mfma_f32_16x16x32_bf16 v[72:75], v[208:211], v[36:39], v[72:75]
v_mfma_f32_16x16x32_bf16 v[80:83], v[208:211], v[40:43], v[80:83]
v_mfma_f32_16x16x32_bf16 v[88:91], v[208:211], v[44:47], v[88:91]
v_mfma_f32_16x16x32_bf16 v[68:71], v[212:215], v[32:35], v[68:71]
ds_read_b128 v[32:35], v14 offset:26624
v_mfma_f32_16x16x32_bf16 v[76:79], v[212:215], v[36:39], v[76:79]
ds_read_b128 v[36:39], v14 offset:27648
v_mfma_f32_16x16x32_bf16 v[84:87], v[212:215], v[40:43], v[84:87]
ds_read_b128 v[40:43], v24 offset:26624
v_mfma_f32_16x16x32_bf16 v[92:95], v[212:215], v[44:47], v[92:95]
ds_read_b128 v[44:47], v24 offset:27648
s_waitcnt vmcnt(8) lgkmcnt(4)
v_mfma_f32_16x16x32_bf16 v[64:67], v[216:219], v[48:51], v[64:67]
v_mfma_f32_16x16x32_bf16 v[72:75], v[216:219], v[52:55], v[72:75]
v_mfma_f32_16x16x32_bf16 v[80:83], v[216:219], v[56:59], v[80:83]
v_mfma_f32_16x16x32_bf16 v[88:91], v[216:219], v[60:63], v[88:91]
v_mfma_f32_16x16x32_bf16 v[68:71], v[220:223], v[48:51], v[68:71]
ds_read_b128 v[48:51], v14 offset:28672
v_mfma_f32_16x16x32_bf16 v[76:79], v[220:223], v[52:55], v[76:79]
ds_read_b128 v[52:55], v14 offset:29696
v_mfma_f32_16x16x32_bf16 v[84:87], v[220:223], v[56:59], v[84:87]
ds_read_b128 v[56:59], v24 offset:28672
v_mfma_f32_16x16x32_bf16 v[92:95], v[220:223], v[60:63], v[92:95]
ds_read_b128 v[60:63], v24 offset:29696
s_waitcnt vmcnt(6) lgkmcnt(4)
v_mfma_f32_16x16x32_bf16 v[64:67], v[224:227], v[32:35], v[64:67]
v_mfma_f32_16x16x32_bf16 v[72:75], v[224:227], v[36:39], v[72:75]
v_mfma_f32_16x16x32_bf16 v[80:83], v[224:227], v[40:43], v[80:83]
v_mfma_f32_16x16x32_bf16 v[88:91], v[224:227], v[44:47], v[88:91]
v_mfma_f32_16x16x32_bf16 v[68:71], v[228:231], v[32:35], v[68:71]
ds_read_b128 v[32:35], v14 offset:30720
v_mfma_f32_16x16x32_bf16 v[76:79], v[228:231], v[36:39], v[76:79]
ds_read_b128 v[36:39], v14 offset:31744
v_mfma_f32_16x16x32_bf16 v[84:87], v[228:231], v[40:43], v[84:87]
ds_read_b128 v[40:43], v24 offset:30720
v_mfma_f32_16x16x32_bf16 v[92:95], v[228:231], v[44:47], v[92:95]
ds_read_b128 v[44:47], v24 offset:31744
s_waitcnt vmcnt(4) lgkmcnt(4)
v_mfma_f32_16x16x32_bf16 v[64:67], v[232:235], v[48:51], v[64:67]
v_mfma_f32_16x16x32_bf16 v[72:75], v[232:235], v[52:55], v[72:75]
v_mfma_f32_16x16x32_bf16 v[80:83], v[232:235], v[56:59], v[80:83]
v_mfma_f32_16x16x32_bf16 v[88:91], v[232:235], v[60:63], v[88:91]
v_mfma_f32_16x16x32_bf16 v[68:71], v[236:239], v[48:51], v[68:71]
ds_read2st64_b64 v[48:51], v1 offset0:64 offset1:144
v_mfma_f32_16x16x32_bf16 v[76:79], v[236:239], v[52:55], v[76:79]
ds_read2st64_b64 v[52:55], v16 offset0:64 offset1:144
v_mfma_f32_16x16x32_bf16 v[84:87], v[236:239], v[56:59], v[84:87]
ds_read2st64_b64 v[56:59], v15 offset0:64 offset1:144
v_mfma_f32_16x16x32_bf16 v[92:95], v[236:239], v[60:63], v[92:95]
ds_read2st64_b64 v[60:63], v17 offset0:64 offset1:144
s_waitcnt vmcnt(2) lgkmcnt(4)
v_mfma_f32_16x16x32_bf16 v[64:67], a[0:3], v[32:35], v[64:67]
v_mfma_f32_16x16x32_bf16 v[72:75], a[0:3], v[36:39], v[72:75]
v_mfma_f32_16x16x32_bf16 v[80:83], a[0:3], v[40:43], v[80:83]
v_mfma_f32_16x16x32_bf16 v[88:91], a[0:3], v[44:47], v[88:91]
v_mfma_f32_16x16x32_bf16 v[68:71], a[4:7], v[32:35], v[68:71]
v_mfma_f32_16x16x32_bf16 v[76:79], a[4:7], v[36:39], v[76:79]
v_mfma_f32_16x16x32_bf16 v[84:87], a[4:7], v[40:43], v[84:87]
v_mfma_f32_16x16x32_bf16 v[92:95], a[4:7], v[44:47], v[92:95]
s_waitcnt vmcnt(0) lgkmcnt(0)
v_mfma_f32_16x16x32_bf16 v[64:67], a[8:11], v[48:51], v[64:67]
v_mfma_f32_16x16x32_bf16 v[68:71], a[12:15], v[48:51], v[68:71]
v_mfma_f32_16x16x32_bf16 v[72:75], a[8:11], v[52:55], v[72:75]
v_mfma_f32_16x16x32_bf16 v[76:79], a[12:15], v[52:55], v[76:79]
v_mfma_f32_16x16x32_bf16 v[80:83], a[8:11], v[56:59], v[80:83]
v_mfma_f32_16x16x32_bf16 v[84:87], a[12:15], v[56:59], v[84:87]
v_mfma_f32_16x16x32_bf16 v[88:91], a[8:11], v[60:63], v[88:91]
v_mfma_f32_16x16x32_bf16 v[92:95], a[12:15], v[60:63], v[92:95]
s_nop 0
v_cvt_pk_bf16_f32 v64, v64, v65
v_cvt_pk_bf16_f32 v65, v66, v67
v_cvt_pk_bf16_f32 v66, v68, v69
v_cvt_pk_bf16_f32 v67, v70, v71
s_nop 0
v_permlane16_swap_b32 v64, v66
v_permlane16_swap_b32 v65, v67
buffer_store_dwordx4 v[64:67], v10, s[32:35], s64 offen sc0 sc1 nt
v_cvt_pk_bf16_f32 v72, v72, v73
v_cvt_pk_bf16_f32 v73, v74, v75
v_cvt_pk_bf16_f32 v74, v76, v77
v_cvt_pk_bf16_f32 v75, v78, v79
s_nop 0
v_permlane16_swap_b32 v72, v74
v_permlane16_swap_b32 v73, v75
buffer_store_dwordx4 v[72:75], v10, s[32:35], s53 offen sc0 sc1 nt
v_cvt_pk_bf16_f32 v80, v80, v81
v_cvt_pk_bf16_f32 v81, v82, v83
v_cvt_pk_bf16_f32 v82, v84, v85
v_cvt_pk_bf16_f32 v83, v86, v87
s_nop 0
v_permlane16_swap_b32 v80, v82
v_permlane16_swap_b32 v81, v83
buffer_store_dwordx4 v[80:83], v10, s[32:35], s60 offen sc0 sc1 nt
v_cvt_pk_bf16_f32 v88, v88, v89
v_cvt_pk_bf16_f32 v89, v90, v91
v_cvt_pk_bf16_f32 v90, v92, v93
v_cvt_pk_bf16_f32 v91, v94, v95
s_nop 0
v_permlane16_swap_b32 v88, v90
v_permlane16_swap_b32 v89, v91
buffer_store_dwordx4 v[88:91], v10, s[32:35], s61 offen sc0 sc1 nt
s_or_b32 s3, s2, s40
s_cmp_lg_u32 s3, 0
s_cbranch_scc1 NOEP
v_mov_b32 v3, 0
buffer_store_dword v2, v3, s[36:39], 0 offen sc1
NOEP:
s_waitcnt vmcnt(0)
END:
s_endpgm
RT_G1:
buffer_load_dwordx4 v[220:223], v1, s[36:39], s68 offen offset:0 sc1
buffer_load_dwordx4 v[224:227], v1, s[36:39], s68 offen offset:1024 sc1
buffer_load_dwordx4 v[228:231], v1, s[36:39], s68 offen offset:2048 sc1
buffer_load_dwordx4 v[232:235], v1, s[36:39], s68 offen offset:3072 sc1
buffer_load_dwordx4 v[236:239], v25, s[36:39], s51 offen sc1
s_add_u32 s49, s49, 1
s_waitcnt vmcnt(3)
v_bitop3_b32 v3, v223, v2, v227 bitop3:0x7e
s_waitcnt vmcnt(2)
v_bitop3_b32 v3, v231, v2, v3 bitop3:0xbe
s_waitcnt vmcnt(1)
v_bitop3_b32 v3, v235, v2, v3 bitop3:0xbe
s_waitcnt vmcnt(0)
v_bitop3_b32 v3, v238, v2, v3 bitop3:0xbe
v_cmp_ne_u32 vcc, 0, v3
s_cmp_lt_u32 s49, 40000
s_cselect_b64 s[70:71], -1, 0
s_and_b64 vcc, vcc, s[70:71]
s_nop 1
s_cbranch_vccnz RT_G1
s_branch RT_G1_B
TP63:
s_cbranch_execz TP10
RT_F1:
v_mov_b32 v254, 0
buffer_atomic_or v254, v246, s[36:39], s68 offen sc0 sc1
s_add_u32 s49, s49, 1
s_waitcnt vmcnt(0)
v_cmp_ne_u32 vcc, v254, v2
s_mov_b32 vcc_hi, 0
s_cmp_lt_u32 s49, 40000
s_cselect_b64 s[70:71], -1, 0
s_and_b64 vcc, vcc, s[70:71]
s_nop 0
s_cbranch_vccnz RT_F1
s_branch RT_F1_B
RT_FP:
v_mov_b32 v254, 0
buffer_atomic_or v254, v246, s[36:39], s55 offen sc0 sc1
s_add_u32 s49, s49, 1
s_waitcnt vmcnt(0)
v_cmp_ne_u32 vcc, v254, v2
s_nop 0
s_and_b64 vcc, vcc, 0xffff
s_cmp_lt_u32 s49, 40000
s_cselect_b64 s[70:71], -1, 0
s_and_b64 vcc, vcc, s[70:71]
s_cbranch_vccnz RT_FP
s_branch RT_FP_B
AT_FB:
s_mov_b32 s53, 1
s_mov_b32 s50, s51
s_mov_b32 s60, 0
v_mov_b32 v24, 0xff800000
v_mov_b32 v25, 0xff800000
v_mov_b32 v26, 0xff800000
v_mov_b32 v27, 0xff800000
AT_FB1:
buffer_load_dwordx4 a[32:35], v240, s[36:39], s50 offen offset:0 sc1
buffer_load_dwordx4 a[36:39], v240, s[36:39], s50 offen offset:512 sc1
s_add_u32 s50, s50, 4096
s_add_u32 s60, s60, 1
s_cmp_lt_u32 s60, 32
s_waitcnt vmcnt(1)
v_mfma_f32_32x32x16_bf16 v[176:191], a[32:35], a[0:3], 0
s_waitcnt vmcnt(0)
v_mfma_f32_32x32x16_bf16 v[176:191], a[36:39], a[4:7], v[176:191]
v_mfma_f32_32x32x16_bf16 v[192:207], a[32:35], a[8:11], 0
v_mfma_f32_32x32x16_bf16 v[192:207], a[36:39], a[12:15], v[192:207]
v_mfma_f32_32x32x16_bf16 v[208:223], a[32:35], a[16:19], 0
v_mfma_f32_32x32x16_bf16 v[208:223], a[36:39], a[20:23], v[208:223]
v_mfma_f32_32x32x16_bf16 v[224:239], a[32:35], a[24:27], 0
v_mfma_f32_32x32x16_bf16 v[224:239], a[36:39], a[28:31], v[224:239]
s_nop 5
v_max3_f32 v24, v24, v176, v177
v_max3_f32 v24, v24, v178, v179
v_max3_f32 v24, v24, v180, v181
v_max3_f32 v24, v24, v182, v183
v_max3_f32 v24, v24, v184, v185
v_max3_f32 v24, v24, v186, v187
v_max3_f32 v24, v24, v188, v189
v_max3_f32 v24, v24, v190, v191
v_max3_f32 v25, v25, v192, v193
v_max3_f32 v25, v25, v194, v195
v_max3_f32 v25, v25, v196, v197
v_max3_f32 v25, v25, v198, v199
v_max3_f32 v25, v25, v200, v201
v_max3_f32 v25, v25, v202, v203
v_max3_f32 v25, v25, v204, v205
v_max3_f32 v25, v25, v206, v207
v_max3_f32 v26, v26, v208, v209
v_max3_f32 v26, v26, v210, v211
v_max3_f32 v26, v26, v212, v213
v_max3_f32 v26, v26, v214, v215
v_max3_f32 v26, v26, v216, v217
v_max3_f32 v26, v26, v218, v219
v_max3_f32 v26, v26, v220, v221
v_max3_f32 v26, v26, v222, v223
v_max3_f32 v27, v27, v224, v225
v_max3_f32 v27, v27, v226, v227
v_max3_f32 v27, v27, v228, v229
v_max3_f32 v27, v27, v230, v231
v_max3_f32 v27, v27, v232, v233
v_max3_f32 v27, v27, v234, v235
v_max3_f32 v27, v27, v236, v237
v_max3_f32 v27, v27, v238, v239
s_cbranch_scc1 AT_FB1
v_mov_b32 v3, v24
s_nop 1
v_permlane32_swap_b32 v3, v24
v_max_f32 v24, v3, v24
v_mov_b32 v3, v25
s_nop 1
v_permlane32_swap_b32 v3, v25
v_max_f32 v25, v3, v25
v_mov_b32 v3, v26
s_nop 1
v_permlane32_swap_b32 v3, v26
v_max_f32 v26, v3, v26
v_mov_b32 v3, v27
s_nop 1
v_permlane32_swap_b32 v3, v27
v_max_f32 v27, v3, v27
ds_write_b128 v8, v[24:27] offset:39936
s_waitcnt lgkmcnt(0)
s_barrier
ds_read_b128 v[28:31], v9 offset:39936
v_mov_b32 v64, 0
v_mov_b32 v65, 0
v_mov_b32 v66, 0
v_mov_b32 v67, 0
v_mov_b32 v68, 0
v_mov_b32 v69, 0
v_mov_b32 v70, 0
v_mov_b32 v71, 0
v_mov_b32 v72, 0
v_mov_b32 v73, 0
v_mov_b32 v74, 0
v_mov_b32 v75, 0
v_mov_b32 v76, 0
v_mov_b32 v77, 0
v_mov_b32 v78, 0
v_mov_b32 v79, 0
v_mov_b32 v80, 0
v_mov_b32 v81, 0
v_mov_b32 v82, 0
v_mov_b32 v83, 0
v_mov_b32 v84, 0
v_mov_b32 v85, 0
v_mov_b32 v86, 0
v_mov_b32 v87, 0
v_mov_b32 v88, 0
v_mov_b32 v89, 0
v_mov_b32 v90, 0
v_mov_b32 v91, 0
v_mov_b32 v92, 0
v_mov_b32 v93, 0
v_mov_b32 v94, 0
v_mov_b32 v95, 0
v_mov_b32 v96, 0
v_mov_b32 v97, 0
v_mov_b32 v98, 0
v_mov_b32 v99, 0
v_mov_b32 v100, 0
v_mov_b32 v101, 0
v_mov_b32 v102, 0
v_mov_b32 v103, 0
v_mov_b32 v104, 0
v_mov_b32 v105, 0
v_mov_b32 v106, 0
v_mov_b32 v107, 0
v_mov_b32 v108, 0
v_mov_b32 v109, 0
v_mov_b32 v110, 0
v_mov_b32 v111, 0
v_mov_b32 v112, 0
v_mov_b32 v113, 0
v_mov_b32 v114, 0
v_mov_b32 v115, 0
v_mov_b32 v116, 0
v_mov_b32 v117, 0
v_mov_b32 v118, 0
v_mov_b32 v119, 0
v_mov_b32 v120, 0
v_mov_b32 v121, 0
v_mov_b32 v122, 0
v_mov_b32 v123, 0
v_mov_b32 v124, 0
v_mov_b32 v125, 0
v_mov_b32 v126, 0
v_mov_b32 v127, 0
v_mov_b32 v160, 0
v_mov_b32 v161, 0
v_mov_b32 v162, 0
v_mov_b32 v163, 0
v_mov_b32 v164, 0
v_mov_b32 v165, 0
v_mov_b32 v166, 0
v_mov_b32 v167, 0
v_mov_b32 v168, 0
v_mov_b32 v169, 0
v_mov_b32 v170, 0
v_mov_b32 v171, 0
v_mov_b32 v172, 0
v_mov_b32 v173, 0
v_mov_b32 v174, 0
v_mov_b32 v175, 0
s_waitcnt lgkmcnt(0)
v_max_f32 v24, v24, v30
v_max_f32 v25, v25, v31
v_max_f32 v26, v26, v28
v_max_f32 v27, v27, v29
s_mov_b32 s50, s51
s_mov_b32 s60, 0
AT_FB2:
buffer_load_dwordx4 a[32:35], v240, s[36:39], s50 offen offset:0 sc1
buffer_load_dwordx4 a[36:39], v240, s[36:39], s50 offen offset:512 sc1
buffer_load_dwordx4 a[40:43], v241, s[36:39], s50 offen offset:2048 sc1
buffer_load_dwordx4 a[44:47], v241, s[36:39], s50 offen offset:2560 sc1
s_add_u32 s50, s50, 4096
s_add_u32 s60, s60, 1
s_cmp_lt_u32 s60, 32
s_waitcnt vmcnt(3)
v_mfma_f32_32x32x16_bf16 v[176:191], a[32:35], a[0:3], 0
s_waitcnt vmcnt(2)
v_mfma_f32_32x32x16_bf16 v[176:191], a[36:39], a[4:7], v[176:191]
v_mfma_f32_32x32x16_bf16 v[192:207], a[32:35], a[8:11], 0
v_mfma_f32_32x32x16_bf16 v[192:207], a[36:39], a[12:15], v[192:207]
v_mfma_f32_32x32x16_bf16 v[208:223], a[32:35], a[16:19], 0
v_mfma_f32_32x32x16_bf16 v[208:223], a[36:39], a[20:23], v[208:223]
v_mfma_f32_32x32x16_bf16 v[224:239], a[32:35], a[24:27], 0
v_mfma_f32_32x32x16_bf16 v[224:239], a[36:39], a[28:31], v[224:239]
s_nop 5
v_sub_f32 v176, v176, v24
v_sub_f32 v177, v177, v24
v_sub_f32 v178, v178, v24
v_sub_f32 v179, v179, v24
v_sub_f32 v180, v180, v24
v_sub_f32 v181, v181, v24
v_sub_f32 v182, v182, v24
v_sub_f32 v183, v183, v24
v_sub_f32 v184, v184, v24
v_sub_f32 v185, v185, v24
v_sub_f32 v186, v186, v24
v_sub_f32 v187, v187, v24
v_sub_f32 v188, v188, v24
v_sub_f32 v189, v189, v24
v_sub_f32 v190, v190, v24
v_sub_f32 v191, v191, v24
v_exp_f32 v176, v176
v_exp_f32 v177, v177
v_exp_f32 v178, v178
v_exp_f32 v179, v179
v_exp_f32 v180, v180
v_exp_f32 v181, v181
v_exp_f32 v182, v182
v_exp_f32 v183, v183
v_exp_f32 v184, v184
v_exp_f32 v185, v185
v_exp_f32 v186, v186
v_exp_f32 v187, v187
v_exp_f32 v188, v188
v_exp_f32 v189, v189
v_exp_f32 v190, v190
v_exp_f32 v191, v191
s_waitcnt vmcnt(1)
v_smfmac_f32_32x32x32_bf16 v[64:79], a[40:43], v[176:183], v36
v_smfmac_f32_16x16x64_bf16 v[160:163], v[32:35], v[176:183], v36
s_waitcnt vmcnt(0)
v_smfmac_f32_32x32x32_bf16 v[64:79], a[44:47], v[184:191], v36
v_smfmac_f32_16x16x64_bf16 v[160:163], v[32:35], v[184:191], v36
v_sub_f32 v192, v192, v25
v_sub_f32 v193, v193, v25
v_sub_f32 v194, v194, v25
v_sub_f32 v195, v195, v25
v_sub_f32 v196, v196, v25
v_sub_f32 v197, v197, v25
v_sub_f32 v198, v198, v25
v_sub_f32 v199, v199, v25
v_sub_f32 v200, v200, v25
v_sub_f32 v201, v201, v25
v_sub_f32 v202, v202, v25
v_sub_f32 v203, v203, v25
v_sub_f32 v204, v204, v25
v_sub_f32 v205, v205, v25
v_sub_f32 v206, v206, v25
v_sub_f32 v207, v207, v25
v_exp_f32 v192, v192
v_exp_f32 v193, v193
v_exp_f32 v194, v194
v_exp_f32 v195, v195
v_exp_f32 v196, v196
v_exp_f32 v197, v197
v_exp_f32 v198, v198
v_exp_f32 v199, v199
v_exp_f32 v200, v200
v_exp_f32 v201, v201
v_exp_f32 v202, v202
v_exp_f32 v203, v203
v_exp_f32 v204, v204
v_exp_f32 v205, v205
v_exp_f32 v206, v206
v_exp_f32 v207, v207
v_smfmac_f32_32x32x32_bf16 v[80:95], a[40:43], v[192:199], v36
v_smfmac_f32_16x16x64_bf16 v[164:167], v[32:35], v[192:199], v36
v_smfmac_f32_32x32x32_bf16 v[80:95], a[44:47], v[200:207], v36
v_smfmac_f32_16x16x64_bf16 v[164:167], v[32:35], v[200:207], v36
v_sub_f32 v208, v208, v26
v_sub_f32 v209, v209, v26
v_sub_f32 v210, v210, v26
v_sub_f32 v211, v211, v26
v_sub_f32 v212, v212, v26
v_sub_f32 v213, v213, v26
v_sub_f32 v214, v214, v26
v_sub_f32 v215, v215, v26
v_sub_f32 v216, v216, v26
v_sub_f32 v217, v217, v26
v_sub_f32 v218, v218, v26
v_sub_f32 v219, v219, v26
v_sub_f32 v220, v220, v26
v_sub_f32 v221, v221, v26
v_sub_f32 v222, v222, v26
v_sub_f32 v223, v223, v26
v_exp_f32 v208, v208
v_exp_f32 v209, v209
v_exp_f32 v210, v210
v_exp_f32 v211, v211
v_exp_f32 v212, v212
v_exp_f32 v213, v213
v_exp_f32 v214, v214
v_exp_f32 v215, v215
v_exp_f32 v216, v216
v_exp_f32 v217, v217
v_exp_f32 v218, v218
v_exp_f32 v219, v219
v_exp_f32 v220, v220
v_exp_f32 v221, v221
v_exp_f32 v222, v222
v_exp_f32 v223, v223
v_smfmac_f32_32x32x32_bf16 v[96:111], a[40:43], v[208:215], v36
v_smfmac_f32_16x16x64_bf16 v[168:171], v[32:35], v[208:215], v36
v_smfmac_f32_32x32x32_bf16 v[96:111], a[44:47], v[216:223], v36
v_smfmac_f32_16x16x64_bf16 v[168:171], v[32:35], v[216:223], v36
v_sub_f32 v224, v224, v27
v_sub_f32 v225, v225, v27
v_sub_f32 v226, v226, v27
v_sub_f32 v227, v227, v27
v_sub_f32 v228, v228, v27
v_sub_f32 v229, v229, v27
v_sub_f32 v230, v230, v27
v_sub_f32 v231, v231, v27
v_sub_f32 v232, v232, v27
v_sub_f32 v233, v233, v27
v_sub_f32 v234, v234, v27
v_sub_f32 v235, v235, v27
v_sub_f32 v236, v236, v27
v_sub_f32 v237, v237, v27
v_sub_f32 v238, v238, v27
v_sub_f32 v239, v239, v27
v_exp_f32 v224, v224
v_exp_f32 v225, v225
v_exp_f32 v226, v226
v_exp_f32 v227, v227
v_exp_f32 v228, v228
v_exp_f32 v229, v229
v_exp_f32 v230, v230
v_exp_f32 v231, v231
v_exp_f32 v232, v232
v_exp_f32 v233, v233
v_exp_f32 v234, v234
v_exp_f32 v235, v235
v_exp_f32 v236, v236
v_exp_f32 v237, v237
v_exp_f32 v238, v238
v_exp_f32 v239, v239
v_smfmac_f32_32x32x32_bf16 v[112:127], a[40:43], v[224:231], v36
v_smfmac_f32_16x16x64_bf16 v[172:175], v[32:35], v[224:231], v36
v_smfmac_f32_32x32x32_bf16 v[112:127], a[44:47], v[232:239], v36
v_smfmac_f32_16x16x64_bf16 v[172:175], v[32:35], v[232:239], v36
s_cbranch_scc1 AT_FB2
ds_write_b128 v8, v[64:67] offset:30720
ds_write_b128 v8, v[68:71] offset:31744
ds_write_b128 v8, v[72:75] offset:32768
ds_write_b128 v8, v[76:79] offset:33792
ds_write_b32 v8, v160 offset:38912
ds_write_b128 v8, v[80:83] offset:34816
ds_write_b128 v8, v[84:87] offset:35840
ds_write_b128 v8, v[88:91] offset:36864
ds_write_b128 v8, v[92:95] offset:37888
ds_write_b32 v8, v164 offset:38916
s_waitcnt lgkmcnt(0)
s_barrier
ds_read_b64 v[44:45], v9 offset:38912
ds_read_b128 v[176:179], v9 offset:30720
ds_read_b128 v[180:183], v9 offset:31744
ds_read_b128 v[184:187], v9 offset:32768
ds_read_b128 v[188:191], v9 offset:33792
ds_read_b128 v[192:195], v9 offset:34816
ds_read_b128 v[196:199], v9 offset:35840
ds_read_b128 v[200:203], v9 offset:36864
ds_read_b128 v[204:207], v9 offset:37888
s_branch AT_FIN
TP64:
s_cbranch_execz TP6
RT_F2:
v_mov_b32 v254, 0
buffer_atomic_or v254, v246, s[36:39], s62 offen sc0 sc1
s_waitcnt vmcnt(1)
v_cmp_ne_u32 vcc, v255, v2
s_mov_b32 vcc_hi, 0
s_nop 3
s_cbranch_vccz RT_F2_B
v_mov_b32 v255, 0
buffer_atomic_or v255, v246, s[36:39], s62 offen sc0 sc1
s_add_u32 s49, s49, 1
s_waitcnt vmcnt(1)
v_cmp_ne_u32 vcc, v254, v2
s_mov_b32 vcc_hi, 0
s_cmp_lt_u32 s49, 40000
s_cselect_b64 s[70:71], -1, 0
s_and_b64 vcc, vcc, s[70:71]
s_nop 0
s_cbranch_vccnz RT_F2
s_branch RT_F2_B
TP65:
s_cbranch_execz TP4
RT_F3:
v_mov_b32 v254, 0
buffer_atomic_or v254, v246, s[36:39], s62 offen sc0 sc1
s_waitcnt vmcnt(1)
v_cmp_ne_u32 vcc, v255, v2
s_nop 0
s_and_b64 vcc, vcc, 0xffff
s_nop 2
s_cbranch_vccz RT_F3_B
v_mov_b32 v255, 0
buffer_atomic_or v255, v246, s[36:39], s62 offen sc0 sc1
s_add_u32 s49, s49, 1
s_waitcnt vmcnt(1)
v_cmp_ne_u32 vcc, v254, v2
s_nop 0
s_and_b64 vcc, vcc, 0xffff
s_cmp_lt_u32 s49, 40000
s_cselect_b64 s[70:71], -1, 0
s_and_b64 vcc, vcc, s[70:71]
s_cbranch_vccnz RT_F3
s_branch RT_F3_B
RT_ZG:
buffer_load_dwordx4 v[192:195], v1, s[36:39], s60 offen offset:0 sc1
buffer_load_dwordx4 v[196:199], v1, s[36:39], s60 offen offset:1024 sc1
buffer_load_dwordx4 v[200:203], v1, s[36:39], s60 offen offset:2048 sc1
buffer_load_dwordx4 v[204:207], v1, s[36:39], s60 offen offset:3072 sc1
buffer_load_dwordx4 v[208:211], v13, s[36:39], s60 offen offset:0 sc1
buffer_load_dwordx4 v[212:215], v13, s[36:39], s60 offen offset:1024 sc1
buffer_load_dwordx4 v[216:219], v13, s[36:39], s60 offen offset:2048 sc1
buffer_load_dwordx4 v[220:223], v13, s[36:39], s60 offen offset:3072 sc1
s_add_u32 s49, s49, 1
s_waitcnt vmcnt(6)
v_bitop3_b32 v3, v194, v2, v198 bitop3:0x7e
s_waitcnt vmcnt(5)
v_bitop3_b32 v3, v202, v2, v3 bitop3:0xbe
s_waitcnt vmcnt(4)
v_bitop3_b32 v3, v206, v2, v3 bitop3:0xbe
s_waitcnt vmcnt(3)
v_bitop3_b32 v3, v210, v2, v3 bitop3:0xbe
s_waitcnt vmcnt(2)
v_bitop3_b32 v3, v214, v2, v3 bitop3:0xbe
s_waitcnt vmcnt(1)
v_bitop3_b32 v3, v218, v2, v3 bitop3:0xbe
s_waitcnt vmcnt(0)
v_bitop3_b32 v3, v222, v2, v3 bitop3:0xbe
v_cmp_ne_u32 vcc, 0, v3
s_cmp_lt_u32 s49, 40000
s_cselect_b64 s[70:71], -1, 0
s_and_b64 vcc, vcc, s[70:71]
s_nop 1
s_cbranch_vccnz RT_ZG
s_branch RT_ZG_B
RT_F4:
v_mov_b32 v254, 0
buffer_atomic_or v254, v246, s[36:39], s62 offen sc0 sc1
s_add_u32 s49, s49, 1
s_waitcnt vmcnt(0)
v_cmp_ne_u32 vcc, v254, v2
s_nop 0
s_and_b64 vcc, vcc, 0xffff
s_cmp_lt_u32 s49, 40000
s_cselect_b64 s[70:71], -1, 0
s_and_b64 vcc, vcc, s[70:71]
s_cbranch_vccnz RT_F4
s_branch RT_F4_B
TP66:
s_cbranch_execz TP2
RT_F5:
v_mov_b32 v254, 0
buffer_atomic_or v254, v246, s[36:39], s62 offen sc0 sc1
s_waitcnt vmcnt(1)
v_cmp_ne_u32 vcc, v255, v2
s_nop 0
s_and_b64 vcc, vcc, 0xff
s_nop 2
s_cbranch_vccz RT_F5_B
v_mov_b32 v255, 0
buffer_atomic_or v255, v246, s[36:39], s62 offen sc0 sc1
s_add_u32 s49, s49, 1
s_waitcnt vmcnt(1)
v_cmp_ne_u32 vcc, v254, v2
s_nop 0
s_and_b64 vcc, vcc, 0xff
s_cmp_lt_u32 s49, 40000
s_cselect_b64 s[70:71], -1, 0
s_and_b64 vcc, vcc, s[70:71]
s_cbranch_vccnz RT_F5
s_branch RT_F5_B
CODE_END:
.section .rodata,"a"
.p2align 6
.amdhsa_kernel sequential_preLN__mha_block__mixer_gmlp__prompt_kernel
  .amdhsa_next_free_vgpr 512
  .amdhsa_next_free_sgpr 102
  .amdhsa_accum_offset 256
  .amdhsa_group_segment_fixed_size 0
  .amdhsa_kernarg_size 88
  .amdhsa_user_sgpr_count 2
  .amdhsa_user_sgpr_kernarg_segment_ptr 1
  .amdhsa_system_sgpr_workgroup_id_x 1
  .amdhsa_float_denorm_mode_32 3
.end_amdhsa_kernel
```
